```python
import torch

def _softmax(x, axis=-1):
    return torch.softmax(x, dim=axis)
def _gelu(x):
    return torch.nn.functional.gelu(x, approximate="tanh")
def _silu(x):
    return torch.nn.functional.silu(x)
def _sigmoid(x):
    return torch.sigmoid(x)
def _layernorm(x, axis=-1, eps=1e-5):
    m = x.mean(dim=axis, keepdim=True)
    v = x.var(dim=axis, keepdim=True, unbiased=False)
    return (x - m) / torch.sqrt(v + eps)
def _scatter_add(tgt, idx, src, axis=0):
    return tgt.clone().index_add_(axis, idx, src)
def _segment_sum(src, seg, n):
    out = torch.zeros((n,) + src.shape[1:], dtype=src.dtype)
    return out.index_add_(0, seg, src)
def _pad(x, pw):
    flat = tuple(v for pair in reversed(pw) for v in pair)
    return torch.nn.functional.pad(x, flat)

kernel_name = 'standalone__gqa_softmax__near_ridge'

def setup_inputs():

    _w = (lambda a: (lambda t: t.to(torch.bfloat16) if t.is_floating_point() else t)(torch.as_tensor(a)))
    B, Hq, Hkv, Sq, Sk, D = 16, 32, 32, 288, 1024, 128
    return {
        "q": _w((lambda *s: torch.randn(*s, dtype=torch.bfloat16) * 0.8)(B, Hq, Sq, D)),
        "k": _w((lambda *s: torch.randn(*s, dtype=torch.bfloat16) * 0.8)(B, Hkv, Sk, D)),
        "v": _w((lambda *s: torch.randn(*s, dtype=torch.bfloat16) * 0.05)(B, Hkv, Sk, D)),
    }

def reference(q, k, v):
    B, Hq, Sq, D = q.shape
    Hkv = k.shape[1]
    rep = Hq // Hkv
    k = (lambda x, n, axis: torch.repeat_interleave(x, n, dim=axis))(k, rep, axis=1)
    v = (lambda x, n, axis: torch.repeat_interleave(x, n, dim=axis))(v, rep, axis=1)
    scale = D ** -0.5
    scores = torch.einsum("bhqd,bhkd->bhqk", q, k) * scale
    p = _softmax(scores, axis=-1)
    return torch.einsum("bhqk,bhkd->bhqd", p, v)
```

```asm
; @launch grid=(256,1,1) block=(256,1,1) lds=163840
.amdgcn_target "amdgcn-amd-amdhsa--gfx950"
.text
.globl standalone__gqa_softmax__near_ridge_kernel
.p2align 8
.type standalone__gqa_softmax__near_ridge_kernel,@function
standalone__gqa_softmax__near_ridge_kernel:
s_cmp_ge_u32 s2, 256
s_cbranch_scc1 L_end
s_load_dwordx4 s[44:47], s[0:1], 0
s_load_dwordx4 s[48:51], s[0:1], 16
v_lshrrev_b32 v1, 6, v0
v_and_b32 v2, 63, v0
v_readfirstlane_b32 s20, v1
v_lshlrev_b32 v96, 4, v2
s_getpc_b64 s[56:57]
L_pc:
s_lshr_b32 s40, s2, 3
s_lshl_b32 s40, s40, 12
v_lshl_add_u32 v4, v0, 4, s40
v_min_u32 v4, L_hot_end-L_pc-16, v4
v_mov_b32 v5, s57
v_add_co_u32 v4, vcc, s56, v4
s_nop 1
v_addc_co_u32 v5, vcc, 0, v5, vcc
global_load_dword v119, v[4:5], off
s_mul_i32 s40, s2, 147456
s_lshl_b32 s41, s2, 19
s_mov_b32 s6, 147456
s_mov_b32 s7, 0x20000
s_mov_b32 s10, 0x80000
s_mov_b32 s11, 0x20000
s_mov_b32 s14, 0x80000
s_mov_b32 s15, 0x20000
s_mov_b32 s18, 147456
s_mov_b32 s19, 0x20000
s_lshl_b32 s31, s20, 14
s_lshr_b32 s32, s20, 1
s_lshl_b32 s32, s32, 12
s_add_u32 s32, s32, 65536
s_and_b32 s34, s20, 1
s_mul_i32 s22, s20, 4224
s_mul_i32 s24, s20, 15616
s_add_u32 s24, s24, 101376
v_and_b32 v97, 0xf0, v96
v_bfe_u32 v3, v0, 4, 1
v_lshl_add_u32 v97, v3, 8, v97
v_bfe_u32 v3, v0, 5, 1
v_lshl_add_u32 v97, v3, 9, v97
v_bfe_u32 v3, v0, 6, 1
v_lshl_add_u32 v97, v3, 15, v97
v_bfe_u32 v3, v0, 7, 1
v_lshl_add_u32 v97, v3, 16, v97
s_mov_b32 s23, 0
s_lshr_b32 s42, s2, 3
s_mul_i32 s43, s2, 1
s_add_u32 s42, s42, s43
s_bfe_u32 s43, s42, 0x10000
s_lshl_b32 s43, s43, 10
s_or_b32 s23, s23, s43
s_bfe_u32 s43, s42, 0x10001
s_lshl_b32 s43, s43, 11
s_or_b32 s23, s23, s43
s_bfe_u32 s43, s42, 0x10002
s_lshl_b32 s43, s43, 14
s_or_b32 s23, s23, s43
s_bfe_u32 s43, s42, 0x10003
s_lshl_b32 s43, s43, 17
s_or_b32 s23, s23, s43
s_bfe_u32 s43, s42, 0x10004
s_lshl_b32 s43, s43, 12
s_or_b32 s23, s23, s43
s_bfe_u32 s43, s42, 0x10005
s_lshl_b32 s43, s43, 13
s_or_b32 s23, s23, s43
s_waitcnt lgkmcnt(0)
s_add_u32 s8, s46, s41
s_addc_u32 s9, s47, 0
s_add_u32 s4, s44, s40
s_addc_u32 s5, s45, 0
s_add_u32 s12, s48, s41
s_addc_u32 s13, s49, 0
s_add_u32 s16, s50, s40
s_addc_u32 s17, s51, 0
s_xor_b32 s21, s23, 0
s_add_u32 m0, s22, 0
s_nop 0
buffer_load_dwordx4 v97, s[8:11], s21 offen offset:0 nt lds
s_xor_b32 s21, s23, 4096
s_add_u32 m0, s22, 1056
s_nop 0
buffer_load_dwordx4 v97, s[8:11], s21 offen offset:0 nt lds
s_xor_b32 s21, s23, 8192
s_add_u32 m0, s22, 2112
s_nop 0
buffer_load_dwordx4 v97, s[8:11], s21 offen offset:0 nt lds
s_xor_b32 s21, s23, 12288
s_add_u32 m0, s22, 3168
s_nop 0
buffer_load_dwordx4 v97, s[8:11], s21 offen offset:0 nt lds
s_add_u32 s37, s31, 0
s_add_u32 m0, s22, 33792
s_nop 0
buffer_load_dwordx4 v96, s[4:7], s37 offen offset:0 nt lds
s_add_u32 m0, s22, 33824
s_nop 0
buffer_load_dwordx4 v96, s[4:7], s37 offen offset:1024 nt lds
s_add_u32 m0, s22, 33856
s_nop 0
buffer_load_dwordx4 v96, s[4:7], s37 offen offset:2048 nt lds
s_add_u32 m0, s22, 33888
s_nop 0
buffer_load_dwordx4 v96, s[4:7], s37 offen offset:3072 nt lds
s_xor_b32 s21, s23, 0
s_add_u32 m0, s22, 50688
s_nop 0
buffer_load_dwordx4 v97, s[12:15], s21 offen offset:0 nt lds
s_xor_b32 s21, s23, 4096
s_add_u32 m0, s22, 51744
s_nop 0
buffer_load_dwordx4 v97, s[12:15], s21 offen offset:0 nt lds
s_xor_b32 s21, s23, 8192
s_add_u32 m0, s22, 52800
s_nop 0
buffer_load_dwordx4 v97, s[12:15], s21 offen offset:0 nt lds
s_xor_b32 s21, s23, 12288
s_add_u32 m0, s22, 53856
s_nop 0
buffer_load_dwordx4 v97, s[12:15], s21 offen offset:0 nt lds
v_lshrrev_b32 v0, 4, v96
s_mov_b32 s38, 0x3e0293ee
s_mov_b32 s39, 0x3e0293ee
s_mov_b32 s35, 0x53800000
s_mov_b32 s36, 0xffff0000
s_mov_b32 s30, 0
s_mul_i32 s40, s34, 8448
s_sub_u32 s41, 8448, s40
s_xor_b32 s25, s20, 1
s_mul_i32 s25, s25, 15616
s_add_u32 s25, s25, 101376
s_add_u32 s42, s25, 4352
s_cmp_eq_u32 s34, 0
s_cselect_b32 s26, s24, s42
s_cselect_b32 s28, s42, s24
v_and_b32 v1, 7, v0
v_mul_u32_u24 v1, 1056, v1
v_bfe_u32 v2, v0, 3, 1
v_lshl_add_u32 v1, v2, 8, v1
v_lshrrev_b32 v2, 4, v0
v_lshl_add_u32 v1, v2, 4, v1
v_add_u32 v88, s40, v1
v_add_u32 v89, s41, v1
v_bfe_u32 v1, v0, 2, 3
v_mul_u32_u24 v1, 1056, v1
v_lshrrev_b32 v2, 5, v0
v_lshl_add_u32 v1, v2, 8, v1
v_and_b32 v2, 3, v0
v_lshl_add_u32 v1, v2, 3, v1
v_add_u32 v1, 50688, v1
v_add_u32 v90, s40, v1
v_add_u32 v91, s41, v1
v_and_b32 v4, 3, v0
v_bfe_u32 v5, v0, 2, 2
v_lshl_add_u32 v1, v4, 2, v5
v_lshrrev_b32 v2, 4, v0
v_mul_u32_u24 v3, 272, v1
v_lshl_add_u32 v3, v2, 3, v3
v_add_u32 v94, s24, v3
v_and_b32 v1, 15, v0
v_mul_u32_u24 v3, 272, v2
v_lshl_add_u32 v3, v1, 4, v3
v_add_u32 v95, s24, v3
v_mul_u32_u24 v1, 1056, v4
v_lshl_add_u32 v1, v5, 8, v1
v_lshl_add_u32 v1, v2, 4, v1
s_add_u32 s40, s22, 33792
v_add_u32 v108, s40, v1
v_add_u32 v93, s24, v1
v_add_u32 v99, s24, v96
v_and_b32 v1, 2, v0
v_mov_b32 v2, 0x3f803f80
v_cmp_eq_u32 vcc, 0, v1
v_and_b32 v4, 1, v0
v_mul_u32_u24 v4, 0xaaaa, v4
v_cndmask_b32 v3, 0, v2, vcc
v_cmp_eq_u32 vcc, 2, v1
v_add_u32 v92, 0x4444, v4
v_mov_b32 v100, 0
v_cndmask_b32 v2, 0, v2, vcc
v_accvgpr_write_b32 a248, v3
v_accvgpr_write_b32 a249, v3
v_accvgpr_write_b32 a250, v3
v_accvgpr_write_b32 a251, v3
v_accvgpr_write_b32 a252, v2
v_accvgpr_write_b32 a253, v2
v_accvgpr_write_b32 a254, v2
v_accvgpr_write_b32 a255, v2
s_waitcnt vmcnt(8)
s_add_u32 s37, s31, 4096
s_add_u32 m0, s22, 84480
s_nop 0
buffer_load_dwordx4 v96, s[4:7], s37 offen offset:0 nt lds
s_add_u32 m0, s22, 84512
s_nop 0
buffer_load_dwordx4 v96, s[4:7], s37 offen offset:1024 nt lds
s_add_u32 m0, s22, 84544
s_nop 0
buffer_load_dwordx4 v96, s[4:7], s37 offen offset:2048 nt lds
s_add_u32 m0, s22, 84576
s_nop 0
buffer_load_dwordx4 v96, s[4:7], s37 offen offset:3072 nt lds
s_barrier
ds_read_b128 a[112:115], v88 offset:0
ds_read_b128 a[116:119], v88 offset:64
ds_read_b128 a[120:123], v88 offset:128
ds_read_b128 a[124:127], v88 offset:192
ds_read_b128 a[140:143], v88 offset:704
ds_read_b128 a[136:139], v88 offset:640
ds_read_b128 a[132:135], v88 offset:576
ds_read_b128 a[128:131], v88 offset:512
ds_read_b128 a[144:147], v89 offset:0
ds_read_b128 a[148:151], v89 offset:64
ds_read_b128 a[152:155], v89 offset:128
ds_read_b128 a[156:159], v89 offset:192
ds_read_b128 a[172:175], v89 offset:704
ds_read_b128 a[168:171], v89 offset:640
ds_read_b128 a[164:167], v89 offset:576
ds_read_b128 a[160:163], v89 offset:512
s_waitcnt vmcnt(8)
ds_read_b128 v[0:3], v108 offset:0
ds_read_b128 v[4:7], v108 offset:64
ds_read_b128 v[8:11], v108 offset:128
ds_read_b128 v[12:15], v108 offset:192
s_add_u32 s37, s31, 8192
s_add_u32 m0, s24, 0
s_nop 0
buffer_load_dwordx4 v96, s[4:7], s37 offen offset:0 nt lds
s_add_u32 m0, s24, 32
s_nop 0
buffer_load_dwordx4 v96, s[4:7], s37 offen offset:1024 nt lds
s_add_u32 m0, s24, 64
s_nop 0
buffer_load_dwordx4 v96, s[4:7], s37 offen offset:2048 nt lds
s_add_u32 m0, s24, 96
s_nop 0
buffer_load_dwordx4 v96, s[4:7], s37 offen offset:3072 nt lds
s_waitcnt lgkmcnt(0)
v_lshlrev_b32 v16, 16, v0
v_lshlrev_b32 v18, 16, v1
v_lshlrev_b32 v20, 16, v2
v_lshlrev_b32 v22, 16, v3
v_lshlrev_b32 v24, 16, v4
v_lshlrev_b32 v26, 16, v5
v_lshlrev_b32 v28, 16, v6
v_lshlrev_b32 v30, 16, v7
v_and_b32 v17, s36, v0
v_and_b32 v19, s36, v1
v_and_b32 v21, s36, v2
v_and_b32 v23, s36, v3
v_and_b32 v25, s36, v4
v_and_b32 v27, s36, v5
v_and_b32 v29, s36, v6
v_and_b32 v31, s36, v7
v_pk_mul_f32 v[16:17], v[16:17], s[38:39]
v_pk_mul_f32 v[18:19], v[18:19], s[38:39]
v_pk_mul_f32 v[20:21], v[20:21], s[38:39]
v_pk_mul_f32 v[22:23], v[22:23], s[38:39]
v_pk_mul_f32 v[24:25], v[24:25], s[38:39]
v_pk_mul_f32 v[26:27], v[26:27], s[38:39]
v_pk_mul_f32 v[28:29], v[28:29], s[38:39]
v_pk_mul_f32 v[30:31], v[30:31], s[38:39]
v_cvt_pk_bf16_f32 v0, v16, v17
v_cvt_pk_bf16_f32 v1, v18, v19
v_cvt_pk_bf16_f32 v2, v20, v21
v_cvt_pk_bf16_f32 v3, v22, v23
v_cvt_pk_bf16_f32 v4, v24, v25
v_cvt_pk_bf16_f32 v5, v26, v27
v_cvt_pk_bf16_f32 v6, v28, v29
v_cvt_pk_bf16_f32 v7, v30, v31
v_lshlrev_b32 v16, 16, v8
v_lshlrev_b32 v18, 16, v9
v_lshlrev_b32 v20, 16, v10
v_lshlrev_b32 v22, 16, v11
v_lshlrev_b32 v24, 16, v12
v_lshlrev_b32 v26, 16, v13
v_lshlrev_b32 v28, 16, v14
v_lshlrev_b32 v30, 16, v15
v_and_b32 v17, s36, v8
v_and_b32 v19, s36, v9
v_and_b32 v21, s36, v10
v_and_b32 v23, s36, v11
v_and_b32 v25, s36, v12
v_and_b32 v27, s36, v13
v_and_b32 v29, s36, v14
v_and_b32 v31, s36, v15
v_pk_mul_f32 v[16:17], v[16:17], s[38:39]
v_pk_mul_f32 v[18:19], v[18:19], s[38:39]
v_pk_mul_f32 v[20:21], v[20:21], s[38:39]
v_pk_mul_f32 v[22:23], v[22:23], s[38:39]
v_pk_mul_f32 v[24:25], v[24:25], s[38:39]
v_pk_mul_f32 v[26:27], v[26:27], s[38:39]
v_pk_mul_f32 v[28:29], v[28:29], s[38:39]
v_pk_mul_f32 v[30:31], v[30:31], s[38:39]
v_cvt_pk_bf16_f32 v8, v16, v17
v_cvt_pk_bf16_f32 v9, v18, v19
v_cvt_pk_bf16_f32 v10, v20, v21
v_cvt_pk_bf16_f32 v11, v22, v23
v_cvt_pk_bf16_f32 v12, v24, v25
v_cvt_pk_bf16_f32 v13, v26, v27
v_cvt_pk_bf16_f32 v14, v28, v29
v_cvt_pk_bf16_f32 v15, v30, v31
v_accvgpr_write_b32 a0, v0
v_accvgpr_write_b32 a1, v1
v_accvgpr_write_b32 a2, v2
v_accvgpr_write_b32 a3, v3
v_accvgpr_write_b32 a4, v4
v_accvgpr_write_b32 a5, v5
v_accvgpr_write_b32 a6, v6
v_accvgpr_write_b32 a7, v7
v_accvgpr_write_b32 a8, v8
v_accvgpr_write_b32 a9, v9
v_accvgpr_write_b32 a10, v10
v_accvgpr_write_b32 a11, v11
v_accvgpr_write_b32 a12, v12
v_accvgpr_write_b32 a13, v13
v_accvgpr_write_b32 a14, v14
v_accvgpr_write_b32 a15, v15
v_mfma_f32_16x16x32_bf16 v[48:51], a[112:115], a[0:3], 0
v_accvgpr_write_b32 a240, 0
v_accvgpr_write_b32 a241, 0
v_mfma_f32_16x16x32_bf16 v[48:51], a[116:119], a[4:7], v[48:51]
v_accvgpr_write_b32 a242, 0
v_accvgpr_write_b32 a243, 0
v_mfma_f32_16x16x32_bf16 v[48:51], a[120:123], a[8:11], v[48:51]
v_mfma_f32_16x16x32_bf16 v[48:51], a[124:127], a[12:15], v[48:51]
s_nop 7
v_max3_f32 v48, v48, v49, v50
v_max_f32 v48, v48, v51
v_mov_b32 v49, v48
s_nop 1
v_permlane16_swap_b32 v48, v49
v_max_f32 v48, v48, v49
v_mov_b32 v49, v48
s_nop 1
v_permlane32_swap_b32 v48, v49
v_min_f32_e64 v50, -v48, -v49
v_min_f32_e64 v51, -v48, -v49
v_mov_b32 v48, v50
v_mov_b32 v49, v50
s_nop 1
v_mfma_f32_16x16x32_bf16 v[68:71], a[112:115], a[0:3], v[48:51]
v_mfma_f32_16x16x32_bf16 v[68:71], a[116:119], a[4:7], v[68:71]
v_mfma_f32_16x16x32_bf16 v[68:71], a[120:123], a[8:11], v[68:71]
v_mfma_f32_16x16x32_bf16 v[68:71], a[124:127], a[12:15], v[68:71]
v_mfma_f32_16x16x32_bf16 v[72:75], a[140:143], a[12:15], v[48:51]
v_mfma_f32_16x16x32_bf16 v[72:75], a[136:139], a[8:11], v[72:75]
v_mfma_f32_16x16x32_bf16 v[72:75], a[132:135], a[4:7], v[72:75]
v_mfma_f32_16x16x32_bf16 v[72:75], a[128:131], a[0:3], v[72:75]
v_mfma_f32_16x16x32_bf16 v[76:79], a[144:147], a[0:3], v[48:51]
v_mfma_f32_16x16x32_bf16 v[76:79], a[148:151], a[4:7], v[76:79]
v_mfma_f32_16x16x32_bf16 v[76:79], a[152:155], a[8:11], v[76:79]
v_mfma_f32_16x16x32_bf16 v[76:79], a[156:159], a[12:15], v[76:79]
v_exp_f32 v68, v68
v_mfma_f32_16x16x32_bf16 v[80:83], a[172:175], a[12:15], v[48:51]
v_exp_f32 v69, v69
v_mfma_f32_16x16x32_bf16 v[80:83], a[168:171], a[8:11], v[80:83]
v_exp_f32 v70, v70
v_mfma_f32_16x16x32_bf16 v[80:83], a[164:167], a[4:7], v[80:83]
v_exp_f32 v71, v71
v_mfma_f32_16x16x32_bf16 v[80:83], a[160:163], a[0:3], v[80:83]
s_waitcnt vmcnt(8)
s_add_u32 s37, s31, 12288
s_add_u32 m0, s24, 4352
s_nop 0
buffer_load_dwordx4 v96, s[4:7], s37 offen offset:0 nt lds
s_add_u32 m0, s24, 4384
s_nop 0
buffer_load_dwordx4 v96, s[4:7], s37 offen offset:1024 nt lds
s_add_u32 m0, s24, 4416
s_nop 0
buffer_load_dwordx4 v96, s[4:7], s37 offen offset:2048 nt lds
s_add_u32 m0, s24, 4448
s_nop 0
buffer_load_dwordx4 v96, s[4:7], s37 offen offset:3072 nt lds
s_barrier
ds_read_b64_tr_b16 a[176:177], v90 offset:0
ds_read_b64_tr_b16 a[178:179], v90 offset:512
ds_read_b64_tr_b16 a[180:181], v90 offset:32
ds_read_b64_tr_b16 a[182:183], v90 offset:544
ds_read_b64_tr_b16 a[184:185], v90 offset:64
ds_read_b64_tr_b16 a[186:187], v90 offset:576
ds_read_b64_tr_b16 a[188:189], v90 offset:96
ds_read_b64_tr_b16 a[190:191], v90 offset:608
ds_read_b64_tr_b16 a[192:193], v90 offset:128
ds_read_b64_tr_b16 a[194:195], v90 offset:640
ds_read_b64_tr_b16 a[196:197], v90 offset:160
ds_read_b64_tr_b16 a[198:199], v90 offset:672
ds_read_b64_tr_b16 a[200:201], v90 offset:192
ds_read_b64_tr_b16 a[202:203], v90 offset:704
ds_read_b64_tr_b16 a[204:205], v90 offset:224
ds_read_b64_tr_b16 a[206:207], v90 offset:736
ds_read_b64_tr_b16 a[208:209], v91 offset:0
ds_read_b64_tr_b16 a[210:211], v91 offset:512
ds_read_b64_tr_b16 a[212:213], v91 offset:32
ds_read_b64_tr_b16 a[214:215], v91 offset:544
ds_read_b64_tr_b16 a[216:217], v91 offset:64
ds_read_b64_tr_b16 a[218:219], v91 offset:576
ds_read_b64_tr_b16 a[220:221], v91 offset:96
ds_read_b64_tr_b16 a[222:223], v91 offset:608
ds_read_b64_tr_b16 a[224:225], v91 offset:128
ds_read_b64_tr_b16 a[226:227], v91 offset:640
ds_read_b64_tr_b16 a[228:229], v91 offset:160
ds_read_b64_tr_b16 a[230:231], v91 offset:672
ds_read_b64_tr_b16 a[232:233], v91 offset:192
ds_read_b64_tr_b16 a[234:235], v91 offset:704
ds_read_b64_tr_b16 a[236:237], v91 offset:224
ds_read_b64_tr_b16 a[238:239], v91 offset:736
s_waitcnt vmcnt(8)
ds_read_b128 v[0:3], v108 offset:50688
ds_read_b128 v[4:7], v108 offset:50752
ds_read_b128 v[8:11], v108 offset:50816
ds_read_b128 v[12:15], v108 offset:50880
s_add_u32 s37, s32, 0
s_add_u32 m0, s24, 8704
s_nop 0
buffer_load_dwordx4 v96, s[4:7], s37 offen offset:0 nt lds
s_add_u32 m0, s24, 8736
s_nop 0
buffer_load_dwordx4 v96, s[4:7], s37 offen offset:1024 nt lds
s_add_u32 m0, s24, 8768
s_nop 0
buffer_load_dwordx4 v96, s[4:7], s37 offen offset:2048 nt lds
s_add_u32 m0, s24, 8800
s_nop 0
buffer_load_dwordx4 v96, s[4:7], s37 offen offset:3072 nt lds
s_waitcnt lgkmcnt(0)
v_lshlrev_b32 v16, 16, v0
v_lshlrev_b32 v18, 16, v1
v_lshlrev_b32 v20, 16, v2
v_lshlrev_b32 v22, 16, v3
v_lshlrev_b32 v24, 16, v4
v_lshlrev_b32 v26, 16, v5
v_lshlrev_b32 v28, 16, v6
v_lshlrev_b32 v30, 16, v7
v_and_b32 v17, s36, v0
v_and_b32 v19, s36, v1
v_and_b32 v21, s36, v2
v_and_b32 v23, s36, v3
v_and_b32 v25, s36, v4
v_and_b32 v27, s36, v5
v_and_b32 v29, s36, v6
v_and_b32 v31, s36, v7
v_pk_mul_f32 v[16:17], v[16:17], s[38:39]
v_pk_mul_f32 v[18:19], v[18:19], s[38:39]
v_pk_mul_f32 v[20:21], v[20:21], s[38:39]
v_pk_mul_f32 v[22:23], v[22:23], s[38:39]
v_pk_mul_f32 v[24:25], v[24:25], s[38:39]
v_pk_mul_f32 v[26:27], v[26:27], s[38:39]
v_pk_mul_f32 v[28:29], v[28:29], s[38:39]
v_pk_mul_f32 v[30:31], v[30:31], s[38:39]
v_cvt_pk_bf16_f32 v0, v16, v17
v_cvt_pk_bf16_f32 v1, v18, v19
v_cvt_pk_bf16_f32 v2, v20, v21
v_cvt_pk_bf16_f32 v3, v22, v23
v_cvt_pk_bf16_f32 v4, v24, v25
v_cvt_pk_bf16_f32 v5, v26, v27
v_cvt_pk_bf16_f32 v6, v28, v29
v_cvt_pk_bf16_f32 v7, v30, v31
v_lshlrev_b32 v16, 16, v8
v_lshlrev_b32 v18, 16, v9
v_lshlrev_b32 v20, 16, v10
v_lshlrev_b32 v22, 16, v11
v_lshlrev_b32 v24, 16, v12
v_lshlrev_b32 v26, 16, v13
v_lshlrev_b32 v28, 16, v14
v_lshlrev_b32 v30, 16, v15
v_and_b32 v17, s36, v8
v_and_b32 v19, s36, v9
v_and_b32 v21, s36, v10
v_and_b32 v23, s36, v11
v_and_b32 v25, s36, v12
v_and_b32 v27, s36, v13
v_and_b32 v29, s36, v14
v_and_b32 v31, s36, v15
v_pk_mul_f32 v[16:17], v[16:17], s[38:39]
v_pk_mul_f32 v[18:19], v[18:19], s[38:39]
v_pk_mul_f32 v[20:21], v[20:21], s[38:39]
v_pk_mul_f32 v[22:23], v[22:23], s[38:39]
v_pk_mul_f32 v[24:25], v[24:25], s[38:39]
v_pk_mul_f32 v[26:27], v[26:27], s[38:39]
v_pk_mul_f32 v[28:29], v[28:29], s[38:39]
v_pk_mul_f32 v[30:31], v[30:31], s[38:39]
v_cvt_pk_bf16_f32 v8, v16, v17
v_cvt_pk_bf16_f32 v9, v18, v19
v_cvt_pk_bf16_f32 v10, v20, v21
v_cvt_pk_bf16_f32 v11, v22, v23
v_cvt_pk_bf16_f32 v12, v24, v25
v_cvt_pk_bf16_f32 v13, v26, v27
v_cvt_pk_bf16_f32 v14, v28, v29
v_cvt_pk_bf16_f32 v15, v30, v31
v_accvgpr_write_b32 a16, v0
v_accvgpr_write_b32 a17, v1
v_accvgpr_write_b32 a18, v2
v_accvgpr_write_b32 a19, v3
v_accvgpr_write_b32 a20, v4
v_accvgpr_write_b32 a21, v5
v_accvgpr_write_b32 a22, v6
v_accvgpr_write_b32 a23, v7
v_accvgpr_write_b32 a24, v8
v_accvgpr_write_b32 a25, v9
v_accvgpr_write_b32 a26, v10
v_accvgpr_write_b32 a27, v11
v_accvgpr_write_b32 a28, v12
v_accvgpr_write_b32 a29, v13
v_accvgpr_write_b32 a30, v14
v_accvgpr_write_b32 a31, v15
v_mfma_f32_16x16x32_bf16 v[52:55], a[112:115], a[16:19], 0
v_cvt_pk_bf16_f32 v32, v68, v69
v_cvt_pk_bf16_f32 v33, v70, v71
v_mfma_f32_16x16x32_bf16 v[52:55], a[116:119], a[20:23], v[52:55]
v_exp_f32 v72, v72
v_mfma_f32_16x16x32_bf16 v[52:55], a[120:123], a[24:27], v[52:55]
v_exp_f32 v73, v73
v_mfma_f32_16x16x32_bf16 v[52:55], a[124:127], a[28:31], v[52:55]
s_nop 7
v_max3_f32 v52, v52, v53, v54
v_max_f32 v52, v52, v55
v_mov_b32 v53, v52
s_nop 1
v_permlane16_swap_b32 v52, v53
v_max_f32 v52, v52, v53
v_mov_b32 v53, v52
s_nop 1
v_permlane32_swap_b32 v52, v53
v_min_f32_e64 v54, -v52, -v53
v_min_f32_e64 v55, -v52, -v53
v_mov_b32 v52, v54
v_mov_b32 v53, v54
s_nop 1
v_mfma_f32_16x16x32_bf16 v[84:87], a[112:115], a[16:19], v[52:55]
v_exp_f32 v74, v74
v_mfma_f32_16x16x32_bf16 v[84:87], a[116:119], a[20:23], v[84:87]
v_exp_f32 v75, v75
v_mfma_f32_16x16x32_bf16 v[84:87], a[120:123], a[24:27], v[84:87]
v_cvt_pk_bf16_f32 v34, v72, v73
v_cvt_pk_bf16_f32 v35, v74, v75
v_mfma_f32_16x16x32_bf16 v[84:87], a[124:127], a[28:31], v[84:87]
v_exp_f32 v76, v76
v_mfma_f32_16x16x32_bf16 v[68:71], a[140:143], a[28:31], v[52:55]
v_exp_f32 v77, v77
v_mfma_f32_16x16x32_bf16 v[68:71], a[136:139], a[24:27], v[68:71]
v_exp_f32 v78, v78
v_mfma_f32_16x16x32_bf16 v[68:71], a[132:135], a[20:23], v[68:71]
v_exp_f32 v79, v79
v_mfma_f32_16x16x32_bf16 v[68:71], a[128:131], a[16:19], v[68:71]
v_cvt_pk_bf16_f32 v36, v76, v77
v_cvt_pk_bf16_f32 v37, v78, v79
v_mfma_f32_16x16x32_bf16 v[72:75], a[144:147], a[16:19], v[52:55]
v_exp_f32 v80, v80
v_mfma_f32_16x16x32_bf16 v[72:75], a[148:151], a[20:23], v[72:75]
v_exp_f32 v81, v81
v_mfma_f32_16x16x32_bf16 v[72:75], a[152:155], a[24:27], v[72:75]
v_exp_f32 v82, v82
v_mfma_f32_16x16x32_bf16 v[72:75], a[156:159], a[28:31], v[72:75]
v_exp_f32 v83, v83
v_mfma_f32_16x16x32_bf16 v[76:79], a[172:175], a[28:31], v[52:55]
v_cvt_pk_bf16_f32 v38, v80, v81
v_cvt_pk_bf16_f32 v39, v82, v83
v_mfma_f32_16x16x32_bf16 v[76:79], a[168:171], a[24:27], v[76:79]
v_exp_f32 v84, v84
v_mfma_f32_16x16x32_bf16 v[76:79], a[164:167], a[20:23], v[76:79]
v_exp_f32 v85, v85
v_mfma_f32_16x16x32_bf16 v[76:79], a[160:163], a[16:19], v[76:79]
v_exp_f32 v86, v86
v_mfma_f32_16x16x32_bf16 v[128:131], a[176:179], v[32:35], 0
v_exp_f32 v87, v87
v_mfma_f32_16x16x32_bf16 v[128:131], a[208:211], v[36:39], v[128:131]
v_cvt_pk_bf16_f32 v40, v84, v85
v_cvt_pk_bf16_f32 v41, v86, v87
v_mfma_f32_16x16x32_bf16 v[132:135], a[212:215], v[36:39], 0
v_exp_f32 v68, v68
v_mfma_f32_16x16x32_bf16 v[132:135], a[180:183], v[32:35], v[132:135]
v_exp_f32 v69, v69
v_mfma_f32_16x16x32_bf16 v[136:139], a[184:187], v[32:35], 0
v_exp_f32 v70, v70
v_mfma_f32_16x16x32_bf16 v[136:139], a[216:219], v[36:39], v[136:139]
v_exp_f32 v71, v71
v_mfma_f32_16x16x32_bf16 v[140:143], a[220:223], v[36:39], 0
v_cvt_pk_bf16_f32 v42, v68, v69
v_cvt_pk_bf16_f32 v43, v70, v71
v_mfma_f32_16x16x32_bf16 v[140:143], a[188:191], v[32:35], v[140:143]
v_exp_f32 v72, v72
v_mfma_f32_16x16x32_bf16 v[144:147], a[192:195], v[32:35], 0
v_exp_f32 v73, v73
v_mfma_f32_16x16x32_bf16 v[144:147], a[224:227], v[36:39], v[144:147]
v_exp_f32 v74, v74
v_mfma_f32_16x16x32_bf16 v[148:151], a[228:231], v[36:39], 0
v_exp_f32 v75, v75
v_mfma_f32_16x16x32_bf16 v[148:151], a[196:199], v[32:35], v[148:151]
v_cvt_pk_bf16_f32 v44, v72, v73
v_cvt_pk_bf16_f32 v45, v74, v75
v_mfma_f32_16x16x32_bf16 v[152:155], a[200:203], v[32:35], 0
v_exp_f32 v76, v76
v_mfma_f32_16x16x32_bf16 v[152:155], a[232:235], v[36:39], v[152:155]
s_xor_b32 s21, s23, 1024
v_exp_f32 v77, v77
v_mfma_f32_16x16x32_bf16 v[156:159], a[236:239], v[36:39], 0
v_exp_f32 v78, v78
v_mfma_f32_16x16x32_bf16 v[156:159], a[204:207], v[32:35], v[156:159]
v_exp_f32 v79, v79
v_smfmac_f32_16x16x64_bf16 a[240:243], a[248:251], v[32:39], v92
s_waitcnt vmcnt(8)
ds_read_b128 v[0:3], v93 offset:0
ds_read_b128 v[4:7], v93 offset:64
ds_read_b128 v[8:11], v93 offset:128
ds_read_b128 v[12:15], v93 offset:192
s_add_u32 m0, s22, 16896
s_nop 0
buffer_load_dwordx4 v97, s[8:11], s21 offen offset:0 nt lds
s_xor_b32 s21, s23, 5120
s_add_u32 m0, s22, 17952
s_nop 0
buffer_load_dwordx4 v97, s[8:11], s21 offen offset:0 nt lds
s_xor_b32 s21, s23, 9216
s_add_u32 m0, s22, 19008
s_nop 0
buffer_load_dwordx4 v97, s[8:11], s21 offen offset:0 nt lds
s_xor_b32 s21, s23, 13312
s_add_u32 m0, s22, 20064
s_nop 0
buffer_load_dwordx4 v97, s[8:11], s21 offen offset:0 nt lds
s_waitcnt lgkmcnt(0)
v_lshlrev_b32 v16, 16, v0
v_lshlrev_b32 v18, 16, v1
v_lshlrev_b32 v20, 16, v2
v_lshlrev_b32 v22, 16, v3
v_lshlrev_b32 v24, 16, v4
v_lshlrev_b32 v26, 16, v5
v_lshlrev_b32 v28, 16, v6
v_lshlrev_b32 v30, 16, v7
v_and_b32 v17, s36, v0
v_and_b32 v19, s36, v1
v_and_b32 v21, s36, v2
v_and_b32 v23, s36, v3
v_and_b32 v25, s36, v4
v_and_b32 v27, s36, v5
v_and_b32 v29, s36, v6
v_and_b32 v31, s36, v7
v_pk_mul_f32 v[16:17], v[16:17], s[38:39]
v_pk_mul_f32 v[18:19], v[18:19], s[38:39]
v_pk_mul_f32 v[20:21], v[20:21], s[38:39]
v_pk_mul_f32 v[22:23], v[22:23], s[38:39]
v_pk_mul_f32 v[24:25], v[24:25], s[38:39]
v_pk_mul_f32 v[26:27], v[26:27], s[38:39]
v_pk_mul_f32 v[28:29], v[28:29], s[38:39]
v_pk_mul_f32 v[30:31], v[30:31], s[38:39]
v_cvt_pk_bf16_f32 v0, v16, v17
v_cvt_pk_bf16_f32 v1, v18, v19
v_cvt_pk_bf16_f32 v2, v20, v21
v_cvt_pk_bf16_f32 v3, v22, v23
v_cvt_pk_bf16_f32 v4, v24, v25
v_cvt_pk_bf16_f32 v5, v26, v27
v_cvt_pk_bf16_f32 v6, v28, v29
v_cvt_pk_bf16_f32 v7, v30, v31
v_lshlrev_b32 v16, 16, v8
v_lshlrev_b32 v18, 16, v9
v_lshlrev_b32 v20, 16, v10
v_lshlrev_b32 v22, 16, v11
v_lshlrev_b32 v24, 16, v12
v_lshlrev_b32 v26, 16, v13
v_lshlrev_b32 v28, 16, v14
v_lshlrev_b32 v30, 16, v15
v_and_b32 v17, s36, v8
v_and_b32 v19, s36, v9
v_and_b32 v21, s36, v10
v_and_b32 v23, s36, v11
v_and_b32 v25, s36, v12
v_and_b32 v27, s36, v13
v_and_b32 v29, s36, v14
v_and_b32 v31, s36, v15
v_pk_mul_f32 v[16:17], v[16:17], s[38:39]
v_pk_mul_f32 v[18:19], v[18:19], s[38:39]
v_pk_mul_f32 v[20:21], v[20:21], s[38:39]
v_pk_mul_f32 v[22:23], v[22:23], s[38:39]
v_pk_mul_f32 v[24:25], v[24:25], s[38:39]
v_pk_mul_f32 v[26:27], v[26:27], s[38:39]
v_pk_mul_f32 v[28:29], v[28:29], s[38:39]
v_pk_mul_f32 v[30:31], v[30:31], s[38:39]
v_cvt_pk_bf16_f32 v8, v16, v17
v_cvt_pk_bf16_f32 v9, v18, v19
v_cvt_pk_bf16_f32 v10, v20, v21
v_cvt_pk_bf16_f32 v11, v22, v23
v_cvt_pk_bf16_f32 v12, v24, v25
v_cvt_pk_bf16_f32 v13, v26, v27
v_cvt_pk_bf16_f32 v14, v28, v29
v_cvt_pk_bf16_f32 v15, v30, v31
v_accvgpr_write_b32 a32, v0
v_accvgpr_write_b32 a33, v1
v_accvgpr_write_b32 a34, v2
v_accvgpr_write_b32 a35, v3
v_accvgpr_write_b32 a36, v4
v_accvgpr_write_b32 a37, v5
v_accvgpr_write_b32 a38, v6
v_accvgpr_write_b32 a39, v7
v_accvgpr_write_b32 a40, v8
v_accvgpr_write_b32 a41, v9
v_accvgpr_write_b32 a42, v10
v_accvgpr_write_b32 a43, v11
v_accvgpr_write_b32 a44, v12
v_accvgpr_write_b32 a45, v13
v_accvgpr_write_b32 a46, v14
v_accvgpr_write_b32 a47, v15
v_mfma_f32_16x16x32_bf16 v[56:59], a[112:115], a[32:35], 0
v_cvt_pk_bf16_f32 v46, v76, v77
v_cvt_pk_bf16_f32 v47, v78, v79
v_mfma_f32_16x16x32_bf16 v[56:59], a[116:119], a[36:39], v[56:59]
v_mfma_f32_16x16x32_bf16 v[56:59], a[120:123], a[40:43], v[56:59]
v_mfma_f32_16x16x32_bf16 v[56:59], a[124:127], a[44:47], v[56:59]
s_nop 7
v_max3_f32 v56, v56, v57, v58
v_max_f32 v56, v56, v59
v_mov_b32 v57, v56
s_nop 1
v_permlane16_swap_b32 v56, v57
v_max_f32 v56, v56, v57
v_mov_b32 v57, v56
s_nop 1
v_permlane32_swap_b32 v56, v57
v_min_f32_e64 v58, -v56, -v57
v_min_f32_e64 v59, -v56, -v57
v_mov_b32 v56, v58
v_mov_b32 v57, v58
s_nop 1
v_mfma_f32_16x16x32_bf16 v[80:83], a[112:115], a[32:35], v[56:59]
v_mfma_f32_16x16x32_bf16 v[80:83], a[116:119], a[36:39], v[80:83]
v_mfma_f32_16x16x32_bf16 v[80:83], a[120:123], a[40:43], v[80:83]
v_mfma_f32_16x16x32_bf16 v[80:83], a[124:127], a[44:47], v[80:83]
v_mfma_f32_16x16x32_bf16 v[84:87], a[140:143], a[44:47], v[56:59]
v_mfma_f32_16x16x32_bf16 v[84:87], a[136:139], a[40:43], v[84:87]
v_mfma_f32_16x16x32_bf16 v[84:87], a[132:135], a[36:39], v[84:87]
v_mfma_f32_16x16x32_bf16 v[84:87], a[128:131], a[32:35], v[84:87]
v_mfma_f32_16x16x32_bf16 v[68:71], a[144:147], a[32:35], v[56:59]
v_mfma_f32_16x16x32_bf16 v[68:71], a[148:151], a[36:39], v[68:71]
v_mfma_f32_16x16x32_bf16 v[68:71], a[152:155], a[40:43], v[68:71]
v_mfma_f32_16x16x32_bf16 v[68:71], a[156:159], a[44:47], v[68:71]
v_exp_f32 v80, v80
v_mfma_f32_16x16x32_bf16 v[72:75], a[172:175], a[44:47], v[56:59]
v_exp_f32 v81, v81
v_mfma_f32_16x16x32_bf16 v[72:75], a[168:171], a[40:43], v[72:75]
v_exp_f32 v82, v82
v_mfma_f32_16x16x32_bf16 v[72:75], a[164:167], a[36:39], v[72:75]
v_exp_f32 v83, v83
v_mfma_f32_16x16x32_bf16 v[72:75], a[160:163], a[32:35], v[72:75]
v_cvt_pk_bf16_f32 v32, v80, v81
v_cvt_pk_bf16_f32 v33, v82, v83
v_mfma_f32_16x16x32_bf16 v[160:163], a[176:179], v[40:43], 0
v_exp_f32 v84, v84
v_mfma_f32_16x16x32_bf16 v[160:163], a[208:211], v[44:47], v[160:163]
v_exp_f32 v85, v85
v_mfma_f32_16x16x32_bf16 v[164:167], a[212:215], v[44:47], 0
v_exp_f32 v86, v86
v_mfma_f32_16x16x32_bf16 v[164:167], a[180:183], v[40:43], v[164:167]
v_exp_f32 v87, v87
v_mfma_f32_16x16x32_bf16 v[168:171], a[184:187], v[40:43], 0
v_cvt_pk_bf16_f32 v34, v84, v85
v_cvt_pk_bf16_f32 v35, v86, v87
v_mfma_f32_16x16x32_bf16 v[168:171], a[216:219], v[44:47], v[168:171]
v_exp_f32 v68, v68
v_mfma_f32_16x16x32_bf16 v[172:175], a[220:223], v[44:47], 0
v_exp_f32 v69, v69
v_mfma_f32_16x16x32_bf16 v[172:175], a[188:191], v[40:43], v[172:175]
v_exp_f32 v70, v70
v_mfma_f32_16x16x32_bf16 v[176:179], a[192:195], v[40:43], 0
v_exp_f32 v71, v71
v_mfma_f32_16x16x32_bf16 v[176:179], a[224:227], v[44:47], v[176:179]
v_cvt_pk_bf16_f32 v36, v68, v69
v_cvt_pk_bf16_f32 v37, v70, v71
v_mfma_f32_16x16x32_bf16 v[180:183], a[228:231], v[44:47], 0
v_exp_f32 v72, v72
v_mfma_f32_16x16x32_bf16 v[180:183], a[196:199], v[40:43], v[180:183]
v_exp_f32 v73, v73
v_mfma_f32_16x16x32_bf16 v[184:187], a[200:203], v[40:43], 0
v_exp_f32 v74, v74
v_mfma_f32_16x16x32_bf16 v[184:187], a[232:235], v[44:47], v[184:187]
s_xor_b32 s21, s23, 1024
v_exp_f32 v75, v75
v_mfma_f32_16x16x32_bf16 v[188:191], a[236:239], v[44:47], 0
v_cvt_pk_bf16_f32 v38, v72, v73
v_cvt_pk_bf16_f32 v39, v74, v75
v_mfma_f32_16x16x32_bf16 v[188:191], a[204:207], v[40:43], v[188:191]
v_accvgpr_write_b32 a244, 0
v_accvgpr_write_b32 a245, 0
v_smfmac_f32_16x16x64_bf16 a[240:243], a[252:255], v[40:47], v92
s_waitcnt vmcnt(8)
ds_read_b128 v[0:3], v93 offset:4352
ds_read_b128 v[4:7], v93 offset:4416
ds_read_b128 v[8:11], v93 offset:4480
ds_read_b128 v[12:15], v93 offset:4544
s_add_u32 m0, s22, 67584
s_nop 0
buffer_load_dwordx4 v97, s[12:15], s21 offen offset:0 nt lds
s_xor_b32 s21, s23, 5120
s_add_u32 m0, s22, 68640
s_nop 0
buffer_load_dwordx4 v97, s[12:15], s21 offen offset:0 nt lds
s_xor_b32 s21, s23, 9216
s_add_u32 m0, s22, 69696
s_nop 0
buffer_load_dwordx4 v97, s[12:15], s21 offen offset:0 nt lds
s_xor_b32 s21, s23, 13312
s_add_u32 m0, s22, 70752
s_nop 0
buffer_load_dwordx4 v97, s[12:15], s21 offen offset:0 nt lds
s_waitcnt lgkmcnt(0)
v_lshlrev_b32 v16, 16, v0
v_lshlrev_b32 v18, 16, v1
v_lshlrev_b32 v20, 16, v2
v_lshlrev_b32 v22, 16, v3
v_lshlrev_b32 v24, 16, v4
v_lshlrev_b32 v26, 16, v5
v_lshlrev_b32 v28, 16, v6
v_lshlrev_b32 v30, 16, v7
v_and_b32 v17, s36, v0
v_and_b32 v19, s36, v1
v_and_b32 v21, s36, v2
v_and_b32 v23, s36, v3
v_and_b32 v25, s36, v4
v_and_b32 v27, s36, v5
v_and_b32 v29, s36, v6
v_and_b32 v31, s36, v7
v_pk_mul_f32 v[16:17], v[16:17], s[38:39]
v_pk_mul_f32 v[18:19], v[18:19], s[38:39]
v_pk_mul_f32 v[20:21], v[20:21], s[38:39]
v_pk_mul_f32 v[22:23], v[22:23], s[38:39]
v_pk_mul_f32 v[24:25], v[24:25], s[38:39]
v_pk_mul_f32 v[26:27], v[26:27], s[38:39]
v_pk_mul_f32 v[28:29], v[28:29], s[38:39]
v_pk_mul_f32 v[30:31], v[30:31], s[38:39]
v_cvt_pk_bf16_f32 v0, v16, v17
v_cvt_pk_bf16_f32 v1, v18, v19
v_cvt_pk_bf16_f32 v2, v20, v21
v_cvt_pk_bf16_f32 v3, v22, v23
v_cvt_pk_bf16_f32 v4, v24, v25
v_cvt_pk_bf16_f32 v5, v26, v27
v_cvt_pk_bf16_f32 v6, v28, v29
v_cvt_pk_bf16_f32 v7, v30, v31
v_lshlrev_b32 v16, 16, v8
v_lshlrev_b32 v18, 16, v9
v_lshlrev_b32 v20, 16, v10
v_lshlrev_b32 v22, 16, v11
v_lshlrev_b32 v24, 16, v12
v_lshlrev_b32 v26, 16, v13
v_lshlrev_b32 v28, 16, v14
v_lshlrev_b32 v30, 16, v15
v_and_b32 v17, s36, v8
v_and_b32 v19, s36, v9
v_and_b32 v21, s36, v10
v_and_b32 v23, s36, v11
v_and_b32 v25, s36, v12
v_and_b32 v27, s36, v13
v_and_b32 v29, s36, v14
v_and_b32 v31, s36, v15
v_pk_mul_f32 v[16:17], v[16:17], s[38:39]
v_pk_mul_f32 v[18:19], v[18:19], s[38:39]
v_pk_mul_f32 v[20:21], v[20:21], s[38:39]
v_pk_mul_f32 v[22:23], v[22:23], s[38:39]
v_pk_mul_f32 v[24:25], v[24:25], s[38:39]
v_pk_mul_f32 v[26:27], v[26:27], s[38:39]
v_pk_mul_f32 v[28:29], v[28:29], s[38:39]
v_pk_mul_f32 v[30:31], v[30:31], s[38:39]
v_cvt_pk_bf16_f32 v8, v16, v17
v_cvt_pk_bf16_f32 v9, v18, v19
v_cvt_pk_bf16_f32 v10, v20, v21
v_cvt_pk_bf16_f32 v11, v22, v23
v_cvt_pk_bf16_f32 v12, v24, v25
v_cvt_pk_bf16_f32 v13, v26, v27
v_cvt_pk_bf16_f32 v14, v28, v29
v_cvt_pk_bf16_f32 v15, v30, v31
v_accvgpr_write_b32 a48, v0
v_accvgpr_write_b32 a49, v1
v_accvgpr_write_b32 a50, v2
v_accvgpr_write_b32 a51, v3
v_accvgpr_write_b32 a52, v4
v_accvgpr_write_b32 a53, v5
v_accvgpr_write_b32 a54, v6
v_accvgpr_write_b32 a55, v7
v_accvgpr_write_b32 a56, v8
v_accvgpr_write_b32 a57, v9
v_accvgpr_write_b32 a58, v10
v_accvgpr_write_b32 a59, v11
v_accvgpr_write_b32 a60, v12
v_accvgpr_write_b32 a61, v13
v_accvgpr_write_b32 a62, v14
v_accvgpr_write_b32 a63, v15
v_mfma_f32_16x16x32_bf16 v[60:63], a[112:115], a[48:51], 0
v_accvgpr_write_b32 a246, 0
v_accvgpr_write_b32 a247, 0
v_mfma_f32_16x16x32_bf16 v[60:63], a[116:119], a[52:55], v[60:63]
v_mfma_f32_16x16x32_bf16 v[60:63], a[120:123], a[56:59], v[60:63]
v_mfma_f32_16x16x32_bf16 v[60:63], a[124:127], a[60:63], v[60:63]
s_nop 7
v_max3_f32 v60, v60, v61, v62
v_max_f32 v60, v60, v63
v_mov_b32 v61, v60
s_nop 1
v_permlane16_swap_b32 v60, v61
v_max_f32 v60, v60, v61
v_mov_b32 v61, v60
s_nop 1
v_permlane32_swap_b32 v60, v61
v_min_f32_e64 v62, -v60, -v61
v_min_f32_e64 v63, -v60, -v61
v_mov_b32 v60, v62
v_mov_b32 v61, v62
s_nop 1
v_mfma_f32_16x16x32_bf16 v[76:79], a[112:115], a[48:51], v[60:63]
v_mfma_f32_16x16x32_bf16 v[76:79], a[116:119], a[52:55], v[76:79]
v_mfma_f32_16x16x32_bf16 v[76:79], a[120:123], a[56:59], v[76:79]
v_mfma_f32_16x16x32_bf16 v[76:79], a[124:127], a[60:63], v[76:79]
v_mfma_f32_16x16x32_bf16 v[80:83], a[140:143], a[60:63], v[60:63]
v_mfma_f32_16x16x32_bf16 v[80:83], a[136:139], a[56:59], v[80:83]
v_mfma_f32_16x16x32_bf16 v[80:83], a[132:135], a[52:55], v[80:83]
v_mfma_f32_16x16x32_bf16 v[80:83], a[128:131], a[48:51], v[80:83]
v_mfma_f32_16x16x32_bf16 v[84:87], a[144:147], a[48:51], v[60:63]
v_mfma_f32_16x16x32_bf16 v[84:87], a[148:151], a[52:55], v[84:87]
v_mfma_f32_16x16x32_bf16 v[84:87], a[152:155], a[56:59], v[84:87]
v_mfma_f32_16x16x32_bf16 v[84:87], a[156:159], a[60:63], v[84:87]
v_exp_f32 v76, v76
v_mfma_f32_16x16x32_bf16 v[68:71], a[172:175], a[60:63], v[60:63]
v_exp_f32 v77, v77
v_mfma_f32_16x16x32_bf16 v[68:71], a[168:171], a[56:59], v[68:71]
v_exp_f32 v78, v78
v_mfma_f32_16x16x32_bf16 v[68:71], a[164:167], a[52:55], v[68:71]
v_exp_f32 v79, v79
v_mfma_f32_16x16x32_bf16 v[68:71], a[160:163], a[48:51], v[68:71]
v_cvt_pk_bf16_f32 v40, v76, v77
v_cvt_pk_bf16_f32 v41, v78, v79
v_mfma_f32_16x16x32_bf16 v[192:195], a[176:179], v[32:35], 0
v_exp_f32 v80, v80
v_mfma_f32_16x16x32_bf16 v[192:195], a[208:211], v[36:39], v[192:195]
v_exp_f32 v81, v81
v_mfma_f32_16x16x32_bf16 v[196:199], a[212:215], v[36:39], 0
v_exp_f32 v82, v82
v_mfma_f32_16x16x32_bf16 v[196:199], a[180:183], v[32:35], v[196:199]
v_exp_f32 v83, v83
v_mfma_f32_16x16x32_bf16 v[200:203], a[184:187], v[32:35], 0
v_cvt_pk_bf16_f32 v42, v80, v81
v_cvt_pk_bf16_f32 v43, v82, v83
v_mfma_f32_16x16x32_bf16 v[200:203], a[216:219], v[36:39], v[200:203]
v_exp_f32 v84, v84
v_mfma_f32_16x16x32_bf16 v[204:207], a[220:223], v[36:39], 0
v_exp_f32 v85, v85
v_mfma_f32_16x16x32_bf16 v[204:207], a[188:191], v[32:35], v[204:207]
v_exp_f32 v86, v86
v_mfma_f32_16x16x32_bf16 v[208:211], a[192:195], v[32:35], 0
v_exp_f32 v87, v87
v_mfma_f32_16x16x32_bf16 v[208:211], a[224:227], v[36:39], v[208:211]
v_exp_f32 v68, v68
v_mfma_f32_16x16x32_bf16 v[212:215], a[228:231], v[36:39], 0
v_exp_f32 v69, v69
v_mfma_f32_16x16x32_bf16 v[212:215], a[196:199], v[32:35], v[212:215]
v_exp_f32 v70, v70
v_mfma_f32_16x16x32_bf16 v[216:219], a[200:203], v[32:35], 0
v_exp_f32 v71, v71
v_mfma_f32_16x16x32_bf16 v[216:219], a[232:235], v[36:39], v[216:219]
s_xor_b32 s21, s23, 2048
v_cvt_pk_bf16_f32 v44, v84, v85
v_cvt_pk_bf16_f32 v45, v86, v87
v_mfma_f32_16x16x32_bf16 v[220:223], a[236:239], v[36:39], 0
v_cvt_pk_bf16_f32 v46, v68, v69
v_cvt_pk_bf16_f32 v47, v70, v71
v_mfma_f32_16x16x32_bf16 v[220:223], a[204:207], v[32:35], v[220:223]
v_smfmac_f32_16x16x64_bf16 a[244:247], a[248:251], v[32:39], v92
s_waitcnt vmcnt(8)
ds_read_b128 v[0:3], v93 offset:8704
ds_read_b128 v[4:7], v93 offset:8768
ds_read_b128 v[8:11], v93 offset:8832
ds_read_b128 v[12:15], v93 offset:8896
s_add_u32 m0, s22, 33792
s_nop 0
buffer_load_dwordx4 v97, s[8:11], s21 offen offset:0 nt lds
s_xor_b32 s21, s23, 6144
s_add_u32 m0, s22, 34848
s_nop 0
buffer_load_dwordx4 v97, s[8:11], s21 offen offset:0 nt lds
s_xor_b32 s21, s23, 10240
s_add_u32 m0, s22, 35904
s_nop 0
buffer_load_dwordx4 v97, s[8:11], s21 offen offset:0 nt lds
s_xor_b32 s21, s23, 14336
s_add_u32 m0, s22, 36960
s_nop 0
buffer_load_dwordx4 v97, s[8:11], s21 offen offset:0 nt lds
s_waitcnt lgkmcnt(0)
v_lshlrev_b32 v16, 16, v0
v_lshlrev_b32 v18, 16, v1
v_lshlrev_b32 v20, 16, v2
v_lshlrev_b32 v22, 16, v3
v_lshlrev_b32 v24, 16, v4
v_lshlrev_b32 v26, 16, v5
v_lshlrev_b32 v28, 16, v6
v_lshlrev_b32 v30, 16, v7
v_and_b32 v17, s36, v0
v_and_b32 v19, s36, v1
v_and_b32 v21, s36, v2
v_and_b32 v23, s36, v3
v_and_b32 v25, s36, v4
v_and_b32 v27, s36, v5
v_and_b32 v29, s36, v6
v_and_b32 v31, s36, v7
v_pk_mul_f32 v[16:17], v[16:17], s[38:39]
v_pk_mul_f32 v[18:19], v[18:19], s[38:39]
v_pk_mul_f32 v[20:21], v[20:21], s[38:39]
v_pk_mul_f32 v[22:23], v[22:23], s[38:39]
v_pk_mul_f32 v[24:25], v[24:25], s[38:39]
v_pk_mul_f32 v[26:27], v[26:27], s[38:39]
v_pk_mul_f32 v[28:29], v[28:29], s[38:39]
v_pk_mul_f32 v[30:31], v[30:31], s[38:39]
v_cvt_pk_bf16_f32 v0, v16, v17
v_cvt_pk_bf16_f32 v1, v18, v19
v_cvt_pk_bf16_f32 v2, v20, v21
v_cvt_pk_bf16_f32 v3, v22, v23
v_cvt_pk_bf16_f32 v4, v24, v25
v_cvt_pk_bf16_f32 v5, v26, v27
v_cvt_pk_bf16_f32 v6, v28, v29
v_cvt_pk_bf16_f32 v7, v30, v31
v_lshlrev_b32 v16, 16, v8
v_lshlrev_b32 v18, 16, v9
v_lshlrev_b32 v20, 16, v10
v_lshlrev_b32 v22, 16, v11
v_lshlrev_b32 v24, 16, v12
v_lshlrev_b32 v26, 16, v13
v_lshlrev_b32 v28, 16, v14
v_lshlrev_b32 v30, 16, v15
v_and_b32 v17, s36, v8
v_and_b32 v19, s36, v9
v_and_b32 v21, s36, v10
v_and_b32 v23, s36, v11
v_and_b32 v25, s36, v12
v_and_b32 v27, s36, v13
v_and_b32 v29, s36, v14
v_and_b32 v31, s36, v15
v_pk_mul_f32 v[16:17], v[16:17], s[38:39]
v_pk_mul_f32 v[18:19], v[18:19], s[38:39]
v_pk_mul_f32 v[20:21], v[20:21], s[38:39]
v_pk_mul_f32 v[22:23], v[22:23], s[38:39]
v_pk_mul_f32 v[24:25], v[24:25], s[38:39]
v_pk_mul_f32 v[26:27], v[26:27], s[38:39]
v_pk_mul_f32 v[28:29], v[28:29], s[38:39]
v_pk_mul_f32 v[30:31], v[30:31], s[38:39]
v_cvt_pk_bf16_f32 v8, v16, v17
v_cvt_pk_bf16_f32 v9, v18, v19
v_cvt_pk_bf16_f32 v10, v20, v21
v_cvt_pk_bf16_f32 v11, v22, v23
v_cvt_pk_bf16_f32 v12, v24, v25
v_cvt_pk_bf16_f32 v13, v26, v27
v_cvt_pk_bf16_f32 v14, v28, v29
v_cvt_pk_bf16_f32 v15, v30, v31
v_accvgpr_write_b32 a64, v0
v_accvgpr_write_b32 a65, v1
v_accvgpr_write_b32 a66, v2
v_accvgpr_write_b32 a67, v3
v_accvgpr_write_b32 a68, v4
v_accvgpr_write_b32 a69, v5
v_accvgpr_write_b32 a70, v6
v_accvgpr_write_b32 a71, v7
v_accvgpr_write_b32 a72, v8
v_accvgpr_write_b32 a73, v9
v_accvgpr_write_b32 a74, v10
v_accvgpr_write_b32 a75, v11
v_accvgpr_write_b32 a76, v12
v_accvgpr_write_b32 a77, v13
v_accvgpr_write_b32 a78, v14
v_accvgpr_write_b32 a79, v15
v_mfma_f32_16x16x32_bf16 v[64:67], a[112:115], a[64:67], 0
v_mfma_f32_16x16x32_bf16 v[64:67], a[116:119], a[68:71], v[64:67]
v_mfma_f32_16x16x32_bf16 v[64:67], a[120:123], a[72:75], v[64:67]
v_mfma_f32_16x16x32_bf16 v[64:67], a[124:127], a[76:79], v[64:67]
s_nop 7
v_max3_f32 v64, v64, v65, v66
v_max_f32 v64, v64, v67
v_mov_b32 v65, v64
s_nop 1
v_permlane16_swap_b32 v64, v65
v_max_f32 v64, v64, v65
v_mov_b32 v65, v64
s_nop 1
v_permlane32_swap_b32 v64, v65
v_min_f32_e64 v66, -v64, -v65
v_min_f32_e64 v67, -v64, -v65
v_mov_b32 v64, v66
v_mov_b32 v65, v66
s_nop 1
v_mfma_f32_16x16x32_bf16 v[72:75], a[112:115], a[64:67], v[64:67]
v_mov_b32 v101, v64
v_mfma_f32_16x16x32_bf16 v[72:75], a[116:119], a[68:71], v[72:75]
v_mfma_f32_16x16x32_bf16 v[72:75], a[120:123], a[72:75], v[72:75]
v_mfma_f32_16x16x32_bf16 v[72:75], a[124:127], a[76:79], v[72:75]
v_mfma_f32_16x16x32_bf16 v[76:79], a[140:143], a[76:79], v[64:67]
v_mfma_f32_16x16x32_bf16 v[76:79], a[136:139], a[72:75], v[76:79]
v_mfma_f32_16x16x32_bf16 v[76:79], a[132:135], a[68:71], v[76:79]
v_mfma_f32_16x16x32_bf16 v[76:79], a[128:131], a[64:67], v[76:79]
s_waitcnt vmcnt(0)
s_barrier
v_mfma_f32_16x16x32_bf16 v[224:227], a[176:179], v[40:43], 0
s_xor_b32 s21, s23, 2048
ds_read_b128 a[144:147], v89 offset:16896
v_mfma_f32_16x16x32_bf16 v[224:227], a[208:211], v[44:47], v[224:227]
s_add_u32 m0, s22, 84480
v_exp_f32 v72, v72
v_mfma_f32_16x16x32_bf16 v[228:231], a[212:215], v[44:47], 0
v_exp_f32 v73, v73
v_mfma_f32_16x16x32_bf16 v[228:231], a[180:183], v[40:43], v[228:231]
buffer_load_dwordx4 v97, s[12:15], s21 offen offset:0 nt lds
v_mfma_f32_16x16x32_bf16 v[232:235], a[184:187], v[40:43], 0
ds_read_b128 a[148:151], v89 offset:16960
v_cvt_pk_bf16_f32 v32, v72, v73
v_mfma_f32_16x16x32_bf16 v[232:235], a[216:219], v[44:47], v[232:235]
v_exp_f32 v74, v74
v_mfma_f32_16x16x32_bf16 v[236:239], a[220:223], v[44:47], 0
v_exp_f32 v75, v75
v_mfma_f32_16x16x32_bf16 v[236:239], a[188:191], v[40:43], v[236:239]
ds_read_b128 a[152:155], v89 offset:17024
v_cvt_pk_bf16_f32 v33, v74, v75
v_mfma_f32_16x16x32_bf16 v[240:243], a[192:195], v[40:43], 0
v_exp_f32 v76, v76
v_mfma_f32_16x16x32_bf16 v[240:243], a[224:227], v[44:47], v[240:243]
v_exp_f32 v77, v77
v_mfma_f32_16x16x32_bf16 v[244:247], a[228:231], v[44:47], 0
ds_read_b128 a[156:159], v89 offset:17088
v_cvt_pk_bf16_f32 v34, v76, v77
v_mfma_f32_16x16x32_bf16 v[244:247], a[196:199], v[40:43], v[244:247]
v_exp_f32 v78, v78
v_mfma_f32_16x16x32_bf16 v[248:251], a[200:203], v[40:43], 0
v_exp_f32 v79, v79
v_mfma_f32_16x16x32_bf16 v[248:251], a[232:235], v[44:47], v[248:251]
ds_read_b128 a[172:175], v89 offset:17600
v_cvt_pk_bf16_f32 v35, v78, v79
v_mfma_f32_16x16x32_bf16 v[252:255], a[236:239], v[44:47], 0
ds_read_b128 a[168:171], v89 offset:17536
v_mfma_f32_16x16x32_bf16 v[252:255], a[204:207], v[40:43], v[252:255]
ds_read_b128 a[164:167], v89 offset:17472
v_smfmac_f32_16x16x64_bf16 a[244:247], a[252:255], v[40:47], v92
s_waitcnt lgkmcnt(4)
ds_read_b128 a[160:163], v89 offset:17408
v_mfma_f32_16x16x32_bf16 v[80:83], a[144:147], a[0:3], v[48:51]
s_xor_b32 s21, s23, 6144
ds_read_b128 a[112:115], v88 offset:16896
v_mfma_f32_16x16x32_bf16 v[80:83], a[148:151], a[4:7], v[80:83]
s_add_u32 m0, s22, 85536
ds_read_b128 a[116:119], v88 offset:16960
v_mfma_f32_16x16x32_bf16 v[80:83], a[152:155], a[8:11], v[80:83]
s_waitcnt lgkmcnt(5)
ds_read_b128 a[120:123], v88 offset:17024
v_mfma_f32_16x16x32_bf16 v[80:83], a[156:159], a[12:15], v[80:83]
buffer_load_dwordx4 v97, s[12:15], s21 offen offset:0 nt lds
v_mfma_f32_16x16x32_bf16 v[84:87], a[172:175], a[12:15], v[48:51]
s_waitcnt lgkmcnt(5)
ds_read_b128 a[124:127], v88 offset:17088
v_mfma_f32_16x16x32_bf16 v[84:87], a[168:171], a[8:11], v[84:87]
s_waitcnt lgkmcnt(5)
ds_read_b128 a[140:143], v88 offset:17600
v_mfma_f32_16x16x32_bf16 v[84:87], a[164:167], a[4:7], v[84:87]
s_waitcnt lgkmcnt(5)
ds_read_b128 a[136:139], v88 offset:17536
v_mfma_f32_16x16x32_bf16 v[84:87], a[160:163], a[0:3], v[84:87]
s_waitcnt lgkmcnt(5)
ds_read_b128 a[132:135], v88 offset:17472
v_mfma_f32_16x16x32_bf16 v[68:71], a[112:115], a[0:3], v[48:51]
s_waitcnt lgkmcnt(5)
ds_read_b128 a[128:131], v88 offset:17408
v_mfma_f32_16x16x32_bf16 v[68:71], a[116:119], a[4:7], v[68:71]
s_waitcnt lgkmcnt(5)
v_exp_f32 v80, v80
v_mfma_f32_16x16x32_bf16 v[68:71], a[120:123], a[8:11], v[68:71]
s_waitcnt lgkmcnt(4)
v_exp_f32 v81, v81
v_mfma_f32_16x16x32_bf16 v[68:71], a[124:127], a[12:15], v[68:71]
s_waitcnt lgkmcnt(3)
v_exp_f32 v82, v82
v_mfma_f32_16x16x32_bf16 v[72:75], a[140:143], a[12:15], v[48:51]
s_waitcnt lgkmcnt(2)
v_exp_f32 v83, v83
v_mfma_f32_16x16x32_bf16 v[72:75], a[136:139], a[8:11], v[72:75]
s_waitcnt lgkmcnt(1)
v_cvt_pk_bf16_f32 v44, v80, v81
v_cvt_pk_bf16_f32 v45, v82, v83
v_mfma_f32_16x16x32_bf16 v[72:75], a[132:135], a[4:7], v[72:75]
s_waitcnt lgkmcnt(0)
v_exp_f32 v84, v84
v_mfma_f32_16x16x32_bf16 v[72:75], a[128:131], a[0:3], v[72:75]
v_exp_f32 v85, v85
v_mfma_f32_16x16x32_bf16 v[104:107], a[248:251], v[32:35], 0
v_exp_f32 v86, v86
v_mfma_f32_16x16x32_bf16 a[80:83], a[176:179], v[32:35], 0
v_exp_f32 v87, v87
v_mfma_f32_16x16x32_bf16 a[84:87], a[180:183], v[32:35], 0
s_xor_b32 s21, s23, 10240
v_cvt_pk_bf16_f32 v46, v84, v85
v_cvt_pk_bf16_f32 v47, v86, v87
v_mfma_f32_16x16x32_bf16 a[88:91], a[184:187], v[32:35], 0
s_add_u32 m0, s22, 86592
ds_read_b64_tr_b16 a[208:209], v91 offset:16896
ds_read_b64_tr_b16 a[210:211], v91 offset:17408
v_mfma_f32_16x16x32_bf16 a[92:95], a[188:191], v[32:35], 0
v_exp_f32 v68, v68
v_mfma_f32_16x16x32_bf16 a[96:99], a[192:195], v[32:35], 0
buffer_load_dwordx4 v97, s[12:15], s21 offen offset:0 nt lds
v_mfma_f32_16x16x32_bf16 a[100:103], a[196:199], v[32:35], 0
v_exp_f32 v69, v69
v_mfma_f32_16x16x32_bf16 a[104:107], a[200:203], v[32:35], 0
v_exp_f32 v70, v70
v_mfma_f32_16x16x32_bf16 a[108:111], a[204:207], v[32:35], 0
v_exp_f32 v71, v71
v_mfma_f32_16x16x32_bf16 v[76:79], a[144:147], a[16:19], v[52:55]
ds_read_b64_tr_b16 a[176:177], v90 offset:16896
ds_read_b64_tr_b16 a[178:179], v90 offset:17408
v_mfma_f32_16x16x32_bf16 v[76:79], a[148:151], a[20:23], v[76:79]
v_cvt_pk_bf16_f32 v40, v68, v69
v_cvt_pk_bf16_f32 v41, v70, v71
v_mfma_f32_16x16x32_bf16 v[76:79], a[152:155], a[24:27], v[76:79]
ds_read_b64_tr_b16 a[180:181], v90 offset:16928
ds_read_b64_tr_b16 a[182:183], v90 offset:17440
v_mfma_f32_16x16x32_bf16 v[76:79], a[156:159], a[28:31], v[76:79]
v_exp_f32 v72, v72
v_mfma_f32_16x16x32_bf16 v[80:83], a[172:175], a[28:31], v[52:55]
ds_read_b64_tr_b16 a[212:213], v91 offset:16928
ds_read_b64_tr_b16 a[214:215], v91 offset:17440
v_mfma_f32_16x16x32_bf16 v[80:83], a[168:171], a[24:27], v[80:83]
v_exp_f32 v73, v73
v_mfma_f32_16x16x32_bf16 v[80:83], a[164:167], a[20:23], v[80:83]
ds_read_b64_tr_b16 a[216:217], v91 offset:16960
ds_read_b64_tr_b16 a[218:219], v91 offset:17472
v_mfma_f32_16x16x32_bf16 v[80:83], a[160:163], a[16:19], v[80:83]
v_exp_f32 v74, v74
v_mfma_f32_16x16x32_bf16 v[84:87], a[112:115], a[16:19], v[52:55]
v_exp_f32 v75, v75
v_mfma_f32_16x16x32_bf16 v[84:87], a[116:119], a[20:23], v[84:87]
ds_read_b64_tr_b16 a[184:185], v90 offset:16960
ds_read_b64_tr_b16 a[186:187], v90 offset:17472
v_mfma_f32_16x16x32_bf16 v[84:87], a[120:123], a[24:27], v[84:87]
s_xor_b32 s21, s23, 14336
v_cvt_pk_bf16_f32 v42, v72, v73
v_cvt_pk_bf16_f32 v43, v74, v75
v_mfma_f32_16x16x32_bf16 v[84:87], a[124:127], a[28:31], v[84:87]
s_add_u32 m0, s22, 87648
ds_read_b64_tr_b16 a[188:189], v90 offset:16992
ds_read_b64_tr_b16 a[190:191], v90 offset:17504
v_mfma_f32_16x16x32_bf16 v[68:71], a[140:143], a[28:31], v[52:55]
v_exp_f32 v76, v76
v_mfma_f32_16x16x32_bf16 v[68:71], a[136:139], a[24:27], v[68:71]
ds_read_b64_tr_b16 a[220:221], v91 offset:16992
ds_read_b64_tr_b16 a[222:223], v91 offset:17504
v_mfma_f32_16x16x32_bf16 v[68:71], a[132:135], a[20:23], v[68:71]
buffer_load_dwordx4 v97, s[12:15], s21 offen offset:0 nt lds
v_mfma_f32_16x16x32_bf16 v[68:71], a[128:131], a[16:19], v[68:71]
s_waitcnt lgkmcnt(6)
ds_read_b64_tr_b16 a[224:225], v91 offset:17024
ds_read_b64_tr_b16 a[226:227], v91 offset:17536
v_mfma_f32_16x16x32_bf16 v[128:131], a[208:211], v[44:47], v[128:131]
v_exp_f32 v77, v77
v_mfma_f32_16x16x32_bf16 v[128:131], a[176:179], v[40:43], v[128:131]
ds_read_b64_tr_b16 a[192:193], v90 offset:17024
ds_read_b64_tr_b16 a[194:195], v90 offset:17536
v_mfma_f32_16x16x32_bf16 v[132:135], a[180:183], v[40:43], v[132:135]
ds_read_b64_tr_b16 a[196:197], v90 offset:17056
v_cvt_pk_bf16_f32 v36, v76, v77
v_mfma_f32_16x16x32_bf16 v[132:135], a[212:215], v[44:47], v[132:135]
ds_read_b64_tr_b16 a[198:199], v90 offset:17568
ds_read_b64_tr_b16 a[228:229], v91 offset:17056
v_mfma_f32_16x16x32_bf16 v[136:139], a[216:219], v[44:47], v[136:139]
s_waitcnt lgkmcnt(9)
ds_read_b64_tr_b16 a[230:231], v91 offset:17568
v_mfma_f32_16x16x32_bf16 v[136:139], a[184:187], v[40:43], v[136:139]
ds_read_b64_tr_b16 a[232:233], v91 offset:17088
ds_read_b64_tr_b16 a[234:235], v91 offset:17600
v_mfma_f32_16x16x32_bf16 v[140:143], a[188:191], v[40:43], v[140:143]
s_waitcnt lgkmcnt(10)
ds_read_b64_tr_b16 a[200:201], v90 offset:17088
ds_read_b64_tr_b16 a[202:203], v90 offset:17600
v_mfma_f32_16x16x32_bf16 v[140:143], a[220:223], v[44:47], v[140:143]
s_waitcnt lgkmcnt(10)
ds_read_b64_tr_b16 a[204:205], v90 offset:17120
ds_read_b64_tr_b16 a[206:207], v90 offset:17632
v_mfma_f32_16x16x32_bf16 v[144:147], a[224:227], v[44:47], v[144:147]
s_waitcnt lgkmcnt(10)
ds_read_b64_tr_b16 a[236:237], v91 offset:17120
ds_read_b64_tr_b16 a[238:239], v91 offset:17632
v_mfma_f32_16x16x32_bf16 v[144:147], a[192:195], v[40:43], v[144:147]
s_waitcnt lgkmcnt(10)
v_exp_f32 v78, v78
v_mfma_f32_16x16x32_bf16 v[148:151], a[196:199], v[40:43], v[148:151]
s_waitcnt lgkmcnt(8)
v_exp_f32 v79, v79
v_mfma_f32_16x16x32_bf16 v[148:151], a[228:231], v[44:47], v[148:151]
s_waitcnt lgkmcnt(4)
v_exp_f32 v80, v80
v_mfma_f32_16x16x32_bf16 v[152:155], a[232:235], v[44:47], v[152:155]
s_xor_b32 s21, s23, 3072
v_exp_f32 v81, v81
v_mfma_f32_16x16x32_bf16 v[152:155], a[200:203], v[40:43], v[152:155]
s_add_u32 m0, s22, 0
v_cvt_pk_bf16_f32 v37, v78, v79
v_cvt_pk_bf16_f32 v38, v80, v81
s_waitcnt lgkmcnt(2)
v_mfma_f32_16x16x32_bf16 v[156:159], a[204:207], v[40:43], v[156:159]
s_waitcnt lgkmcnt(0)
v_exp_f32 v82, v82
v_mfma_f32_16x16x32_bf16 v[156:159], a[236:239], v[44:47], v[156:159]
buffer_load_dwordx4 v97, s[8:11], s21 offen offset:0 nt lds
v_smfmac_f32_16x16x64_bf16 a[240:243], a[248:251], v[40:47], v92
v_mfma_f32_16x16x32_bf16 v[72:75], a[144:147], a[32:35], v[56:59]
v_exp_f32 v83, v83
v_mfma_f32_16x16x32_bf16 v[72:75], a[148:151], a[36:39], v[72:75]
v_exp_f32 v84, v84
v_mfma_f32_16x16x32_bf16 v[72:75], a[152:155], a[40:43], v[72:75]
v_exp_f32 v85, v85
v_mfma_f32_16x16x32_bf16 v[72:75], a[156:159], a[44:47], v[72:75]
v_cvt_pk_bf16_f32 v39, v82, v83
v_cvt_pk_bf16_f32 v32, v84, v85
v_mfma_f32_16x16x32_bf16 v[76:79], a[172:175], a[44:47], v[56:59]
v_exp_f32 v86, v86
v_mfma_f32_16x16x32_bf16 v[76:79], a[168:171], a[40:43], v[76:79]
v_exp_f32 v87, v87
v_mfma_f32_16x16x32_bf16 v[76:79], a[164:167], a[36:39], v[76:79]
v_exp_f32 v68, v68
v_mfma_f32_16x16x32_bf16 v[76:79], a[160:163], a[32:35], v[76:79]
v_exp_f32 v69, v69
v_mfma_f32_16x16x32_bf16 v[80:83], a[112:115], a[32:35], v[56:59]
v_cvt_pk_bf16_f32 v33, v86, v87
v_cvt_pk_bf16_f32 v34, v68, v69
v_mfma_f32_16x16x32_bf16 v[80:83], a[116:119], a[36:39], v[80:83]
v_exp_f32 v70, v70
v_mfma_f32_16x16x32_bf16 v[80:83], a[120:123], a[40:43], v[80:83]
v_exp_f32 v71, v71
v_mfma_f32_16x16x32_bf16 v[80:83], a[124:127], a[44:47], v[80:83]
v_exp_f32 v72, v72
v_mfma_f32_16x16x32_bf16 v[84:87], a[140:143], a[44:47], v[56:59]
s_xor_b32 s21, s23, 7168
v_exp_f32 v73, v73
v_mfma_f32_16x16x32_bf16 v[84:87], a[136:139], a[40:43], v[84:87]
s_add_u32 m0, s22, 1056
v_cvt_pk_bf16_f32 v35, v70, v71
v_cvt_pk_bf16_f32 v44, v72, v73
v_mfma_f32_16x16x32_bf16 v[84:87], a[132:135], a[36:39], v[84:87]
v_exp_f32 v74, v74
v_mfma_f32_16x16x32_bf16 v[84:87], a[128:131], a[32:35], v[84:87]
buffer_load_dwordx4 v97, s[8:11], s21 offen offset:0 nt lds
v_mfma_f32_16x16x32_bf16 v[160:163], a[208:211], v[36:39], v[160:163]
v_exp_f32 v75, v75
v_mfma_f32_16x16x32_bf16 v[160:163], a[176:179], v[32:35], v[160:163]
v_exp_f32 v76, v76
v_mfma_f32_16x16x32_bf16 v[164:167], a[180:183], v[32:35], v[164:167]
v_exp_f32 v77, v77
v_mfma_f32_16x16x32_bf16 v[164:167], a[212:215], v[36:39], v[164:167]
v_cvt_pk_bf16_f32 v45, v74, v75
v_cvt_pk_bf16_f32 v46, v76, v77
v_mfma_f32_16x16x32_bf16 v[168:171], a[216:219], v[36:39], v[168:171]
v_exp_f32 v78, v78
v_mfma_f32_16x16x32_bf16 v[168:171], a[184:187], v[32:35], v[168:171]
v_exp_f32 v79, v79
v_mfma_f32_16x16x32_bf16 v[172:175], a[188:191], v[32:35], v[172:175]
v_exp_f32 v80, v80
v_mfma_f32_16x16x32_bf16 v[172:175], a[220:223], v[36:39], v[172:175]
v_exp_f32 v81, v81
v_mfma_f32_16x16x32_bf16 v[176:179], a[224:227], v[36:39], v[176:179]
v_cvt_pk_bf16_f32 v47, v78, v79
v_cvt_pk_bf16_f32 v40, v80, v81
v_mfma_f32_16x16x32_bf16 v[176:179], a[192:195], v[32:35], v[176:179]
v_exp_f32 v82, v82
v_mfma_f32_16x16x32_bf16 v[180:183], a[196:199], v[32:35], v[180:183]
v_exp_f32 v83, v83
v_mfma_f32_16x16x32_bf16 v[180:183], a[228:231], v[36:39], v[180:183]
v_exp_f32 v84, v84
v_mfma_f32_16x16x32_bf16 v[184:187], a[232:235], v[36:39], v[184:187]
v_exp_f32 v85, v85
v_mfma_f32_16x16x32_bf16 v[184:187], a[200:203], v[32:35], v[184:187]
v_cvt_pk_bf16_f32 v41, v82, v83
v_cvt_pk_bf16_f32 v42, v84, v85
v_mfma_f32_16x16x32_bf16 v[188:191], a[204:207], v[32:35], v[188:191]
s_xor_b32 s21, s23, 11264
v_exp_f32 v86, v86
v_mfma_f32_16x16x32_bf16 v[188:191], a[236:239], v[36:39], v[188:191]
s_add_u32 m0, s22, 2112
v_exp_f32 v87, v87
v_smfmac_f32_16x16x64_bf16 a[240:243], a[252:255], v[32:39], v92
v_cvt_pk_bf16_f32 v43, v86, v87
v_mfma_f32_16x16x32_bf16 v[68:71], a[144:147], a[48:51], v[60:63]
buffer_load_dwordx4 v97, s[8:11], s21 offen offset:0 nt lds
v_mfma_f32_16x16x32_bf16 v[68:71], a[148:151], a[52:55], v[68:71]
v_mfma_f32_16x16x32_bf16 v[68:71], a[152:155], a[56:59], v[68:71]
v_mfma_f32_16x16x32_bf16 v[68:71], a[156:159], a[60:63], v[68:71]
v_mfma_f32_16x16x32_bf16 v[72:75], a[172:175], a[60:63], v[60:63]
v_mfma_f32_16x16x32_bf16 v[72:75], a[168:171], a[56:59], v[72:75]
v_mfma_f32_16x16x32_bf16 v[72:75], a[164:167], a[52:55], v[72:75]
v_mfma_f32_16x16x32_bf16 v[72:75], a[160:163], a[48:51], v[72:75]
v_mfma_f32_16x16x32_bf16 v[76:79], a[112:115], a[48:51], v[60:63]
v_mfma_f32_16x16x32_bf16 v[76:79], a[116:119], a[52:55], v[76:79]
v_mfma_f32_16x16x32_bf16 v[76:79], a[120:123], a[56:59], v[76:79]
v_mfma_f32_16x16x32_bf16 v[76:79], a[124:127], a[60:63], v[76:79]
v_exp_f32 v68, v68
v_mfma_f32_16x16x32_bf16 v[80:83], a[140:143], a[60:63], v[60:63]
v_exp_f32 v69, v69
v_mfma_f32_16x16x32_bf16 v[80:83], a[136:139], a[56:59], v[80:83]
v_exp_f32 v70, v70
v_mfma_f32_16x16x32_bf16 v[80:83], a[132:135], a[52:55], v[80:83]
s_xor_b32 s21, s23, 15360
v_exp_f32 v71, v71
v_mfma_f32_16x16x32_bf16 v[80:83], a[128:131], a[48:51], v[80:83]
s_add_u32 m0, s22, 3168
v_cvt_pk_bf16_f32 v36, v68, v69
v_cvt_pk_bf16_f32 v37, v70, v71
v_mfma_f32_16x16x32_bf16 v[192:195], a[208:211], v[44:47], v[192:195]
v_exp_f32 v72, v72
v_mfma_f32_16x16x32_bf16 v[192:195], a[176:179], v[40:43], v[192:195]
buffer_load_dwordx4 v97, s[8:11], s21 offen offset:0 nt lds
v_mfma_f32_16x16x32_bf16 v[196:199], a[180:183], v[40:43], v[196:199]
v_exp_f32 v73, v73
v_mfma_f32_16x16x32_bf16 v[196:199], a[212:215], v[44:47], v[196:199]
v_exp_f32 v74, v74
v_mfma_f32_16x16x32_bf16 v[200:203], a[216:219], v[44:47], v[200:203]
v_exp_f32 v75, v75
v_mfma_f32_16x16x32_bf16 v[200:203], a[184:187], v[40:43], v[200:203]
v_cvt_pk_bf16_f32 v38, v72, v73
v_cvt_pk_bf16_f32 v39, v74, v75
v_mfma_f32_16x16x32_bf16 v[204:207], a[188:191], v[40:43], v[204:207]
v_exp_f32 v76, v76
v_mfma_f32_16x16x32_bf16 v[204:207], a[220:223], v[44:47], v[204:207]
v_exp_f32 v77, v77
v_mfma_f32_16x16x32_bf16 v[208:211], a[224:227], v[44:47], v[208:211]
v_exp_f32 v78, v78
v_mfma_f32_16x16x32_bf16 v[208:211], a[192:195], v[40:43], v[208:211]
v_exp_f32 v79, v79
v_mfma_f32_16x16x32_bf16 v[212:215], a[196:199], v[40:43], v[212:215]
v_exp_f32 v80, v80
v_mfma_f32_16x16x32_bf16 v[212:215], a[228:231], v[44:47], v[212:215]
v_exp_f32 v81, v81
v_mfma_f32_16x16x32_bf16 v[216:219], a[232:235], v[44:47], v[216:219]
v_exp_f32 v82, v82
v_mfma_f32_16x16x32_bf16 v[216:219], a[200:203], v[40:43], v[216:219]
v_exp_f32 v83, v83
v_mfma_f32_16x16x32_bf16 v[220:223], a[204:207], v[40:43], v[220:223]
s_waitcnt vmcnt(4)
s_barrier
v_mfma_f32_16x16x32_bf16 v[220:223], a[236:239], v[44:47], v[220:223]
s_xor_b32 s21, s23, 3072
v_cvt_pk_bf16_f32 v32, v76, v77
v_cvt_pk_bf16_f32 v33, v78, v79
v_smfmac_f32_16x16x64_bf16 a[244:247], a[248:251], v[40:47], v92
s_add_u32 m0, s22, 50688
v_cvt_pk_bf16_f32 v34, v80, v81
v_mfma_f32_16x16x32_bf16 v[84:87], a[112:115], a[64:67], v[64:67]
ds_read_b128 a[144:147], v89 offset:33792
v_cvt_pk_bf16_f32 v35, v82, v83
v_mfma_f32_16x16x32_bf16 v[84:87], a[116:119], a[68:71], v[84:87]
buffer_load_dwordx4 v97, s[12:15], s21 offen offset:0 nt lds
v_mfma_f32_16x16x32_bf16 v[84:87], a[120:123], a[72:75], v[84:87]
ds_read_b128 a[148:151], v89 offset:33856
v_mfma_f32_16x16x32_bf16 v[84:87], a[124:127], a[76:79], v[84:87]
ds_read_b128 a[152:155], v89 offset:33920
v_mfma_f32_16x16x32_bf16 v[68:71], a[140:143], a[76:79], v[64:67]
ds_read_b128 a[156:159], v89 offset:33984
v_mfma_f32_16x16x32_bf16 v[68:71], a[136:139], a[72:75], v[68:71]
ds_read_b128 a[172:175], v89 offset:34496
v_mfma_f32_16x16x32_bf16 v[68:71], a[132:135], a[68:71], v[68:71]
ds_read_b128 a[168:171], v89 offset:34432
v_mfma_f32_16x16x32_bf16 v[68:71], a[128:131], a[64:67], v[68:71]
v_exp_f32 v84, v84
v_mfma_f32_16x16x32_bf16 v[224:227], a[208:211], v[36:39], v[224:227]
v_exp_f32 v85, v85
v_mfma_f32_16x16x32_bf16 v[224:227], a[176:179], v[32:35], v[224:227]
ds_read_b128 a[164:167], v89 offset:34368
v_cvt_pk_bf16_f32 v40, v84, v85
v_mfma_f32_16x16x32_bf16 v[228:231], a[180:183], v[32:35], v[228:231]
v_exp_f32 v86, v86
v_mfma_f32_16x16x32_bf16 v[228:231], a[212:215], v[36:39], v[228:231]
v_exp_f32 v87, v87
v_mfma_f32_16x16x32_bf16 v[232:235], a[216:219], v[36:39], v[232:235]
ds_read_b128 a[160:163], v89 offset:34304
v_cvt_pk_bf16_f32 v41, v86, v87
v_mfma_f32_16x16x32_bf16 v[232:235], a[184:187], v[32:35], v[232:235]
v_exp_f32 v68, v68
v_mfma_f32_16x16x32_bf16 v[236:239], a[188:191], v[32:35], v[236:239]
v_exp_f32 v69, v69
v_mfma_f32_16x16x32_bf16 v[236:239], a[220:223], v[36:39], v[236:239]
ds_read_b128 a[112:115], v88 offset:33792
v_cvt_pk_bf16_f32 v42, v68, v69
v_mfma_f32_16x16x32_bf16 v[240:243], a[224:227], v[36:39], v[240:243]
s_xor_b32 s21, s23, 7168
v_exp_f32 v70, v70
v_mfma_f32_16x16x32_bf16 v[240:243], a[192:195], v[32:35], v[240:243]
s_add_u32 m0, s22, 51744
v_exp_f32 v71, v71
v_mfma_f32_16x16x32_bf16 v[244:247], a[196:199], v[32:35], v[244:247]
ds_read_b128 a[116:119], v88 offset:33856
v_cvt_pk_bf16_f32 v43, v70, v71
v_mfma_f32_16x16x32_bf16 v[244:247], a[228:231], v[36:39], v[244:247]
buffer_load_dwordx4 v97, s[12:15], s21 offen offset:0 nt lds
v_mfma_f32_16x16x32_bf16 v[248:251], a[232:235], v[36:39], v[248:251]
ds_read_b128 a[120:123], v88 offset:33920
v_mfma_f32_16x16x32_bf16 v[248:251], a[200:203], v[32:35], v[248:251]
ds_read_b128 a[124:127], v88 offset:33984
v_mfma_f32_16x16x32_bf16 v[252:255], a[204:207], v[32:35], v[252:255]
ds_read_b128 a[140:143], v88 offset:34496
v_mfma_f32_16x16x32_bf16 v[252:255], a[236:239], v[36:39], v[252:255]
ds_read_b128 a[136:139], v88 offset:34432
v_smfmac_f32_16x16x64_bf16 a[244:247], a[252:255], v[32:39], v92
s_waitcnt lgkmcnt(5)
ds_read_b128 a[132:135], v88 offset:34368
v_mfma_f32_16x16x32_bf16 v[72:75], a[144:147], a[0:3], v[48:51]
ds_read_b128 a[128:131], v88 offset:34304
v_mfma_f32_16x16x32_bf16 v[72:75], a[148:151], a[4:7], v[72:75]
ds_read_b64_tr_b16 a[208:209], v91 offset:33792
ds_read_b64_tr_b16 a[210:211], v91 offset:34304
v_mfma_f32_16x16x32_bf16 v[72:75], a[152:155], a[8:11], v[72:75]
ds_read_b64_tr_b16 a[212:213], v91 offset:33824
v_mfma_f32_16x16x32_bf16 v[72:75], a[156:159], a[12:15], v[72:75]
ds_read_b64_tr_b16 a[214:215], v91 offset:34336
ds_read_b64_tr_b16 a[216:217], v91 offset:33856
v_mfma_f32_16x16x32_bf16 v[76:79], a[172:175], a[12:15], v[48:51]
ds_read_b64_tr_b16 a[218:219], v91 offset:34368
v_mfma_f32_16x16x32_bf16 v[76:79], a[168:171], a[8:11], v[76:79]
ds_read_b64_tr_b16 a[220:221], v91 offset:33888
ds_read_b64_tr_b16 a[222:223], v91 offset:34400
v_mfma_f32_16x16x32_bf16 v[76:79], a[164:167], a[4:7], v[76:79]
ds_read_b64_tr_b16 a[224:225], v91 offset:33920
v_mfma_f32_16x16x32_bf16 v[76:79], a[160:163], a[0:3], v[76:79]
s_waitcnt lgkmcnt(10)
v_exp_f32 v72, v72
v_mfma_f32_16x16x32_bf16 v[80:83], a[112:115], a[0:3], v[48:51]
s_xor_b32 s21, s23, 11264
v_exp_f32 v73, v73
v_mfma_f32_16x16x32_bf16 v[80:83], a[116:119], a[4:7], v[80:83]
s_add_u32 m0, s22, 52800
v_exp_f32 v74, v74
v_mfma_f32_16x16x32_bf16 v[80:83], a[120:123], a[8:11], v[80:83]
v_exp_f32 v75, v75
v_mfma_f32_16x16x32_bf16 v[80:83], a[124:127], a[12:15], v[80:83]
buffer_load_dwordx4 v97, s[12:15], s21 offen offset:0 nt lds
v_mfma_f32_16x16x32_bf16 v[84:87], a[140:143], a[12:15], v[48:51]
v_cvt_pk_bf16_f32 v36, v72, v73
v_cvt_pk_bf16_f32 v37, v74, v75
v_mfma_f32_16x16x32_bf16 v[84:87], a[136:139], a[8:11], v[84:87]
v_exp_f32 v76, v76
v_mfma_f32_16x16x32_bf16 v[84:87], a[132:135], a[4:7], v[84:87]
s_waitcnt lgkmcnt(0)
v_exp_f32 v77, v77
v_mfma_f32_16x16x32_bf16 v[84:87], a[128:131], a[0:3], v[84:87]
v_exp_f32 v78, v78
v_mfma_f32_16x16x32_bf16 v[104:107], a[248:251], v[40:43], v[104:107]
v_exp_f32 v79, v79
v_mfma_f32_16x16x32_bf16 a[80:83], a[176:179], v[40:43], a[80:83]
v_cvt_pk_bf16_f32 v38, v76, v77
v_cvt_pk_bf16_f32 v39, v78, v79
v_mfma_f32_16x16x32_bf16 a[84:87], a[180:183], v[40:43], a[84:87]
v_exp_f32 v80, v80
v_mfma_f32_16x16x32_bf16 a[88:91], a[184:187], v[40:43], a[88:91]
v_exp_f32 v81, v81
v_mfma_f32_16x16x32_bf16 a[92:95], a[188:191], v[40:43], a[92:95]
v_exp_f32 v82, v82
v_mfma_f32_16x16x32_bf16 a[96:99], a[192:195], v[40:43], a[96:99]
v_exp_f32 v83, v83
v_mfma_f32_16x16x32_bf16 a[100:103], a[196:199], v[40:43], a[100:103]
ds_read_b64_tr_b16 a[176:177], v90 offset:33792
ds_read_b64_tr_b16 a[178:179], v90 offset:34304
v_mfma_f32_16x16x32_bf16 a[104:107], a[200:203], v[40:43], a[104:107]
v_cvt_pk_bf16_f32 v32, v80, v81
v_cvt_pk_bf16_f32 v33, v82, v83
v_mfma_f32_16x16x32_bf16 a[108:111], a[204:207], v[40:43], a[108:111]
ds_read_b64_tr_b16 a[180:181], v90 offset:33824
ds_read_b64_tr_b16 a[182:183], v90 offset:34336
v_mfma_f32_16x16x32_bf16 v[68:71], a[144:147], a[16:19], v[52:55]
s_xor_b32 s21, s23, 15360
v_exp_f32 v84, v84
v_mfma_f32_16x16x32_bf16 v[68:71], a[148:151], a[20:23], v[68:71]
s_add_u32 m0, s22, 53856
v_exp_f32 v85, v85
v_mfma_f32_16x16x32_bf16 v[68:71], a[152:155], a[24:27], v[68:71]
v_exp_f32 v86, v86
v_mfma_f32_16x16x32_bf16 v[68:71], a[156:159], a[28:31], v[68:71]
buffer_load_dwordx4 v97, s[12:15], s21 offen offset:0 nt lds
v_mfma_f32_16x16x32_bf16 v[72:75], a[172:175], a[28:31], v[52:55]
v_exp_f32 v87, v87
v_mfma_f32_16x16x32_bf16 v[72:75], a[168:171], a[24:27], v[72:75]
ds_read_b64_tr_b16 a[184:185], v90 offset:33856
ds_read_b64_tr_b16 a[186:187], v90 offset:34368
v_mfma_f32_16x16x32_bf16 v[72:75], a[164:167], a[20:23], v[72:75]
v_cvt_pk_bf16_f32 v34, v84, v85
v_cvt_pk_bf16_f32 v35, v86, v87
v_mfma_f32_16x16x32_bf16 v[72:75], a[160:163], a[16:19], v[72:75]
ds_read_b64_tr_b16 a[188:189], v90 offset:33888
ds_read_b64_tr_b16 a[190:191], v90 offset:34400
v_mfma_f32_16x16x32_bf16 v[76:79], a[112:115], a[16:19], v[52:55]
v_exp_f32 v68, v68
v_mfma_f32_16x16x32_bf16 v[76:79], a[116:119], a[20:23], v[76:79]
ds_read_b64_tr_b16 a[226:227], v91 offset:34432
ds_read_b64_tr_b16 a[192:193], v90 offset:33920
v_mfma_f32_16x16x32_bf16 v[76:79], a[120:123], a[24:27], v[76:79]
v_exp_f32 v69, v69
v_mfma_f32_16x16x32_bf16 v[76:79], a[124:127], a[28:31], v[76:79]
ds_read_b64_tr_b16 a[194:195], v90 offset:34432
ds_read_b64_tr_b16 a[196:197], v90 offset:33952
v_mfma_f32_16x16x32_bf16 v[80:83], a[140:143], a[28:31], v[52:55]
ds_read_b64_tr_b16 a[198:199], v90 offset:34464
v_cvt_pk_bf16_f32 v44, v68, v69
v_mfma_f32_16x16x32_bf16 v[80:83], a[136:139], a[24:27], v[80:83]
ds_read_b64_tr_b16 a[228:229], v91 offset:33952
ds_read_b64_tr_b16 a[230:231], v91 offset:34464
v_mfma_f32_16x16x32_bf16 v[80:83], a[132:135], a[20:23], v[80:83]
v_exp_f32 v70, v70
v_mfma_f32_16x16x32_bf16 v[80:83], a[128:131], a[16:19], v[80:83]
ds_read_b64_tr_b16 a[232:233], v91 offset:33984
ds_read_b64_tr_b16 a[234:235], v91 offset:34496
v_mfma_f32_16x16x32_bf16 v[128:131], a[208:211], v[36:39], v[128:131]
s_waitcnt lgkmcnt(9)
v_exp_f32 v71, v71
v_mfma_f32_16x16x32_bf16 v[128:131], a[176:179], v[32:35], v[128:131]
s_add_u32 s37, s31, 73728
ds_read_b64_tr_b16 a[200:201], v90 offset:33984
ds_read_b64_tr_b16 a[202:203], v90 offset:34496
v_mfma_f32_16x16x32_bf16 v[132:135], a[180:183], v[32:35], v[132:135]
s_add_u32 m0, s24, 0
ds_read_b64_tr_b16 a[204:205], v90 offset:34016
v_cvt_pk_bf16_f32 v45, v70, v71
v_mfma_f32_16x16x32_bf16 v[132:135], a[212:215], v[36:39], v[132:135]
ds_read_b64_tr_b16 a[206:207], v90 offset:34528
ds_read_b64_tr_b16 a[236:237], v91 offset:34016
v_mfma_f32_16x16x32_bf16 v[136:139], a[216:219], v[36:39], v[136:139]
buffer_load_dwordx4 v96, s[4:7], s37 offen offset:0 nt lds
v_mfma_f32_16x16x32_bf16 v[136:139], a[184:187], v[32:35], v[136:139]
v_exp_f32 v72, v72
v_mfma_f32_16x16x32_bf16 v[140:143], a[188:191], v[32:35], v[140:143]
v_exp_f32 v73, v73
v_mfma_f32_16x16x32_bf16 v[140:143], a[220:223], v[36:39], v[140:143]
s_waitcnt lgkmcnt(5)
ds_read_b64_tr_b16 a[238:239], v91 offset:34528
v_cvt_pk_bf16_f32 v46, v72, v73
v_mfma_f32_16x16x32_bf16 v[144:147], a[224:227], v[36:39], v[144:147]
v_exp_f32 v74, v74
v_mfma_f32_16x16x32_bf16 v[144:147], a[192:195], v[32:35], v[144:147]
v_exp_f32 v75, v75
v_mfma_f32_16x16x32_bf16 v[148:151], a[196:199], v[32:35], v[148:151]
v_exp_f32 v76, v76
v_mfma_f32_16x16x32_bf16 v[148:151], a[228:231], v[36:39], v[148:151]
v_exp_f32 v77, v77
v_mfma_f32_16x16x32_bf16 v[152:155], a[232:235], v[36:39], v[152:155]
s_waitcnt lgkmcnt(1)
v_cvt_pk_bf16_f32 v47, v74, v75
v_cvt_pk_bf16_f32 v40, v76, v77
v_mfma_f32_16x16x32_bf16 v[152:155], a[200:203], v[32:35], v[152:155]
v_exp_f32 v78, v78
v_mfma_f32_16x16x32_bf16 v[156:159], a[204:207], v[32:35], v[156:159]
s_waitcnt lgkmcnt(0)
v_exp_f32 v79, v79
v_mfma_f32_16x16x32_bf16 v[156:159], a[236:239], v[36:39], v[156:159]
v_exp_f32 v80, v80
v_smfmac_f32_16x16x64_bf16 a[240:243], a[248:251], v[32:39], v92
v_cvt_pk_bf16_f32 v41, v78, v79
v_mfma_f32_16x16x32_bf16 v[84:87], a[144:147], a[32:35], v[56:59]
v_exp_f32 v81, v81
v_mfma_f32_16x16x32_bf16 v[84:87], a[148:151], a[36:39], v[84:87]
s_xor_b32 s21, s23, 16384
v_exp_f32 v82, v82
v_mfma_f32_16x16x32_bf16 v[84:87], a[152:155], a[40:43], v[84:87]
s_add_u32 m0, s22, 16896
v_exp_f32 v83, v83
v_mfma_f32_16x16x32_bf16 v[84:87], a[156:159], a[44:47], v[84:87]
v_cvt_pk_bf16_f32 v42, v80, v81
v_cvt_pk_bf16_f32 v43, v82, v83
v_mfma_f32_16x16x32_bf16 v[68:71], a[172:175], a[44:47], v[56:59]
buffer_load_dwordx4 v97, s[8:11], s21 offen offset:0 nt lds
v_mfma_f32_16x16x32_bf16 v[68:71], a[168:171], a[40:43], v[68:71]
v_mfma_f32_16x16x32_bf16 v[68:71], a[164:167], a[36:39], v[68:71]
v_mfma_f32_16x16x32_bf16 v[68:71], a[160:163], a[32:35], v[68:71]
v_mfma_f32_16x16x32_bf16 v[72:75], a[112:115], a[32:35], v[56:59]
v_exp_f32 v84, v84
v_mfma_f32_16x16x32_bf16 v[72:75], a[116:119], a[36:39], v[72:75]
v_exp_f32 v85, v85
v_mfma_f32_16x16x32_bf16 v[72:75], a[120:123], a[40:43], v[72:75]
v_exp_f32 v86, v86
v_mfma_f32_16x16x32_bf16 v[72:75], a[124:127], a[44:47], v[72:75]
v_exp_f32 v87, v87
v_mfma_f32_16x16x32_bf16 v[76:79], a[140:143], a[44:47], v[56:59]
v_cvt_pk_bf16_f32 v36, v84, v85
v_cvt_pk_bf16_f32 v37, v86, v87
v_mfma_f32_16x16x32_bf16 v[76:79], a[136:139], a[40:43], v[76:79]
v_exp_f32 v68, v68
v_mfma_f32_16x16x32_bf16 v[76:79], a[132:135], a[36:39], v[76:79]
v_exp_f32 v69, v69
v_mfma_f32_16x16x32_bf16 v[76:79], a[128:131], a[32:35], v[76:79]
v_exp_f32 v70, v70
v_mfma_f32_16x16x32_bf16 v[160:163], a[208:211], v[44:47], v[160:163]
v_exp_f32 v71, v71
v_mfma_f32_16x16x32_bf16 v[160:163], a[176:179], v[40:43], v[160:163]
v_cvt_pk_bf16_f32 v38, v68, v69
v_cvt_pk_bf16_f32 v39, v70, v71
v_mfma_f32_16x16x32_bf16 v[164:167], a[180:183], v[40:43], v[164:167]
s_xor_b32 s21, s23, 20480
v_exp_f32 v72, v72
v_mfma_f32_16x16x32_bf16 v[164:167], a[212:215], v[44:47], v[164:167]
s_add_u32 m0, s22, 17952
v_exp_f32 v73, v73
v_mfma_f32_16x16x32_bf16 v[168:171], a[216:219], v[44:47], v[168:171]
v_exp_f32 v74, v74
v_mfma_f32_16x16x32_bf16 v[168:171], a[184:187], v[40:43], v[168:171]
buffer_load_dwordx4 v97, s[8:11], s21 offen offset:0 nt lds
v_mfma_f32_16x16x32_bf16 v[172:175], a[188:191], v[40:43], v[172:175]
v_exp_f32 v75, v75
v_mfma_f32_16x16x32_bf16 v[172:175], a[220:223], v[44:47], v[172:175]
v_cvt_pk_bf16_f32 v32, v72, v73
v_cvt_pk_bf16_f32 v33, v74, v75
v_mfma_f32_16x16x32_bf16 v[176:179], a[224:227], v[44:47], v[176:179]
v_exp_f32 v76, v76
v_mfma_f32_16x16x32_bf16 v[176:179], a[192:195], v[40:43], v[176:179]
v_exp_f32 v77, v77
v_mfma_f32_16x16x32_bf16 v[180:183], a[196:199], v[40:43], v[180:183]
v_exp_f32 v78, v78
v_mfma_f32_16x16x32_bf16 v[180:183], a[228:231], v[44:47], v[180:183]
v_exp_f32 v79, v79
v_mfma_f32_16x16x32_bf16 v[184:187], a[232:235], v[44:47], v[184:187]
v_cvt_pk_bf16_f32 v34, v76, v77
v_cvt_pk_bf16_f32 v35, v78, v79
v_mfma_f32_16x16x32_bf16 v[184:187], a[200:203], v[40:43], v[184:187]
v_mfma_f32_16x16x32_bf16 v[188:191], a[204:207], v[40:43], v[188:191]
v_mfma_f32_16x16x32_bf16 v[188:191], a[236:239], v[44:47], v[188:191]
v_smfmac_f32_16x16x64_bf16 a[240:243], a[252:255], v[40:47], v92
v_mfma_f32_16x16x32_bf16 v[80:83], a[144:147], a[48:51], v[60:63]
v_mfma_f32_16x16x32_bf16 v[80:83], a[148:151], a[52:55], v[80:83]
v_mfma_f32_16x16x32_bf16 v[80:83], a[152:155], a[56:59], v[80:83]
s_xor_b32 s21, s23, 24576
v_mfma_f32_16x16x32_bf16 v[80:83], a[156:159], a[60:63], v[80:83]
s_add_u32 m0, s22, 19008
v_mfma_f32_16x16x32_bf16 v[84:87], a[172:175], a[60:63], v[60:63]
v_mfma_f32_16x16x32_bf16 v[84:87], a[168:171], a[56:59], v[84:87]
buffer_load_dwordx4 v97, s[8:11], s21 offen offset:0 nt lds
v_mfma_f32_16x16x32_bf16 v[84:87], a[164:167], a[52:55], v[84:87]
v_mfma_f32_16x16x32_bf16 v[84:87], a[160:163], a[48:51], v[84:87]
v_mfma_f32_16x16x32_bf16 v[68:71], a[112:115], a[48:51], v[60:63]
v_mfma_f32_16x16x32_bf16 v[68:71], a[116:119], a[52:55], v[68:71]
v_exp_f32 v80, v80
v_mfma_f32_16x16x32_bf16 v[68:71], a[120:123], a[56:59], v[68:71]
v_exp_f32 v81, v81
v_mfma_f32_16x16x32_bf16 v[68:71], a[124:127], a[60:63], v[68:71]
v_exp_f32 v82, v82
v_mfma_f32_16x16x32_bf16 v[72:75], a[140:143], a[60:63], v[60:63]
v_exp_f32 v83, v83
v_mfma_f32_16x16x32_bf16 v[72:75], a[136:139], a[56:59], v[72:75]
v_cvt_pk_bf16_f32 v44, v80, v81
v_cvt_pk_bf16_f32 v45, v82, v83
v_mfma_f32_16x16x32_bf16 v[72:75], a[132:135], a[52:55], v[72:75]
v_exp_f32 v84, v84
v_mfma_f32_16x16x32_bf16 v[72:75], a[128:131], a[48:51], v[72:75]
v_exp_f32 v85, v85
v_mfma_f32_16x16x32_bf16 v[192:195], a[208:211], v[36:39], v[192:195]
v_exp_f32 v86, v86
v_mfma_f32_16x16x32_bf16 v[192:195], a[176:179], v[32:35], v[192:195]
v_exp_f32 v87, v87
v_mfma_f32_16x16x32_bf16 v[196:199], a[180:183], v[32:35], v[196:199]
v_cvt_pk_bf16_f32 v46, v84, v85
v_cvt_pk_bf16_f32 v47, v86, v87
v_mfma_f32_16x16x32_bf16 v[196:199], a[212:215], v[36:39], v[196:199]
s_xor_b32 s21, s23, 28672
v_exp_f32 v68, v68
v_mfma_f32_16x16x32_bf16 v[200:203], a[216:219], v[36:39], v[200:203]
s_add_u32 m0, s22, 20064
v_exp_f32 v69, v69
v_mfma_f32_16x16x32_bf16 v[200:203], a[184:187], v[32:35], v[200:203]
v_exp_f32 v70, v70
v_mfma_f32_16x16x32_bf16 v[204:207], a[188:191], v[32:35], v[204:207]
buffer_load_dwordx4 v97, s[8:11], s21 offen offset:0 nt lds
v_mfma_f32_16x16x32_bf16 v[204:207], a[220:223], v[36:39], v[204:207]
v_exp_f32 v71, v71
v_mfma_f32_16x16x32_bf16 v[208:211], a[224:227], v[36:39], v[208:211]
v_exp_f32 v72, v72
v_mfma_f32_16x16x32_bf16 v[208:211], a[192:195], v[32:35], v[208:211]
v_exp_f32 v73, v73
v_mfma_f32_16x16x32_bf16 v[212:215], a[196:199], v[32:35], v[212:215]
v_exp_f32 v74, v74
v_mfma_f32_16x16x32_bf16 v[212:215], a[228:231], v[36:39], v[212:215]
v_exp_f32 v75, v75
v_mfma_f32_16x16x32_bf16 v[216:219], a[232:235], v[36:39], v[216:219]
v_cvt_pk_bf16_f32 v40, v68, v69
v_cvt_pk_bf16_f32 v41, v70, v71
v_mfma_f32_16x16x32_bf16 v[216:219], a[200:203], v[32:35], v[216:219]
v_cvt_pk_bf16_f32 v42, v72, v73
v_cvt_pk_bf16_f32 v43, v74, v75
v_mfma_f32_16x16x32_bf16 v[220:223], a[204:207], v[32:35], v[220:223]
s_waitcnt vmcnt(5)
s_barrier
v_mfma_f32_16x16x32_bf16 v[220:223], a[236:239], v[36:39], v[220:223]
ds_read_b128 a[144:147], v89 offset:0
v_smfmac_f32_16x16x64_bf16 a[244:247], a[248:251], v[32:39], v92
ds_read_b128 a[148:151], v89 offset:64
v_mfma_f32_16x16x32_bf16 v[76:79], a[112:115], a[64:67], v[64:67]
ds_read_b128 a[152:155], v89 offset:128
v_mfma_f32_16x16x32_bf16 v[76:79], a[116:119], a[68:71], v[76:79]
ds_read_b128 a[156:159], v89 offset:192
v_mfma_f32_16x16x32_bf16 v[76:79], a[120:123], a[72:75], v[76:79]
ds_read_b128 a[172:175], v89 offset:704
v_mfma_f32_16x16x32_bf16 v[76:79], a[124:127], a[76:79], v[76:79]
s_xor_b32 s21, s23, 16384
ds_read_b128 a[168:171], v89 offset:640
v_mfma_f32_16x16x32_bf16 v[80:83], a[140:143], a[76:79], v[64:67]
s_add_u32 m0, s22, 67584
ds_read_b128 a[164:167], v89 offset:576
v_mfma_f32_16x16x32_bf16 v[80:83], a[136:139], a[72:75], v[80:83]
ds_read_b128 a[160:163], v89 offset:512
v_mfma_f32_16x16x32_bf16 v[80:83], a[132:135], a[68:71], v[80:83]
buffer_load_dwordx4 v97, s[12:15], s21 offen offset:0 nt lds
v_mfma_f32_16x16x32_bf16 v[80:83], a[128:131], a[64:67], v[80:83]
v_exp_f32 v76, v76
v_mfma_f32_16x16x32_bf16 v[224:227], a[208:211], v[44:47], v[224:227]
v_exp_f32 v77, v77
v_mfma_f32_16x16x32_bf16 v[224:227], a[176:179], v[40:43], v[224:227]
ds_read_b128 a[112:115], v88 offset:0
v_cvt_pk_bf16_f32 v32, v76, v77
v_mfma_f32_16x16x32_bf16 v[228:231], a[180:183], v[40:43], v[228:231]
v_exp_f32 v78, v78
v_mfma_f32_16x16x32_bf16 v[228:231], a[212:215], v[44:47], v[228:231]
v_exp_f32 v79, v79
v_mfma_f32_16x16x32_bf16 v[232:235], a[216:219], v[44:47], v[232:235]
ds_read_b128 a[116:119], v88 offset:64
v_cvt_pk_bf16_f32 v33, v78, v79
v_mfma_f32_16x16x32_bf16 v[232:235], a[184:187], v[40:43], v[232:235]
v_exp_f32 v80, v80
v_mfma_f32_16x16x32_bf16 v[236:239], a[188:191], v[40:43], v[236:239]
v_exp_f32 v81, v81
v_mfma_f32_16x16x32_bf16 v[236:239], a[220:223], v[44:47], v[236:239]
ds_read_b128 a[120:123], v88 offset:128
v_cvt_pk_bf16_f32 v34, v80, v81
v_mfma_f32_16x16x32_bf16 v[240:243], a[224:227], v[44:47], v[240:243]
v_exp_f32 v82, v82
v_mfma_f32_16x16x32_bf16 v[240:243], a[192:195], v[40:43], v[240:243]
v_exp_f32 v83, v83
v_mfma_f32_16x16x32_bf16 v[244:247], a[196:199], v[40:43], v[244:247]
ds_read_b128 a[124:127], v88 offset:192
v_cvt_pk_bf16_f32 v35, v82, v83
v_mfma_f32_16x16x32_bf16 v[244:247], a[228:231], v[44:47], v[244:247]
ds_read_b128 a[140:143], v88 offset:704
v_mfma_f32_16x16x32_bf16 v[248:251], a[232:235], v[44:47], v[248:251]
s_xor_b32 s21, s23, 20480
ds_read_b128 a[136:139], v88 offset:640
v_mfma_f32_16x16x32_bf16 v[248:251], a[200:203], v[40:43], v[248:251]
s_add_u32 m0, s22, 68640
ds_read_b128 a[132:135], v88 offset:576
v_mfma_f32_16x16x32_bf16 v[252:255], a[204:207], v[40:43], v[252:255]
ds_read_b128 a[128:131], v88 offset:512
v_mfma_f32_16x16x32_bf16 v[252:255], a[236:239], v[44:47], v[252:255]
buffer_load_dwordx4 v97, s[12:15], s21 offen offset:0 nt lds
v_smfmac_f32_16x16x64_bf16 a[244:247], a[252:255], v[40:47], v92
s_waitcnt lgkmcnt(5)
ds_read_b64_tr_b16 a[208:209], v91 offset:0
v_mfma_f32_16x16x32_bf16 v[84:87], a[144:147], a[0:3], v[48:51]
ds_read_b64_tr_b16 a[210:211], v91 offset:512
ds_read_b64_tr_b16 a[212:213], v91 offset:32
v_mfma_f32_16x16x32_bf16 v[84:87], a[148:151], a[4:7], v[84:87]
ds_read_b64_tr_b16 a[214:215], v91 offset:544
v_mfma_f32_16x16x32_bf16 v[84:87], a[152:155], a[8:11], v[84:87]
ds_read_b64_tr_b16 a[216:217], v91 offset:64
ds_read_b64_tr_b16 a[218:219], v91 offset:576
v_mfma_f32_16x16x32_bf16 v[84:87], a[156:159], a[12:15], v[84:87]
ds_read_b64_tr_b16 a[220:221], v91 offset:96
v_mfma_f32_16x16x32_bf16 v[68:71], a[172:175], a[12:15], v[48:51]
ds_read_b64_tr_b16 a[222:223], v91 offset:608
ds_read_b64_tr_b16 a[224:225], v91 offset:128
v_mfma_f32_16x16x32_bf16 v[68:71], a[168:171], a[8:11], v[68:71]
ds_read_b64_tr_b16 a[226:227], v91 offset:640
v_mfma_f32_16x16x32_bf16 v[68:71], a[164:167], a[4:7], v[68:71]
ds_read_b64_tr_b16 a[228:229], v91 offset:160
ds_read_b64_tr_b16 a[230:231], v91 offset:672
v_mfma_f32_16x16x32_bf16 v[68:71], a[160:163], a[0:3], v[68:71]
v_exp_f32 v84, v84
v_mfma_f32_16x16x32_bf16 v[72:75], a[112:115], a[0:3], v[48:51]
v_exp_f32 v85, v85
v_mfma_f32_16x16x32_bf16 v[72:75], a[116:119], a[4:7], v[72:75]
v_exp_f32 v86, v86
v_mfma_f32_16x16x32_bf16 v[72:75], a[120:123], a[8:11], v[72:75]
s_waitcnt lgkmcnt(6)
v_exp_f32 v87, v87
v_mfma_f32_16x16x32_bf16 v[72:75], a[124:127], a[12:15], v[72:75]
v_cvt_pk_bf16_f32 v44, v84, v85
v_cvt_pk_bf16_f32 v45, v86, v87
v_mfma_f32_16x16x32_bf16 v[76:79], a[140:143], a[12:15], v[48:51]
s_xor_b32 s21, s23, 24576
v_exp_f32 v68, v68
v_mfma_f32_16x16x32_bf16 v[76:79], a[136:139], a[8:11], v[76:79]
s_add_u32 m0, s22, 69696
v_exp_f32 v69, v69
v_mfma_f32_16x16x32_bf16 v[76:79], a[132:135], a[4:7], v[76:79]
v_exp_f32 v70, v70
v_mfma_f32_16x16x32_bf16 v[76:79], a[128:131], a[0:3], v[76:79]
buffer_load_dwordx4 v97, s[12:15], s21 offen offset:0 nt lds
v_mfma_f32_16x16x32_bf16 v[104:107], a[248:251], v[32:35], v[104:107]
v_exp_f32 v71, v71
v_mfma_f32_16x16x32_bf16 a[80:83], a[176:179], v[32:35], a[80:83]
v_cvt_pk_bf16_f32 v46, v68, v69
v_cvt_pk_bf16_f32 v47, v70, v71
v_mfma_f32_16x16x32_bf16 a[84:87], a[180:183], v[32:35], a[84:87]
v_exp_f32 v72, v72
v_mfma_f32_16x16x32_bf16 a[88:91], a[184:187], v[32:35], a[88:91]
v_exp_f32 v73, v73
v_mfma_f32_16x16x32_bf16 a[92:95], a[188:191], v[32:35], a[92:95]
v_exp_f32 v74, v74
v_mfma_f32_16x16x32_bf16 a[96:99], a[192:195], v[32:35], a[96:99]
v_exp_f32 v75, v75
v_mfma_f32_16x16x32_bf16 a[100:103], a[196:199], v[32:35], a[100:103]
ds_read_b64_tr_b16 a[176:177], v90 offset:0
ds_read_b64_tr_b16 a[178:179], v90 offset:512
v_mfma_f32_16x16x32_bf16 a[104:107], a[200:203], v[32:35], a[104:107]
v_cvt_pk_bf16_f32 v40, v72, v73
v_cvt_pk_bf16_f32 v41, v74, v75
v_mfma_f32_16x16x32_bf16 a[108:111], a[204:207], v[32:35], a[108:111]
ds_read_b64_tr_b16 a[180:181], v90 offset:32
ds_read_b64_tr_b16 a[182:183], v90 offset:544
v_mfma_f32_16x16x32_bf16 v[80:83], a[144:147], a[16:19], v[52:55]
v_exp_f32 v76, v76
v_mfma_f32_16x16x32_bf16 v[80:83], a[148:151], a[20:23], v[80:83]
v_exp_f32 v77, v77
v_mfma_f32_16x16x32_bf16 v[80:83], a[152:155], a[24:27], v[80:83]
v_exp_f32 v78, v78
v_mfma_f32_16x16x32_bf16 v[80:83], a[156:159], a[28:31], v[80:83]
v_exp_f32 v79, v79
v_mfma_f32_16x16x32_bf16 v[84:87], a[172:175], a[28:31], v[52:55]
s_xor_b32 s21, s23, 28672
ds_read_b64_tr_b16 a[184:185], v90 offset:64
ds_read_b64_tr_b16 a[186:187], v90 offset:576
v_mfma_f32_16x16x32_bf16 v[84:87], a[168:171], a[24:27], v[84:87]
s_add_u32 m0, s22, 70752
v_cvt_pk_bf16_f32 v42, v76, v77
v_cvt_pk_bf16_f32 v43, v78, v79
v_mfma_f32_16x16x32_bf16 v[84:87], a[164:167], a[20:23], v[84:87]
ds_read_b64_tr_b16 a[188:189], v90 offset:96
ds_read_b64_tr_b16 a[190:191], v90 offset:608
v_mfma_f32_16x16x32_bf16 v[84:87], a[160:163], a[16:19], v[84:87]
buffer_load_dwordx4 v97, s[12:15], s21 offen offset:0 nt lds
v_mfma_f32_16x16x32_bf16 v[68:71], a[112:115], a[16:19], v[52:55]
ds_read_b64_tr_b16 a[192:193], v90 offset:128
ds_read_b64_tr_b16 a[194:195], v90 offset:640
v_mfma_f32_16x16x32_bf16 v[68:71], a[116:119], a[20:23], v[68:71]
v_exp_f32 v80, v80
v_mfma_f32_16x16x32_bf16 v[68:71], a[120:123], a[24:27], v[68:71]
ds_read_b64_tr_b16 a[196:197], v90 offset:160
ds_read_b64_tr_b16 a[198:199], v90 offset:672
v_mfma_f32_16x16x32_bf16 v[68:71], a[124:127], a[28:31], v[68:71]
v_exp_f32 v81, v81
v_mfma_f32_16x16x32_bf16 v[72:75], a[140:143], a[28:31], v[52:55]
ds_read_b64_tr_b16 a[232:233], v91 offset:192
ds_read_b64_tr_b16 a[234:235], v91 offset:704
v_mfma_f32_16x16x32_bf16 v[72:75], a[136:139], a[24:27], v[72:75]
ds_read_b64_tr_b16 a[200:201], v90 offset:192
v_cvt_pk_bf16_f32 v36, v80, v81
v_mfma_f32_16x16x32_bf16 v[72:75], a[132:135], a[20:23], v[72:75]
ds_read_b64_tr_b16 a[202:203], v90 offset:704
ds_read_b64_tr_b16 a[204:205], v90 offset:224
v_mfma_f32_16x16x32_bf16 v[72:75], a[128:131], a[16:19], v[72:75]
v_exp_f32 v82, v82
v_mfma_f32_16x16x32_bf16 v[128:131], a[208:211], v[44:47], v[128:131]
s_waitcnt lgkmcnt(7)
ds_read_b64_tr_b16 a[206:207], v90 offset:736
ds_read_b64_tr_b16 a[236:237], v91 offset:224
v_mfma_f32_16x16x32_bf16 v[128:131], a[176:179], v[40:43], v[128:131]
v_exp_f32 v83, v83
v_mfma_f32_16x16x32_bf16 v[132:135], a[180:183], v[40:43], v[132:135]
ds_read_b64_tr_b16 a[238:239], v91 offset:736
v_cvt_pk_bf16_f32 v37, v82, v83
v_mfma_f32_16x16x32_bf16 v[132:135], a[212:215], v[44:47], v[132:135]
v_exp_f32 v84, v84
v_mfma_f32_16x16x32_bf16 v[136:139], a[216:219], v[44:47], v[136:139]
v_exp_f32 v85, v85
v_mfma_f32_16x16x32_bf16 v[136:139], a[184:187], v[40:43], v[136:139]
s_add_u32 m0, s24, 32
v_exp_f32 v86, v86
v_mfma_f32_16x16x32_bf16 v[140:143], a[188:191], v[40:43], v[140:143]
v_exp_f32 v87, v87
v_mfma_f32_16x16x32_bf16 v[140:143], a[220:223], v[44:47], v[140:143]
buffer_load_dwordx4 v96, s[4:7], s37 offen offset:1024 nt lds
v_mfma_f32_16x16x32_bf16 v[144:147], a[224:227], v[44:47], v[144:147]
v_cvt_pk_bf16_f32 v38, v84, v85
v_cvt_pk_bf16_f32 v39, v86, v87
v_mfma_f32_16x16x32_bf16 v[144:147], a[192:195], v[40:43], v[144:147]
s_waitcnt lgkmcnt(1)
v_exp_f32 v68, v68
v_mfma_f32_16x16x32_bf16 v[148:151], a[196:199], v[40:43], v[148:151]
v_exp_f32 v69, v69
v_mfma_f32_16x16x32_bf16 v[148:151], a[228:231], v[44:47], v[148:151]
v_exp_f32 v70, v70
v_mfma_f32_16x16x32_bf16 v[152:155], a[232:235], v[44:47], v[152:155]
v_exp_f32 v71, v71
v_mfma_f32_16x16x32_bf16 v[152:155], a[200:203], v[40:43], v[152:155]
v_cvt_pk_bf16_f32 v32, v68, v69
v_cvt_pk_bf16_f32 v33, v70, v71
v_mfma_f32_16x16x32_bf16 v[156:159], a[204:207], v[40:43], v[156:159]
s_waitcnt lgkmcnt(0)
v_exp_f32 v72, v72
v_mfma_f32_16x16x32_bf16 v[156:159], a[236:239], v[44:47], v[156:159]
v_exp_f32 v73, v73
v_smfmac_f32_16x16x64_bf16 a[240:243], a[248:251], v[40:47], v92
v_cvt_pk_bf16_f32 v34, v72, v73
v_mfma_f32_16x16x32_bf16 v[76:79], a[144:147], a[32:35], v[56:59]
v_exp_f32 v74, v74
v_mfma_f32_16x16x32_bf16 v[76:79], a[148:151], a[36:39], v[76:79]
v_exp_f32 v75, v75
v_mfma_f32_16x16x32_bf16 v[76:79], a[152:155], a[40:43], v[76:79]
s_waitcnt vmcnt(9)
ds_read_b128 v[108:111], v99 offset:0
v_cvt_pk_bf16_f32 v35, v74, v75
v_mfma_f32_16x16x32_bf16 v[76:79], a[156:159], a[44:47], v[76:79]
v_mfma_f32_16x16x32_bf16 v[80:83], a[172:175], a[44:47], v[56:59]
s_xor_b32 s21, s23, 17408
v_mfma_f32_16x16x32_bf16 v[80:83], a[168:171], a[40:43], v[80:83]
s_add_u32 m0, s22, 33792
v_mfma_f32_16x16x32_bf16 v[80:83], a[164:167], a[36:39], v[80:83]
v_mfma_f32_16x16x32_bf16 v[80:83], a[160:163], a[32:35], v[80:83]
buffer_load_dwordx4 v97, s[8:11], s21 offen offset:0 nt lds
v_mfma_f32_16x16x32_bf16 v[84:87], a[112:115], a[32:35], v[56:59]
v_exp_f32 v76, v76
v_mfma_f32_16x16x32_bf16 v[84:87], a[116:119], a[36:39], v[84:87]
v_exp_f32 v77, v77
v_mfma_f32_16x16x32_bf16 v[84:87], a[120:123], a[40:43], v[84:87]
v_exp_f32 v78, v78
v_mfma_f32_16x16x32_bf16 v[84:87], a[124:127], a[44:47], v[84:87]
v_exp_f32 v79, v79
v_mfma_f32_16x16x32_bf16 v[68:71], a[140:143], a[44:47], v[56:59]
v_cvt_pk_bf16_f32 v44, v76, v77
v_cvt_pk_bf16_f32 v45, v78, v79
v_mfma_f32_16x16x32_bf16 v[68:71], a[136:139], a[40:43], v[68:71]
v_exp_f32 v80, v80
v_mfma_f32_16x16x32_bf16 v[68:71], a[132:135], a[36:39], v[68:71]
v_exp_f32 v81, v81
v_mfma_f32_16x16x32_bf16 v[68:71], a[128:131], a[32:35], v[68:71]
v_exp_f32 v82, v82
v_mfma_f32_16x16x32_bf16 v[160:163], a[208:211], v[36:39], v[160:163]
v_exp_f32 v83, v83
v_mfma_f32_16x16x32_bf16 v[160:163], a[176:179], v[32:35], v[160:163]
v_cvt_pk_bf16_f32 v46, v80, v81
v_cvt_pk_bf16_f32 v47, v82, v83
v_mfma_f32_16x16x32_bf16 v[164:167], a[180:183], v[32:35], v[164:167]
v_exp_f32 v84, v84
v_mfma_f32_16x16x32_bf16 v[164:167], a[212:215], v[36:39], v[164:167]
v_exp_f32 v85, v85
v_mfma_f32_16x16x32_bf16 v[168:171], a[216:219], v[36:39], v[168:171]
v_exp_f32 v86, v86
v_mfma_f32_16x16x32_bf16 v[168:171], a[184:187], v[32:35], v[168:171]
s_xor_b32 s21, s23, 21504
v_exp_f32 v87, v87
v_mfma_f32_16x16x32_bf16 v[172:175], a[188:191], v[32:35], v[172:175]
s_add_u32 m0, s22, 34848
v_cvt_pk_bf16_f32 v40, v84, v85
v_cvt_pk_bf16_f32 v41, v86, v87
v_mfma_f32_16x16x32_bf16 v[172:175], a[220:223], v[36:39], v[172:175]
v_exp_f32 v68, v68
v_mfma_f32_16x16x32_bf16 v[176:179], a[224:227], v[36:39], v[176:179]
buffer_load_dwordx4 v97, s[8:11], s21 offen offset:0 nt lds
v_mfma_f32_16x16x32_bf16 v[176:179], a[192:195], v[32:35], v[176:179]
v_exp_f32 v69, v69
v_mfma_f32_16x16x32_bf16 v[180:183], a[196:199], v[32:35], v[180:183]
v_exp_f32 v70, v70
v_mfma_f32_16x16x32_bf16 v[180:183], a[228:231], v[36:39], v[180:183]
v_exp_f32 v71, v71
v_mfma_f32_16x16x32_bf16 v[184:187], a[232:235], v[36:39], v[184:187]
v_cvt_pk_bf16_f32 v42, v68, v69
v_cvt_pk_bf16_f32 v43, v70, v71
v_mfma_f32_16x16x32_bf16 v[184:187], a[200:203], v[32:35], v[184:187]
s_waitcnt lgkmcnt(0)
v_lshlrev_b32 v116, 16, v108
v_and_b32 v108, s36, v108
v_mfma_f32_16x16x32_bf16 v[188:191], a[204:207], v[32:35], v[188:191]
v_mul_f32 v116, s38, v116
v_mul_f32 v108, s38, v108
v_mfma_f32_16x16x32_bf16 v[188:191], a[236:239], v[36:39], v[188:191]
v_cvt_pk_bf16_f32 v108, v116, v108
v_lshlrev_b32 v117, 16, v109
v_smfmac_f32_16x16x64_bf16 a[240:243], a[252:255], v[32:39], v92
v_and_b32 v109, s36, v109
v_mfma_f32_16x16x32_bf16 v[72:75], a[144:147], a[48:51], v[60:63]
v_mul_f32 v117, s38, v117
v_mul_f32 v109, s38, v109
v_mfma_f32_16x16x32_bf16 v[72:75], a[148:151], a[52:55], v[72:75]
v_cvt_pk_bf16_f32 v109, v117, v109
v_lshlrev_b32 v118, 16, v110
v_mfma_f32_16x16x32_bf16 v[72:75], a[152:155], a[56:59], v[72:75]
v_and_b32 v110, s36, v110
v_mul_f32 v118, s38, v118
v_mfma_f32_16x16x32_bf16 v[72:75], a[156:159], a[60:63], v[72:75]
v_mul_f32 v110, s38, v110
v_cvt_pk_bf16_f32 v110, v118, v110
v_mfma_f32_16x16x32_bf16 v[76:79], a[172:175], a[60:63], v[60:63]
s_xor_b32 s21, s23, 25600
v_lshlrev_b32 v119, 16, v111
v_and_b32 v111, s36, v111
v_mfma_f32_16x16x32_bf16 v[76:79], a[168:171], a[56:59], v[76:79]
s_add_u32 m0, s22, 35904
v_mul_f32 v119, s38, v119
v_mul_f32 v111, s38, v111
v_mfma_f32_16x16x32_bf16 v[76:79], a[164:167], a[52:55], v[76:79]
v_cvt_pk_bf16_f32 v111, v119, v111
v_mfma_f32_16x16x32_bf16 v[76:79], a[160:163], a[48:51], v[76:79]
buffer_load_dwordx4 v97, s[8:11], s21 offen offset:0 nt lds
v_mfma_f32_16x16x32_bf16 v[80:83], a[112:115], a[48:51], v[60:63]
v_exp_f32 v72, v72
v_mfma_f32_16x16x32_bf16 v[80:83], a[116:119], a[52:55], v[80:83]
v_exp_f32 v73, v73
v_mfma_f32_16x16x32_bf16 v[80:83], a[120:123], a[56:59], v[80:83]
v_exp_f32 v74, v74
v_mfma_f32_16x16x32_bf16 v[80:83], a[124:127], a[60:63], v[80:83]
v_exp_f32 v75, v75
v_mfma_f32_16x16x32_bf16 v[84:87], a[140:143], a[60:63], v[60:63]
v_cvt_pk_bf16_f32 v36, v72, v73
v_cvt_pk_bf16_f32 v37, v74, v75
v_mfma_f32_16x16x32_bf16 v[84:87], a[136:139], a[56:59], v[84:87]
v_exp_f32 v76, v76
v_mfma_f32_16x16x32_bf16 v[84:87], a[132:135], a[52:55], v[84:87]
v_exp_f32 v77, v77
v_mfma_f32_16x16x32_bf16 v[84:87], a[128:131], a[48:51], v[84:87]
v_exp_f32 v78, v78
v_mfma_f32_16x16x32_bf16 v[192:195], a[208:211], v[44:47], v[192:195]
v_exp_f32 v79, v79
v_mfma_f32_16x16x32_bf16 v[192:195], a[176:179], v[40:43], v[192:195]
v_cvt_pk_bf16_f32 v38, v76, v77
v_cvt_pk_bf16_f32 v39, v78, v79
v_mfma_f32_16x16x32_bf16 v[196:199], a[180:183], v[40:43], v[196:199]
v_exp_f32 v80, v80
v_mfma_f32_16x16x32_bf16 v[196:199], a[212:215], v[44:47], v[196:199]
v_exp_f32 v81, v81
v_mfma_f32_16x16x32_bf16 v[200:203], a[216:219], v[44:47], v[200:203]
v_exp_f32 v82, v82
v_mfma_f32_16x16x32_bf16 v[200:203], a[184:187], v[40:43], v[200:203]
s_xor_b32 s21, s23, 29696
v_exp_f32 v83, v83
v_mfma_f32_16x16x32_bf16 v[204:207], a[188:191], v[40:43], v[204:207]
s_add_u32 m0, s22, 36960
v_exp_f32 v84, v84
v_mfma_f32_16x16x32_bf16 v[204:207], a[220:223], v[44:47], v[204:207]
v_exp_f32 v85, v85
v_mfma_f32_16x16x32_bf16 v[208:211], a[224:227], v[44:47], v[208:211]
buffer_load_dwordx4 v97, s[8:11], s21 offen offset:0 nt lds
v_mfma_f32_16x16x32_bf16 v[208:211], a[192:195], v[40:43], v[208:211]
v_exp_f32 v86, v86
v_mfma_f32_16x16x32_bf16 v[212:215], a[196:199], v[40:43], v[212:215]
v_exp_f32 v87, v87
v_mfma_f32_16x16x32_bf16 v[212:215], a[228:231], v[44:47], v[212:215]
v_cvt_pk_bf16_f32 v32, v80, v81
v_cvt_pk_bf16_f32 v33, v82, v83
v_mfma_f32_16x16x32_bf16 v[216:219], a[232:235], v[44:47], v[216:219]
v_cvt_pk_bf16_f32 v34, v84, v85
v_cvt_pk_bf16_f32 v35, v86, v87
v_mfma_f32_16x16x32_bf16 v[216:219], a[200:203], v[40:43], v[216:219]
ds_write_b128 v99, v[108:111] offset:0
v_mfma_f32_16x16x32_bf16 v[220:223], a[204:207], v[40:43], v[220:223]
s_waitcnt vmcnt(5)
s_barrier
v_mfma_f32_16x16x32_bf16 v[220:223], a[236:239], v[44:47], v[220:223]
ds_read_b128 a[144:147], v89 offset:16896
v_smfmac_f32_16x16x64_bf16 a[244:247], a[248:251], v[40:47], v92
ds_read_b128 a[148:151], v89 offset:16960
v_mfma_f32_16x16x32_bf16 v[68:71], a[112:115], a[64:67], v[64:67]
ds_read_b128 a[152:155], v89 offset:17024
v_mfma_f32_16x16x32_bf16 v[68:71], a[116:119], a[68:71], v[68:71]
ds_read_b128 a[156:159], v89 offset:17088
v_mfma_f32_16x16x32_bf16 v[68:71], a[120:123], a[72:75], v[68:71]
ds_read_b128 a[172:175], v89 offset:17600
v_mfma_f32_16x16x32_bf16 v[68:71], a[124:127], a[76:79], v[68:71]
ds_read_b128 a[168:171], v89 offset:17536
v_mfma_f32_16x16x32_bf16 v[72:75], a[140:143], a[76:79], v[64:67]
s_xor_b32 s21, s23, 17408
ds_read_b128 a[164:167], v89 offset:17472
v_mfma_f32_16x16x32_bf16 v[72:75], a[136:139], a[72:75], v[72:75]
s_add_u32 m0, s22, 84480
ds_read_b128 a[160:163], v89 offset:17408
v_mfma_f32_16x16x32_bf16 v[72:75], a[132:135], a[68:71], v[72:75]
ds_read_b128 a[112:115], v88 offset:16896
v_mfma_f32_16x16x32_bf16 v[72:75], a[128:131], a[64:67], v[72:75]
buffer_load_dwordx4 v97, s[12:15], s21 offen offset:0 nt lds
v_mfma_f32_16x16x32_bf16 v[224:227], a[208:211], v[36:39], v[224:227]
v_exp_f32 v68, v68
v_mfma_f32_16x16x32_bf16 v[224:227], a[176:179], v[32:35], v[224:227]
v_exp_f32 v69, v69
v_mfma_f32_16x16x32_bf16 v[228:231], a[180:183], v[32:35], v[228:231]
ds_read_b128 a[116:119], v88 offset:16960
v_cvt_pk_bf16_f32 v40, v68, v69
v_mfma_f32_16x16x32_bf16 v[228:231], a[212:215], v[36:39], v[228:231]
v_exp_f32 v70, v70
v_mfma_f32_16x16x32_bf16 v[232:235], a[216:219], v[36:39], v[232:235]
v_exp_f32 v71, v71
v_mfma_f32_16x16x32_bf16 v[232:235], a[184:187], v[32:35], v[232:235]
ds_read_b128 a[120:123], v88 offset:17024
v_cvt_pk_bf16_f32 v41, v70, v71
v_mfma_f32_16x16x32_bf16 v[236:239], a[188:191], v[32:35], v[236:239]
v_exp_f32 v72, v72
v_mfma_f32_16x16x32_bf16 v[236:239], a[220:223], v[36:39], v[236:239]
v_exp_f32 v73, v73
v_mfma_f32_16x16x32_bf16 v[240:243], a[224:227], v[36:39], v[240:243]
ds_read_b128 a[124:127], v88 offset:17088
v_cvt_pk_bf16_f32 v42, v72, v73
v_mfma_f32_16x16x32_bf16 v[240:243], a[192:195], v[32:35], v[240:243]
v_exp_f32 v74, v74
v_mfma_f32_16x16x32_bf16 v[244:247], a[196:199], v[32:35], v[244:247]
v_exp_f32 v75, v75
v_mfma_f32_16x16x32_bf16 v[244:247], a[228:231], v[36:39], v[244:247]
ds_read_b128 a[140:143], v88 offset:17600
v_cvt_pk_bf16_f32 v43, v74, v75
v_mfma_f32_16x16x32_bf16 v[248:251], a[232:235], v[36:39], v[248:251]
ds_read_b128 a[136:139], v88 offset:17536
v_mfma_f32_16x16x32_bf16 v[248:251], a[200:203], v[32:35], v[248:251]
s_xor_b32 s21, s23, 21504
ds_read_b128 a[132:135], v88 offset:17472
v_mfma_f32_16x16x32_bf16 v[252:255], a[204:207], v[32:35], v[252:255]
s_add_u32 m0, s22, 85536
ds_read_b128 a[128:131], v88 offset:17408
v_mfma_f32_16x16x32_bf16 v[252:255], a[236:239], v[36:39], v[252:255]
ds_read_b64_tr_b16 a[208:209], v91 offset:16896
ds_read_b64_tr_b16 a[210:211], v91 offset:17408
v_smfmac_f32_16x16x64_bf16 a[244:247], a[252:255], v[32:39], v92
s_waitcnt lgkmcnt(6)
ds_read_b64_tr_b16 a[212:213], v91 offset:16928
v_mfma_f32_16x16x32_bf16 v[76:79], a[144:147], a[0:3], v[48:51]
buffer_load_dwordx4 v97, s[12:15], s21 offen offset:0 nt lds
v_mfma_f32_16x16x32_bf16 v[76:79], a[148:151], a[4:7], v[76:79]
ds_read_b64_tr_b16 a[214:215], v91 offset:17440
ds_read_b64_tr_b16 a[216:217], v91 offset:16960
v_mfma_f32_16x16x32_bf16 v[76:79], a[152:155], a[8:11], v[76:79]
ds_read_b64_tr_b16 a[218:219], v91 offset:17472
v_mfma_f32_16x16x32_bf16 v[76:79], a[156:159], a[12:15], v[76:79]
ds_read_b64_tr_b16 a[220:221], v91 offset:16992
ds_read_b64_tr_b16 a[222:223], v91 offset:17504
v_mfma_f32_16x16x32_bf16 v[80:83], a[172:175], a[12:15], v[48:51]
ds_read_b64_tr_b16 a[224:225], v91 offset:17024
v_mfma_f32_16x16x32_bf16 v[80:83], a[168:171], a[8:11], v[80:83]
ds_read_b64_tr_b16 a[226:227], v91 offset:17536
ds_read_b64_tr_b16 a[228:229], v91 offset:17056
v_mfma_f32_16x16x32_bf16 v[80:83], a[164:167], a[4:7], v[80:83]
ds_read_b64_tr_b16 a[230:231], v91 offset:17568
v_mfma_f32_16x16x32_bf16 v[80:83], a[160:163], a[0:3], v[80:83]
v_exp_f32 v76, v76
v_mfma_f32_16x16x32_bf16 v[84:87], a[112:115], a[0:3], v[48:51]
v_exp_f32 v77, v77
v_mfma_f32_16x16x32_bf16 v[84:87], a[116:119], a[4:7], v[84:87]
v_exp_f32 v78, v78
v_mfma_f32_16x16x32_bf16 v[84:87], a[120:123], a[8:11], v[84:87]
v_exp_f32 v79, v79
v_mfma_f32_16x16x32_bf16 v[84:87], a[124:127], a[12:15], v[84:87]
s_waitcnt lgkmcnt(4)
v_cvt_pk_bf16_f32 v36, v76, v77
v_cvt_pk_bf16_f32 v37, v78, v79
v_mfma_f32_16x16x32_bf16 v[68:71], a[140:143], a[12:15], v[48:51]
s_xor_b32 s21, s23, 25600
v_exp_f32 v80, v80
v_mfma_f32_16x16x32_bf16 v[68:71], a[136:139], a[8:11], v[68:71]
s_add_u32 m0, s22, 86592
v_exp_f32 v81, v81
v_mfma_f32_16x16x32_bf16 v[68:71], a[132:135], a[4:7], v[68:71]
v_exp_f32 v82, v82
v_mfma_f32_16x16x32_bf16 v[68:71], a[128:131], a[0:3], v[68:71]
buffer_load_dwordx4 v97, s[12:15], s21 offen offset:0 nt lds
v_mfma_f32_16x16x32_bf16 v[104:107], a[248:251], v[40:43], v[104:107]
v_exp_f32 v83, v83
v_mfma_f32_16x16x32_bf16 a[80:83], a[176:179], v[40:43], a[80:83]
v_cvt_pk_bf16_f32 v38, v80, v81
v_cvt_pk_bf16_f32 v39, v82, v83
v_mfma_f32_16x16x32_bf16 a[84:87], a[180:183], v[40:43], a[84:87]
v_exp_f32 v84, v84
v_mfma_f32_16x16x32_bf16 a[88:91], a[184:187], v[40:43], a[88:91]
v_exp_f32 v85, v85
v_mfma_f32_16x16x32_bf16 a[92:95], a[188:191], v[40:43], a[92:95]
v_exp_f32 v86, v86
v_mfma_f32_16x16x32_bf16 a[96:99], a[192:195], v[40:43], a[96:99]
v_exp_f32 v87, v87
v_mfma_f32_16x16x32_bf16 a[100:103], a[196:199], v[40:43], a[100:103]
ds_read_b64_tr_b16 a[176:177], v90 offset:16896
ds_read_b64_tr_b16 a[178:179], v90 offset:17408
v_mfma_f32_16x16x32_bf16 a[104:107], a[200:203], v[40:43], a[104:107]
v_cvt_pk_bf16_f32 v32, v84, v85
v_cvt_pk_bf16_f32 v33, v86, v87
v_mfma_f32_16x16x32_bf16 a[108:111], a[204:207], v[40:43], a[108:111]
ds_read_b64_tr_b16 a[180:181], v90 offset:16928
ds_read_b64_tr_b16 a[182:183], v90 offset:17440
v_mfma_f32_16x16x32_bf16 v[72:75], a[144:147], a[16:19], v[52:55]
v_exp_f32 v68, v68
v_mfma_f32_16x16x32_bf16 v[72:75], a[148:151], a[20:23], v[72:75]
v_exp_f32 v69, v69
v_mfma_f32_16x16x32_bf16 v[72:75], a[152:155], a[24:27], v[72:75]
s_xor_b32 s21, s23, 29696
v_exp_f32 v70, v70
v_mfma_f32_16x16x32_bf16 v[72:75], a[156:159], a[28:31], v[72:75]
s_add_u32 m0, s22, 87648
v_exp_f32 v71, v71
v_mfma_f32_16x16x32_bf16 v[76:79], a[172:175], a[28:31], v[52:55]
ds_read_b64_tr_b16 a[184:185], v90 offset:16960
ds_read_b64_tr_b16 a[186:187], v90 offset:17472
v_mfma_f32_16x16x32_bf16 v[76:79], a[168:171], a[24:27], v[76:79]
buffer_load_dwordx4 v97, s[12:15], s21 offen offset:0 nt lds
v_mfma_f32_16x16x32_bf16 v[76:79], a[164:167], a[20:23], v[76:79]
v_cvt_pk_bf16_f32 v34, v68, v69
v_cvt_pk_bf16_f32 v35, v70, v71
v_mfma_f32_16x16x32_bf16 v[76:79], a[160:163], a[16:19], v[76:79]
ds_read_b64_tr_b16 a[188:189], v90 offset:16992
ds_read_b64_tr_b16 a[190:191], v90 offset:17504
v_mfma_f32_16x16x32_bf16 v[80:83], a[112:115], a[16:19], v[52:55]
v_exp_f32 v72, v72
v_mfma_f32_16x16x32_bf16 v[80:83], a[116:119], a[20:23], v[80:83]
ds_read_b64_tr_b16 a[192:193], v90 offset:17024
ds_read_b64_tr_b16 a[194:195], v90 offset:17536
v_mfma_f32_16x16x32_bf16 v[80:83], a[120:123], a[24:27], v[80:83]
v_exp_f32 v73, v73
v_mfma_f32_16x16x32_bf16 v[80:83], a[124:127], a[28:31], v[80:83]
ds_read_b64_tr_b16 a[196:197], v90 offset:17056
ds_read_b64_tr_b16 a[198:199], v90 offset:17568
v_mfma_f32_16x16x32_bf16 v[84:87], a[140:143], a[28:31], v[52:55]
ds_read_b64_tr_b16 a[232:233], v91 offset:17088
v_cvt_pk_bf16_f32 v44, v72, v73
v_mfma_f32_16x16x32_bf16 v[84:87], a[136:139], a[24:27], v[84:87]
ds_read_b64_tr_b16 a[234:235], v91 offset:17600
ds_read_b64_tr_b16 a[200:201], v90 offset:17088
v_mfma_f32_16x16x32_bf16 v[84:87], a[132:135], a[20:23], v[84:87]
v_exp_f32 v74, v74
v_mfma_f32_16x16x32_bf16 v[84:87], a[128:131], a[16:19], v[84:87]
ds_read_b64_tr_b16 a[202:203], v90 offset:17600
ds_read_b64_tr_b16 a[204:205], v90 offset:17120
v_mfma_f32_16x16x32_bf16 v[128:131], a[208:211], v[36:39], v[128:131]
s_waitcnt lgkmcnt(9)
v_exp_f32 v75, v75
v_mfma_f32_16x16x32_bf16 v[128:131], a[176:179], v[32:35], v[128:131]
ds_read_b64_tr_b16 a[206:207], v90 offset:17632
ds_read_b64_tr_b16 a[236:237], v91 offset:17120
v_mfma_f32_16x16x32_bf16 v[132:135], a[180:183], v[32:35], v[132:135]
ds_read_b64_tr_b16 a[238:239], v91 offset:17632
v_cvt_pk_bf16_f32 v45, v74, v75
v_mfma_f32_16x16x32_bf16 v[132:135], a[212:215], v[36:39], v[132:135]
s_add_u32 m0, s24, 64
v_exp_f32 v76, v76
v_mfma_f32_16x16x32_bf16 v[136:139], a[216:219], v[36:39], v[136:139]
v_exp_f32 v77, v77
v_mfma_f32_16x16x32_bf16 v[136:139], a[184:187], v[32:35], v[136:139]
buffer_load_dwordx4 v96, s[4:7], s37 offen offset:2048 nt lds
v_mfma_f32_16x16x32_bf16 v[140:143], a[188:191], v[32:35], v[140:143]
v_exp_f32 v78, v78
v_mfma_f32_16x16x32_bf16 v[140:143], a[220:223], v[36:39], v[140:143]
v_exp_f32 v79, v79
v_mfma_f32_16x16x32_bf16 v[144:147], a[224:227], v[36:39], v[144:147]
s_waitcnt lgkmcnt(3)
v_cvt_pk_bf16_f32 v46, v76, v77
v_cvt_pk_bf16_f32 v47, v78, v79
v_mfma_f32_16x16x32_bf16 v[144:147], a[192:195], v[32:35], v[144:147]
v_exp_f32 v80, v80
v_mfma_f32_16x16x32_bf16 v[148:151], a[196:199], v[32:35], v[148:151]
v_exp_f32 v81, v81
v_mfma_f32_16x16x32_bf16 v[148:151], a[228:231], v[36:39], v[148:151]
v_exp_f32 v82, v82
v_mfma_f32_16x16x32_bf16 v[152:155], a[232:235], v[36:39], v[152:155]
v_exp_f32 v83, v83
v_mfma_f32_16x16x32_bf16 v[152:155], a[200:203], v[32:35], v[152:155]
s_waitcnt lgkmcnt(0)
v_cvt_pk_bf16_f32 v40, v80, v81
v_cvt_pk_bf16_f32 v41, v82, v83
v_mfma_f32_16x16x32_bf16 v[156:159], a[204:207], v[32:35], v[156:159]
v_exp_f32 v84, v84
v_mfma_f32_16x16x32_bf16 v[156:159], a[236:239], v[36:39], v[156:159]
v_exp_f32 v85, v85
v_smfmac_f32_16x16x64_bf16 a[240:243], a[248:251], v[32:39], v92
v_cvt_pk_bf16_f32 v42, v84, v85
v_mfma_f32_16x16x32_bf16 v[68:71], a[144:147], a[32:35], v[56:59]
v_exp_f32 v86, v86
v_mfma_f32_16x16x32_bf16 v[68:71], a[148:151], a[36:39], v[68:71]
s_add_u32 m0, s24, 96
v_exp_f32 v87, v87
v_mfma_f32_16x16x32_bf16 v[68:71], a[152:155], a[40:43], v[68:71]
s_waitcnt vmcnt(9)
ds_read_b128 v[112:115], v99 offset:1056
v_cvt_pk_bf16_f32 v43, v86, v87
v_mfma_f32_16x16x32_bf16 v[68:71], a[156:159], a[44:47], v[68:71]
buffer_load_dwordx4 v96, s[4:7], s37 offen offset:3072 nt lds
v_mfma_f32_16x16x32_bf16 v[72:75], a[172:175], a[44:47], v[56:59]
v_mfma_f32_16x16x32_bf16 v[72:75], a[168:171], a[40:43], v[72:75]
v_mfma_f32_16x16x32_bf16 v[72:75], a[164:167], a[36:39], v[72:75]
v_mfma_f32_16x16x32_bf16 v[72:75], a[160:163], a[32:35], v[72:75]
v_mfma_f32_16x16x32_bf16 v[76:79], a[112:115], a[32:35], v[56:59]
v_mfma_f32_16x16x32_bf16 v[76:79], a[116:119], a[36:39], v[76:79]
s_waitcnt lgkmcnt(0)
v_lshlrev_b32 v116, 16, v112
v_and_b32 v112, s36, v112
v_mfma_f32_16x16x32_bf16 v[76:79], a[120:123], a[40:43], v[76:79]
v_exp_f32 v68, v68
v_mfma_f32_16x16x32_bf16 v[76:79], a[124:127], a[44:47], v[76:79]
v_exp_f32 v69, v69
v_mfma_f32_16x16x32_bf16 v[80:83], a[140:143], a[44:47], v[56:59]
v_exp_f32 v70, v70
v_mfma_f32_16x16x32_bf16 v[80:83], a[136:139], a[40:43], v[80:83]
v_exp_f32 v71, v71
v_mfma_f32_16x16x32_bf16 v[80:83], a[132:135], a[36:39], v[80:83]
v_cvt_pk_bf16_f32 v36, v68, v69
v_cvt_pk_bf16_f32 v37, v70, v71
v_mfma_f32_16x16x32_bf16 v[80:83], a[128:131], a[32:35], v[80:83]
s_xor_b32 s21, s23, 18432
v_exp_f32 v72, v72
v_mfma_f32_16x16x32_bf16 v[160:163], a[208:211], v[44:47], v[160:163]
s_add_u32 m0, s22, 0
v_exp_f32 v73, v73
v_mfma_f32_16x16x32_bf16 v[160:163], a[176:179], v[40:43], v[160:163]
v_exp_f32 v74, v74
v_mfma_f32_16x16x32_bf16 v[164:167], a[180:183], v[40:43], v[164:167]
buffer_load_dwordx4 v97, s[8:11], s21 offen offset:0 nt lds
v_mfma_f32_16x16x32_bf16 v[164:167], a[212:215], v[44:47], v[164:167]
v_exp_f32 v75, v75
v_mfma_f32_16x16x32_bf16 v[168:171], a[216:219], v[44:47], v[168:171]
v_cvt_pk_bf16_f32 v38, v72, v73
v_cvt_pk_bf16_f32 v39, v74, v75
v_mfma_f32_16x16x32_bf16 v[168:171], a[184:187], v[40:43], v[168:171]
v_exp_f32 v76, v76
v_mfma_f32_16x16x32_bf16 v[172:175], a[188:191], v[40:43], v[172:175]
v_exp_f32 v77, v77
v_mfma_f32_16x16x32_bf16 v[172:175], a[220:223], v[44:47], v[172:175]
v_exp_f32 v78, v78
v_mfma_f32_16x16x32_bf16 v[176:179], a[224:227], v[44:47], v[176:179]
v_exp_f32 v79, v79
v_mfma_f32_16x16x32_bf16 v[176:179], a[192:195], v[40:43], v[176:179]
v_cvt_pk_bf16_f32 v32, v76, v77
v_cvt_pk_bf16_f32 v33, v78, v79
v_mfma_f32_16x16x32_bf16 v[180:183], a[196:199], v[40:43], v[180:183]
v_exp_f32 v80, v80
v_mfma_f32_16x16x32_bf16 v[180:183], a[228:231], v[44:47], v[180:183]
v_exp_f32 v81, v81
v_mfma_f32_16x16x32_bf16 v[184:187], a[232:235], v[44:47], v[184:187]
v_exp_f32 v82, v82
v_mfma_f32_16x16x32_bf16 v[184:187], a[200:203], v[40:43], v[184:187]
v_exp_f32 v83, v83
v_mfma_f32_16x16x32_bf16 v[188:191], a[204:207], v[40:43], v[188:191]
s_xor_b32 s21, s23, 22528
v_cvt_pk_bf16_f32 v34, v80, v81
v_cvt_pk_bf16_f32 v35, v82, v83
v_mfma_f32_16x16x32_bf16 v[188:191], a[236:239], v[44:47], v[188:191]
s_add_u32 m0, s22, 1056
v_mul_f32 v116, s38, v116
v_mul_f32 v112, s38, v112
v_smfmac_f32_16x16x64_bf16 a[240:243], a[252:255], v[40:47], v92
v_cvt_pk_bf16_f32 v112, v116, v112
v_mfma_f32_16x16x32_bf16 v[84:87], a[144:147], a[48:51], v[60:63]
buffer_load_dwordx4 v97, s[8:11], s21 offen offset:0 nt lds
v_mfma_f32_16x16x32_bf16 v[84:87], a[148:151], a[52:55], v[84:87]
v_lshlrev_b32 v117, 16, v113
v_and_b32 v113, s36, v113
v_mfma_f32_16x16x32_bf16 v[84:87], a[152:155], a[56:59], v[84:87]
v_mul_f32 v117, s38, v117
v_mul_f32 v113, s38, v113
v_mfma_f32_16x16x32_bf16 v[84:87], a[156:159], a[60:63], v[84:87]
v_cvt_pk_bf16_f32 v113, v117, v113
v_lshlrev_b32 v118, 16, v114
v_mfma_f32_16x16x32_bf16 v[68:71], a[172:175], a[60:63], v[60:63]
v_and_b32 v114, s36, v114
v_mul_f32 v118, s38, v118
v_mfma_f32_16x16x32_bf16 v[68:71], a[168:171], a[56:59], v[68:71]
v_mul_f32 v114, s38, v114
v_cvt_pk_bf16_f32 v114, v118, v114
v_mfma_f32_16x16x32_bf16 v[68:71], a[164:167], a[52:55], v[68:71]
v_lshlrev_b32 v119, 16, v115
v_and_b32 v115, s36, v115
v_mfma_f32_16x16x32_bf16 v[68:71], a[160:163], a[48:51], v[68:71]
v_exp_f32 v84, v84
v_mfma_f32_16x16x32_bf16 v[72:75], a[112:115], a[48:51], v[60:63]
v_exp_f32 v85, v85
v_mfma_f32_16x16x32_bf16 v[72:75], a[116:119], a[52:55], v[72:75]
v_exp_f32 v86, v86
v_mfma_f32_16x16x32_bf16 v[72:75], a[120:123], a[56:59], v[72:75]
v_exp_f32 v87, v87
v_mfma_f32_16x16x32_bf16 v[72:75], a[124:127], a[60:63], v[72:75]
s_add_u32 s37, s31, 86016
v_cvt_pk_bf16_f32 v44, v84, v85
v_cvt_pk_bf16_f32 v45, v86, v87
v_mfma_f32_16x16x32_bf16 v[76:79], a[140:143], a[60:63], v[60:63]
s_add_u32 m0, s24, 4352
v_exp_f32 v68, v68
v_mfma_f32_16x16x32_bf16 v[76:79], a[136:139], a[56:59], v[76:79]
v_exp_f32 v69, v69
v_mfma_f32_16x16x32_bf16 v[76:79], a[132:135], a[52:55], v[76:79]
buffer_load_dwordx4 v96, s[4:7], s37 offen offset:0 nt lds
v_mfma_f32_16x16x32_bf16 v[76:79], a[128:131], a[48:51], v[76:79]
v_exp_f32 v70, v70
v_mfma_f32_16x16x32_bf16 v[192:195], a[208:211], v[36:39], v[192:195]
v_exp_f32 v71, v71
v_mfma_f32_16x16x32_bf16 v[192:195], a[176:179], v[32:35], v[192:195]
v_cvt_pk_bf16_f32 v46, v68, v69
v_cvt_pk_bf16_f32 v47, v70, v71
v_mfma_f32_16x16x32_bf16 v[196:199], a[180:183], v[32:35], v[196:199]
v_exp_f32 v72, v72
v_mfma_f32_16x16x32_bf16 v[196:199], a[212:215], v[36:39], v[196:199]
v_exp_f32 v73, v73
v_mfma_f32_16x16x32_bf16 v[200:203], a[216:219], v[36:39], v[200:203]
v_exp_f32 v74, v74
v_mfma_f32_16x16x32_bf16 v[200:203], a[184:187], v[32:35], v[200:203]
v_exp_f32 v75, v75
v_mfma_f32_16x16x32_bf16 v[204:207], a[188:191], v[32:35], v[204:207]
v_exp_f32 v76, v76
v_mfma_f32_16x16x32_bf16 v[204:207], a[220:223], v[36:39], v[204:207]
v_exp_f32 v77, v77
v_mfma_f32_16x16x32_bf16 v[208:211], a[224:227], v[36:39], v[208:211]
v_exp_f32 v78, v78
v_mfma_f32_16x16x32_bf16 v[208:211], a[192:195], v[32:35], v[208:211]
v_exp_f32 v79, v79
v_mfma_f32_16x16x32_bf16 v[212:215], a[196:199], v[32:35], v[212:215]
s_xor_b32 s21, s23, 26624
v_cvt_pk_bf16_f32 v40, v72, v73
v_cvt_pk_bf16_f32 v41, v74, v75
v_mfma_f32_16x16x32_bf16 v[212:215], a[228:231], v[36:39], v[212:215]
s_add_u32 m0, s22, 2112
v_cvt_pk_bf16_f32 v42, v76, v77
v_cvt_pk_bf16_f32 v43, v78, v79
v_mfma_f32_16x16x32_bf16 v[216:219], a[232:235], v[36:39], v[216:219]
v_mul_f32 v119, s38, v119
v_mul_f32 v115, s38, v115
v_mfma_f32_16x16x32_bf16 v[216:219], a[200:203], v[32:35], v[216:219]
buffer_load_dwordx4 v97, s[8:11], s21 offen offset:0 nt lds
v_mfma_f32_16x16x32_bf16 v[220:223], a[204:207], v[32:35], v[220:223]
s_waitcnt vmcnt(6)
s_barrier
v_mfma_f32_16x16x32_bf16 v[220:223], a[236:239], v[36:39], v[220:223]
ds_read_b128 a[144:147], v89 offset:33792
v_cvt_pk_bf16_f32 v115, v119, v115
v_smfmac_f32_16x16x64_bf16 a[244:247], a[248:251], v[32:39], v92
ds_read_b128 a[148:151], v89 offset:33856
v_mfma_f32_16x16x32_bf16 v[80:83], a[112:115], a[64:67], v[64:67]
ds_write_b128 v99, v[112:115] offset:1056
v_mfma_f32_16x16x32_bf16 v[80:83], a[116:119], a[68:71], v[80:83]
ds_read_b128 a[152:155], v89 offset:33920
v_mfma_f32_16x16x32_bf16 v[80:83], a[120:123], a[72:75], v[80:83]
ds_read_b128 a[156:159], v89 offset:33984
v_mfma_f32_16x16x32_bf16 v[80:83], a[124:127], a[76:79], v[80:83]
ds_read_b128 a[172:175], v89 offset:34496
v_mfma_f32_16x16x32_bf16 v[84:87], a[140:143], a[76:79], v[64:67]
ds_read_b128 a[168:171], v89 offset:34432
v_mfma_f32_16x16x32_bf16 v[84:87], a[136:139], a[72:75], v[84:87]
ds_read_b128 a[164:167], v89 offset:34368
v_mfma_f32_16x16x32_bf16 v[84:87], a[132:135], a[68:71], v[84:87]
ds_read_b128 a[160:163], v89 offset:34304
v_mfma_f32_16x16x32_bf16 v[84:87], a[128:131], a[64:67], v[84:87]
s_xor_b32 s21, s23, 30720
v_exp_f32 v80, v80
v_mfma_f32_16x16x32_bf16 v[224:227], a[208:211], v[44:47], v[224:227]
s_add_u32 m0, s22, 3168
v_exp_f32 v81, v81
v_mfma_f32_16x16x32_bf16 v[224:227], a[176:179], v[40:43], v[224:227]
ds_read_b128 a[112:115], v88 offset:33792
v_cvt_pk_bf16_f32 v32, v80, v81
v_mfma_f32_16x16x32_bf16 v[228:231], a[180:183], v[40:43], v[228:231]
buffer_load_dwordx4 v97, s[8:11], s21 offen offset:0 nt lds
v_mfma_f32_16x16x32_bf16 v[228:231], a[212:215], v[44:47], v[228:231]
v_exp_f32 v82, v82
v_mfma_f32_16x16x32_bf16 v[232:235], a[216:219], v[44:47], v[232:235]
v_exp_f32 v83, v83
v_mfma_f32_16x16x32_bf16 v[232:235], a[184:187], v[40:43], v[232:235]
ds_read_b128 a[116:119], v88 offset:33856
v_cvt_pk_bf16_f32 v33, v82, v83
v_mfma_f32_16x16x32_bf16 v[236:239], a[188:191], v[40:43], v[236:239]
v_exp_f32 v84, v84
v_mfma_f32_16x16x32_bf16 v[236:239], a[220:223], v[44:47], v[236:239]
v_exp_f32 v85, v85
v_mfma_f32_16x16x32_bf16 v[240:243], a[224:227], v[44:47], v[240:243]
ds_read_b128 a[120:123], v88 offset:33920
v_cvt_pk_bf16_f32 v34, v84, v85
v_mfma_f32_16x16x32_bf16 v[240:243], a[192:195], v[40:43], v[240:243]
v_exp_f32 v86, v86
v_mfma_f32_16x16x32_bf16 v[244:247], a[196:199], v[40:43], v[244:247]
v_exp_f32 v87, v87
v_mfma_f32_16x16x32_bf16 v[244:247], a[228:231], v[44:47], v[244:247]
ds_read_b128 a[124:127], v88 offset:33984
v_cvt_pk_bf16_f32 v35, v86, v87
v_mfma_f32_16x16x32_bf16 v[248:251], a[232:235], v[44:47], v[248:251]
ds_read_b128 a[140:143], v88 offset:34496
v_mfma_f32_16x16x32_bf16 v[248:251], a[200:203], v[40:43], v[248:251]
s_xor_b32 s21, s23, 18432
ds_read_b128 a[136:139], v88 offset:34432
v_mfma_f32_16x16x32_bf16 v[252:255], a[204:207], v[40:43], v[252:255]
s_add_u32 m0, s22, 50688
ds_read_b128 a[132:135], v88 offset:34368
v_mfma_f32_16x16x32_bf16 v[252:255], a[236:239], v[44:47], v[252:255]
ds_read_b128 a[128:131], v88 offset:34304
v_smfmac_f32_16x16x64_bf16 a[244:247], a[252:255], v[40:47], v92
s_waitcnt lgkmcnt(5)
ds_read_b64_tr_b16 a[208:209], v91 offset:33792
v_mfma_f32_16x16x32_bf16 v[68:71], a[144:147], a[0:3], v[48:51]
buffer_load_dwordx4 v97, s[12:15], s21 offen offset:0 nt lds
v_mfma_f32_16x16x32_bf16 v[68:71], a[148:151], a[4:7], v[68:71]
ds_read_b64_tr_b16 a[210:211], v91 offset:34304
ds_read_b64_tr_b16 a[212:213], v91 offset:33824
v_mfma_f32_16x16x32_bf16 v[68:71], a[152:155], a[8:11], v[68:71]
ds_read_b64_tr_b16 a[214:215], v91 offset:34336
v_mfma_f32_16x16x32_bf16 v[68:71], a[156:159], a[12:15], v[68:71]
ds_read_b64_tr_b16 a[216:217], v91 offset:33856
ds_read_b64_tr_b16 a[218:219], v91 offset:34368
v_mfma_f32_16x16x32_bf16 v[72:75], a[172:175], a[12:15], v[48:51]
ds_read_b64_tr_b16 a[220:221], v91 offset:33888
v_mfma_f32_16x16x32_bf16 v[72:75], a[168:171], a[8:11], v[72:75]
ds_read_b64_tr_b16 a[222:223], v91 offset:34400
ds_read_b64_tr_b16 a[224:225], v91 offset:33920
v_mfma_f32_16x16x32_bf16 v[72:75], a[164:167], a[4:7], v[72:75]
ds_read_b64_tr_b16 a[226:227], v91 offset:34432
v_mfma_f32_16x16x32_bf16 v[72:75], a[160:163], a[0:3], v[72:75]
v_exp_f32 v68, v68
v_mfma_f32_16x16x32_bf16 v[76:79], a[112:115], a[0:3], v[48:51]
v_exp_f32 v69, v69
v_mfma_f32_16x16x32_bf16 v[76:79], a[116:119], a[4:7], v[76:79]
s_waitcnt lgkmcnt(7)
v_exp_f32 v70, v70
v_mfma_f32_16x16x32_bf16 v[76:79], a[120:123], a[8:11], v[76:79]
s_xor_b32 s21, s23, 22528
v_exp_f32 v71, v71
v_mfma_f32_16x16x32_bf16 v[76:79], a[124:127], a[12:15], v[76:79]
s_add_u32 m0, s22, 51744
v_cvt_pk_bf16_f32 v44, v68, v69
v_cvt_pk_bf16_f32 v45, v70, v71
v_mfma_f32_16x16x32_bf16 v[80:83], a[140:143], a[12:15], v[48:51]
v_exp_f32 v72, v72
v_mfma_f32_16x16x32_bf16 v[80:83], a[136:139], a[8:11], v[80:83]
buffer_load_dwordx4 v97, s[12:15], s21 offen offset:0 nt lds
v_mfma_f32_16x16x32_bf16 v[80:83], a[132:135], a[4:7], v[80:83]
v_exp_f32 v73, v73
v_mfma_f32_16x16x32_bf16 v[80:83], a[128:131], a[0:3], v[80:83]
v_exp_f32 v74, v74
v_mfma_f32_16x16x32_bf16 v[104:107], a[248:251], v[32:35], v[104:107]
v_exp_f32 v75, v75
v_mfma_f32_16x16x32_bf16 a[80:83], a[176:179], v[32:35], a[80:83]
v_cvt_pk_bf16_f32 v46, v72, v73
v_cvt_pk_bf16_f32 v47, v74, v75
v_mfma_f32_16x16x32_bf16 a[84:87], a[180:183], v[32:35], a[84:87]
v_exp_f32 v76, v76
v_mfma_f32_16x16x32_bf16 a[88:91], a[184:187], v[32:35], a[88:91]
v_exp_f32 v77, v77
v_mfma_f32_16x16x32_bf16 a[92:95], a[188:191], v[32:35], a[92:95]
v_exp_f32 v78, v78
v_mfma_f32_16x16x32_bf16 a[96:99], a[192:195], v[32:35], a[96:99]
v_exp_f32 v79, v79
v_mfma_f32_16x16x32_bf16 a[100:103], a[196:199], v[32:35], a[100:103]
ds_read_b64_tr_b16 a[176:177], v90 offset:33792
ds_read_b64_tr_b16 a[178:179], v90 offset:34304
v_mfma_f32_16x16x32_bf16 a[104:107], a[200:203], v[32:35], a[104:107]
v_cvt_pk_bf16_f32 v40, v76, v77
v_cvt_pk_bf16_f32 v41, v78, v79
v_mfma_f32_16x16x32_bf16 a[108:111], a[204:207], v[32:35], a[108:111]
s_xor_b32 s21, s23, 26624
ds_read_b64_tr_b16 a[180:181], v90 offset:33824
ds_read_b64_tr_b16 a[182:183], v90 offset:34336
v_mfma_f32_16x16x32_bf16 v[84:87], a[144:147], a[16:19], v[52:55]
s_add_u32 m0, s22, 52800
v_exp_f32 v80, v80
v_mfma_f32_16x16x32_bf16 v[84:87], a[148:151], a[20:23], v[84:87]
v_exp_f32 v81, v81
v_mfma_f32_16x16x32_bf16 v[84:87], a[152:155], a[24:27], v[84:87]
buffer_load_dwordx4 v97, s[12:15], s21 offen offset:0 nt lds
v_mfma_f32_16x16x32_bf16 v[84:87], a[156:159], a[28:31], v[84:87]
v_exp_f32 v82, v82
v_mfma_f32_16x16x32_bf16 v[68:71], a[172:175], a[28:31], v[52:55]
v_exp_f32 v83, v83
v_mfma_f32_16x16x32_bf16 v[68:71], a[168:171], a[24:27], v[68:71]
ds_read_b64_tr_b16 a[184:185], v90 offset:33856
ds_read_b64_tr_b16 a[186:187], v90 offset:34368
v_mfma_f32_16x16x32_bf16 v[68:71], a[164:167], a[20:23], v[68:71]
v_cvt_pk_bf16_f32 v42, v80, v81
v_cvt_pk_bf16_f32 v43, v82, v83
v_mfma_f32_16x16x32_bf16 v[68:71], a[160:163], a[16:19], v[68:71]
ds_read_b64_tr_b16 a[188:189], v90 offset:33888
ds_read_b64_tr_b16 a[190:191], v90 offset:34400
v_mfma_f32_16x16x32_bf16 v[72:75], a[112:115], a[16:19], v[52:55]
v_exp_f32 v84, v84
v_mfma_f32_16x16x32_bf16 v[72:75], a[116:119], a[20:23], v[72:75]
ds_read_b64_tr_b16 a[192:193], v90 offset:33920
ds_read_b64_tr_b16 a[194:195], v90 offset:34432
v_mfma_f32_16x16x32_bf16 v[72:75], a[120:123], a[24:27], v[72:75]
v_exp_f32 v85, v85
v_mfma_f32_16x16x32_bf16 v[72:75], a[124:127], a[28:31], v[72:75]
ds_read_b64_tr_b16 a[196:197], v90 offset:33952
ds_read_b64_tr_b16 a[198:199], v90 offset:34464
v_mfma_f32_16x16x32_bf16 v[76:79], a[140:143], a[28:31], v[52:55]
ds_read_b64_tr_b16 a[228:229], v91 offset:33952
v_cvt_pk_bf16_f32 v36, v84, v85
v_mfma_f32_16x16x32_bf16 v[76:79], a[136:139], a[24:27], v[76:79]
ds_read_b64_tr_b16 a[230:231], v91 offset:34464
ds_read_b64_tr_b16 a[232:233], v91 offset:33984
v_mfma_f32_16x16x32_bf16 v[76:79], a[132:135], a[20:23], v[76:79]
s_xor_b32 s21, s23, 30720
v_exp_f32 v86, v86
v_mfma_f32_16x16x32_bf16 v[76:79], a[128:131], a[16:19], v[76:79]
s_add_u32 m0, s22, 53856
ds_read_b64_tr_b16 a[234:235], v91 offset:34496
ds_read_b64_tr_b16 a[200:201], v90 offset:33984
v_mfma_f32_16x16x32_bf16 v[128:131], a[208:211], v[44:47], v[128:131]
s_waitcnt lgkmcnt(9)
v_exp_f32 v87, v87
v_mfma_f32_16x16x32_bf16 v[128:131], a[176:179], v[40:43], v[128:131]
ds_read_b64_tr_b16 a[202:203], v90 offset:34496
ds_read_b64_tr_b16 a[204:205], v90 offset:34016
v_mfma_f32_16x16x32_bf16 v[132:135], a[180:183], v[40:43], v[132:135]
buffer_load_dwordx4 v97, s[12:15], s21 offen offset:0 nt lds
v_mfma_f32_16x16x32_bf16 v[132:135], a[212:215], v[44:47], v[132:135]
ds_read_b64_tr_b16 a[206:207], v90 offset:34528
ds_read_b64_tr_b16 a[236:237], v91 offset:34016
v_mfma_f32_16x16x32_bf16 v[136:139], a[216:219], v[44:47], v[136:139]
ds_read_b64_tr_b16 a[238:239], v91 offset:34528
v_cvt_pk_bf16_f32 v37, v86, v87
v_mfma_f32_16x16x32_bf16 v[136:139], a[184:187], v[40:43], v[136:139]
v_exp_f32 v68, v68
v_mfma_f32_16x16x32_bf16 v[140:143], a[188:191], v[40:43], v[140:143]
v_exp_f32 v69, v69
v_mfma_f32_16x16x32_bf16 v[140:143], a[220:223], v[44:47], v[140:143]
v_exp_f32 v70, v70
v_mfma_f32_16x16x32_bf16 v[144:147], a[224:227], v[44:47], v[144:147]
s_waitcnt lgkmcnt(5)
v_exp_f32 v71, v71
v_mfma_f32_16x16x32_bf16 v[144:147], a[192:195], v[40:43], v[144:147]
v_cvt_pk_bf16_f32 v38, v68, v69
v_cvt_pk_bf16_f32 v39, v70, v71
v_mfma_f32_16x16x32_bf16 v[148:151], a[196:199], v[40:43], v[148:151]
v_exp_f32 v72, v72
v_mfma_f32_16x16x32_bf16 v[148:151], a[228:231], v[44:47], v[148:151]
v_exp_f32 v73, v73
v_mfma_f32_16x16x32_bf16 v[152:155], a[232:235], v[44:47], v[152:155]
s_waitcnt lgkmcnt(0)
v_exp_f32 v74, v74
v_mfma_f32_16x16x32_bf16 v[152:155], a[200:203], v[40:43], v[152:155]
s_add_u32 m0, s24, 4384
v_exp_f32 v75, v75
v_mfma_f32_16x16x32_bf16 v[156:159], a[204:207], v[40:43], v[156:159]
v_cvt_pk_bf16_f32 v32, v72, v73
v_cvt_pk_bf16_f32 v33, v74, v75
v_mfma_f32_16x16x32_bf16 v[156:159], a[236:239], v[44:47], v[156:159]
buffer_load_dwordx4 v96, s[4:7], s37 offen offset:1024 nt lds
v_smfmac_f32_16x16x64_bf16 a[240:243], a[248:251], v[40:47], v92
s_waitcnt vmcnt(11)
ds_read_b128 v[108:111], v99 offset:2112
v_mfma_f32_16x16x32_bf16 v[80:83], a[144:147], a[32:35], v[56:59]
v_exp_f32 v76, v76
v_mfma_f32_16x16x32_bf16 v[80:83], a[148:151], a[36:39], v[80:83]
v_exp_f32 v77, v77
v_mfma_f32_16x16x32_bf16 v[80:83], a[152:155], a[40:43], v[80:83]
v_exp_f32 v78, v78
v_mfma_f32_16x16x32_bf16 v[80:83], a[156:159], a[44:47], v[80:83]
v_exp_f32 v79, v79
v_mfma_f32_16x16x32_bf16 v[84:87], a[172:175], a[44:47], v[56:59]
v_cvt_pk_bf16_f32 v34, v76, v77
v_cvt_pk_bf16_f32 v35, v78, v79
v_mfma_f32_16x16x32_bf16 v[84:87], a[168:171], a[40:43], v[84:87]
s_waitcnt vmcnt(10)
ds_read_b128 v[112:115], v99 offset:3168
v_mfma_f32_16x16x32_bf16 v[84:87], a[164:167], a[36:39], v[84:87]
s_waitcnt lgkmcnt(1)
v_lshlrev_b32 v116, 16, v108
v_and_b32 v108, s36, v108
v_mfma_f32_16x16x32_bf16 v[84:87], a[160:163], a[32:35], v[84:87]
v_exp_f32 v80, v80
v_mfma_f32_16x16x32_bf16 v[68:71], a[112:115], a[32:35], v[56:59]
v_exp_f32 v81, v81
v_mfma_f32_16x16x32_bf16 v[68:71], a[116:119], a[36:39], v[68:71]
v_exp_f32 v82, v82
v_mfma_f32_16x16x32_bf16 v[68:71], a[120:123], a[40:43], v[68:71]
s_add_u32 m0, s24, 4416
v_exp_f32 v83, v83
v_mfma_f32_16x16x32_bf16 v[68:71], a[124:127], a[44:47], v[68:71]
v_cvt_pk_bf16_f32 v44, v80, v81
v_cvt_pk_bf16_f32 v45, v82, v83
v_mfma_f32_16x16x32_bf16 v[72:75], a[140:143], a[44:47], v[56:59]
buffer_load_dwordx4 v96, s[4:7], s37 offen offset:2048 nt lds
v_mfma_f32_16x16x32_bf16 v[72:75], a[136:139], a[40:43], v[72:75]
v_exp_f32 v84, v84
v_mfma_f32_16x16x32_bf16 v[72:75], a[132:135], a[36:39], v[72:75]
v_exp_f32 v85, v85
v_mfma_f32_16x16x32_bf16 v[72:75], a[128:131], a[32:35], v[72:75]
v_exp_f32 v86, v86
v_mfma_f32_16x16x32_bf16 v[160:163], a[208:211], v[36:39], v[160:163]
v_exp_f32 v87, v87
v_mfma_f32_16x16x32_bf16 v[160:163], a[176:179], v[32:35], v[160:163]
v_cvt_pk_bf16_f32 v46, v84, v85
v_cvt_pk_bf16_f32 v47, v86, v87
v_mfma_f32_16x16x32_bf16 v[164:167], a[180:183], v[32:35], v[164:167]
v_exp_f32 v68, v68
v_mfma_f32_16x16x32_bf16 v[164:167], a[212:215], v[36:39], v[164:167]
v_exp_f32 v69, v69
v_mfma_f32_16x16x32_bf16 v[168:171], a[216:219], v[36:39], v[168:171]
v_exp_f32 v70, v70
v_mfma_f32_16x16x32_bf16 v[168:171], a[184:187], v[32:35], v[168:171]
v_exp_f32 v71, v71
v_mfma_f32_16x16x32_bf16 v[172:175], a[188:191], v[32:35], v[172:175]
v_cvt_pk_bf16_f32 v40, v68, v69
v_cvt_pk_bf16_f32 v41, v70, v71
v_mfma_f32_16x16x32_bf16 v[172:175], a[220:223], v[36:39], v[172:175]
s_xor_b32 s21, s23, 19456
v_exp_f32 v72, v72
v_mfma_f32_16x16x32_bf16 v[176:179], a[224:227], v[36:39], v[176:179]
s_add_u32 m0, s22, 16896
v_exp_f32 v73, v73
v_mfma_f32_16x16x32_bf16 v[176:179], a[192:195], v[32:35], v[176:179]
v_exp_f32 v74, v74
v_mfma_f32_16x16x32_bf16 v[180:183], a[196:199], v[32:35], v[180:183]
buffer_load_dwordx4 v97, s[8:11], s21 offen offset:0 nt lds
v_mfma_f32_16x16x32_bf16 v[180:183], a[228:231], v[36:39], v[180:183]
v_exp_f32 v75, v75
v_mfma_f32_16x16x32_bf16 v[184:187], a[232:235], v[36:39], v[184:187]
v_cvt_pk_bf16_f32 v42, v72, v73
v_cvt_pk_bf16_f32 v43, v74, v75
v_mfma_f32_16x16x32_bf16 v[184:187], a[200:203], v[32:35], v[184:187]
v_mul_f32 v116, s38, v116
v_mul_f32 v108, s38, v108
v_mfma_f32_16x16x32_bf16 v[188:191], a[204:207], v[32:35], v[188:191]
v_cvt_pk_bf16_f32 v108, v116, v108
v_lshlrev_b32 v117, 16, v109
v_mfma_f32_16x16x32_bf16 v[188:191], a[236:239], v[36:39], v[188:191]
v_and_b32 v109, s36, v109
v_mul_f32 v117, s38, v117
v_smfmac_f32_16x16x64_bf16 a[240:243], a[252:255], v[32:39], v92
v_mul_f32 v109, s38, v109
v_mfma_f32_16x16x32_bf16 v[76:79], a[144:147], a[48:51], v[60:63]
v_cvt_pk_bf16_f32 v109, v117, v109
v_lshlrev_b32 v118, 16, v110
v_mfma_f32_16x16x32_bf16 v[76:79], a[148:151], a[52:55], v[76:79]
v_and_b32 v110, s36, v110
v_mul_f32 v118, s38, v118
v_mfma_f32_16x16x32_bf16 v[76:79], a[152:155], a[56:59], v[76:79]
v_mul_f32 v110, s38, v110
v_cvt_pk_bf16_f32 v110, v118, v110
v_mfma_f32_16x16x32_bf16 v[76:79], a[156:159], a[60:63], v[76:79]
v_lshlrev_b32 v119, 16, v111
v_and_b32 v111, s36, v111
v_mfma_f32_16x16x32_bf16 v[80:83], a[172:175], a[60:63], v[60:63]
s_xor_b32 s21, s23, 23552
v_mul_f32 v119, s38, v119
v_mul_f32 v111, s38, v111
v_mfma_f32_16x16x32_bf16 v[80:83], a[168:171], a[56:59], v[80:83]
s_add_u32 m0, s22, 17952
v_cvt_pk_bf16_f32 v111, v119, v111
s_waitcnt lgkmcnt(0)
v_lshlrev_b32 v116, 16, v112
v_mfma_f32_16x16x32_bf16 v[80:83], a[164:167], a[52:55], v[80:83]
v_and_b32 v112, s36, v112
v_mul_f32 v116, s38, v116
v_mfma_f32_16x16x32_bf16 v[80:83], a[160:163], a[48:51], v[80:83]
buffer_load_dwordx4 v97, s[8:11], s21 offen offset:0 nt lds
v_mfma_f32_16x16x32_bf16 v[84:87], a[112:115], a[48:51], v[60:63]
v_exp_f32 v76, v76
v_mfma_f32_16x16x32_bf16 v[84:87], a[116:119], a[52:55], v[84:87]
v_exp_f32 v77, v77
v_mfma_f32_16x16x32_bf16 v[84:87], a[120:123], a[56:59], v[84:87]
v_exp_f32 v78, v78
v_mfma_f32_16x16x32_bf16 v[84:87], a[124:127], a[60:63], v[84:87]
v_exp_f32 v79, v79
v_mfma_f32_16x16x32_bf16 v[68:71], a[140:143], a[60:63], v[60:63]
v_cvt_pk_bf16_f32 v36, v76, v77
v_cvt_pk_bf16_f32 v37, v78, v79
v_mfma_f32_16x16x32_bf16 v[68:71], a[136:139], a[56:59], v[68:71]
v_exp_f32 v80, v80
v_mfma_f32_16x16x32_bf16 v[68:71], a[132:135], a[52:55], v[68:71]
v_exp_f32 v81, v81
v_mfma_f32_16x16x32_bf16 v[68:71], a[128:131], a[48:51], v[68:71]
v_exp_f32 v82, v82
v_mfma_f32_16x16x32_bf16 v[192:195], a[208:211], v[44:47], v[192:195]
v_exp_f32 v83, v83
v_mfma_f32_16x16x32_bf16 v[192:195], a[176:179], v[40:43], v[192:195]
v_cvt_pk_bf16_f32 v38, v80, v81
v_cvt_pk_bf16_f32 v39, v82, v83
v_mfma_f32_16x16x32_bf16 v[196:199], a[180:183], v[40:43], v[196:199]
s_xor_b32 s21, s23, 27648
v_exp_f32 v84, v84
v_mfma_f32_16x16x32_bf16 v[196:199], a[212:215], v[44:47], v[196:199]
s_add_u32 m0, s22, 19008
v_exp_f32 v85, v85
v_mfma_f32_16x16x32_bf16 v[200:203], a[216:219], v[44:47], v[200:203]
v_exp_f32 v86, v86
v_mfma_f32_16x16x32_bf16 v[200:203], a[184:187], v[40:43], v[200:203]
buffer_load_dwordx4 v97, s[8:11], s21 offen offset:0 nt lds
v_mfma_f32_16x16x32_bf16 v[204:207], a[188:191], v[40:43], v[204:207]
v_exp_f32 v87, v87
v_mfma_f32_16x16x32_bf16 v[204:207], a[220:223], v[44:47], v[204:207]
v_exp_f32 v68, v68
v_mfma_f32_16x16x32_bf16 v[208:211], a[224:227], v[44:47], v[208:211]
v_exp_f32 v69, v69
v_mfma_f32_16x16x32_bf16 v[208:211], a[192:195], v[40:43], v[208:211]
v_exp_f32 v70, v70
v_mfma_f32_16x16x32_bf16 v[212:215], a[196:199], v[40:43], v[212:215]
v_exp_f32 v71, v71
v_mfma_f32_16x16x32_bf16 v[212:215], a[228:231], v[44:47], v[212:215]
v_cvt_pk_bf16_f32 v32, v84, v85
v_cvt_pk_bf16_f32 v33, v86, v87
v_mfma_f32_16x16x32_bf16 v[216:219], a[232:235], v[44:47], v[216:219]
v_cvt_pk_bf16_f32 v34, v68, v69
v_cvt_pk_bf16_f32 v35, v70, v71
v_mfma_f32_16x16x32_bf16 v[216:219], a[200:203], v[40:43], v[216:219]
v_mul_f32 v112, s38, v112
v_cvt_pk_bf16_f32 v112, v116, v112
v_mfma_f32_16x16x32_bf16 v[220:223], a[204:207], v[40:43], v[220:223]
s_waitcnt vmcnt(5)
s_barrier
v_mfma_f32_16x16x32_bf16 v[220:223], a[236:239], v[44:47], v[220:223]
ds_read_b128 a[144:147], v89 offset:0
v_lshlrev_b32 v117, 16, v113
v_smfmac_f32_16x16x64_bf16 a[244:247], a[248:251], v[40:47], v92
s_xor_b32 s21, s23, 31744
ds_read_b128 a[148:151], v89 offset:64
v_mfma_f32_16x16x32_bf16 v[72:75], a[112:115], a[64:67], v[64:67]
s_add_u32 m0, s22, 20064
ds_read_b128 a[152:155], v89 offset:128
v_and_b32 v113, s36, v113
v_mfma_f32_16x16x32_bf16 v[72:75], a[116:119], a[68:71], v[72:75]
ds_read_b128 a[156:159], v89 offset:192
v_mul_f32 v117, s38, v117
v_mfma_f32_16x16x32_bf16 v[72:75], a[120:123], a[72:75], v[72:75]
buffer_load_dwordx4 v97, s[8:11], s21 offen offset:0 nt lds
v_mfma_f32_16x16x32_bf16 v[72:75], a[124:127], a[76:79], v[72:75]
ds_read_b128 a[172:175], v89 offset:704
v_mul_f32 v113, s38, v113
v_mfma_f32_16x16x32_bf16 v[76:79], a[140:143], a[76:79], v[64:67]
ds_read_b128 a[168:171], v89 offset:640
v_cvt_pk_bf16_f32 v113, v117, v113
v_mfma_f32_16x16x32_bf16 v[76:79], a[136:139], a[72:75], v[76:79]
ds_read_b128 a[164:167], v89 offset:576
v_lshlrev_b32 v118, 16, v114
v_mfma_f32_16x16x32_bf16 v[76:79], a[132:135], a[68:71], v[76:79]
ds_read_b128 a[160:163], v89 offset:512
v_and_b32 v114, s36, v114
v_mfma_f32_16x16x32_bf16 v[76:79], a[128:131], a[64:67], v[76:79]
ds_read_b128 a[112:115], v88 offset:0
v_mul_f32 v118, s38, v118
v_mfma_f32_16x16x32_bf16 v[224:227], a[208:211], v[36:39], v[224:227]
ds_read_b128 a[116:119], v88 offset:64
v_mul_f32 v114, s38, v114
v_mfma_f32_16x16x32_bf16 v[224:227], a[176:179], v[32:35], v[224:227]
ds_read_b128 a[120:123], v88 offset:128
v_cvt_pk_bf16_f32 v114, v118, v114
v_mfma_f32_16x16x32_bf16 v[228:231], a[180:183], v[32:35], v[228:231]
ds_read_b128 a[124:127], v88 offset:192
v_lshlrev_b32 v119, 16, v115
v_mfma_f32_16x16x32_bf16 v[228:231], a[212:215], v[36:39], v[228:231]
ds_read_b128 a[140:143], v88 offset:704
v_and_b32 v115, s36, v115
v_mfma_f32_16x16x32_bf16 v[232:235], a[216:219], v[36:39], v[232:235]
ds_read_b128 a[136:139], v88 offset:640
v_mul_f32 v119, s38, v119
v_mfma_f32_16x16x32_bf16 v[232:235], a[184:187], v[32:35], v[232:235]
ds_read_b128 a[132:135], v88 offset:576
v_mul_f32 v115, s38, v115
v_mfma_f32_16x16x32_bf16 v[236:239], a[188:191], v[32:35], v[236:239]
s_xor_b32 s21, s23, 19456
ds_read_b128 a[128:131], v88 offset:512
v_cvt_pk_bf16_f32 v115, v119, v115
v_mfma_f32_16x16x32_bf16 v[236:239], a[220:223], v[36:39], v[236:239]
s_add_u32 m0, s22, 67584
v_exp_f32 v72, v72
v_mfma_f32_16x16x32_bf16 v[240:243], a[224:227], v[36:39], v[240:243]
v_exp_f32 v73, v73
v_mfma_f32_16x16x32_bf16 v[240:243], a[192:195], v[32:35], v[240:243]
buffer_load_dwordx4 v97, s[12:15], s21 offen offset:0 nt lds
v_mfma_f32_16x16x32_bf16 v[244:247], a[196:199], v[32:35], v[244:247]
v_exp_f32 v74, v74
v_mfma_f32_16x16x32_bf16 v[244:247], a[228:231], v[36:39], v[244:247]
v_exp_f32 v75, v75
v_mfma_f32_16x16x32_bf16 v[248:251], a[232:235], v[36:39], v[248:251]
v_cvt_pk_bf16_f32 v40, v72, v73
v_cvt_pk_bf16_f32 v41, v74, v75
v_mfma_f32_16x16x32_bf16 v[248:251], a[200:203], v[32:35], v[248:251]
v_exp_f32 v76, v76
v_mfma_f32_16x16x32_bf16 v[252:255], a[204:207], v[32:35], v[252:255]
v_exp_f32 v77, v77
v_mfma_f32_16x16x32_bf16 v[252:255], a[236:239], v[36:39], v[252:255]
v_exp_f32 v78, v78
v_smfmac_f32_16x16x64_bf16 a[244:247], a[252:255], v[32:39], v92
s_waitcnt lgkmcnt(0)
v_cvt_pk_bf16_f32 v42, v76, v77
v_mfma_f32_16x16x32_bf16 v[80:83], a[144:147], a[0:3], v[48:51]
v_exp_f32 v79, v79
v_mfma_f32_16x16x32_bf16 v[80:83], a[148:151], a[4:7], v[80:83]
ds_read_b64_tr_b16 a[208:209], v91 offset:0
v_cvt_pk_bf16_f32 v43, v78, v79
v_mfma_f32_16x16x32_bf16 v[80:83], a[152:155], a[8:11], v[80:83]
ds_read_b64_tr_b16 a[210:211], v91 offset:512
ds_read_b64_tr_b16 a[212:213], v91 offset:32
v_mfma_f32_16x16x32_bf16 v[80:83], a[156:159], a[12:15], v[80:83]
s_xor_b32 s21, s23, 23552
v_mfma_f32_16x16x32_bf16 v[84:87], a[172:175], a[12:15], v[48:51]
s_add_u32 m0, s22, 68640
ds_read_b64_tr_b16 a[214:215], v91 offset:544
ds_read_b64_tr_b16 a[216:217], v91 offset:64
v_mfma_f32_16x16x32_bf16 v[84:87], a[168:171], a[8:11], v[84:87]
ds_write_b128 v99, v[108:111] offset:2112
v_mfma_f32_16x16x32_bf16 v[84:87], a[164:167], a[4:7], v[84:87]
buffer_load_dwordx4 v97, s[12:15], s21 offen offset:0 nt lds
v_mfma_f32_16x16x32_bf16 v[84:87], a[160:163], a[0:3], v[84:87]
v_exp_f32 v80, v80
v_mfma_f32_16x16x32_bf16 v[68:71], a[112:115], a[0:3], v[48:51]
v_exp_f32 v81, v81
v_mfma_f32_16x16x32_bf16 v[68:71], a[116:119], a[4:7], v[68:71]
v_exp_f32 v82, v82
v_mfma_f32_16x16x32_bf16 v[68:71], a[120:123], a[8:11], v[68:71]
v_exp_f32 v83, v83
v_mfma_f32_16x16x32_bf16 v[68:71], a[124:127], a[12:15], v[68:71]
v_cvt_pk_bf16_f32 v36, v80, v81
v_cvt_pk_bf16_f32 v37, v82, v83
v_mfma_f32_16x16x32_bf16 v[72:75], a[140:143], a[12:15], v[48:51]
v_exp_f32 v84, v84
v_mfma_f32_16x16x32_bf16 v[72:75], a[136:139], a[8:11], v[72:75]
v_exp_f32 v85, v85
v_mfma_f32_16x16x32_bf16 v[72:75], a[132:135], a[4:7], v[72:75]
v_exp_f32 v86, v86
v_mfma_f32_16x16x32_bf16 v[72:75], a[128:131], a[0:3], v[72:75]
v_exp_f32 v87, v87
v_mfma_f32_16x16x32_bf16 v[104:107], a[248:251], v[40:43], v[104:107]
v_cvt_pk_bf16_f32 v38, v84, v85
v_cvt_pk_bf16_f32 v39, v86, v87
v_mfma_f32_16x16x32_bf16 a[80:83], a[176:179], v[40:43], a[80:83]
s_xor_b32 s21, s23, 27648
v_exp_f32 v68, v68
v_mfma_f32_16x16x32_bf16 a[84:87], a[180:183], v[40:43], a[84:87]
s_add_u32 m0, s22, 69696
v_exp_f32 v69, v69
v_mfma_f32_16x16x32_bf16 a[88:91], a[184:187], v[40:43], a[88:91]
v_exp_f32 v70, v70
v_mfma_f32_16x16x32_bf16 a[92:95], a[188:191], v[40:43], a[92:95]
buffer_load_dwordx4 v97, s[12:15], s21 offen offset:0 nt lds
v_mfma_f32_16x16x32_bf16 a[96:99], a[192:195], v[40:43], a[96:99]
v_exp_f32 v71, v71
v_mfma_f32_16x16x32_bf16 a[100:103], a[196:199], v[40:43], a[100:103]
ds_read_b64_tr_b16 a[176:177], v90 offset:0
ds_read_b64_tr_b16 a[178:179], v90 offset:512
v_mfma_f32_16x16x32_bf16 a[104:107], a[200:203], v[40:43], a[104:107]
v_cvt_pk_bf16_f32 v32, v68, v69
v_cvt_pk_bf16_f32 v33, v70, v71
v_mfma_f32_16x16x32_bf16 a[108:111], a[204:207], v[40:43], a[108:111]
ds_read_b64_tr_b16 a[180:181], v90 offset:32
ds_read_b64_tr_b16 a[182:183], v90 offset:544
v_mfma_f32_16x16x32_bf16 v[76:79], a[144:147], a[16:19], v[52:55]
v_exp_f32 v72, v72
v_mfma_f32_16x16x32_bf16 v[76:79], a[148:151], a[20:23], v[76:79]
ds_read_b64_tr_b16 a[218:219], v91 offset:576
ds_read_b64_tr_b16 a[184:185], v90 offset:64
v_mfma_f32_16x16x32_bf16 v[76:79], a[152:155], a[24:27], v[76:79]
v_exp_f32 v73, v73
v_mfma_f32_16x16x32_bf16 v[76:79], a[156:159], a[28:31], v[76:79]
v_exp_f32 v74, v74
v_mfma_f32_16x16x32_bf16 v[80:83], a[172:175], a[28:31], v[52:55]
v_exp_f32 v75, v75
v_mfma_f32_16x16x32_bf16 v[80:83], a[168:171], a[24:27], v[80:83]
ds_read_b64_tr_b16 a[186:187], v90 offset:576
v_cvt_pk_bf16_f32 v34, v72, v73
v_mfma_f32_16x16x32_bf16 v[80:83], a[164:167], a[20:23], v[80:83]
s_xor_b32 s21, s23, 31744
ds_read_b64_tr_b16 a[188:189], v90 offset:96
v_cvt_pk_bf16_f32 v35, v74, v75
v_mfma_f32_16x16x32_bf16 v[80:83], a[160:163], a[16:19], v[80:83]
s_add_u32 m0, s22, 70752
ds_read_b64_tr_b16 a[190:191], v90 offset:608
ds_read_b64_tr_b16 a[220:221], v91 offset:96
v_mfma_f32_16x16x32_bf16 v[84:87], a[112:115], a[16:19], v[52:55]
v_exp_f32 v76, v76
v_mfma_f32_16x16x32_bf16 v[84:87], a[116:119], a[20:23], v[84:87]
buffer_load_dwordx4 v97, s[12:15], s21 offen offset:0 nt lds
v_mfma_f32_16x16x32_bf16 v[84:87], a[120:123], a[24:27], v[84:87]
ds_read_b64_tr_b16 a[222:223], v91 offset:608
ds_read_b64_tr_b16 a[224:225], v91 offset:128
v_mfma_f32_16x16x32_bf16 v[84:87], a[124:127], a[28:31], v[84:87]
v_exp_f32 v77, v77
v_mfma_f32_16x16x32_bf16 v[68:71], a[140:143], a[28:31], v[52:55]
ds_read_b64_tr_b16 a[226:227], v91 offset:640
ds_read_b64_tr_b16 a[192:193], v90 offset:128
v_mfma_f32_16x16x32_bf16 v[68:71], a[136:139], a[24:27], v[68:71]
ds_read_b64_tr_b16 a[194:195], v90 offset:640
v_cvt_pk_bf16_f32 v44, v76, v77
v_mfma_f32_16x16x32_bf16 v[68:71], a[132:135], a[20:23], v[68:71]
ds_read_b64_tr_b16 a[196:197], v90 offset:160
ds_read_b64_tr_b16 a[198:199], v90 offset:672
v_mfma_f32_16x16x32_bf16 v[68:71], a[128:131], a[16:19], v[68:71]
s_waitcnt lgkmcnt(7)
v_exp_f32 v78, v78
v_mfma_f32_16x16x32_bf16 v[128:131], a[208:211], v[36:39], v[128:131]
ds_read_b64_tr_b16 a[228:229], v91 offset:160
ds_read_b64_tr_b16 a[230:231], v91 offset:672
v_mfma_f32_16x16x32_bf16 v[128:131], a[176:179], v[32:35], v[128:131]
v_exp_f32 v79, v79
v_mfma_f32_16x16x32_bf16 v[132:135], a[180:183], v[32:35], v[132:135]
ds_read_b64_tr_b16 a[232:233], v91 offset:192
ds_read_b64_tr_b16 a[234:235], v91 offset:704
v_mfma_f32_16x16x32_bf16 v[132:135], a[212:215], v[36:39], v[132:135]
ds_read_b64_tr_b16 a[200:201], v90 offset:192
v_cvt_pk_bf16_f32 v45, v78, v79
v_mfma_f32_16x16x32_bf16 v[136:139], a[216:219], v[36:39], v[136:139]
ds_read_b64_tr_b16 a[202:203], v90 offset:704
ds_read_b64_tr_b16 a[204:205], v90 offset:224
v_mfma_f32_16x16x32_bf16 v[136:139], a[184:187], v[32:35], v[136:139]
s_add_u32 m0, s24, 4448
v_exp_f32 v80, v80
v_mfma_f32_16x16x32_bf16 v[140:143], a[188:191], v[32:35], v[140:143]
s_waitcnt lgkmcnt(7)
ds_read_b64_tr_b16 a[206:207], v90 offset:736
ds_read_b64_tr_b16 a[236:237], v91 offset:224
v_mfma_f32_16x16x32_bf16 v[140:143], a[220:223], v[36:39], v[140:143]
buffer_load_dwordx4 v96, s[4:7], s37 offen offset:3072 nt lds
v_mfma_f32_16x16x32_bf16 v[144:147], a[224:227], v[36:39], v[144:147]
ds_read_b64_tr_b16 a[238:239], v91 offset:736
v_mfma_f32_16x16x32_bf16 v[144:147], a[192:195], v[32:35], v[144:147]
v_exp_f32 v81, v81
v_mfma_f32_16x16x32_bf16 v[148:151], a[196:199], v[32:35], v[148:151]
s_waitcnt lgkmcnt(6)
v_exp_f32 v82, v82
v_mfma_f32_16x16x32_bf16 v[148:151], a[228:231], v[36:39], v[148:151]
v_exp_f32 v83, v83
v_mfma_f32_16x16x32_bf16 v[152:155], a[232:235], v[36:39], v[152:155]
s_waitcnt lgkmcnt(3)
v_cvt_pk_bf16_f32 v46, v80, v81
v_cvt_pk_bf16_f32 v47, v82, v83
v_mfma_f32_16x16x32_bf16 v[152:155], a[200:203], v[32:35], v[152:155]
s_waitcnt lgkmcnt(2)
v_exp_f32 v84, v84
v_mfma_f32_16x16x32_bf16 v[156:159], a[204:207], v[32:35], v[156:159]
s_waitcnt lgkmcnt(0)
v_exp_f32 v85, v85
v_mfma_f32_16x16x32_bf16 v[156:159], a[236:239], v[36:39], v[156:159]
v_exp_f32 v86, v86
v_smfmac_f32_16x16x64_bf16 a[240:243], a[248:251], v[32:39], v92
v_cvt_pk_bf16_f32 v40, v84, v85
v_mfma_f32_16x16x32_bf16 v[72:75], a[144:147], a[32:35], v[56:59]
v_exp_f32 v87, v87
v_mfma_f32_16x16x32_bf16 v[72:75], a[148:151], a[36:39], v[72:75]
s_add_u32 s37, s32, 73728
v_exp_f32 v68, v68
v_mfma_f32_16x16x32_bf16 v[72:75], a[152:155], a[40:43], v[72:75]
s_add_u32 m0, s24, 8704
v_exp_f32 v69, v69
v_mfma_f32_16x16x32_bf16 v[72:75], a[156:159], a[44:47], v[72:75]
v_cvt_pk_bf16_f32 v41, v86, v87
v_cvt_pk_bf16_f32 v42, v68, v69
v_mfma_f32_16x16x32_bf16 v[76:79], a[172:175], a[44:47], v[56:59]
buffer_load_dwordx4 v96, s[4:7], s37 offen offset:0 nt lds
v_mfma_f32_16x16x32_bf16 v[76:79], a[168:171], a[40:43], v[76:79]
v_exp_f32 v70, v70
v_mfma_f32_16x16x32_bf16 v[76:79], a[164:167], a[36:39], v[76:79]
v_exp_f32 v71, v71
v_mfma_f32_16x16x32_bf16 v[76:79], a[160:163], a[32:35], v[76:79]
v_exp_f32 v72, v72
v_mfma_f32_16x16x32_bf16 v[80:83], a[112:115], a[32:35], v[56:59]
v_exp_f32 v73, v73
v_mfma_f32_16x16x32_bf16 v[80:83], a[116:119], a[36:39], v[80:83]
v_cvt_pk_bf16_f32 v43, v70, v71
v_cvt_pk_bf16_f32 v36, v72, v73
v_mfma_f32_16x16x32_bf16 v[80:83], a[120:123], a[40:43], v[80:83]
v_exp_f32 v74, v74
v_mfma_f32_16x16x32_bf16 v[80:83], a[124:127], a[44:47], v[80:83]
v_exp_f32 v75, v75
v_mfma_f32_16x16x32_bf16 v[84:87], a[140:143], a[44:47], v[56:59]
v_exp_f32 v76, v76
v_mfma_f32_16x16x32_bf16 v[84:87], a[136:139], a[40:43], v[84:87]
v_exp_f32 v77, v77
v_mfma_f32_16x16x32_bf16 v[84:87], a[132:135], a[36:39], v[84:87]
v_cvt_pk_bf16_f32 v37, v74, v75
v_cvt_pk_bf16_f32 v38, v76, v77
v_mfma_f32_16x16x32_bf16 v[84:87], a[128:131], a[32:35], v[84:87]
v_exp_f32 v78, v78
v_mfma_f32_16x16x32_bf16 v[160:163], a[208:211], v[44:47], v[160:163]
s_add_u32 m0, s24, 8736
v_exp_f32 v79, v79
v_mfma_f32_16x16x32_bf16 v[160:163], a[176:179], v[40:43], v[160:163]
v_exp_f32 v80, v80
v_mfma_f32_16x16x32_bf16 v[164:167], a[180:183], v[40:43], v[164:167]
buffer_load_dwordx4 v96, s[4:7], s37 offen offset:1024 nt lds
v_mfma_f32_16x16x32_bf16 v[164:167], a[212:215], v[44:47], v[164:167]
v_exp_f32 v81, v81
v_mfma_f32_16x16x32_bf16 v[168:171], a[216:219], v[44:47], v[168:171]
v_cvt_pk_bf16_f32 v39, v78, v79
v_cvt_pk_bf16_f32 v32, v80, v81
v_mfma_f32_16x16x32_bf16 v[168:171], a[184:187], v[40:43], v[168:171]
v_exp_f32 v82, v82
v_mfma_f32_16x16x32_bf16 v[172:175], a[188:191], v[40:43], v[172:175]
v_exp_f32 v83, v83
v_mfma_f32_16x16x32_bf16 v[172:175], a[220:223], v[44:47], v[172:175]
v_exp_f32 v84, v84
v_mfma_f32_16x16x32_bf16 v[176:179], a[224:227], v[44:47], v[176:179]
v_exp_f32 v85, v85
v_mfma_f32_16x16x32_bf16 v[176:179], a[192:195], v[40:43], v[176:179]
v_cvt_pk_bf16_f32 v33, v82, v83
v_cvt_pk_bf16_f32 v34, v84, v85
v_mfma_f32_16x16x32_bf16 v[180:183], a[196:199], v[40:43], v[180:183]
v_exp_f32 v86, v86
v_mfma_f32_16x16x32_bf16 v[180:183], a[228:231], v[44:47], v[180:183]
v_exp_f32 v87, v87
v_mfma_f32_16x16x32_bf16 v[184:187], a[232:235], v[44:47], v[184:187]
ds_write_b128 v99, v[112:115] offset:3168
v_mfma_f32_16x16x32_bf16 v[184:187], a[200:203], v[40:43], v[184:187]
v_cvt_pk_bf16_f32 v35, v86, v87
v_mfma_f32_16x16x32_bf16 v[188:191], a[204:207], v[40:43], v[188:191]
s_xor_b32 s21, s23, 131072
v_mfma_f32_16x16x32_bf16 v[188:191], a[236:239], v[44:47], v[188:191]
s_add_u32 m0, s22, 33792
v_smfmac_f32_16x16x64_bf16 a[240:243], a[252:255], v[40:47], v92
v_mfma_f32_16x16x32_bf16 v[68:71], a[144:147], a[48:51], v[60:63]
buffer_load_dwordx4 v97, s[8:11], s21 offen offset:0 nt lds
v_mfma_f32_16x16x32_bf16 v[68:71], a[148:151], a[52:55], v[68:71]
v_mfma_f32_16x16x32_bf16 v[68:71], a[152:155], a[56:59], v[68:71]
v_mfma_f32_16x16x32_bf16 v[68:71], a[156:159], a[60:63], v[68:71]
v_mfma_f32_16x16x32_bf16 v[72:75], a[172:175], a[60:63], v[60:63]
v_mfma_f32_16x16x32_bf16 v[72:75], a[168:171], a[56:59], v[72:75]
v_mfma_f32_16x16x32_bf16 v[72:75], a[164:167], a[52:55], v[72:75]
v_mfma_f32_16x16x32_bf16 v[72:75], a[160:163], a[48:51], v[72:75]
v_mfma_f32_16x16x32_bf16 v[76:79], a[112:115], a[48:51], v[60:63]
v_mfma_f32_16x16x32_bf16 v[76:79], a[116:119], a[52:55], v[76:79]
v_mfma_f32_16x16x32_bf16 v[76:79], a[120:123], a[56:59], v[76:79]
v_mfma_f32_16x16x32_bf16 v[76:79], a[124:127], a[60:63], v[76:79]
s_xor_b32 s21, s23, 135168
v_exp_f32 v68, v68
v_mfma_f32_16x16x32_bf16 v[80:83], a[140:143], a[60:63], v[60:63]
s_add_u32 m0, s22, 34848
v_exp_f32 v69, v69
v_mfma_f32_16x16x32_bf16 v[80:83], a[136:139], a[56:59], v[80:83]
v_exp_f32 v70, v70
v_mfma_f32_16x16x32_bf16 v[80:83], a[132:135], a[52:55], v[80:83]
buffer_load_dwordx4 v97, s[8:11], s21 offen offset:0 nt lds
v_mfma_f32_16x16x32_bf16 v[80:83], a[128:131], a[48:51], v[80:83]
v_exp_f32 v71, v71
v_mfma_f32_16x16x32_bf16 v[192:195], a[208:211], v[36:39], v[192:195]
v_cvt_pk_bf16_f32 v44, v68, v69
v_cvt_pk_bf16_f32 v45, v70, v71
v_mfma_f32_16x16x32_bf16 v[192:195], a[176:179], v[32:35], v[192:195]
v_exp_f32 v72, v72
v_mfma_f32_16x16x32_bf16 v[196:199], a[180:183], v[32:35], v[196:199]
v_exp_f32 v73, v73
v_mfma_f32_16x16x32_bf16 v[196:199], a[212:215], v[36:39], v[196:199]
v_exp_f32 v74, v74
v_mfma_f32_16x16x32_bf16 v[200:203], a[216:219], v[36:39], v[200:203]
v_exp_f32 v75, v75
v_mfma_f32_16x16x32_bf16 v[200:203], a[184:187], v[32:35], v[200:203]
v_cvt_pk_bf16_f32 v46, v72, v73
v_cvt_pk_bf16_f32 v47, v74, v75
v_mfma_f32_16x16x32_bf16 v[204:207], a[188:191], v[32:35], v[204:207]
v_exp_f32 v76, v76
v_mfma_f32_16x16x32_bf16 v[204:207], a[220:223], v[36:39], v[204:207]
v_exp_f32 v77, v77
v_mfma_f32_16x16x32_bf16 v[208:211], a[224:227], v[36:39], v[208:211]
v_exp_f32 v78, v78
v_mfma_f32_16x16x32_bf16 v[208:211], a[192:195], v[32:35], v[208:211]
s_xor_b32 s21, s23, 139264
v_exp_f32 v79, v79
v_mfma_f32_16x16x32_bf16 v[212:215], a[196:199], v[32:35], v[212:215]
s_add_u32 m0, s22, 35904
v_exp_f32 v80, v80
v_mfma_f32_16x16x32_bf16 v[212:215], a[228:231], v[36:39], v[212:215]
v_exp_f32 v81, v81
v_mfma_f32_16x16x32_bf16 v[216:219], a[232:235], v[36:39], v[216:219]
buffer_load_dwordx4 v97, s[8:11], s21 offen offset:0 nt lds
v_mfma_f32_16x16x32_bf16 v[216:219], a[200:203], v[32:35], v[216:219]
v_exp_f32 v82, v82
v_mfma_f32_16x16x32_bf16 v[220:223], a[204:207], v[32:35], v[220:223]
s_waitcnt vmcnt(6)
s_barrier
v_mfma_f32_16x16x32_bf16 v[220:223], a[236:239], v[36:39], v[220:223]
v_exp_f32 v83, v83
v_smfmac_f32_16x16x64_bf16 a[244:247], a[248:251], v[32:39], v92
v_cvt_pk_bf16_f32 v40, v76, v77
v_mfma_f32_16x16x32_bf16 v[84:87], a[112:115], a[64:67], v[64:67]
v_cvt_pk_bf16_f32 v41, v78, v79
v_cvt_pk_bf16_f32 v42, v80, v81
v_mfma_f32_16x16x32_bf16 v[84:87], a[116:119], a[68:71], v[84:87]
ds_read_b128 a[144:147], v89 offset:16896
v_cvt_pk_bf16_f32 v43, v82, v83
v_mfma_f32_16x16x32_bf16 v[84:87], a[120:123], a[72:75], v[84:87]
ds_read_b128 a[148:151], v89 offset:16960
v_mfma_f32_16x16x32_bf16 v[84:87], a[124:127], a[76:79], v[84:87]
ds_read_b128 a[152:155], v89 offset:17024
v_mfma_f32_16x16x32_bf16 v[68:71], a[140:143], a[76:79], v[64:67]
ds_read_b128 a[156:159], v89 offset:17088
v_mfma_f32_16x16x32_bf16 v[68:71], a[136:139], a[72:75], v[68:71]
ds_read_b128 a[172:175], v89 offset:17600
v_mfma_f32_16x16x32_bf16 v[68:71], a[132:135], a[68:71], v[68:71]
s_xor_b32 s21, s23, 143360
ds_read_b128 a[168:171], v89 offset:17536
v_mfma_f32_16x16x32_bf16 v[68:71], a[128:131], a[64:67], v[68:71]
s_add_u32 m0, s22, 36960
v_exp_f32 v84, v84
v_mfma_f32_16x16x32_bf16 v[224:227], a[208:211], v[44:47], v[224:227]
v_exp_f32 v85, v85
v_mfma_f32_16x16x32_bf16 v[224:227], a[176:179], v[40:43], v[224:227]
buffer_load_dwordx4 v97, s[8:11], s21 offen offset:0 nt lds
v_mfma_f32_16x16x32_bf16 v[228:231], a[180:183], v[40:43], v[228:231]
ds_read_b128 a[164:167], v89 offset:17472
v_cvt_pk_bf16_f32 v32, v84, v85
v_mfma_f32_16x16x32_bf16 v[228:231], a[212:215], v[44:47], v[228:231]
v_exp_f32 v86, v86
v_mfma_f32_16x16x32_bf16 v[232:235], a[216:219], v[44:47], v[232:235]
v_exp_f32 v87, v87
v_mfma_f32_16x16x32_bf16 v[232:235], a[184:187], v[40:43], v[232:235]
ds_read_b128 a[160:163], v89 offset:17408
v_cvt_pk_bf16_f32 v33, v86, v87
v_mfma_f32_16x16x32_bf16 v[236:239], a[188:191], v[40:43], v[236:239]
v_exp_f32 v68, v68
v_mfma_f32_16x16x32_bf16 v[236:239], a[220:223], v[44:47], v[236:239]
v_exp_f32 v69, v69
v_mfma_f32_16x16x32_bf16 v[240:243], a[224:227], v[44:47], v[240:243]
ds_read_b128 a[112:115], v88 offset:16896
v_cvt_pk_bf16_f32 v34, v68, v69
v_mfma_f32_16x16x32_bf16 v[240:243], a[192:195], v[40:43], v[240:243]
v_exp_f32 v70, v70
v_mfma_f32_16x16x32_bf16 v[244:247], a[196:199], v[40:43], v[244:247]
v_exp_f32 v71, v71
v_mfma_f32_16x16x32_bf16 v[244:247], a[228:231], v[44:47], v[244:247]
ds_read_b128 a[116:119], v88 offset:16960
v_cvt_pk_bf16_f32 v35, v70, v71
v_mfma_f32_16x16x32_bf16 v[248:251], a[232:235], v[44:47], v[248:251]
s_xor_b32 s21, s23, 131072
ds_read_b128 a[120:123], v88 offset:17024
v_mfma_f32_16x16x32_bf16 v[248:251], a[200:203], v[40:43], v[248:251]
s_add_u32 m0, s22, 84480
ds_read_b128 a[124:127], v88 offset:17088
v_mfma_f32_16x16x32_bf16 v[252:255], a[204:207], v[40:43], v[252:255]
ds_read_b128 a[140:143], v88 offset:17600
v_mfma_f32_16x16x32_bf16 v[252:255], a[236:239], v[44:47], v[252:255]
buffer_load_dwordx4 v97, s[12:15], s21 offen offset:0 nt lds
v_smfmac_f32_16x16x64_bf16 a[244:247], a[252:255], v[40:47], v92
s_waitcnt lgkmcnt(4)
ds_read_b128 a[136:139], v88 offset:17536
v_mfma_f32_16x16x32_bf16 v[72:75], a[144:147], a[0:3], v[48:51]
ds_read_b128 a[132:135], v88 offset:17472
v_mfma_f32_16x16x32_bf16 v[72:75], a[148:151], a[4:7], v[72:75]
ds_read_b128 a[128:131], v88 offset:17408
v_mfma_f32_16x16x32_bf16 v[72:75], a[152:155], a[8:11], v[72:75]
ds_read_b64_tr_b16 a[208:209], v91 offset:16896
ds_read_b64_tr_b16 a[210:211], v91 offset:17408
v_mfma_f32_16x16x32_bf16 v[72:75], a[156:159], a[12:15], v[72:75]
ds_read_b64_tr_b16 a[212:213], v91 offset:16928
v_mfma_f32_16x16x32_bf16 v[76:79], a[172:175], a[12:15], v[48:51]
ds_read_b64_tr_b16 a[214:215], v91 offset:17440
ds_read_b64_tr_b16 a[216:217], v91 offset:16960
v_mfma_f32_16x16x32_bf16 v[76:79], a[168:171], a[8:11], v[76:79]
ds_read_b64_tr_b16 a[218:219], v91 offset:17472
v_mfma_f32_16x16x32_bf16 v[76:79], a[164:167], a[4:7], v[76:79]
ds_read_b64_tr_b16 a[220:221], v91 offset:16992
ds_read_b64_tr_b16 a[222:223], v91 offset:17504
v_mfma_f32_16x16x32_bf16 v[76:79], a[160:163], a[0:3], v[76:79]
v_exp_f32 v72, v72
v_mfma_f32_16x16x32_bf16 v[80:83], a[112:115], a[0:3], v[48:51]
s_waitcnt lgkmcnt(9)
v_exp_f32 v73, v73
v_mfma_f32_16x16x32_bf16 v[80:83], a[116:119], a[4:7], v[80:83]
s_xor_b32 s21, s23, 135168
v_exp_f32 v74, v74
v_mfma_f32_16x16x32_bf16 v[80:83], a[120:123], a[8:11], v[80:83]
s_add_u32 m0, s22, 85536
v_exp_f32 v75, v75
v_mfma_f32_16x16x32_bf16 v[80:83], a[124:127], a[12:15], v[80:83]
v_cvt_pk_bf16_f32 v44, v72, v73
v_cvt_pk_bf16_f32 v45, v74, v75
v_mfma_f32_16x16x32_bf16 v[84:87], a[140:143], a[12:15], v[48:51]
buffer_load_dwordx4 v97, s[12:15], s21 offen offset:0 nt lds
v_mfma_f32_16x16x32_bf16 v[84:87], a[136:139], a[8:11], v[84:87]
v_exp_f32 v76, v76
v_mfma_f32_16x16x32_bf16 v[84:87], a[132:135], a[4:7], v[84:87]
s_waitcnt lgkmcnt(0)
v_exp_f32 v77, v77
v_mfma_f32_16x16x32_bf16 v[84:87], a[128:131], a[0:3], v[84:87]
v_exp_f32 v78, v78
v_mfma_f32_16x16x32_bf16 v[104:107], a[248:251], v[32:35], v[104:107]
v_exp_f32 v79, v79
v_mfma_f32_16x16x32_bf16 a[80:83], a[176:179], v[32:35], a[80:83]
v_cvt_pk_bf16_f32 v46, v76, v77
v_cvt_pk_bf16_f32 v47, v78, v79
v_mfma_f32_16x16x32_bf16 a[84:87], a[180:183], v[32:35], a[84:87]
v_exp_f32 v80, v80
v_mfma_f32_16x16x32_bf16 a[88:91], a[184:187], v[32:35], a[88:91]
v_exp_f32 v81, v81
v_mfma_f32_16x16x32_bf16 a[92:95], a[188:191], v[32:35], a[92:95]
v_exp_f32 v82, v82
v_mfma_f32_16x16x32_bf16 a[96:99], a[192:195], v[32:35], a[96:99]
v_exp_f32 v83, v83
v_mfma_f32_16x16x32_bf16 a[100:103], a[196:199], v[32:35], a[100:103]
ds_read_b64_tr_b16 a[176:177], v90 offset:16896
ds_read_b64_tr_b16 a[178:179], v90 offset:17408
v_mfma_f32_16x16x32_bf16 a[104:107], a[200:203], v[32:35], a[104:107]
s_xor_b32 s21, s23, 139264
v_cvt_pk_bf16_f32 v40, v80, v81
v_cvt_pk_bf16_f32 v41, v82, v83
v_mfma_f32_16x16x32_bf16 a[108:111], a[204:207], v[32:35], a[108:111]
s_add_u32 m0, s22, 86592
ds_read_b64_tr_b16 a[180:181], v90 offset:16928
ds_read_b64_tr_b16 a[182:183], v90 offset:17440
v_mfma_f32_16x16x32_bf16 v[68:71], a[144:147], a[16:19], v[52:55]
v_exp_f32 v84, v84
v_mfma_f32_16x16x32_bf16 v[68:71], a[148:151], a[20:23], v[68:71]
buffer_load_dwordx4 v97, s[12:15], s21 offen offset:0 nt lds
v_mfma_f32_16x16x32_bf16 v[68:71], a[152:155], a[24:27], v[68:71]
v_exp_f32 v85, v85
v_mfma_f32_16x16x32_bf16 v[68:71], a[156:159], a[28:31], v[68:71]
v_exp_f32 v86, v86
v_mfma_f32_16x16x32_bf16 v[72:75], a[172:175], a[28:31], v[52:55]
v_exp_f32 v87, v87
v_mfma_f32_16x16x32_bf16 v[72:75], a[168:171], a[24:27], v[72:75]
ds_read_b64_tr_b16 a[184:185], v90 offset:16960
ds_read_b64_tr_b16 a[186:187], v90 offset:17472
v_mfma_f32_16x16x32_bf16 v[72:75], a[164:167], a[20:23], v[72:75]
v_cvt_pk_bf16_f32 v42, v84, v85
v_cvt_pk_bf16_f32 v43, v86, v87
v_mfma_f32_16x16x32_bf16 v[72:75], a[160:163], a[16:19], v[72:75]
ds_read_b64_tr_b16 a[188:189], v90 offset:16992
ds_read_b64_tr_b16 a[190:191], v90 offset:17504
v_mfma_f32_16x16x32_bf16 v[76:79], a[112:115], a[16:19], v[52:55]
v_exp_f32 v68, v68
v_mfma_f32_16x16x32_bf16 v[76:79], a[116:119], a[20:23], v[76:79]
ds_read_b64_tr_b16 a[224:225], v91 offset:17024
ds_read_b64_tr_b16 a[226:227], v91 offset:17536
v_mfma_f32_16x16x32_bf16 v[76:79], a[120:123], a[24:27], v[76:79]
v_exp_f32 v69, v69
v_mfma_f32_16x16x32_bf16 v[76:79], a[124:127], a[28:31], v[76:79]
ds_read_b64_tr_b16 a[192:193], v90 offset:17024
ds_read_b64_tr_b16 a[194:195], v90 offset:17536
v_mfma_f32_16x16x32_bf16 v[80:83], a[140:143], a[28:31], v[52:55]
ds_read_b64_tr_b16 a[196:197], v90 offset:17056
v_cvt_pk_bf16_f32 v36, v68, v69
v_mfma_f32_16x16x32_bf16 v[80:83], a[136:139], a[24:27], v[80:83]
s_xor_b32 s21, s23, 143360
ds_read_b64_tr_b16 a[198:199], v90 offset:17568
ds_read_b64_tr_b16 a[228:229], v91 offset:17056
v_mfma_f32_16x16x32_bf16 v[80:83], a[132:135], a[20:23], v[80:83]
s_add_u32 m0, s22, 87648
v_exp_f32 v70, v70
v_mfma_f32_16x16x32_bf16 v[80:83], a[128:131], a[16:19], v[80:83]
s_waitcnt lgkmcnt(7)
ds_read_b64_tr_b16 a[230:231], v91 offset:17568
ds_read_b64_tr_b16 a[232:233], v91 offset:17088
v_mfma_f32_16x16x32_bf16 v[128:131], a[208:211], v[44:47], v[128:131]
buffer_load_dwordx4 v97, s[12:15], s21 offen offset:0 nt lds
v_mfma_f32_16x16x32_bf16 v[128:131], a[176:179], v[40:43], v[128:131]
ds_read_b64_tr_b16 a[234:235], v91 offset:17600
ds_read_b64_tr_b16 a[200:201], v90 offset:17088
v_mfma_f32_16x16x32_bf16 v[132:135], a[180:183], v[40:43], v[132:135]
v_exp_f32 v71, v71
v_mfma_f32_16x16x32_bf16 v[132:135], a[212:215], v[44:47], v[132:135]
ds_read_b64_tr_b16 a[202:203], v90 offset:17600
ds_read_b64_tr_b16 a[204:205], v90 offset:17120
v_mfma_f32_16x16x32_bf16 v[136:139], a[216:219], v[44:47], v[136:139]
ds_read_b64_tr_b16 a[206:207], v90 offset:17632
v_cvt_pk_bf16_f32 v37, v70, v71
v_mfma_f32_16x16x32_bf16 v[136:139], a[184:187], v[40:43], v[136:139]
ds_read_b64_tr_b16 a[236:237], v91 offset:17120
ds_read_b64_tr_b16 a[238:239], v91 offset:17632
v_mfma_f32_16x16x32_bf16 v[140:143], a[188:191], v[40:43], v[140:143]
v_exp_f32 v72, v72
v_mfma_f32_16x16x32_bf16 v[140:143], a[220:223], v[44:47], v[140:143]
s_waitcnt lgkmcnt(7)
v_exp_f32 v73, v73
v_mfma_f32_16x16x32_bf16 v[144:147], a[224:227], v[44:47], v[144:147]
s_waitcnt vmcnt(10)
ds_read_b128 v[0:3], v93 offset:4352
v_cvt_pk_bf16_f32 v38, v72, v73
v_mfma_f32_16x16x32_bf16 v[144:147], a[192:195], v[40:43], v[144:147]
v_exp_f32 v74, v74
v_mfma_f32_16x16x32_bf16 v[148:151], a[196:199], v[40:43], v[148:151]
v_exp_f32 v75, v75
v_mfma_f32_16x16x32_bf16 v[148:151], a[228:231], v[44:47], v[148:151]
s_waitcnt lgkmcnt(4)
ds_read_b128 v[4:7], v93 offset:4416
v_cvt_pk_bf16_f32 v39, v74, v75
v_mfma_f32_16x16x32_bf16 v[152:155], a[232:235], v[44:47], v[152:155]
s_add_u32 m0, s24, 8768
v_exp_f32 v76, v76
v_mfma_f32_16x16x32_bf16 v[152:155], a[200:203], v[40:43], v[152:155]
s_waitcnt lgkmcnt(2)
v_exp_f32 v77, v77
v_mfma_f32_16x16x32_bf16 v[156:159], a[204:207], v[40:43], v[156:159]
ds_read_b128 v[8:11], v93 offset:4480
v_cvt_pk_bf16_f32 v32, v76, v77
v_mfma_f32_16x16x32_bf16 v[156:159], a[236:239], v[44:47], v[156:159]
s_waitcnt lgkmcnt(2)
ds_read_b128 v[12:15], v93 offset:4544
v_lshlrev_b32 v116, 16, v0
v_smfmac_f32_16x16x64_bf16 a[240:243], a[248:251], v[40:47], v92
v_and_b32 v0, s36, v0
v_mfma_f32_16x16x32_bf16 v[84:87], a[144:147], a[32:35], v[56:59]
buffer_load_dwordx4 v96, s[4:7], s37 offen offset:2048 nt lds
v_mfma_f32_16x16x32_bf16 v[84:87], a[148:151], a[36:39], v[84:87]
v_exp_f32 v78, v78
v_mfma_f32_16x16x32_bf16 v[84:87], a[152:155], a[40:43], v[84:87]
v_exp_f32 v79, v79
v_mfma_f32_16x16x32_bf16 v[84:87], a[156:159], a[44:47], v[84:87]
v_cvt_pk_bf16_f32 v33, v78, v79
v_mul_f32 v116, s38, v116
v_mfma_f32_16x16x32_bf16 v[68:71], a[172:175], a[44:47], v[56:59]
v_exp_f32 v80, v80
v_mfma_f32_16x16x32_bf16 v[68:71], a[168:171], a[40:43], v[68:71]
v_exp_f32 v81, v81
v_mfma_f32_16x16x32_bf16 v[68:71], a[164:167], a[36:39], v[68:71]
v_exp_f32 v82, v82
v_mfma_f32_16x16x32_bf16 v[68:71], a[160:163], a[32:35], v[68:71]
v_exp_f32 v83, v83
v_mfma_f32_16x16x32_bf16 v[72:75], a[112:115], a[32:35], v[56:59]
v_cvt_pk_bf16_f32 v34, v80, v81
v_cvt_pk_bf16_f32 v35, v82, v83
v_mfma_f32_16x16x32_bf16 v[72:75], a[116:119], a[36:39], v[72:75]
s_add_u32 m0, s24, 8800
v_exp_f32 v84, v84
v_mfma_f32_16x16x32_bf16 v[72:75], a[120:123], a[40:43], v[72:75]
v_exp_f32 v85, v85
v_mfma_f32_16x16x32_bf16 v[72:75], a[124:127], a[44:47], v[72:75]
buffer_load_dwordx4 v96, s[4:7], s37 offen offset:3072 nt lds
v_mfma_f32_16x16x32_bf16 v[76:79], a[140:143], a[44:47], v[56:59]
v_exp_f32 v86, v86
v_mfma_f32_16x16x32_bf16 v[76:79], a[136:139], a[40:43], v[76:79]
v_exp_f32 v87, v87
v_mfma_f32_16x16x32_bf16 v[76:79], a[132:135], a[36:39], v[76:79]
v_cvt_pk_bf16_f32 v44, v84, v85
v_cvt_pk_bf16_f32 v45, v86, v87
v_mfma_f32_16x16x32_bf16 v[76:79], a[128:131], a[32:35], v[76:79]
v_exp_f32 v68, v68
v_mfma_f32_16x16x32_bf16 v[160:163], a[208:211], v[36:39], v[160:163]
v_exp_f32 v69, v69
v_mfma_f32_16x16x32_bf16 v[160:163], a[176:179], v[32:35], v[160:163]
v_exp_f32 v70, v70
v_mfma_f32_16x16x32_bf16 v[164:167], a[180:183], v[32:35], v[164:167]
v_exp_f32 v71, v71
v_mfma_f32_16x16x32_bf16 v[164:167], a[212:215], v[36:39], v[164:167]
v_cvt_pk_bf16_f32 v46, v68, v69
v_cvt_pk_bf16_f32 v47, v70, v71
v_mfma_f32_16x16x32_bf16 v[168:171], a[216:219], v[36:39], v[168:171]
v_exp_f32 v72, v72
v_mfma_f32_16x16x32_bf16 v[168:171], a[184:187], v[32:35], v[168:171]
v_exp_f32 v73, v73
v_mfma_f32_16x16x32_bf16 v[172:175], a[188:191], v[32:35], v[172:175]
s_xor_b32 s21, s23, 132096
v_exp_f32 v74, v74
v_mfma_f32_16x16x32_bf16 v[172:175], a[220:223], v[36:39], v[172:175]
s_add_u32 m0, s22, 0
v_exp_f32 v75, v75
v_mfma_f32_16x16x32_bf16 v[176:179], a[224:227], v[36:39], v[176:179]
v_cvt_pk_bf16_f32 v40, v72, v73
v_cvt_pk_bf16_f32 v41, v74, v75
v_mfma_f32_16x16x32_bf16 v[176:179], a[192:195], v[32:35], v[176:179]
buffer_load_dwordx4 v97, s[8:11], s21 offen offset:0 nt lds
v_mfma_f32_16x16x32_bf16 v[180:183], a[196:199], v[32:35], v[180:183]
v_exp_f32 v76, v76
v_mfma_f32_16x16x32_bf16 v[180:183], a[228:231], v[36:39], v[180:183]
v_exp_f32 v77, v77
v_mfma_f32_16x16x32_bf16 v[184:187], a[232:235], v[36:39], v[184:187]
v_exp_f32 v78, v78
v_mfma_f32_16x16x32_bf16 v[184:187], a[200:203], v[32:35], v[184:187]
v_exp_f32 v79, v79
v_mfma_f32_16x16x32_bf16 v[188:191], a[204:207], v[32:35], v[188:191]
v_cvt_pk_bf16_f32 v42, v76, v77
v_cvt_pk_bf16_f32 v43, v78, v79
v_mfma_f32_16x16x32_bf16 v[188:191], a[236:239], v[36:39], v[188:191]
v_mul_f32 v0, s38, v0
v_cvt_pk_bf16_f32 v0, v116, v0
v_smfmac_f32_16x16x64_bf16 a[240:243], a[252:255], v[32:39], v92
v_lshlrev_b32 v117, 16, v1
v_mfma_f32_16x16x32_bf16 v[80:83], a[144:147], a[48:51], v[60:63]
v_and_b32 v1, s36, v1
v_mul_f32 v117, s38, v117
v_mfma_f32_16x16x32_bf16 v[80:83], a[148:151], a[52:55], v[80:83]
v_mul_f32 v1, s38, v1
v_cvt_pk_bf16_f32 v1, v117, v1
v_mfma_f32_16x16x32_bf16 v[80:83], a[152:155], a[56:59], v[80:83]
v_lshlrev_b32 v118, 16, v2
v_and_b32 v2, s36, v2
v_mfma_f32_16x16x32_bf16 v[80:83], a[156:159], a[60:63], v[80:83]
s_xor_b32 s21, s23, 136192
v_mul_f32 v118, s38, v118
v_mul_f32 v2, s38, v2
v_mfma_f32_16x16x32_bf16 v[84:87], a[172:175], a[60:63], v[60:63]
s_add_u32 m0, s22, 1056
v_cvt_pk_bf16_f32 v2, v118, v2
v_lshlrev_b32 v119, 16, v3
v_mfma_f32_16x16x32_bf16 v[84:87], a[168:171], a[56:59], v[84:87]
v_and_b32 v3, s36, v3
v_mul_f32 v119, s38, v119
v_mfma_f32_16x16x32_bf16 v[84:87], a[164:167], a[52:55], v[84:87]
buffer_load_dwordx4 v97, s[8:11], s21 offen offset:0 nt lds
v_mfma_f32_16x16x32_bf16 v[84:87], a[160:163], a[48:51], v[84:87]
v_exp_f32 v80, v80
v_mfma_f32_16x16x32_bf16 v[68:71], a[112:115], a[48:51], v[60:63]
v_exp_f32 v81, v81
v_mfma_f32_16x16x32_bf16 v[68:71], a[116:119], a[52:55], v[68:71]
v_exp_f32 v82, v82
v_mfma_f32_16x16x32_bf16 v[68:71], a[120:123], a[56:59], v[68:71]
v_exp_f32 v83, v83
v_mfma_f32_16x16x32_bf16 v[68:71], a[124:127], a[60:63], v[68:71]
v_cvt_pk_bf16_f32 v36, v80, v81
v_cvt_pk_bf16_f32 v37, v82, v83
v_mfma_f32_16x16x32_bf16 v[72:75], a[140:143], a[60:63], v[60:63]
v_exp_f32 v84, v84
v_mfma_f32_16x16x32_bf16 v[72:75], a[136:139], a[56:59], v[72:75]
v_exp_f32 v85, v85
v_mfma_f32_16x16x32_bf16 v[72:75], a[132:135], a[52:55], v[72:75]
v_exp_f32 v86, v86
v_mfma_f32_16x16x32_bf16 v[72:75], a[128:131], a[48:51], v[72:75]
v_exp_f32 v87, v87
v_mfma_f32_16x16x32_bf16 v[192:195], a[208:211], v[44:47], v[192:195]
v_cvt_pk_bf16_f32 v38, v84, v85
v_cvt_pk_bf16_f32 v39, v86, v87
v_mfma_f32_16x16x32_bf16 v[192:195], a[176:179], v[40:43], v[192:195]
s_xor_b32 s21, s23, 140288
v_exp_f32 v68, v68
v_mfma_f32_16x16x32_bf16 v[196:199], a[180:183], v[40:43], v[196:199]
s_add_u32 m0, s22, 2112
v_exp_f32 v69, v69
v_mfma_f32_16x16x32_bf16 v[196:199], a[212:215], v[44:47], v[196:199]
v_exp_f32 v70, v70
v_mfma_f32_16x16x32_bf16 v[200:203], a[216:219], v[44:47], v[200:203]
buffer_load_dwordx4 v97, s[8:11], s21 offen offset:0 nt lds
v_mfma_f32_16x16x32_bf16 v[200:203], a[184:187], v[40:43], v[200:203]
v_exp_f32 v71, v71
v_mfma_f32_16x16x32_bf16 v[204:207], a[188:191], v[40:43], v[204:207]
v_exp_f32 v72, v72
v_mfma_f32_16x16x32_bf16 v[204:207], a[220:223], v[44:47], v[204:207]
v_exp_f32 v73, v73
v_mfma_f32_16x16x32_bf16 v[208:211], a[224:227], v[44:47], v[208:211]
v_exp_f32 v74, v74
v_mfma_f32_16x16x32_bf16 v[208:211], a[192:195], v[40:43], v[208:211]
v_exp_f32 v75, v75
v_mfma_f32_16x16x32_bf16 v[212:215], a[196:199], v[40:43], v[212:215]
v_cvt_pk_bf16_f32 v32, v68, v69
v_cvt_pk_bf16_f32 v33, v70, v71
v_mfma_f32_16x16x32_bf16 v[212:215], a[228:231], v[44:47], v[212:215]
v_cvt_pk_bf16_f32 v34, v72, v73
v_cvt_pk_bf16_f32 v35, v74, v75
v_mfma_f32_16x16x32_bf16 v[216:219], a[232:235], v[44:47], v[216:219]
v_mul_f32 v3, s38, v3
v_cvt_pk_bf16_f32 v3, v119, v3
v_mfma_f32_16x16x32_bf16 v[216:219], a[200:203], v[40:43], v[216:219]
s_waitcnt lgkmcnt(0)
v_lshlrev_b32 v116, 16, v4
v_and_b32 v4, s36, v4
v_mfma_f32_16x16x32_bf16 v[220:223], a[204:207], v[40:43], v[220:223]
s_waitcnt vmcnt(5)
s_barrier
v_mfma_f32_16x16x32_bf16 v[220:223], a[236:239], v[44:47], v[220:223]
s_xor_b32 s21, s23, 144384
ds_read_b128 a[144:147], v89 offset:33792
v_mul_f32 v116, s38, v116
v_smfmac_f32_16x16x64_bf16 a[244:247], a[248:251], v[40:47], v92
s_add_u32 m0, s22, 3168
ds_read_b128 a[148:151], v89 offset:33856
v_mfma_f32_16x16x32_bf16 v[76:79], a[112:115], a[64:67], v[64:67]
ds_read_b128 a[152:155], v89 offset:33920
v_mul_f32 v4, s38, v4
v_mfma_f32_16x16x32_bf16 v[76:79], a[116:119], a[68:71], v[76:79]
buffer_load_dwordx4 v97, s[8:11], s21 offen offset:0 nt lds
v_mfma_f32_16x16x32_bf16 v[76:79], a[120:123], a[72:75], v[76:79]
ds_read_b128 a[156:159], v89 offset:33984
v_cvt_pk_bf16_f32 v4, v116, v4
v_mfma_f32_16x16x32_bf16 v[76:79], a[124:127], a[76:79], v[76:79]
ds_read_b128 a[172:175], v89 offset:34496
v_lshlrev_b32 v117, 16, v5
v_mfma_f32_16x16x32_bf16 v[80:83], a[140:143], a[76:79], v[64:67]
ds_read_b128 a[168:171], v89 offset:34432
v_and_b32 v5, s36, v5
v_mfma_f32_16x16x32_bf16 v[80:83], a[136:139], a[72:75], v[80:83]
ds_read_b128 a[164:167], v89 offset:34368
v_mul_f32 v117, s38, v117
v_mfma_f32_16x16x32_bf16 v[80:83], a[132:135], a[68:71], v[80:83]
ds_read_b128 a[160:163], v89 offset:34304
v_mul_f32 v5, s38, v5
v_mfma_f32_16x16x32_bf16 v[80:83], a[128:131], a[64:67], v[80:83]
ds_read_b128 a[112:115], v88 offset:33792
v_cvt_pk_bf16_f32 v5, v117, v5
v_mfma_f32_16x16x32_bf16 v[224:227], a[208:211], v[36:39], v[224:227]
ds_read_b128 a[116:119], v88 offset:33856
v_lshlrev_b32 v118, 16, v6
v_mfma_f32_16x16x32_bf16 v[224:227], a[176:179], v[32:35], v[224:227]
ds_read_b128 a[120:123], v88 offset:33920
v_and_b32 v6, s36, v6
v_mfma_f32_16x16x32_bf16 v[228:231], a[180:183], v[32:35], v[228:231]
ds_read_b128 a[124:127], v88 offset:33984
v_mul_f32 v118, s38, v118
v_mfma_f32_16x16x32_bf16 v[228:231], a[212:215], v[36:39], v[228:231]
ds_read_b128 a[140:143], v88 offset:34496
v_mul_f32 v6, s38, v6
v_mfma_f32_16x16x32_bf16 v[232:235], a[216:219], v[36:39], v[232:235]
ds_read_b128 a[136:139], v88 offset:34432
v_cvt_pk_bf16_f32 v6, v118, v6
v_mfma_f32_16x16x32_bf16 v[232:235], a[184:187], v[32:35], v[232:235]
s_xor_b32 s21, s23, 132096
ds_read_b128 a[132:135], v88 offset:34368
v_lshlrev_b32 v119, 16, v7
v_mfma_f32_16x16x32_bf16 v[236:239], a[188:191], v[32:35], v[236:239]
s_add_u32 m0, s22, 50688
ds_read_b128 a[128:131], v88 offset:34304
v_and_b32 v7, s36, v7
v_mfma_f32_16x16x32_bf16 v[236:239], a[220:223], v[36:39], v[236:239]
v_exp_f32 v76, v76
v_mfma_f32_16x16x32_bf16 v[240:243], a[224:227], v[36:39], v[240:243]
buffer_load_dwordx4 v97, s[12:15], s21 offen offset:0 nt lds
v_mfma_f32_16x16x32_bf16 v[240:243], a[192:195], v[32:35], v[240:243]
v_exp_f32 v77, v77
v_mfma_f32_16x16x32_bf16 v[244:247], a[196:199], v[32:35], v[244:247]
v_exp_f32 v78, v78
v_mfma_f32_16x16x32_bf16 v[244:247], a[228:231], v[36:39], v[244:247]
v_exp_f32 v79, v79
v_mfma_f32_16x16x32_bf16 v[248:251], a[232:235], v[36:39], v[248:251]
v_cvt_pk_bf16_f32 v40, v76, v77
v_cvt_pk_bf16_f32 v41, v78, v79
v_mfma_f32_16x16x32_bf16 v[248:251], a[200:203], v[32:35], v[248:251]
v_exp_f32 v80, v80
v_mfma_f32_16x16x32_bf16 v[252:255], a[204:207], v[32:35], v[252:255]
v_exp_f32 v81, v81
v_mfma_f32_16x16x32_bf16 v[252:255], a[236:239], v[36:39], v[252:255]
v_exp_f32 v82, v82
v_smfmac_f32_16x16x64_bf16 a[244:247], a[252:255], v[32:39], v92
s_waitcnt lgkmcnt(0)
v_cvt_pk_bf16_f32 v42, v80, v81
v_mfma_f32_16x16x32_bf16 v[84:87], a[144:147], a[0:3], v[48:51]
v_exp_f32 v83, v83
v_mfma_f32_16x16x32_bf16 v[84:87], a[148:151], a[4:7], v[84:87]
ds_read_b64_tr_b16 a[208:209], v91 offset:33792
v_cvt_pk_bf16_f32 v43, v82, v83
v_mfma_f32_16x16x32_bf16 v[84:87], a[152:155], a[8:11], v[84:87]
s_xor_b32 s21, s23, 136192
ds_read_b64_tr_b16 a[210:211], v91 offset:34304
ds_read_b64_tr_b16 a[212:213], v91 offset:33824
v_mfma_f32_16x16x32_bf16 v[84:87], a[156:159], a[12:15], v[84:87]
s_add_u32 m0, s22, 51744
ds_read_b64_tr_b16 a[214:215], v91 offset:34336
v_mul_f32 v119, s38, v119
v_mfma_f32_16x16x32_bf16 v[68:71], a[172:175], a[12:15], v[48:51]
ds_read_b64_tr_b16 a[216:217], v91 offset:33856
ds_read_b64_tr_b16 a[218:219], v91 offset:34368
v_mfma_f32_16x16x32_bf16 v[68:71], a[168:171], a[8:11], v[68:71]
buffer_load_dwordx4 v97, s[12:15], s21 offen offset:0 nt lds
v_mfma_f32_16x16x32_bf16 v[68:71], a[164:167], a[4:7], v[68:71]
ds_read_b64_tr_b16 a[220:221], v91 offset:33888
ds_read_b64_tr_b16 a[222:223], v91 offset:34400
v_mfma_f32_16x16x32_bf16 v[68:71], a[160:163], a[0:3], v[68:71]
v_exp_f32 v84, v84
v_mfma_f32_16x16x32_bf16 v[72:75], a[112:115], a[0:3], v[48:51]
v_exp_f32 v85, v85
v_mfma_f32_16x16x32_bf16 v[72:75], a[116:119], a[4:7], v[72:75]
v_exp_f32 v86, v86
v_mfma_f32_16x16x32_bf16 v[72:75], a[120:123], a[8:11], v[72:75]
v_exp_f32 v87, v87
v_mfma_f32_16x16x32_bf16 v[72:75], a[124:127], a[12:15], v[72:75]
v_cvt_pk_bf16_f32 v36, v84, v85
v_cvt_pk_bf16_f32 v37, v86, v87
v_mfma_f32_16x16x32_bf16 v[76:79], a[140:143], a[12:15], v[48:51]
v_exp_f32 v68, v68
v_mfma_f32_16x16x32_bf16 v[76:79], a[136:139], a[8:11], v[76:79]
v_exp_f32 v69, v69
v_mfma_f32_16x16x32_bf16 v[76:79], a[132:135], a[4:7], v[76:79]
v_exp_f32 v70, v70
v_mfma_f32_16x16x32_bf16 v[76:79], a[128:131], a[0:3], v[76:79]
v_exp_f32 v71, v71
v_mfma_f32_16x16x32_bf16 v[104:107], a[248:251], v[40:43], v[104:107]
s_xor_b32 s21, s23, 140288
v_cvt_pk_bf16_f32 v38, v68, v69
v_cvt_pk_bf16_f32 v39, v70, v71
v_mfma_f32_16x16x32_bf16 a[80:83], a[176:179], v[40:43], a[80:83]
s_add_u32 m0, s22, 52800
v_exp_f32 v72, v72
v_mfma_f32_16x16x32_bf16 a[84:87], a[180:183], v[40:43], a[84:87]
v_exp_f32 v73, v73
v_mfma_f32_16x16x32_bf16 a[88:91], a[184:187], v[40:43], a[88:91]
buffer_load_dwordx4 v97, s[12:15], s21 offen offset:0 nt lds
v_mfma_f32_16x16x32_bf16 a[92:95], a[188:191], v[40:43], a[92:95]
v_exp_f32 v74, v74
v_mfma_f32_16x16x32_bf16 a[96:99], a[192:195], v[40:43], a[96:99]
v_exp_f32 v75, v75
v_mfma_f32_16x16x32_bf16 a[100:103], a[196:199], v[40:43], a[100:103]
ds_read_b64_tr_b16 a[176:177], v90 offset:33792
ds_read_b64_tr_b16 a[178:179], v90 offset:34304
v_mfma_f32_16x16x32_bf16 a[104:107], a[200:203], v[40:43], a[104:107]
v_cvt_pk_bf16_f32 v32, v72, v73
v_cvt_pk_bf16_f32 v33, v74, v75
v_mfma_f32_16x16x32_bf16 a[108:111], a[204:207], v[40:43], a[108:111]
ds_read_b64_tr_b16 a[180:181], v90 offset:33824
ds_read_b64_tr_b16 a[182:183], v90 offset:34336
v_mfma_f32_16x16x32_bf16 v[80:83], a[144:147], a[16:19], v[52:55]
v_exp_f32 v76, v76
v_mfma_f32_16x16x32_bf16 v[80:83], a[148:151], a[20:23], v[80:83]
v_exp_f32 v77, v77
v_mfma_f32_16x16x32_bf16 v[80:83], a[152:155], a[24:27], v[80:83]
v_exp_f32 v78, v78
v_mfma_f32_16x16x32_bf16 v[80:83], a[156:159], a[28:31], v[80:83]
v_exp_f32 v79, v79
v_mfma_f32_16x16x32_bf16 v[84:87], a[172:175], a[28:31], v[52:55]
ds_read_b64_tr_b16 a[184:185], v90 offset:33856
ds_read_b64_tr_b16 a[186:187], v90 offset:34368
v_mfma_f32_16x16x32_bf16 v[84:87], a[168:171], a[24:27], v[84:87]
s_xor_b32 s21, s23, 144384
v_cvt_pk_bf16_f32 v34, v76, v77
v_cvt_pk_bf16_f32 v35, v78, v79
v_mfma_f32_16x16x32_bf16 v[84:87], a[164:167], a[20:23], v[84:87]
s_add_u32 m0, s22, 53856
ds_read_b64_tr_b16 a[188:189], v90 offset:33888
ds_read_b64_tr_b16 a[190:191], v90 offset:34400
v_mfma_f32_16x16x32_bf16 v[84:87], a[160:163], a[16:19], v[84:87]
ds_read_b64_tr_b16 a[224:225], v91 offset:33920
v_mul_f32 v7, s38, v7
v_mfma_f32_16x16x32_bf16 v[68:71], a[112:115], a[16:19], v[52:55]
buffer_load_dwordx4 v97, s[12:15], s21 offen offset:0 nt lds
v_mfma_f32_16x16x32_bf16 v[68:71], a[116:119], a[20:23], v[68:71]
ds_read_b64_tr_b16 a[226:227], v91 offset:34432
ds_read_b64_tr_b16 a[192:193], v90 offset:33920
v_mfma_f32_16x16x32_bf16 v[68:71], a[120:123], a[24:27], v[68:71]
ds_read_b64_tr_b16 a[194:195], v90 offset:34432
v_cvt_pk_bf16_f32 v7, v119, v7
v_mfma_f32_16x16x32_bf16 v[68:71], a[124:127], a[28:31], v[68:71]
ds_read_b64_tr_b16 a[196:197], v90 offset:33952
ds_read_b64_tr_b16 a[198:199], v90 offset:34464
v_mfma_f32_16x16x32_bf16 v[72:75], a[140:143], a[28:31], v[52:55]
ds_read_b64_tr_b16 a[228:229], v91 offset:33952
v_lshlrev_b32 v116, 16, v8
v_mfma_f32_16x16x32_bf16 v[72:75], a[136:139], a[24:27], v[72:75]
ds_read_b64_tr_b16 a[230:231], v91 offset:34464
ds_read_b64_tr_b16 a[232:233], v91 offset:33984
v_mfma_f32_16x16x32_bf16 v[72:75], a[132:135], a[20:23], v[72:75]
ds_read_b64_tr_b16 a[234:235], v91 offset:34496
v_and_b32 v8, s36, v8
v_mfma_f32_16x16x32_bf16 v[72:75], a[128:131], a[16:19], v[72:75]
s_waitcnt lgkmcnt(9)
ds_read_b64_tr_b16 a[200:201], v90 offset:33984
ds_read_b64_tr_b16 a[202:203], v90 offset:34496
v_mfma_f32_16x16x32_bf16 v[128:131], a[208:211], v[36:39], v[128:131]
ds_read_b64_tr_b16 a[204:205], v90 offset:34016
v_mul_f32 v116, s38, v116
v_mfma_f32_16x16x32_bf16 v[128:131], a[176:179], v[32:35], v[128:131]
ds_read_b64_tr_b16 a[206:207], v90 offset:34528
ds_read_b64_tr_b16 a[236:237], v91 offset:34016
v_mfma_f32_16x16x32_bf16 v[132:135], a[180:183], v[32:35], v[132:135]
ds_read_b64_tr_b16 a[238:239], v91 offset:34528
v_mul_f32 v8, s38, v8
v_mfma_f32_16x16x32_bf16 v[132:135], a[212:215], v[36:39], v[132:135]
s_add_u32 s37, s31, 77824
v_exp_f32 v80, v80
v_mfma_f32_16x16x32_bf16 v[136:139], a[216:219], v[36:39], v[136:139]
s_add_u32 m0, s24, 4352
v_exp_f32 v81, v81
v_mfma_f32_16x16x32_bf16 v[136:139], a[184:187], v[32:35], v[136:139]
v_exp_f32 v82, v82
v_mfma_f32_16x16x32_bf16 v[140:143], a[188:191], v[32:35], v[140:143]
buffer_load_dwordx4 v96, s[4:7], s37 offen offset:0 nt lds
v_mfma_f32_16x16x32_bf16 v[140:143], a[220:223], v[36:39], v[140:143]
s_waitcnt lgkmcnt(4)
v_exp_f32 v83, v83
v_mfma_f32_16x16x32_bf16 v[144:147], a[224:227], v[36:39], v[144:147]
v_cvt_pk_bf16_f32 v44, v80, v81
v_cvt_pk_bf16_f32 v45, v82, v83
v_mfma_f32_16x16x32_bf16 v[144:147], a[192:195], v[32:35], v[144:147]
v_exp_f32 v84, v84
v_mfma_f32_16x16x32_bf16 v[148:151], a[196:199], v[32:35], v[148:151]
v_exp_f32 v85, v85
v_mfma_f32_16x16x32_bf16 v[148:151], a[228:231], v[36:39], v[148:151]
v_exp_f32 v86, v86
v_mfma_f32_16x16x32_bf16 v[152:155], a[232:235], v[36:39], v[152:155]
v_exp_f32 v87, v87
v_mfma_f32_16x16x32_bf16 v[152:155], a[200:203], v[32:35], v[152:155]
s_waitcnt lgkmcnt(0)
v_cvt_pk_bf16_f32 v46, v84, v85
v_cvt_pk_bf16_f32 v47, v86, v87
v_mfma_f32_16x16x32_bf16 v[156:159], a[204:207], v[32:35], v[156:159]
v_exp_f32 v68, v68
v_mfma_f32_16x16x32_bf16 v[156:159], a[236:239], v[36:39], v[156:159]
v_exp_f32 v69, v69
v_smfmac_f32_16x16x64_bf16 a[240:243], a[248:251], v[32:39], v92
v_cvt_pk_bf16_f32 v40, v68, v69
v_mfma_f32_16x16x32_bf16 v[76:79], a[144:147], a[32:35], v[56:59]
v_exp_f32 v70, v70
v_mfma_f32_16x16x32_bf16 v[76:79], a[148:151], a[36:39], v[76:79]
s_add_u32 m0, s24, 4384
v_exp_f32 v71, v71
v_mfma_f32_16x16x32_bf16 v[76:79], a[152:155], a[40:43], v[76:79]
s_waitcnt vmcnt(9)
ds_read_b128 v[16:19], v93 offset:8704
v_cvt_pk_bf16_f32 v41, v70, v71
v_mfma_f32_16x16x32_bf16 v[76:79], a[156:159], a[44:47], v[76:79]
buffer_load_dwordx4 v96, s[4:7], s37 offen offset:1024 nt lds
v_mfma_f32_16x16x32_bf16 v[80:83], a[172:175], a[44:47], v[56:59]
v_exp_f32 v72, v72
v_mfma_f32_16x16x32_bf16 v[80:83], a[168:171], a[40:43], v[80:83]
v_exp_f32 v73, v73
v_mfma_f32_16x16x32_bf16 v[80:83], a[164:167], a[36:39], v[80:83]
v_exp_f32 v74, v74
v_mfma_f32_16x16x32_bf16 v[80:83], a[160:163], a[32:35], v[80:83]
v_exp_f32 v75, v75
v_mfma_f32_16x16x32_bf16 v[84:87], a[112:115], a[32:35], v[56:59]
v_cvt_pk_bf16_f32 v42, v72, v73
v_cvt_pk_bf16_f32 v43, v74, v75
v_mfma_f32_16x16x32_bf16 v[84:87], a[116:119], a[36:39], v[84:87]
ds_read_b128 v[20:23], v93 offset:8768
v_cvt_pk_bf16_f32 v8, v116, v8
v_mfma_f32_16x16x32_bf16 v[84:87], a[120:123], a[40:43], v[84:87]
ds_read_b128 v[24:27], v93 offset:8832
v_lshlrev_b32 v117, 16, v9
v_mfma_f32_16x16x32_bf16 v[84:87], a[124:127], a[44:47], v[84:87]
ds_read_b128 v[28:31], v93 offset:8896
v_and_b32 v9, s36, v9
v_mfma_f32_16x16x32_bf16 v[68:71], a[140:143], a[44:47], v[56:59]
v_exp_f32 v76, v76
v_mfma_f32_16x16x32_bf16 v[68:71], a[136:139], a[40:43], v[68:71]
v_exp_f32 v77, v77
v_mfma_f32_16x16x32_bf16 v[68:71], a[132:135], a[36:39], v[68:71]
v_exp_f32 v78, v78
v_mfma_f32_16x16x32_bf16 v[68:71], a[128:131], a[32:35], v[68:71]
s_add_u32 m0, s24, 4416
v_exp_f32 v79, v79
v_mfma_f32_16x16x32_bf16 v[160:163], a[208:211], v[44:47], v[160:163]
v_cvt_pk_bf16_f32 v36, v76, v77
v_cvt_pk_bf16_f32 v37, v78, v79
v_mfma_f32_16x16x32_bf16 v[160:163], a[176:179], v[40:43], v[160:163]
buffer_load_dwordx4 v96, s[4:7], s37 offen offset:2048 nt lds
v_mfma_f32_16x16x32_bf16 v[164:167], a[180:183], v[40:43], v[164:167]
v_exp_f32 v80, v80
v_mfma_f32_16x16x32_bf16 v[164:167], a[212:215], v[44:47], v[164:167]
v_exp_f32 v81, v81
v_mfma_f32_16x16x32_bf16 v[168:171], a[216:219], v[44:47], v[168:171]
v_exp_f32 v82, v82
v_mfma_f32_16x16x32_bf16 v[168:171], a[184:187], v[40:43], v[168:171]
v_exp_f32 v83, v83
v_mfma_f32_16x16x32_bf16 v[172:175], a[188:191], v[40:43], v[172:175]
v_cvt_pk_bf16_f32 v38, v80, v81
v_cvt_pk_bf16_f32 v39, v82, v83
v_mfma_f32_16x16x32_bf16 v[172:175], a[220:223], v[44:47], v[172:175]
v_exp_f32 v84, v84
v_mfma_f32_16x16x32_bf16 v[176:179], a[224:227], v[44:47], v[176:179]
v_exp_f32 v85, v85
v_mfma_f32_16x16x32_bf16 v[176:179], a[192:195], v[40:43], v[176:179]
v_exp_f32 v86, v86
v_mfma_f32_16x16x32_bf16 v[180:183], a[196:199], v[40:43], v[180:183]
v_exp_f32 v87, v87
v_mfma_f32_16x16x32_bf16 v[180:183], a[228:231], v[44:47], v[180:183]
v_cvt_pk_bf16_f32 v32, v84, v85
v_cvt_pk_bf16_f32 v33, v86, v87
v_mfma_f32_16x16x32_bf16 v[184:187], a[232:235], v[44:47], v[184:187]
v_exp_f32 v68, v68
v_mfma_f32_16x16x32_bf16 v[184:187], a[200:203], v[40:43], v[184:187]
s_xor_b32 s21, s23, 133120
v_exp_f32 v69, v69
v_mfma_f32_16x16x32_bf16 v[188:191], a[204:207], v[40:43], v[188:191]
s_add_u32 m0, s22, 16896
v_exp_f32 v70, v70
v_mfma_f32_16x16x32_bf16 v[188:191], a[236:239], v[44:47], v[188:191]
v_exp_f32 v71, v71
v_smfmac_f32_16x16x64_bf16 a[240:243], a[252:255], v[40:47], v92
v_cvt_pk_bf16_f32 v34, v68, v69
v_mfma_f32_16x16x32_bf16 v[72:75], a[144:147], a[48:51], v[60:63]
buffer_load_dwordx4 v97, s[8:11], s21 offen offset:0 nt lds
v_mfma_f32_16x16x32_bf16 v[72:75], a[148:151], a[52:55], v[72:75]
v_cvt_pk_bf16_f32 v35, v70, v71
v_mul_f32 v117, s38, v117
v_mfma_f32_16x16x32_bf16 v[72:75], a[152:155], a[56:59], v[72:75]
v_mul_f32 v9, s38, v9
v_cvt_pk_bf16_f32 v9, v117, v9
v_mfma_f32_16x16x32_bf16 v[72:75], a[156:159], a[60:63], v[72:75]
v_lshlrev_b32 v118, 16, v10
v_and_b32 v10, s36, v10
v_mfma_f32_16x16x32_bf16 v[76:79], a[172:175], a[60:63], v[60:63]
v_mul_f32 v118, s38, v118
v_mul_f32 v10, s38, v10
v_mfma_f32_16x16x32_bf16 v[76:79], a[168:171], a[56:59], v[76:79]
v_cvt_pk_bf16_f32 v10, v118, v10
v_lshlrev_b32 v119, 16, v11
v_mfma_f32_16x16x32_bf16 v[76:79], a[164:167], a[52:55], v[76:79]
v_and_b32 v11, s36, v11
v_mul_f32 v119, s38, v119
v_mfma_f32_16x16x32_bf16 v[76:79], a[160:163], a[48:51], v[76:79]
v_exp_f32 v72, v72
v_mfma_f32_16x16x32_bf16 v[80:83], a[112:115], a[48:51], v[60:63]
v_exp_f32 v73, v73
v_mfma_f32_16x16x32_bf16 v[80:83], a[116:119], a[52:55], v[80:83]
v_exp_f32 v74, v74
v_mfma_f32_16x16x32_bf16 v[80:83], a[120:123], a[56:59], v[80:83]
s_xor_b32 s21, s23, 137216
v_exp_f32 v75, v75
v_mfma_f32_16x16x32_bf16 v[80:83], a[124:127], a[60:63], v[80:83]
s_add_u32 m0, s22, 17952
v_cvt_pk_bf16_f32 v44, v72, v73
v_cvt_pk_bf16_f32 v45, v74, v75
v_mfma_f32_16x16x32_bf16 v[84:87], a[140:143], a[60:63], v[60:63]
v_exp_f32 v76, v76
v_mfma_f32_16x16x32_bf16 v[84:87], a[136:139], a[56:59], v[84:87]
buffer_load_dwordx4 v97, s[8:11], s21 offen offset:0 nt lds
v_mfma_f32_16x16x32_bf16 v[84:87], a[132:135], a[52:55], v[84:87]
v_exp_f32 v77, v77
v_mfma_f32_16x16x32_bf16 v[84:87], a[128:131], a[48:51], v[84:87]
v_exp_f32 v78, v78
v_mfma_f32_16x16x32_bf16 v[192:195], a[208:211], v[36:39], v[192:195]
v_exp_f32 v79, v79
v_mfma_f32_16x16x32_bf16 v[192:195], a[176:179], v[32:35], v[192:195]
v_cvt_pk_bf16_f32 v46, v76, v77
v_cvt_pk_bf16_f32 v47, v78, v79
v_mfma_f32_16x16x32_bf16 v[196:199], a[180:183], v[32:35], v[196:199]
v_exp_f32 v80, v80
v_mfma_f32_16x16x32_bf16 v[196:199], a[212:215], v[36:39], v[196:199]
v_exp_f32 v81, v81
v_mfma_f32_16x16x32_bf16 v[200:203], a[216:219], v[36:39], v[200:203]
v_exp_f32 v82, v82
v_mfma_f32_16x16x32_bf16 v[200:203], a[184:187], v[32:35], v[200:203]
v_exp_f32 v83, v83
v_mfma_f32_16x16x32_bf16 v[204:207], a[188:191], v[32:35], v[204:207]
v_exp_f32 v84, v84
v_mfma_f32_16x16x32_bf16 v[204:207], a[220:223], v[36:39], v[204:207]
v_exp_f32 v85, v85
v_mfma_f32_16x16x32_bf16 v[208:211], a[224:227], v[36:39], v[208:211]
s_xor_b32 s21, s23, 141312
v_exp_f32 v86, v86
v_mfma_f32_16x16x32_bf16 v[208:211], a[192:195], v[32:35], v[208:211]
s_add_u32 m0, s22, 19008
v_exp_f32 v87, v87
v_mfma_f32_16x16x32_bf16 v[212:215], a[196:199], v[32:35], v[212:215]
v_cvt_pk_bf16_f32 v40, v80, v81
v_cvt_pk_bf16_f32 v41, v82, v83
v_mfma_f32_16x16x32_bf16 v[212:215], a[228:231], v[36:39], v[212:215]
buffer_load_dwordx4 v97, s[8:11], s21 offen offset:0 nt lds
v_mfma_f32_16x16x32_bf16 v[216:219], a[232:235], v[36:39], v[216:219]
v_cvt_pk_bf16_f32 v42, v84, v85
v_cvt_pk_bf16_f32 v43, v86, v87
v_mfma_f32_16x16x32_bf16 v[216:219], a[200:203], v[32:35], v[216:219]
v_mul_f32 v11, s38, v11
v_cvt_pk_bf16_f32 v11, v119, v11
v_mfma_f32_16x16x32_bf16 v[220:223], a[204:207], v[32:35], v[220:223]
s_waitcnt vmcnt(6)
s_barrier
v_mfma_f32_16x16x32_bf16 v[220:223], a[236:239], v[36:39], v[220:223]
ds_read_b128 a[144:147], v89 offset:0
v_lshlrev_b32 v116, 16, v12
v_smfmac_f32_16x16x64_bf16 a[244:247], a[248:251], v[32:39], v92
ds_read_b128 a[148:151], v89 offset:64
v_mfma_f32_16x16x32_bf16 v[68:71], a[112:115], a[64:67], v[64:67]
ds_read_b128 a[152:155], v89 offset:128
v_and_b32 v12, s36, v12
v_mfma_f32_16x16x32_bf16 v[68:71], a[116:119], a[68:71], v[68:71]
ds_read_b128 a[156:159], v89 offset:192
v_mul_f32 v116, s38, v116
v_mfma_f32_16x16x32_bf16 v[68:71], a[120:123], a[72:75], v[68:71]
ds_read_b128 a[172:175], v89 offset:704
v_mul_f32 v12, s38, v12
v_mfma_f32_16x16x32_bf16 v[68:71], a[124:127], a[76:79], v[68:71]
ds_read_b128 a[168:171], v89 offset:640
v_cvt_pk_bf16_f32 v12, v116, v12
v_mfma_f32_16x16x32_bf16 v[72:75], a[140:143], a[76:79], v[64:67]
ds_read_b128 a[164:167], v89 offset:576
v_lshlrev_b32 v117, 16, v13
v_mfma_f32_16x16x32_bf16 v[72:75], a[136:139], a[72:75], v[72:75]
s_xor_b32 s21, s23, 145408
ds_read_b128 a[160:163], v89 offset:512
v_and_b32 v13, s36, v13
v_mfma_f32_16x16x32_bf16 v[72:75], a[132:135], a[68:71], v[72:75]
s_add_u32 m0, s22, 20064
ds_read_b128 a[112:115], v88 offset:0
v_mul_f32 v117, s38, v117
v_mfma_f32_16x16x32_bf16 v[72:75], a[128:131], a[64:67], v[72:75]
ds_read_b128 a[116:119], v88 offset:64
v_mul_f32 v13, s38, v13
v_mfma_f32_16x16x32_bf16 v[224:227], a[208:211], v[44:47], v[224:227]
buffer_load_dwordx4 v97, s[8:11], s21 offen offset:0 nt lds
v_mfma_f32_16x16x32_bf16 v[224:227], a[176:179], v[40:43], v[224:227]
ds_read_b128 a[120:123], v88 offset:128
v_cvt_pk_bf16_f32 v13, v117, v13
v_mfma_f32_16x16x32_bf16 v[228:231], a[180:183], v[40:43], v[228:231]
ds_read_b128 a[124:127], v88 offset:192
v_lshlrev_b32 v118, 16, v14
v_mfma_f32_16x16x32_bf16 v[228:231], a[212:215], v[44:47], v[228:231]
ds_read_b128 a[140:143], v88 offset:704
v_and_b32 v14, s36, v14
v_mfma_f32_16x16x32_bf16 v[232:235], a[216:219], v[44:47], v[232:235]
ds_read_b128 a[136:139], v88 offset:640
v_mul_f32 v118, s38, v118
v_mfma_f32_16x16x32_bf16 v[232:235], a[184:187], v[40:43], v[232:235]
ds_read_b128 a[132:135], v88 offset:576
v_mul_f32 v14, s38, v14
v_mfma_f32_16x16x32_bf16 v[236:239], a[188:191], v[40:43], v[236:239]
ds_read_b128 a[128:131], v88 offset:512
v_cvt_pk_bf16_f32 v14, v118, v14
v_mfma_f32_16x16x32_bf16 v[236:239], a[220:223], v[44:47], v[236:239]
v_exp_f32 v68, v68
v_mfma_f32_16x16x32_bf16 v[240:243], a[224:227], v[44:47], v[240:243]
v_exp_f32 v69, v69
v_mfma_f32_16x16x32_bf16 v[240:243], a[192:195], v[40:43], v[240:243]
v_exp_f32 v70, v70
v_mfma_f32_16x16x32_bf16 v[244:247], a[196:199], v[40:43], v[244:247]
v_exp_f32 v71, v71
v_mfma_f32_16x16x32_bf16 v[244:247], a[228:231], v[44:47], v[244:247]
s_xor_b32 s21, s23, 133120
v_cvt_pk_bf16_f32 v32, v68, v69
v_cvt_pk_bf16_f32 v33, v70, v71
v_mfma_f32_16x16x32_bf16 v[248:251], a[232:235], v[44:47], v[248:251]
s_add_u32 m0, s22, 67584
v_exp_f32 v72, v72
v_mfma_f32_16x16x32_bf16 v[248:251], a[200:203], v[40:43], v[248:251]
v_exp_f32 v73, v73
v_mfma_f32_16x16x32_bf16 v[252:255], a[204:207], v[40:43], v[252:255]
buffer_load_dwordx4 v97, s[12:15], s21 offen offset:0 nt lds
v_mfma_f32_16x16x32_bf16 v[252:255], a[236:239], v[44:47], v[252:255]
v_exp_f32 v74, v74
v_smfmac_f32_16x16x64_bf16 a[244:247], a[252:255], v[40:47], v92
s_waitcnt lgkmcnt(0)
v_cvt_pk_bf16_f32 v34, v72, v73
v_mfma_f32_16x16x32_bf16 v[76:79], a[144:147], a[0:3], v[48:51]
v_exp_f32 v75, v75
v_mfma_f32_16x16x32_bf16 v[76:79], a[148:151], a[4:7], v[76:79]
ds_read_b64_tr_b16 a[208:209], v91 offset:0
v_cvt_pk_bf16_f32 v35, v74, v75
v_mfma_f32_16x16x32_bf16 v[76:79], a[152:155], a[8:11], v[76:79]
ds_read_b64_tr_b16 a[210:211], v91 offset:512
ds_read_b64_tr_b16 a[212:213], v91 offset:32
v_mfma_f32_16x16x32_bf16 v[76:79], a[156:159], a[12:15], v[76:79]
ds_read_b64_tr_b16 a[214:215], v91 offset:544
v_lshlrev_b32 v119, 16, v15
v_mfma_f32_16x16x32_bf16 v[80:83], a[172:175], a[12:15], v[48:51]
ds_read_b64_tr_b16 a[216:217], v91 offset:64
ds_read_b64_tr_b16 a[218:219], v91 offset:576
v_mfma_f32_16x16x32_bf16 v[80:83], a[168:171], a[8:11], v[80:83]
ds_read_b64_tr_b16 a[220:221], v91 offset:96
v_and_b32 v15, s36, v15
v_mfma_f32_16x16x32_bf16 v[80:83], a[164:167], a[4:7], v[80:83]
ds_read_b64_tr_b16 a[222:223], v91 offset:608
ds_read_b64_tr_b16 a[224:225], v91 offset:128
v_mfma_f32_16x16x32_bf16 v[80:83], a[160:163], a[0:3], v[80:83]
v_exp_f32 v76, v76
v_mfma_f32_16x16x32_bf16 v[84:87], a[112:115], a[0:3], v[48:51]
s_xor_b32 s21, s23, 137216
v_exp_f32 v77, v77
v_mfma_f32_16x16x32_bf16 v[84:87], a[116:119], a[4:7], v[84:87]
s_add_u32 m0, s22, 68640
v_exp_f32 v78, v78
v_mfma_f32_16x16x32_bf16 v[84:87], a[120:123], a[8:11], v[84:87]
v_exp_f32 v79, v79
v_mfma_f32_16x16x32_bf16 v[84:87], a[124:127], a[12:15], v[84:87]
buffer_load_dwordx4 v97, s[12:15], s21 offen offset:0 nt lds
v_mfma_f32_16x16x32_bf16 v[68:71], a[140:143], a[12:15], v[48:51]
v_cvt_pk_bf16_f32 v44, v76, v77
v_cvt_pk_bf16_f32 v45, v78, v79
v_mfma_f32_16x16x32_bf16 v[68:71], a[136:139], a[8:11], v[68:71]
v_exp_f32 v80, v80
v_mfma_f32_16x16x32_bf16 v[68:71], a[132:135], a[4:7], v[68:71]
v_exp_f32 v81, v81
v_mfma_f32_16x16x32_bf16 v[68:71], a[128:131], a[0:3], v[68:71]
v_exp_f32 v82, v82
v_mfma_f32_16x16x32_bf16 v[104:107], a[248:251], v[32:35], v[104:107]
v_exp_f32 v83, v83
v_mfma_f32_16x16x32_bf16 a[80:83], a[176:179], v[32:35], a[80:83]
v_cvt_pk_bf16_f32 v46, v80, v81
v_cvt_pk_bf16_f32 v47, v82, v83
v_mfma_f32_16x16x32_bf16 a[84:87], a[180:183], v[32:35], a[84:87]
v_exp_f32 v84, v84
v_mfma_f32_16x16x32_bf16 a[88:91], a[184:187], v[32:35], a[88:91]
v_exp_f32 v85, v85
v_mfma_f32_16x16x32_bf16 a[92:95], a[188:191], v[32:35], a[92:95]
v_exp_f32 v86, v86
v_mfma_f32_16x16x32_bf16 a[96:99], a[192:195], v[32:35], a[96:99]
v_exp_f32 v87, v87
v_mfma_f32_16x16x32_bf16 a[100:103], a[196:199], v[32:35], a[100:103]
s_xor_b32 s21, s23, 141312
ds_read_b64_tr_b16 a[176:177], v90 offset:0
ds_read_b64_tr_b16 a[178:179], v90 offset:512
v_mfma_f32_16x16x32_bf16 a[104:107], a[200:203], v[32:35], a[104:107]
s_add_u32 m0, s22, 69696
v_cvt_pk_bf16_f32 v40, v84, v85
v_cvt_pk_bf16_f32 v41, v86, v87
v_mfma_f32_16x16x32_bf16 a[108:111], a[204:207], v[32:35], a[108:111]
ds_read_b64_tr_b16 a[180:181], v90 offset:32
ds_read_b64_tr_b16 a[182:183], v90 offset:544
v_mfma_f32_16x16x32_bf16 v[72:75], a[144:147], a[16:19], v[52:55]
buffer_load_dwordx4 v97, s[12:15], s21 offen offset:0 nt lds
v_mfma_f32_16x16x32_bf16 v[72:75], a[148:151], a[20:23], v[72:75]
v_exp_f32 v68, v68
v_mfma_f32_16x16x32_bf16 v[72:75], a[152:155], a[24:27], v[72:75]
v_exp_f32 v69, v69
v_mfma_f32_16x16x32_bf16 v[72:75], a[156:159], a[28:31], v[72:75]
v_exp_f32 v70, v70
v_mfma_f32_16x16x32_bf16 v[76:79], a[172:175], a[28:31], v[52:55]
v_exp_f32 v71, v71
v_mfma_f32_16x16x32_bf16 v[76:79], a[168:171], a[24:27], v[76:79]
ds_read_b64_tr_b16 a[184:185], v90 offset:64
ds_read_b64_tr_b16 a[186:187], v90 offset:576
v_mfma_f32_16x16x32_bf16 v[76:79], a[164:167], a[20:23], v[76:79]
v_cvt_pk_bf16_f32 v42, v68, v69
v_cvt_pk_bf16_f32 v43, v70, v71
v_mfma_f32_16x16x32_bf16 v[76:79], a[160:163], a[16:19], v[76:79]
ds_read_b64_tr_b16 a[188:189], v90 offset:96
ds_read_b64_tr_b16 a[190:191], v90 offset:608
v_mfma_f32_16x16x32_bf16 v[80:83], a[112:115], a[16:19], v[52:55]
ds_read_b64_tr_b16 a[226:227], v91 offset:640
v_mul_f32 v119, s38, v119
v_mfma_f32_16x16x32_bf16 v[80:83], a[116:119], a[20:23], v[80:83]
ds_read_b64_tr_b16 a[192:193], v90 offset:128
ds_read_b64_tr_b16 a[194:195], v90 offset:640
v_mfma_f32_16x16x32_bf16 v[80:83], a[120:123], a[24:27], v[80:83]
ds_read_b64_tr_b16 a[196:197], v90 offset:160
v_mul_f32 v15, s38, v15
v_mfma_f32_16x16x32_bf16 v[80:83], a[124:127], a[28:31], v[80:83]
ds_read_b64_tr_b16 a[198:199], v90 offset:672
ds_read_b64_tr_b16 a[228:229], v91 offset:160
v_mfma_f32_16x16x32_bf16 v[84:87], a[140:143], a[28:31], v[52:55]
s_xor_b32 s21, s23, 145408
ds_read_b64_tr_b16 a[230:231], v91 offset:672
v_cvt_pk_bf16_f32 v15, v119, v15
v_mfma_f32_16x16x32_bf16 v[84:87], a[136:139], a[24:27], v[84:87]
s_add_u32 m0, s22, 70752
ds_read_b64_tr_b16 a[232:233], v91 offset:192
ds_read_b64_tr_b16 a[234:235], v91 offset:704
v_mfma_f32_16x16x32_bf16 v[84:87], a[132:135], a[20:23], v[84:87]
s_waitcnt lgkmcnt(11)
ds_read_b64_tr_b16 a[200:201], v90 offset:192
v_lshlrev_b32 v116, 16, v16
v_mfma_f32_16x16x32_bf16 v[84:87], a[128:131], a[16:19], v[84:87]
buffer_load_dwordx4 v97, s[12:15], s21 offen offset:0 nt lds
v_mfma_f32_16x16x32_bf16 v[128:131], a[208:211], v[44:47], v[128:131]
ds_read_b64_tr_b16 a[202:203], v90 offset:704
ds_read_b64_tr_b16 a[204:205], v90 offset:224
v_mfma_f32_16x16x32_bf16 v[128:131], a[176:179], v[40:43], v[128:131]
ds_read_b64_tr_b16 a[206:207], v90 offset:736
v_and_b32 v16, s36, v16
v_mfma_f32_16x16x32_bf16 v[132:135], a[180:183], v[40:43], v[132:135]
ds_read_b64_tr_b16 a[236:237], v91 offset:224
ds_read_b64_tr_b16 a[238:239], v91 offset:736
v_mfma_f32_16x16x32_bf16 v[132:135], a[212:215], v[44:47], v[132:135]
v_exp_f32 v72, v72
v_mfma_f32_16x16x32_bf16 v[136:139], a[216:219], v[44:47], v[136:139]
v_exp_f32 v73, v73
v_mfma_f32_16x16x32_bf16 v[136:139], a[184:187], v[40:43], v[136:139]
s_waitcnt lgkmcnt(6)
v_exp_f32 v74, v74
v_mfma_f32_16x16x32_bf16 v[140:143], a[188:191], v[40:43], v[140:143]
v_exp_f32 v75, v75
v_mfma_f32_16x16x32_bf16 v[140:143], a[220:223], v[44:47], v[140:143]
v_cvt_pk_bf16_f32 v36, v72, v73
v_cvt_pk_bf16_f32 v37, v74, v75
v_mfma_f32_16x16x32_bf16 v[144:147], a[224:227], v[44:47], v[144:147]
v_exp_f32 v76, v76
v_mfma_f32_16x16x32_bf16 v[144:147], a[192:195], v[40:43], v[144:147]
v_exp_f32 v77, v77
v_mfma_f32_16x16x32_bf16 v[148:151], a[196:199], v[40:43], v[148:151]
v_exp_f32 v78, v78
v_mfma_f32_16x16x32_bf16 v[148:151], a[228:231], v[44:47], v[148:151]
s_add_u32 m0, s24, 4448
v_exp_f32 v79, v79
v_mfma_f32_16x16x32_bf16 v[152:155], a[232:235], v[44:47], v[152:155]
s_waitcnt lgkmcnt(0)
v_cvt_pk_bf16_f32 v38, v76, v77
v_cvt_pk_bf16_f32 v39, v78, v79
v_mfma_f32_16x16x32_bf16 v[152:155], a[200:203], v[40:43], v[152:155]
buffer_load_dwordx4 v96, s[4:7], s37 offen offset:3072 nt lds
v_mfma_f32_16x16x32_bf16 v[156:159], a[204:207], v[40:43], v[156:159]
v_exp_f32 v80, v80
v_mfma_f32_16x16x32_bf16 v[156:159], a[236:239], v[44:47], v[156:159]
v_exp_f32 v81, v81
v_smfmac_f32_16x16x64_bf16 a[240:243], a[248:251], v[40:47], v92
v_cvt_pk_bf16_f32 v32, v80, v81
v_mfma_f32_16x16x32_bf16 v[68:71], a[144:147], a[32:35], v[56:59]
v_exp_f32 v82, v82
v_mfma_f32_16x16x32_bf16 v[68:71], a[148:151], a[36:39], v[68:71]
v_exp_f32 v83, v83
v_mfma_f32_16x16x32_bf16 v[68:71], a[152:155], a[40:43], v[68:71]
s_waitcnt vmcnt(11)
ds_read_b128 v[108:111], v99 offset:4352
v_cvt_pk_bf16_f32 v33, v82, v83
v_mfma_f32_16x16x32_bf16 v[68:71], a[156:159], a[44:47], v[68:71]
v_exp_f32 v84, v84
v_mfma_f32_16x16x32_bf16 v[72:75], a[172:175], a[44:47], v[56:59]
v_exp_f32 v85, v85
v_mfma_f32_16x16x32_bf16 v[72:75], a[168:171], a[40:43], v[72:75]
v_exp_f32 v86, v86
v_mfma_f32_16x16x32_bf16 v[72:75], a[164:167], a[36:39], v[72:75]
v_exp_f32 v87, v87
v_mfma_f32_16x16x32_bf16 v[72:75], a[160:163], a[32:35], v[72:75]
s_add_u32 s37, s31, 81920
v_cvt_pk_bf16_f32 v34, v84, v85
v_cvt_pk_bf16_f32 v35, v86, v87
v_mfma_f32_16x16x32_bf16 v[76:79], a[112:115], a[32:35], v[56:59]
s_add_u32 m0, s24, 8704
v_exp_f32 v68, v68
v_mfma_f32_16x16x32_bf16 v[76:79], a[116:119], a[36:39], v[76:79]
v_exp_f32 v69, v69
v_mfma_f32_16x16x32_bf16 v[76:79], a[120:123], a[40:43], v[76:79]
buffer_load_dwordx4 v96, s[4:7], s37 offen offset:0 nt lds
v_mfma_f32_16x16x32_bf16 v[76:79], a[124:127], a[44:47], v[76:79]
v_exp_f32 v70, v70
v_mfma_f32_16x16x32_bf16 v[80:83], a[140:143], a[44:47], v[56:59]
v_exp_f32 v71, v71
v_mfma_f32_16x16x32_bf16 v[80:83], a[136:139], a[40:43], v[80:83]
v_cvt_pk_bf16_f32 v44, v68, v69
v_cvt_pk_bf16_f32 v45, v70, v71
v_mfma_f32_16x16x32_bf16 v[80:83], a[132:135], a[36:39], v[80:83]
v_exp_f32 v72, v72
v_mfma_f32_16x16x32_bf16 v[80:83], a[128:131], a[32:35], v[80:83]
v_exp_f32 v73, v73
v_mfma_f32_16x16x32_bf16 v[160:163], a[208:211], v[36:39], v[160:163]
v_exp_f32 v74, v74
v_mfma_f32_16x16x32_bf16 v[160:163], a[176:179], v[32:35], v[160:163]
v_exp_f32 v75, v75
v_mfma_f32_16x16x32_bf16 v[164:167], a[180:183], v[32:35], v[164:167]
v_cvt_pk_bf16_f32 v46, v72, v73
v_cvt_pk_bf16_f32 v47, v74, v75
v_mfma_f32_16x16x32_bf16 v[164:167], a[212:215], v[36:39], v[164:167]
v_exp_f32 v76, v76
v_mfma_f32_16x16x32_bf16 v[168:171], a[216:219], v[36:39], v[168:171]
v_exp_f32 v77, v77
v_mfma_f32_16x16x32_bf16 v[168:171], a[184:187], v[32:35], v[168:171]
s_xor_b32 s21, s23, 134144
v_exp_f32 v78, v78
v_mfma_f32_16x16x32_bf16 v[172:175], a[188:191], v[32:35], v[172:175]
s_add_u32 m0, s22, 33792
v_exp_f32 v79, v79
v_mfma_f32_16x16x32_bf16 v[172:175], a[220:223], v[36:39], v[172:175]
v_cvt_pk_bf16_f32 v40, v76, v77
v_cvt_pk_bf16_f32 v41, v78, v79
v_mfma_f32_16x16x32_bf16 v[176:179], a[224:227], v[36:39], v[176:179]
buffer_load_dwordx4 v97, s[8:11], s21 offen offset:0 nt lds
v_mfma_f32_16x16x32_bf16 v[176:179], a[192:195], v[32:35], v[176:179]
v_exp_f32 v80, v80
v_mfma_f32_16x16x32_bf16 v[180:183], a[196:199], v[32:35], v[180:183]
v_exp_f32 v81, v81
v_mfma_f32_16x16x32_bf16 v[180:183], a[228:231], v[36:39], v[180:183]
v_exp_f32 v82, v82
v_mfma_f32_16x16x32_bf16 v[184:187], a[232:235], v[36:39], v[184:187]
v_exp_f32 v83, v83
v_mfma_f32_16x16x32_bf16 v[184:187], a[200:203], v[32:35], v[184:187]
v_cvt_pk_bf16_f32 v42, v80, v81
v_cvt_pk_bf16_f32 v43, v82, v83
v_mfma_f32_16x16x32_bf16 v[188:191], a[204:207], v[32:35], v[188:191]
s_waitcnt vmcnt(12)
ds_read_b128 v[112:115], v99 offset:5408
v_mul_f32 v116, s38, v116
v_mfma_f32_16x16x32_bf16 v[188:191], a[236:239], v[36:39], v[188:191]
v_mul_f32 v16, s38, v16
v_cvt_pk_bf16_f32 v16, v116, v16
v_smfmac_f32_16x16x64_bf16 a[240:243], a[252:255], v[32:39], v92
v_lshlrev_b32 v117, 16, v17
v_mfma_f32_16x16x32_bf16 v[84:87], a[144:147], a[48:51], v[60:63]
v_and_b32 v17, s36, v17
v_mul_f32 v117, s38, v117
v_mfma_f32_16x16x32_bf16 v[84:87], a[148:151], a[52:55], v[84:87]
v_mul_f32 v17, s38, v17
v_cvt_pk_bf16_f32 v17, v117, v17
v_mfma_f32_16x16x32_bf16 v[84:87], a[152:155], a[56:59], v[84:87]
s_xor_b32 s21, s23, 138240
v_lshlrev_b32 v118, 16, v18
v_and_b32 v18, s36, v18
v_mfma_f32_16x16x32_bf16 v[84:87], a[156:159], a[60:63], v[84:87]
s_add_u32 m0, s22, 34848
v_mul_f32 v118, s38, v118
v_mul_f32 v18, s38, v18
v_mfma_f32_16x16x32_bf16 v[68:71], a[172:175], a[60:63], v[60:63]
v_cvt_pk_bf16_f32 v18, v118, v18
v_lshlrev_b32 v119, 16, v19
v_mfma_f32_16x16x32_bf16 v[68:71], a[168:171], a[56:59], v[68:71]
buffer_load_dwordx4 v97, s[8:11], s21 offen offset:0 nt lds
v_mfma_f32_16x16x32_bf16 v[68:71], a[164:167], a[52:55], v[68:71]
v_and_b32 v19, s36, v19
v_mul_f32 v119, s38, v119
v_mfma_f32_16x16x32_bf16 v[68:71], a[160:163], a[48:51], v[68:71]
v_exp_f32 v84, v84
v_mfma_f32_16x16x32_bf16 v[72:75], a[112:115], a[48:51], v[60:63]
v_exp_f32 v85, v85
v_mfma_f32_16x16x32_bf16 v[72:75], a[116:119], a[52:55], v[72:75]
v_exp_f32 v86, v86
v_mfma_f32_16x16x32_bf16 v[72:75], a[120:123], a[56:59], v[72:75]
v_exp_f32 v87, v87
v_mfma_f32_16x16x32_bf16 v[72:75], a[124:127], a[60:63], v[72:75]
v_cvt_pk_bf16_f32 v36, v84, v85
v_cvt_pk_bf16_f32 v37, v86, v87
v_mfma_f32_16x16x32_bf16 v[76:79], a[140:143], a[60:63], v[60:63]
v_exp_f32 v68, v68
v_mfma_f32_16x16x32_bf16 v[76:79], a[136:139], a[56:59], v[76:79]
v_exp_f32 v69, v69
v_mfma_f32_16x16x32_bf16 v[76:79], a[132:135], a[52:55], v[76:79]
v_exp_f32 v70, v70
v_mfma_f32_16x16x32_bf16 v[76:79], a[128:131], a[48:51], v[76:79]
v_exp_f32 v71, v71
v_mfma_f32_16x16x32_bf16 v[192:195], a[208:211], v[44:47], v[192:195]
s_xor_b32 s21, s23, 142336
v_cvt_pk_bf16_f32 v38, v68, v69
v_cvt_pk_bf16_f32 v39, v70, v71
v_mfma_f32_16x16x32_bf16 v[192:195], a[176:179], v[40:43], v[192:195]
s_add_u32 m0, s22, 35904
v_exp_f32 v72, v72
v_mfma_f32_16x16x32_bf16 v[196:199], a[180:183], v[40:43], v[196:199]
v_exp_f32 v73, v73
v_mfma_f32_16x16x32_bf16 v[196:199], a[212:215], v[44:47], v[196:199]
buffer_load_dwordx4 v97, s[8:11], s21 offen offset:0 nt lds
v_mfma_f32_16x16x32_bf16 v[200:203], a[216:219], v[44:47], v[200:203]
v_exp_f32 v74, v74
v_mfma_f32_16x16x32_bf16 v[200:203], a[184:187], v[40:43], v[200:203]
v_exp_f32 v75, v75
v_mfma_f32_16x16x32_bf16 v[204:207], a[188:191], v[40:43], v[204:207]
v_exp_f32 v76, v76
v_mfma_f32_16x16x32_bf16 v[204:207], a[220:223], v[44:47], v[204:207]
v_exp_f32 v77, v77
v_mfma_f32_16x16x32_bf16 v[208:211], a[224:227], v[44:47], v[208:211]
v_exp_f32 v78, v78
v_mfma_f32_16x16x32_bf16 v[208:211], a[192:195], v[40:43], v[208:211]
v_exp_f32 v79, v79
v_mfma_f32_16x16x32_bf16 v[212:215], a[196:199], v[40:43], v[212:215]
v_cvt_pk_bf16_f32 v32, v72, v73
v_cvt_pk_bf16_f32 v33, v74, v75
v_mfma_f32_16x16x32_bf16 v[212:215], a[228:231], v[44:47], v[212:215]
v_cvt_pk_bf16_f32 v34, v76, v77
v_cvt_pk_bf16_f32 v35, v78, v79
v_mfma_f32_16x16x32_bf16 v[216:219], a[232:235], v[44:47], v[216:219]
v_mul_f32 v19, s38, v19
v_cvt_pk_bf16_f32 v19, v119, v19
v_mfma_f32_16x16x32_bf16 v[216:219], a[200:203], v[40:43], v[216:219]
v_lshlrev_b32 v116, 16, v20
v_and_b32 v20, s36, v20
v_mfma_f32_16x16x32_bf16 v[220:223], a[204:207], v[40:43], v[220:223]
s_waitcnt vmcnt(5)
s_barrier
v_mfma_f32_16x16x32_bf16 v[220:223], a[236:239], v[44:47], v[220:223]
s_xor_b32 s21, s23, 146432
ds_read_b128 a[144:147], v89 offset:16896
v_mul_f32 v116, s38, v116
v_smfmac_f32_16x16x64_bf16 a[244:247], a[248:251], v[40:47], v92
s_add_u32 m0, s22, 36960
ds_read_b128 a[148:151], v89 offset:16960
v_mfma_f32_16x16x32_bf16 v[80:83], a[112:115], a[64:67], v[64:67]
buffer_load_dwordx4 v97, s[8:11], s21 offen offset:0 nt lds
v_mfma_f32_16x16x32_bf16 v[80:83], a[116:119], a[68:71], v[80:83]
ds_read_b128 a[152:155], v89 offset:17024
v_mul_f32 v20, s38, v20
v_mfma_f32_16x16x32_bf16 v[80:83], a[120:123], a[72:75], v[80:83]
ds_read_b128 a[156:159], v89 offset:17088
v_cvt_pk_bf16_f32 v20, v116, v20
v_mfma_f32_16x16x32_bf16 v[80:83], a[124:127], a[76:79], v[80:83]
ds_read_b128 a[172:175], v89 offset:17600
v_lshlrev_b32 v117, 16, v21
v_mfma_f32_16x16x32_bf16 v[84:87], a[140:143], a[76:79], v[64:67]
ds_read_b128 a[168:171], v89 offset:17536
v_and_b32 v21, s36, v21
v_mfma_f32_16x16x32_bf16 v[84:87], a[136:139], a[72:75], v[84:87]
ds_read_b128 a[164:167], v89 offset:17472
v_mul_f32 v117, s38, v117
v_mfma_f32_16x16x32_bf16 v[84:87], a[132:135], a[68:71], v[84:87]
ds_read_b128 a[160:163], v89 offset:17408
v_mul_f32 v21, s38, v21
v_mfma_f32_16x16x32_bf16 v[84:87], a[128:131], a[64:67], v[84:87]
ds_read_b128 a[112:115], v88 offset:16896
v_cvt_pk_bf16_f32 v21, v117, v21
v_mfma_f32_16x16x32_bf16 v[224:227], a[208:211], v[36:39], v[224:227]
ds_read_b128 a[116:119], v88 offset:16960
v_lshlrev_b32 v118, 16, v22
v_mfma_f32_16x16x32_bf16 v[224:227], a[176:179], v[32:35], v[224:227]
ds_read_b128 a[120:123], v88 offset:17024
v_and_b32 v22, s36, v22
v_mfma_f32_16x16x32_bf16 v[228:231], a[180:183], v[32:35], v[228:231]
ds_read_b128 a[124:127], v88 offset:17088
v_mul_f32 v118, s38, v118
v_mfma_f32_16x16x32_bf16 v[228:231], a[212:215], v[36:39], v[228:231]
ds_read_b128 a[140:143], v88 offset:17600
v_mul_f32 v22, s38, v22
v_mfma_f32_16x16x32_bf16 v[232:235], a[216:219], v[36:39], v[232:235]
s_xor_b32 s21, s23, 134144
ds_read_b128 a[136:139], v88 offset:17536
v_cvt_pk_bf16_f32 v22, v118, v22
v_mfma_f32_16x16x32_bf16 v[232:235], a[184:187], v[32:35], v[232:235]
s_add_u32 m0, s22, 84480
ds_read_b128 a[132:135], v88 offset:17472
v_lshlrev_b32 v119, 16, v23
v_mfma_f32_16x16x32_bf16 v[236:239], a[188:191], v[32:35], v[236:239]
ds_read_b128 a[128:131], v88 offset:17408
v_and_b32 v23, s36, v23
v_mfma_f32_16x16x32_bf16 v[236:239], a[220:223], v[36:39], v[236:239]
buffer_load_dwordx4 v97, s[12:15], s21 offen offset:0 nt lds
v_mfma_f32_16x16x32_bf16 v[240:243], a[224:227], v[36:39], v[240:243]
v_exp_f32 v80, v80
v_mfma_f32_16x16x32_bf16 v[240:243], a[192:195], v[32:35], v[240:243]
v_exp_f32 v81, v81
v_mfma_f32_16x16x32_bf16 v[244:247], a[196:199], v[32:35], v[244:247]
v_exp_f32 v82, v82
v_mfma_f32_16x16x32_bf16 v[244:247], a[228:231], v[36:39], v[244:247]
v_exp_f32 v83, v83
v_mfma_f32_16x16x32_bf16 v[248:251], a[232:235], v[36:39], v[248:251]
v_cvt_pk_bf16_f32 v40, v80, v81
v_cvt_pk_bf16_f32 v41, v82, v83
v_mfma_f32_16x16x32_bf16 v[248:251], a[200:203], v[32:35], v[248:251]
v_exp_f32 v84, v84
v_mfma_f32_16x16x32_bf16 v[252:255], a[204:207], v[32:35], v[252:255]
v_exp_f32 v85, v85
v_mfma_f32_16x16x32_bf16 v[252:255], a[236:239], v[36:39], v[252:255]
v_exp_f32 v86, v86
v_smfmac_f32_16x16x64_bf16 a[244:247], a[252:255], v[32:39], v92
s_waitcnt lgkmcnt(0)
v_cvt_pk_bf16_f32 v42, v84, v85
v_mfma_f32_16x16x32_bf16 v[68:71], a[144:147], a[0:3], v[48:51]
v_exp_f32 v87, v87
v_mfma_f32_16x16x32_bf16 v[68:71], a[148:151], a[4:7], v[68:71]
s_xor_b32 s21, s23, 138240
ds_read_b64_tr_b16 a[208:209], v91 offset:16896
v_cvt_pk_bf16_f32 v43, v86, v87
v_mfma_f32_16x16x32_bf16 v[68:71], a[152:155], a[8:11], v[68:71]
s_add_u32 m0, s22, 85536
ds_read_b64_tr_b16 a[210:211], v91 offset:17408
ds_read_b64_tr_b16 a[212:213], v91 offset:16928
v_mfma_f32_16x16x32_bf16 v[68:71], a[156:159], a[12:15], v[68:71]
ds_read_b64_tr_b16 a[214:215], v91 offset:17440
v_mul_f32 v119, s38, v119
v_mfma_f32_16x16x32_bf16 v[72:75], a[172:175], a[12:15], v[48:51]
buffer_load_dwordx4 v97, s[12:15], s21 offen offset:0 nt lds
v_mfma_f32_16x16x32_bf16 v[72:75], a[168:171], a[8:11], v[72:75]
ds_read_b64_tr_b16 a[216:217], v91 offset:16960
ds_read_b64_tr_b16 a[218:219], v91 offset:17472
v_mfma_f32_16x16x32_bf16 v[72:75], a[164:167], a[4:7], v[72:75]
ds_read_b64_tr_b16 a[220:221], v91 offset:16992
v_mul_f32 v23, s38, v23
v_mfma_f32_16x16x32_bf16 v[72:75], a[160:163], a[0:3], v[72:75]
v_exp_f32 v68, v68
v_mfma_f32_16x16x32_bf16 v[76:79], a[112:115], a[0:3], v[48:51]
v_exp_f32 v69, v69
v_mfma_f32_16x16x32_bf16 v[76:79], a[116:119], a[4:7], v[76:79]
v_exp_f32 v70, v70
v_mfma_f32_16x16x32_bf16 v[76:79], a[120:123], a[8:11], v[76:79]
v_exp_f32 v71, v71
v_mfma_f32_16x16x32_bf16 v[76:79], a[124:127], a[12:15], v[76:79]
v_cvt_pk_bf16_f32 v36, v68, v69
v_cvt_pk_bf16_f32 v37, v70, v71
v_mfma_f32_16x16x32_bf16 v[80:83], a[140:143], a[12:15], v[48:51]
v_exp_f32 v72, v72
v_mfma_f32_16x16x32_bf16 v[80:83], a[136:139], a[8:11], v[80:83]
v_exp_f32 v73, v73
v_mfma_f32_16x16x32_bf16 v[80:83], a[132:135], a[4:7], v[80:83]
v_exp_f32 v74, v74
v_mfma_f32_16x16x32_bf16 v[80:83], a[128:131], a[0:3], v[80:83]
s_xor_b32 s21, s23, 142336
v_exp_f32 v75, v75
v_mfma_f32_16x16x32_bf16 v[104:107], a[248:251], v[40:43], v[104:107]
s_add_u32 m0, s22, 86592
v_cvt_pk_bf16_f32 v38, v72, v73
v_cvt_pk_bf16_f32 v39, v74, v75
v_mfma_f32_16x16x32_bf16 a[80:83], a[176:179], v[40:43], a[80:83]
v_exp_f32 v76, v76
v_mfma_f32_16x16x32_bf16 a[84:87], a[180:183], v[40:43], a[84:87]
buffer_load_dwordx4 v97, s[12:15], s21 offen offset:0 nt lds
v_mfma_f32_16x16x32_bf16 a[88:91], a[184:187], v[40:43], a[88:91]
v_exp_f32 v77, v77
v_mfma_f32_16x16x32_bf16 a[92:95], a[188:191], v[40:43], a[92:95]
v_exp_f32 v78, v78
v_mfma_f32_16x16x32_bf16 a[96:99], a[192:195], v[40:43], a[96:99]
v_exp_f32 v79, v79
v_mfma_f32_16x16x32_bf16 a[100:103], a[196:199], v[40:43], a[100:103]
ds_read_b64_tr_b16 a[176:177], v90 offset:16896
ds_read_b64_tr_b16 a[178:179], v90 offset:17408
v_mfma_f32_16x16x32_bf16 a[104:107], a[200:203], v[40:43], a[104:107]
v_cvt_pk_bf16_f32 v32, v76, v77
v_cvt_pk_bf16_f32 v33, v78, v79
v_mfma_f32_16x16x32_bf16 a[108:111], a[204:207], v[40:43], a[108:111]
ds_read_b64_tr_b16 a[180:181], v90 offset:16928
ds_read_b64_tr_b16 a[182:183], v90 offset:17440
v_mfma_f32_16x16x32_bf16 v[84:87], a[144:147], a[16:19], v[52:55]
v_exp_f32 v80, v80
v_mfma_f32_16x16x32_bf16 v[84:87], a[148:151], a[20:23], v[84:87]
v_exp_f32 v81, v81
v_mfma_f32_16x16x32_bf16 v[84:87], a[152:155], a[24:27], v[84:87]
v_exp_f32 v82, v82
v_mfma_f32_16x16x32_bf16 v[84:87], a[156:159], a[28:31], v[84:87]
v_exp_f32 v83, v83
v_mfma_f32_16x16x32_bf16 v[68:71], a[172:175], a[28:31], v[52:55]
ds_read_b64_tr_b16 a[184:185], v90 offset:16960
ds_read_b64_tr_b16 a[186:187], v90 offset:17472
v_mfma_f32_16x16x32_bf16 v[68:71], a[168:171], a[24:27], v[68:71]
s_xor_b32 s21, s23, 146432
v_cvt_pk_bf16_f32 v34, v80, v81
v_cvt_pk_bf16_f32 v35, v82, v83
v_mfma_f32_16x16x32_bf16 v[68:71], a[164:167], a[20:23], v[68:71]
s_add_u32 m0, s22, 87648
ds_read_b64_tr_b16 a[188:189], v90 offset:16992
ds_read_b64_tr_b16 a[190:191], v90 offset:17504
v_mfma_f32_16x16x32_bf16 v[68:71], a[160:163], a[16:19], v[68:71]
ds_read_b64_tr_b16 a[222:223], v91 offset:17504
v_cvt_pk_bf16_f32 v23, v119, v23
v_mfma_f32_16x16x32_bf16 v[72:75], a[112:115], a[16:19], v[52:55]
buffer_load_dwordx4 v97, s[12:15], s21 offen offset:0 nt lds
v_mfma_f32_16x16x32_bf16 v[72:75], a[116:119], a[20:23], v[72:75]
ds_read_b64_tr_b16 a[224:225], v91 offset:17024
ds_read_b64_tr_b16 a[226:227], v91 offset:17536
v_mfma_f32_16x16x32_bf16 v[72:75], a[120:123], a[24:27], v[72:75]
ds_read_b64_tr_b16 a[192:193], v90 offset:17024
v_lshlrev_b32 v116, 16, v24
v_mfma_f32_16x16x32_bf16 v[72:75], a[124:127], a[28:31], v[72:75]
ds_read_b64_tr_b16 a[194:195], v90 offset:17536
ds_read_b64_tr_b16 a[196:197], v90 offset:17056
v_mfma_f32_16x16x32_bf16 v[76:79], a[140:143], a[28:31], v[52:55]
ds_read_b64_tr_b16 a[198:199], v90 offset:17568
v_and_b32 v24, s36, v24
v_mfma_f32_16x16x32_bf16 v[76:79], a[136:139], a[24:27], v[76:79]
ds_read_b64_tr_b16 a[228:229], v91 offset:17056
ds_read_b64_tr_b16 a[230:231], v91 offset:17568
v_mfma_f32_16x16x32_bf16 v[76:79], a[132:135], a[20:23], v[76:79]
ds_read_b64_tr_b16 a[232:233], v91 offset:17088
v_mul_f32 v116, s38, v116
v_mfma_f32_16x16x32_bf16 v[76:79], a[128:131], a[16:19], v[76:79]
s_waitcnt lgkmcnt(9)
ds_read_b64_tr_b16 a[234:235], v91 offset:17600
ds_read_b64_tr_b16 a[200:201], v90 offset:17088
v_mfma_f32_16x16x32_bf16 v[128:131], a[208:211], v[36:39], v[128:131]
ds_read_b64_tr_b16 a[202:203], v90 offset:17600
v_mul_f32 v24, s38, v24
v_mfma_f32_16x16x32_bf16 v[128:131], a[176:179], v[32:35], v[128:131]
ds_read_b64_tr_b16 a[204:205], v90 offset:17120
ds_read_b64_tr_b16 a[206:207], v90 offset:17632
v_mfma_f32_16x16x32_bf16 v[132:135], a[180:183], v[32:35], v[132:135]
ds_read_b64_tr_b16 a[236:237], v91 offset:17120
v_cvt_pk_bf16_f32 v24, v116, v24
v_mfma_f32_16x16x32_bf16 v[132:135], a[212:215], v[36:39], v[132:135]
ds_read_b64_tr_b16 a[238:239], v91 offset:17632
v_lshlrev_b32 v117, 16, v25
v_mfma_f32_16x16x32_bf16 v[136:139], a[216:219], v[36:39], v[136:139]
v_exp_f32 v84, v84
v_mfma_f32_16x16x32_bf16 v[136:139], a[184:187], v[32:35], v[136:139]
s_add_u32 m0, s24, 8736
v_exp_f32 v85, v85
v_mfma_f32_16x16x32_bf16 v[140:143], a[188:191], v[32:35], v[140:143]
s_waitcnt lgkmcnt(7)
v_exp_f32 v86, v86
v_mfma_f32_16x16x32_bf16 v[140:143], a[220:223], v[36:39], v[140:143]
buffer_load_dwordx4 v96, s[4:7], s37 offen offset:1024 nt lds
v_mfma_f32_16x16x32_bf16 v[144:147], a[224:227], v[36:39], v[144:147]
v_exp_f32 v87, v87
v_mfma_f32_16x16x32_bf16 v[144:147], a[192:195], v[32:35], v[144:147]
v_cvt_pk_bf16_f32 v44, v84, v85
v_cvt_pk_bf16_f32 v45, v86, v87
v_mfma_f32_16x16x32_bf16 v[148:151], a[196:199], v[32:35], v[148:151]
v_exp_f32 v68, v68
v_mfma_f32_16x16x32_bf16 v[148:151], a[228:231], v[36:39], v[148:151]
s_waitcnt lgkmcnt(0)
v_exp_f32 v69, v69
v_mfma_f32_16x16x32_bf16 v[152:155], a[232:235], v[36:39], v[152:155]
v_exp_f32 v70, v70
v_mfma_f32_16x16x32_bf16 v[152:155], a[200:203], v[32:35], v[152:155]
v_exp_f32 v71, v71
v_mfma_f32_16x16x32_bf16 v[156:159], a[204:207], v[32:35], v[156:159]
v_cvt_pk_bf16_f32 v46, v68, v69
v_cvt_pk_bf16_f32 v47, v70, v71
v_mfma_f32_16x16x32_bf16 v[156:159], a[236:239], v[36:39], v[156:159]
v_exp_f32 v72, v72
v_smfmac_f32_16x16x64_bf16 a[240:243], a[248:251], v[32:39], v92
v_and_b32 v25, s36, v25
v_mfma_f32_16x16x32_bf16 v[80:83], a[144:147], a[32:35], v[56:59]
v_exp_f32 v73, v73
v_mfma_f32_16x16x32_bf16 v[80:83], a[148:151], a[36:39], v[80:83]
v_exp_f32 v74, v74
v_mfma_f32_16x16x32_bf16 v[80:83], a[152:155], a[40:43], v[80:83]
s_add_u32 m0, s24, 8768
v_exp_f32 v75, v75
v_mfma_f32_16x16x32_bf16 v[80:83], a[156:159], a[44:47], v[80:83]
v_cvt_pk_bf16_f32 v40, v72, v73
v_cvt_pk_bf16_f32 v41, v74, v75
v_mfma_f32_16x16x32_bf16 v[84:87], a[172:175], a[44:47], v[56:59]
buffer_load_dwordx4 v96, s[4:7], s37 offen offset:2048 nt lds
v_mfma_f32_16x16x32_bf16 v[84:87], a[168:171], a[40:43], v[84:87]
v_exp_f32 v76, v76
v_mfma_f32_16x16x32_bf16 v[84:87], a[164:167], a[36:39], v[84:87]
v_exp_f32 v77, v77
v_mfma_f32_16x16x32_bf16 v[84:87], a[160:163], a[32:35], v[84:87]
v_exp_f32 v78, v78
v_mfma_f32_16x16x32_bf16 v[68:71], a[112:115], a[32:35], v[56:59]
v_exp_f32 v79, v79
v_mfma_f32_16x16x32_bf16 v[68:71], a[116:119], a[36:39], v[68:71]
v_cvt_pk_bf16_f32 v42, v76, v77
v_cvt_pk_bf16_f32 v43, v78, v79
v_mfma_f32_16x16x32_bf16 v[68:71], a[120:123], a[40:43], v[68:71]
v_exp_f32 v80, v80
v_mfma_f32_16x16x32_bf16 v[68:71], a[124:127], a[44:47], v[68:71]
v_exp_f32 v81, v81
v_mfma_f32_16x16x32_bf16 v[72:75], a[140:143], a[44:47], v[56:59]
v_exp_f32 v82, v82
v_mfma_f32_16x16x32_bf16 v[72:75], a[136:139], a[40:43], v[72:75]
v_exp_f32 v83, v83
v_mfma_f32_16x16x32_bf16 v[72:75], a[132:135], a[36:39], v[72:75]
v_cvt_pk_bf16_f32 v36, v80, v81
v_cvt_pk_bf16_f32 v37, v82, v83
v_mfma_f32_16x16x32_bf16 v[72:75], a[128:131], a[32:35], v[72:75]
v_exp_f32 v84, v84
v_mfma_f32_16x16x32_bf16 v[160:163], a[208:211], v[44:47], v[160:163]
v_exp_f32 v85, v85
v_mfma_f32_16x16x32_bf16 v[160:163], a[176:179], v[40:43], v[160:163]
s_xor_b32 s21, s23, 147456
v_exp_f32 v86, v86
v_mfma_f32_16x16x32_bf16 v[164:167], a[180:183], v[40:43], v[164:167]
s_add_u32 m0, s22, 0
v_exp_f32 v87, v87
v_mfma_f32_16x16x32_bf16 v[164:167], a[212:215], v[44:47], v[164:167]
v_cvt_pk_bf16_f32 v38, v84, v85
v_cvt_pk_bf16_f32 v39, v86, v87
v_mfma_f32_16x16x32_bf16 v[168:171], a[216:219], v[44:47], v[168:171]
buffer_load_dwordx4 v97, s[8:11], s21 offen offset:0 nt lds
v_mfma_f32_16x16x32_bf16 v[168:171], a[184:187], v[40:43], v[168:171]
v_exp_f32 v68, v68
v_mfma_f32_16x16x32_bf16 v[172:175], a[188:191], v[40:43], v[172:175]
v_exp_f32 v69, v69
v_mfma_f32_16x16x32_bf16 v[172:175], a[220:223], v[44:47], v[172:175]
v_exp_f32 v70, v70
v_mfma_f32_16x16x32_bf16 v[176:179], a[224:227], v[44:47], v[176:179]
v_exp_f32 v71, v71
v_mfma_f32_16x16x32_bf16 v[176:179], a[192:195], v[40:43], v[176:179]
v_cvt_pk_bf16_f32 v32, v68, v69
v_cvt_pk_bf16_f32 v33, v70, v71
v_mfma_f32_16x16x32_bf16 v[180:183], a[196:199], v[40:43], v[180:183]
v_exp_f32 v72, v72
v_mfma_f32_16x16x32_bf16 v[180:183], a[228:231], v[44:47], v[180:183]
v_exp_f32 v73, v73
v_mfma_f32_16x16x32_bf16 v[184:187], a[232:235], v[44:47], v[184:187]
v_exp_f32 v74, v74
v_mfma_f32_16x16x32_bf16 v[184:187], a[200:203], v[40:43], v[184:187]
v_exp_f32 v75, v75
v_mfma_f32_16x16x32_bf16 v[188:191], a[204:207], v[40:43], v[188:191]
v_cvt_pk_bf16_f32 v34, v72, v73
v_cvt_pk_bf16_f32 v35, v74, v75
v_mfma_f32_16x16x32_bf16 v[188:191], a[236:239], v[44:47], v[188:191]
v_mul_f32 v117, s38, v117
v_mul_f32 v25, s38, v25
v_smfmac_f32_16x16x64_bf16 a[240:243], a[252:255], v[40:47], v92
s_xor_b32 s21, s23, 151552
v_cvt_pk_bf16_f32 v25, v117, v25
v_mfma_f32_16x16x32_bf16 v[76:79], a[144:147], a[48:51], v[60:63]
s_add_u32 m0, s22, 1056
v_lshlrev_b32 v118, 16, v26
v_and_b32 v26, s36, v26
v_mfma_f32_16x16x32_bf16 v[76:79], a[148:151], a[52:55], v[76:79]
v_mul_f32 v118, s38, v118
v_mul_f32 v26, s38, v26
v_mfma_f32_16x16x32_bf16 v[76:79], a[152:155], a[56:59], v[76:79]
buffer_load_dwordx4 v97, s[8:11], s21 offen offset:0 nt lds
v_mfma_f32_16x16x32_bf16 v[76:79], a[156:159], a[60:63], v[76:79]
v_cvt_pk_bf16_f32 v26, v118, v26
v_lshlrev_b32 v119, 16, v27
v_mfma_f32_16x16x32_bf16 v[80:83], a[172:175], a[60:63], v[60:63]
v_and_b32 v27, s36, v27
v_mul_f32 v119, s38, v119
v_mfma_f32_16x16x32_bf16 v[80:83], a[168:171], a[56:59], v[80:83]
v_mul_f32 v27, s38, v27
v_cvt_pk_bf16_f32 v27, v119, v27
v_mfma_f32_16x16x32_bf16 v[80:83], a[164:167], a[52:55], v[80:83]
v_lshlrev_b32 v116, 16, v28
v_and_b32 v28, s36, v28
v_mfma_f32_16x16x32_bf16 v[80:83], a[160:163], a[48:51], v[80:83]
v_exp_f32 v76, v76
v_mfma_f32_16x16x32_bf16 v[84:87], a[112:115], a[48:51], v[60:63]
v_exp_f32 v77, v77
v_mfma_f32_16x16x32_bf16 v[84:87], a[116:119], a[52:55], v[84:87]
v_exp_f32 v78, v78
v_mfma_f32_16x16x32_bf16 v[84:87], a[120:123], a[56:59], v[84:87]
v_exp_f32 v79, v79
v_mfma_f32_16x16x32_bf16 v[84:87], a[124:127], a[60:63], v[84:87]
v_cvt_pk_bf16_f32 v44, v76, v77
v_cvt_pk_bf16_f32 v45, v78, v79
v_mfma_f32_16x16x32_bf16 v[68:71], a[140:143], a[60:63], v[60:63]
v_exp_f32 v80, v80
v_mfma_f32_16x16x32_bf16 v[68:71], a[136:139], a[56:59], v[68:71]
v_exp_f32 v81, v81
v_mfma_f32_16x16x32_bf16 v[68:71], a[132:135], a[52:55], v[68:71]
s_xor_b32 s21, s23, 155648
v_exp_f32 v82, v82
v_mfma_f32_16x16x32_bf16 v[68:71], a[128:131], a[48:51], v[68:71]
s_add_u32 m0, s22, 2112
v_exp_f32 v83, v83
v_mfma_f32_16x16x32_bf16 v[192:195], a[208:211], v[36:39], v[192:195]
v_cvt_pk_bf16_f32 v46, v80, v81
v_cvt_pk_bf16_f32 v47, v82, v83
v_mfma_f32_16x16x32_bf16 v[192:195], a[176:179], v[32:35], v[192:195]
buffer_load_dwordx4 v97, s[8:11], s21 offen offset:0 nt lds
v_mfma_f32_16x16x32_bf16 v[196:199], a[180:183], v[32:35], v[196:199]
v_exp_f32 v84, v84
v_mfma_f32_16x16x32_bf16 v[196:199], a[212:215], v[36:39], v[196:199]
v_exp_f32 v85, v85
v_mfma_f32_16x16x32_bf16 v[200:203], a[216:219], v[36:39], v[200:203]
v_exp_f32 v86, v86
v_mfma_f32_16x16x32_bf16 v[200:203], a[184:187], v[32:35], v[200:203]
v_exp_f32 v87, v87
v_mfma_f32_16x16x32_bf16 v[204:207], a[188:191], v[32:35], v[204:207]
v_exp_f32 v68, v68
v_mfma_f32_16x16x32_bf16 v[204:207], a[220:223], v[36:39], v[204:207]
v_exp_f32 v69, v69
v_mfma_f32_16x16x32_bf16 v[208:211], a[224:227], v[36:39], v[208:211]
v_exp_f32 v70, v70
v_mfma_f32_16x16x32_bf16 v[208:211], a[192:195], v[32:35], v[208:211]
v_exp_f32 v71, v71
v_mfma_f32_16x16x32_bf16 v[212:215], a[196:199], v[32:35], v[212:215]
v_cvt_pk_bf16_f32 v40, v84, v85
v_cvt_pk_bf16_f32 v41, v86, v87
v_mfma_f32_16x16x32_bf16 v[212:215], a[228:231], v[36:39], v[212:215]
v_cvt_pk_bf16_f32 v42, v68, v69
v_cvt_pk_bf16_f32 v43, v70, v71
v_mfma_f32_16x16x32_bf16 v[216:219], a[232:235], v[36:39], v[216:219]
v_mul_f32 v116, s38, v116
v_mul_f32 v28, s38, v28
v_mfma_f32_16x16x32_bf16 v[216:219], a[200:203], v[32:35], v[216:219]
s_xor_b32 s21, s23, 159744
v_cvt_pk_bf16_f32 v28, v116, v28
v_lshlrev_b32 v117, 16, v29
v_mfma_f32_16x16x32_bf16 v[220:223], a[204:207], v[32:35], v[220:223]
s_waitcnt vmcnt(5)
s_barrier
v_mfma_f32_16x16x32_bf16 v[220:223], a[236:239], v[36:39], v[220:223]
s_add_u32 m0, s22, 3168
ds_read_b128 a[144:147], v89 offset:33792
v_and_b32 v29, s36, v29
v_smfmac_f32_16x16x64_bf16 a[244:247], a[248:251], v[32:39], v92
ds_read_b128 a[148:151], v89 offset:33856
v_mfma_f32_16x16x32_bf16 v[72:75], a[112:115], a[64:67], v[64:67]
buffer_load_dwordx4 v97, s[8:11], s21 offen offset:0 nt lds
v_mfma_f32_16x16x32_bf16 v[72:75], a[116:119], a[68:71], v[72:75]
ds_read_b128 a[152:155], v89 offset:33920
v_mul_f32 v117, s38, v117
v_mfma_f32_16x16x32_bf16 v[72:75], a[120:123], a[72:75], v[72:75]
ds_read_b128 a[156:159], v89 offset:33984
v_mul_f32 v29, s38, v29
v_mfma_f32_16x16x32_bf16 v[72:75], a[124:127], a[76:79], v[72:75]
ds_read_b128 a[172:175], v89 offset:34496
v_cvt_pk_bf16_f32 v29, v117, v29
v_mfma_f32_16x16x32_bf16 v[76:79], a[140:143], a[76:79], v[64:67]
ds_read_b128 a[168:171], v89 offset:34432
v_lshlrev_b32 v118, 16, v30
v_mfma_f32_16x16x32_bf16 v[76:79], a[136:139], a[72:75], v[76:79]
ds_read_b128 a[164:167], v89 offset:34368
v_and_b32 v30, s36, v30
v_mfma_f32_16x16x32_bf16 v[76:79], a[132:135], a[68:71], v[76:79]
ds_read_b128 a[160:163], v89 offset:34304
v_mul_f32 v118, s38, v118
v_mfma_f32_16x16x32_bf16 v[76:79], a[128:131], a[64:67], v[76:79]
ds_read_b128 a[112:115], v88 offset:33792
v_mul_f32 v30, s38, v30
v_mfma_f32_16x16x32_bf16 v[224:227], a[208:211], v[44:47], v[224:227]
ds_read_b128 a[116:119], v88 offset:33856
v_cvt_pk_bf16_f32 v30, v118, v30
v_mfma_f32_16x16x32_bf16 v[224:227], a[176:179], v[40:43], v[224:227]
ds_read_b128 a[120:123], v88 offset:33920
v_lshlrev_b32 v119, 16, v31
v_mfma_f32_16x16x32_bf16 v[228:231], a[180:183], v[40:43], v[228:231]
ds_read_b128 a[124:127], v88 offset:33984
v_and_b32 v31, s36, v31
v_mfma_f32_16x16x32_bf16 v[228:231], a[212:215], v[44:47], v[228:231]
ds_read_b128 a[140:143], v88 offset:34496
v_mul_f32 v119, s38, v119
v_mfma_f32_16x16x32_bf16 v[232:235], a[216:219], v[44:47], v[232:235]
s_xor_b32 s21, s23, 147456
ds_read_b128 a[136:139], v88 offset:34432
v_mul_f32 v31, s38, v31
v_mfma_f32_16x16x32_bf16 v[232:235], a[184:187], v[40:43], v[232:235]
s_add_u32 m0, s22, 50688
ds_read_b128 a[132:135], v88 offset:34368
v_cvt_pk_bf16_f32 v31, v119, v31
v_mfma_f32_16x16x32_bf16 v[236:239], a[188:191], v[40:43], v[236:239]
ds_read_b128 a[128:131], v88 offset:34304
v_lshlrev_b32 v116, 16, v108
v_mfma_f32_16x16x32_bf16 v[236:239], a[220:223], v[44:47], v[236:239]
buffer_load_dwordx4 v97, s[12:15], s21 offen offset:0 nt lds
v_mfma_f32_16x16x32_bf16 v[240:243], a[224:227], v[44:47], v[240:243]
v_exp_f32 v72, v72
v_mfma_f32_16x16x32_bf16 v[240:243], a[192:195], v[40:43], v[240:243]
v_exp_f32 v73, v73
v_mfma_f32_16x16x32_bf16 v[244:247], a[196:199], v[40:43], v[244:247]
v_exp_f32 v74, v74
v_mfma_f32_16x16x32_bf16 v[244:247], a[228:231], v[44:47], v[244:247]
v_exp_f32 v75, v75
v_mfma_f32_16x16x32_bf16 v[248:251], a[232:235], v[44:47], v[248:251]
v_cvt_pk_bf16_f32 v32, v72, v73
v_cvt_pk_bf16_f32 v33, v74, v75
v_mfma_f32_16x16x32_bf16 v[248:251], a[200:203], v[40:43], v[248:251]
v_exp_f32 v76, v76
v_mfma_f32_16x16x32_bf16 v[252:255], a[204:207], v[40:43], v[252:255]
v_exp_f32 v77, v77
v_mfma_f32_16x16x32_bf16 v[252:255], a[236:239], v[44:47], v[252:255]
v_exp_f32 v78, v78
v_smfmac_f32_16x16x64_bf16 a[244:247], a[252:255], v[40:47], v92
s_waitcnt lgkmcnt(0)
v_cvt_pk_bf16_f32 v34, v76, v77
v_mfma_f32_16x16x32_bf16 v[80:83], a[144:147], a[0:3], v[48:51]
v_exp_f32 v79, v79
v_mfma_f32_16x16x32_bf16 v[80:83], a[148:151], a[4:7], v[80:83]
ds_read_b64_tr_b16 a[208:209], v91 offset:33792
v_cvt_pk_bf16_f32 v35, v78, v79
v_mfma_f32_16x16x32_bf16 v[80:83], a[152:155], a[8:11], v[80:83]
ds_read_b64_tr_b16 a[210:211], v91 offset:34304
ds_read_b64_tr_b16 a[212:213], v91 offset:33824
v_mfma_f32_16x16x32_bf16 v[80:83], a[156:159], a[12:15], v[80:83]
s_xor_b32 s21, s23, 151552
ds_read_b64_tr_b16 a[214:215], v91 offset:34336
v_and_b32 v108, s36, v108
v_mfma_f32_16x16x32_bf16 v[84:87], a[172:175], a[12:15], v[48:51]
s_add_u32 m0, s22, 51744
ds_read_b64_tr_b16 a[216:217], v91 offset:33856
ds_read_b64_tr_b16 a[218:219], v91 offset:34368
v_mfma_f32_16x16x32_bf16 v[84:87], a[168:171], a[8:11], v[84:87]
ds_read_b64_tr_b16 a[220:221], v91 offset:33888
v_mul_f32 v116, s38, v116
v_mfma_f32_16x16x32_bf16 v[84:87], a[164:167], a[4:7], v[84:87]
buffer_load_dwordx4 v97, s[12:15], s21 offen offset:0 nt lds
v_mfma_f32_16x16x32_bf16 v[84:87], a[160:163], a[0:3], v[84:87]
v_exp_f32 v80, v80
v_mfma_f32_16x16x32_bf16 v[68:71], a[112:115], a[0:3], v[48:51]
v_exp_f32 v81, v81
v_mfma_f32_16x16x32_bf16 v[68:71], a[116:119], a[4:7], v[68:71]
v_exp_f32 v82, v82
v_mfma_f32_16x16x32_bf16 v[68:71], a[120:123], a[8:11], v[68:71]
v_exp_f32 v83, v83
v_mfma_f32_16x16x32_bf16 v[68:71], a[124:127], a[12:15], v[68:71]
v_cvt_pk_bf16_f32 v44, v80, v81
v_cvt_pk_bf16_f32 v45, v82, v83
v_mfma_f32_16x16x32_bf16 v[72:75], a[140:143], a[12:15], v[48:51]
v_exp_f32 v84, v84
v_mfma_f32_16x16x32_bf16 v[72:75], a[136:139], a[8:11], v[72:75]
v_exp_f32 v85, v85
v_mfma_f32_16x16x32_bf16 v[72:75], a[132:135], a[4:7], v[72:75]
v_exp_f32 v86, v86
v_mfma_f32_16x16x32_bf16 v[72:75], a[128:131], a[0:3], v[72:75]
v_exp_f32 v87, v87
v_mfma_f32_16x16x32_bf16 v[104:107], a[248:251], v[32:35], v[104:107]
v_cvt_pk_bf16_f32 v46, v84, v85
v_cvt_pk_bf16_f32 v47, v86, v87
v_mfma_f32_16x16x32_bf16 a[80:83], a[176:179], v[32:35], a[80:83]
v_exp_f32 v68, v68
v_mfma_f32_16x16x32_bf16 a[84:87], a[180:183], v[32:35], a[84:87]
v_exp_f32 v69, v69
v_mfma_f32_16x16x32_bf16 a[88:91], a[184:187], v[32:35], a[88:91]
s_xor_b32 s21, s23, 155648
v_exp_f32 v70, v70
v_mfma_f32_16x16x32_bf16 a[92:95], a[188:191], v[32:35], a[92:95]
s_add_u32 m0, s22, 52800
v_exp_f32 v71, v71
v_mfma_f32_16x16x32_bf16 a[96:99], a[192:195], v[32:35], a[96:99]
ds_read_b64_tr_b16 a[176:177], v90 offset:33792
ds_read_b64_tr_b16 a[178:179], v90 offset:34304
v_mfma_f32_16x16x32_bf16 a[100:103], a[196:199], v[32:35], a[100:103]
buffer_load_dwordx4 v97, s[12:15], s21 offen offset:0 nt lds
v_mfma_f32_16x16x32_bf16 a[104:107], a[200:203], v[32:35], a[104:107]
v_cvt_pk_bf16_f32 v40, v68, v69
v_cvt_pk_bf16_f32 v41, v70, v71
v_mfma_f32_16x16x32_bf16 a[108:111], a[204:207], v[32:35], a[108:111]
ds_read_b64_tr_b16 a[180:181], v90 offset:33824
ds_read_b64_tr_b16 a[182:183], v90 offset:34336
v_mfma_f32_16x16x32_bf16 v[76:79], a[144:147], a[16:19], v[52:55]
v_exp_f32 v72, v72
v_mfma_f32_16x16x32_bf16 v[76:79], a[148:151], a[20:23], v[76:79]
v_exp_f32 v73, v73
v_mfma_f32_16x16x32_bf16 v[76:79], a[152:155], a[24:27], v[76:79]
v_exp_f32 v74, v74
v_mfma_f32_16x16x32_bf16 v[76:79], a[156:159], a[28:31], v[76:79]
v_exp_f32 v75, v75
v_mfma_f32_16x16x32_bf16 v[80:83], a[172:175], a[28:31], v[52:55]
ds_read_b64_tr_b16 a[184:185], v90 offset:33856
ds_read_b64_tr_b16 a[186:187], v90 offset:34368
v_mfma_f32_16x16x32_bf16 v[80:83], a[168:171], a[24:27], v[80:83]
v_cvt_pk_bf16_f32 v42, v72, v73
v_cvt_pk_bf16_f32 v43, v74, v75
v_mfma_f32_16x16x32_bf16 v[80:83], a[164:167], a[20:23], v[80:83]
ds_read_b64_tr_b16 a[188:189], v90 offset:33888
ds_read_b64_tr_b16 a[190:191], v90 offset:34400
v_mfma_f32_16x16x32_bf16 v[80:83], a[160:163], a[16:19], v[80:83]
ds_read_b64_tr_b16 a[222:223], v91 offset:34400
v_mul_f32 v108, s38, v108
v_mfma_f32_16x16x32_bf16 v[84:87], a[112:115], a[16:19], v[52:55]
ds_read_b64_tr_b16 a[224:225], v91 offset:33920
ds_read_b64_tr_b16 a[226:227], v91 offset:34432
v_mfma_f32_16x16x32_bf16 v[84:87], a[116:119], a[20:23], v[84:87]
ds_read_b64_tr_b16 a[192:193], v90 offset:33920
v_cvt_pk_bf16_f32 v108, v116, v108
v_mfma_f32_16x16x32_bf16 v[84:87], a[120:123], a[24:27], v[84:87]
s_xor_b32 s21, s23, 159744
ds_read_b64_tr_b16 a[194:195], v90 offset:34432
ds_read_b64_tr_b16 a[196:197], v90 offset:33952
v_mfma_f32_16x16x32_bf16 v[84:87], a[124:127], a[28:31], v[84:87]
s_add_u32 m0, s22, 53856
ds_read_b64_tr_b16 a[198:199], v90 offset:34464
v_lshlrev_b32 v117, 16, v109
v_mfma_f32_16x16x32_bf16 v[68:71], a[140:143], a[28:31], v[52:55]
ds_read_b64_tr_b16 a[228:229], v91 offset:33952
ds_read_b64_tr_b16 a[230:231], v91 offset:34464
v_mfma_f32_16x16x32_bf16 v[68:71], a[136:139], a[24:27], v[68:71]
buffer_load_dwordx4 v97, s[12:15], s21 offen offset:0 nt lds
v_mfma_f32_16x16x32_bf16 v[68:71], a[132:135], a[20:23], v[68:71]
ds_read_b64_tr_b16 a[232:233], v91 offset:33984
ds_read_b64_tr_b16 a[234:235], v91 offset:34496
v_mfma_f32_16x16x32_bf16 v[68:71], a[128:131], a[16:19], v[68:71]
s_waitcnt lgkmcnt(10)
ds_read_b64_tr_b16 a[200:201], v90 offset:33984
v_and_b32 v109, s36, v109
v_mfma_f32_16x16x32_bf16 v[128:131], a[208:211], v[44:47], v[128:131]
ds_read_b64_tr_b16 a[202:203], v90 offset:34496
ds_read_b64_tr_b16 a[204:205], v90 offset:34016
v_mfma_f32_16x16x32_bf16 v[128:131], a[176:179], v[40:43], v[128:131]
ds_read_b64_tr_b16 a[206:207], v90 offset:34528
v_mul_f32 v117, s38, v117
v_mfma_f32_16x16x32_bf16 v[132:135], a[180:183], v[40:43], v[132:135]
ds_read_b64_tr_b16 a[236:237], v91 offset:34016
ds_read_b64_tr_b16 a[238:239], v91 offset:34528
v_mfma_f32_16x16x32_bf16 v[132:135], a[212:215], v[44:47], v[132:135]
v_exp_f32 v76, v76
v_mfma_f32_16x16x32_bf16 v[136:139], a[216:219], v[44:47], v[136:139]
v_exp_f32 v77, v77
v_mfma_f32_16x16x32_bf16 v[136:139], a[184:187], v[40:43], v[136:139]
v_exp_f32 v78, v78
v_mfma_f32_16x16x32_bf16 v[140:143], a[188:191], v[40:43], v[140:143]
v_exp_f32 v79, v79
v_mfma_f32_16x16x32_bf16 v[140:143], a[220:223], v[44:47], v[140:143]
s_waitcnt lgkmcnt(5)
v_cvt_pk_bf16_f32 v36, v76, v77
v_cvt_pk_bf16_f32 v37, v78, v79
v_mfma_f32_16x16x32_bf16 v[144:147], a[224:227], v[44:47], v[144:147]
v_exp_f32 v80, v80
v_mfma_f32_16x16x32_bf16 v[144:147], a[192:195], v[40:43], v[144:147]
v_exp_f32 v81, v81
v_mfma_f32_16x16x32_bf16 v[148:151], a[196:199], v[40:43], v[148:151]
v_exp_f32 v82, v82
v_mfma_f32_16x16x32_bf16 v[148:151], a[228:231], v[44:47], v[148:151]
s_waitcnt lgkmcnt(0)
v_exp_f32 v83, v83
v_mfma_f32_16x16x32_bf16 v[152:155], a[232:235], v[44:47], v[152:155]
s_add_u32 m0, s24, 8800
v_cvt_pk_bf16_f32 v38, v80, v81
v_cvt_pk_bf16_f32 v39, v82, v83
v_mfma_f32_16x16x32_bf16 v[152:155], a[200:203], v[40:43], v[152:155]
v_exp_f32 v84, v84
v_mfma_f32_16x16x32_bf16 v[156:159], a[204:207], v[40:43], v[156:159]
buffer_load_dwordx4 v96, s[4:7], s37 offen offset:3072 nt lds
v_mfma_f32_16x16x32_bf16 v[156:159], a[236:239], v[44:47], v[156:159]
v_exp_f32 v85, v85
v_smfmac_f32_16x16x64_bf16 a[240:243], a[248:251], v[40:47], v92
v_cvt_pk_bf16_f32 v32, v84, v85
v_mfma_f32_16x16x32_bf16 v[72:75], a[144:147], a[32:35], v[56:59]
v_exp_f32 v86, v86
v_mfma_f32_16x16x32_bf16 v[72:75], a[148:151], a[36:39], v[72:75]
v_exp_f32 v87, v87
v_mfma_f32_16x16x32_bf16 v[72:75], a[152:155], a[40:43], v[72:75]
v_cvt_pk_bf16_f32 v33, v86, v87
v_mul_f32 v109, s38, v109
v_mfma_f32_16x16x32_bf16 v[72:75], a[156:159], a[44:47], v[72:75]
v_exp_f32 v68, v68
v_mfma_f32_16x16x32_bf16 v[76:79], a[172:175], a[44:47], v[56:59]
v_exp_f32 v69, v69
v_mfma_f32_16x16x32_bf16 v[76:79], a[168:171], a[40:43], v[76:79]
v_exp_f32 v70, v70
v_mfma_f32_16x16x32_bf16 v[76:79], a[164:167], a[36:39], v[76:79]
v_exp_f32 v71, v71
v_mfma_f32_16x16x32_bf16 v[76:79], a[160:163], a[32:35], v[76:79]
v_cvt_pk_bf16_f32 v34, v68, v69
v_cvt_pk_bf16_f32 v35, v70, v71
v_mfma_f32_16x16x32_bf16 v[80:83], a[112:115], a[32:35], v[56:59]
v_exp_f32 v72, v72
v_mfma_f32_16x16x32_bf16 v[80:83], a[116:119], a[36:39], v[80:83]
v_exp_f32 v73, v73
v_mfma_f32_16x16x32_bf16 v[80:83], a[120:123], a[40:43], v[80:83]
s_xor_b32 s21, s23, 148480
v_exp_f32 v74, v74
v_mfma_f32_16x16x32_bf16 v[80:83], a[124:127], a[44:47], v[80:83]
s_add_u32 m0, s22, 16896
v_exp_f32 v75, v75
v_mfma_f32_16x16x32_bf16 v[84:87], a[140:143], a[44:47], v[56:59]
v_cvt_pk_bf16_f32 v44, v72, v73
v_cvt_pk_bf16_f32 v45, v74, v75
v_mfma_f32_16x16x32_bf16 v[84:87], a[136:139], a[40:43], v[84:87]
buffer_load_dwordx4 v97, s[8:11], s21 offen offset:0 nt lds
v_mfma_f32_16x16x32_bf16 v[84:87], a[132:135], a[36:39], v[84:87]
v_exp_f32 v76, v76
v_mfma_f32_16x16x32_bf16 v[84:87], a[128:131], a[32:35], v[84:87]
v_exp_f32 v77, v77
v_mfma_f32_16x16x32_bf16 v[160:163], a[208:211], v[36:39], v[160:163]
v_exp_f32 v78, v78
v_mfma_f32_16x16x32_bf16 v[160:163], a[176:179], v[32:35], v[160:163]
v_exp_f32 v79, v79
v_mfma_f32_16x16x32_bf16 v[164:167], a[180:183], v[32:35], v[164:167]
v_cvt_pk_bf16_f32 v46, v76, v77
v_cvt_pk_bf16_f32 v47, v78, v79
v_mfma_f32_16x16x32_bf16 v[164:167], a[212:215], v[36:39], v[164:167]
v_exp_f32 v80, v80
v_mfma_f32_16x16x32_bf16 v[168:171], a[216:219], v[36:39], v[168:171]
v_exp_f32 v81, v81
v_mfma_f32_16x16x32_bf16 v[168:171], a[184:187], v[32:35], v[168:171]
v_exp_f32 v82, v82
v_mfma_f32_16x16x32_bf16 v[172:175], a[188:191], v[32:35], v[172:175]
v_exp_f32 v83, v83
v_mfma_f32_16x16x32_bf16 v[172:175], a[220:223], v[36:39], v[172:175]
v_cvt_pk_bf16_f32 v40, v80, v81
v_cvt_pk_bf16_f32 v41, v82, v83
v_mfma_f32_16x16x32_bf16 v[176:179], a[224:227], v[36:39], v[176:179]
v_exp_f32 v84, v84
v_mfma_f32_16x16x32_bf16 v[176:179], a[192:195], v[32:35], v[176:179]
v_exp_f32 v85, v85
v_mfma_f32_16x16x32_bf16 v[180:183], a[196:199], v[32:35], v[180:183]
v_exp_f32 v86, v86
v_mfma_f32_16x16x32_bf16 v[180:183], a[228:231], v[36:39], v[180:183]
s_xor_b32 s21, s23, 152576
v_exp_f32 v87, v87
v_mfma_f32_16x16x32_bf16 v[184:187], a[232:235], v[36:39], v[184:187]
s_add_u32 m0, s22, 17952
v_cvt_pk_bf16_f32 v42, v84, v85
v_cvt_pk_bf16_f32 v43, v86, v87
v_mfma_f32_16x16x32_bf16 v[184:187], a[200:203], v[32:35], v[184:187]
v_cvt_pk_bf16_f32 v109, v117, v109
v_lshlrev_b32 v118, 16, v110
v_mfma_f32_16x16x32_bf16 v[188:191], a[204:207], v[32:35], v[188:191]
buffer_load_dwordx4 v97, s[8:11], s21 offen offset:0 nt lds
v_mfma_f32_16x16x32_bf16 v[188:191], a[236:239], v[36:39], v[188:191]
v_and_b32 v110, s36, v110
v_mul_f32 v118, s38, v118
v_smfmac_f32_16x16x64_bf16 a[240:243], a[252:255], v[32:39], v92
v_mul_f32 v110, s38, v110
v_mfma_f32_16x16x32_bf16 v[68:71], a[144:147], a[48:51], v[60:63]
v_cvt_pk_bf16_f32 v110, v118, v110
v_lshlrev_b32 v119, 16, v111
v_mfma_f32_16x16x32_bf16 v[68:71], a[148:151], a[52:55], v[68:71]
v_and_b32 v111, s36, v111
v_mul_f32 v119, s38, v119
v_mfma_f32_16x16x32_bf16 v[68:71], a[152:155], a[56:59], v[68:71]
v_mul_f32 v111, s38, v111
v_cvt_pk_bf16_f32 v111, v119, v111
v_mfma_f32_16x16x32_bf16 v[68:71], a[156:159], a[60:63], v[68:71]
v_lshlrev_b32 v116, 16, v112
v_and_b32 v112, s36, v112
v_mfma_f32_16x16x32_bf16 v[72:75], a[172:175], a[60:63], v[60:63]
v_mul_f32 v116, s38, v116
v_mul_f32 v112, s38, v112
v_mfma_f32_16x16x32_bf16 v[72:75], a[168:171], a[56:59], v[72:75]
v_cvt_pk_bf16_f32 v112, v116, v112
v_lshlrev_b32 v117, 16, v113
v_mfma_f32_16x16x32_bf16 v[72:75], a[164:167], a[52:55], v[72:75]
v_and_b32 v113, s36, v113
v_mul_f32 v117, s38, v117
v_mfma_f32_16x16x32_bf16 v[72:75], a[160:163], a[48:51], v[72:75]
v_exp_f32 v68, v68
v_mfma_f32_16x16x32_bf16 v[76:79], a[112:115], a[48:51], v[60:63]
v_exp_f32 v69, v69
v_mfma_f32_16x16x32_bf16 v[76:79], a[116:119], a[52:55], v[76:79]
v_exp_f32 v70, v70
v_mfma_f32_16x16x32_bf16 v[76:79], a[120:123], a[56:59], v[76:79]
v_exp_f32 v71, v71
v_mfma_f32_16x16x32_bf16 v[76:79], a[124:127], a[60:63], v[76:79]
s_xor_b32 s21, s23, 156672
v_cvt_pk_bf16_f32 v36, v68, v69
v_cvt_pk_bf16_f32 v37, v70, v71
v_mfma_f32_16x16x32_bf16 v[80:83], a[140:143], a[60:63], v[60:63]
s_add_u32 m0, s22, 19008
v_exp_f32 v72, v72
v_mfma_f32_16x16x32_bf16 v[80:83], a[136:139], a[56:59], v[80:83]
v_exp_f32 v73, v73
v_mfma_f32_16x16x32_bf16 v[80:83], a[132:135], a[52:55], v[80:83]
buffer_load_dwordx4 v97, s[8:11], s21 offen offset:0 nt lds
v_mfma_f32_16x16x32_bf16 v[80:83], a[128:131], a[48:51], v[80:83]
v_exp_f32 v74, v74
v_mfma_f32_16x16x32_bf16 v[192:195], a[208:211], v[44:47], v[192:195]
v_exp_f32 v75, v75
v_mfma_f32_16x16x32_bf16 v[192:195], a[176:179], v[40:43], v[192:195]
v_cvt_pk_bf16_f32 v38, v72, v73
v_cvt_pk_bf16_f32 v39, v74, v75
v_mfma_f32_16x16x32_bf16 v[196:199], a[180:183], v[40:43], v[196:199]
v_exp_f32 v76, v76
v_mfma_f32_16x16x32_bf16 v[196:199], a[212:215], v[44:47], v[196:199]
v_exp_f32 v77, v77
v_mfma_f32_16x16x32_bf16 v[200:203], a[216:219], v[44:47], v[200:203]
v_exp_f32 v78, v78
v_mfma_f32_16x16x32_bf16 v[200:203], a[184:187], v[40:43], v[200:203]
v_exp_f32 v79, v79
v_mfma_f32_16x16x32_bf16 v[204:207], a[188:191], v[40:43], v[204:207]
v_exp_f32 v80, v80
v_mfma_f32_16x16x32_bf16 v[204:207], a[220:223], v[44:47], v[204:207]
v_exp_f32 v81, v81
v_mfma_f32_16x16x32_bf16 v[208:211], a[224:227], v[44:47], v[208:211]
v_exp_f32 v82, v82
v_mfma_f32_16x16x32_bf16 v[208:211], a[192:195], v[40:43], v[208:211]
v_exp_f32 v83, v83
v_mfma_f32_16x16x32_bf16 v[212:215], a[196:199], v[40:43], v[212:215]
v_cvt_pk_bf16_f32 v32, v76, v77
v_cvt_pk_bf16_f32 v33, v78, v79
v_mfma_f32_16x16x32_bf16 v[212:215], a[228:231], v[44:47], v[212:215]
v_cvt_pk_bf16_f32 v34, v80, v81
v_cvt_pk_bf16_f32 v35, v82, v83
v_mfma_f32_16x16x32_bf16 v[216:219], a[232:235], v[44:47], v[216:219]
s_xor_b32 s21, s23, 160768
v_mul_f32 v113, s38, v113
v_cvt_pk_bf16_f32 v113, v117, v113
v_mfma_f32_16x16x32_bf16 v[216:219], a[200:203], v[40:43], v[216:219]
s_add_u32 m0, s22, 20064
v_lshlrev_b32 v118, 16, v114
v_and_b32 v114, s36, v114
v_mfma_f32_16x16x32_bf16 v[220:223], a[204:207], v[40:43], v[220:223]
s_waitcnt vmcnt(4)
s_barrier
v_mfma_f32_16x16x32_bf16 v[220:223], a[236:239], v[44:47], v[220:223]
buffer_load_dwordx4 v97, s[8:11], s21 offen offset:0 nt lds
v_smfmac_f32_16x16x64_bf16 a[244:247], a[248:251], v[40:47], v92
ds_read_b128 a[144:147], v89 offset:0
v_mfma_f32_16x16x32_bf16 v[84:87], a[112:115], a[64:67], v[64:67]
ds_read_b128 a[148:151], v89 offset:64
v_mul_f32 v118, s38, v118
v_mfma_f32_16x16x32_bf16 v[84:87], a[116:119], a[68:71], v[84:87]
ds_read_b128 a[152:155], v89 offset:128
v_mul_f32 v114, s38, v114
v_mfma_f32_16x16x32_bf16 v[84:87], a[120:123], a[72:75], v[84:87]
ds_read_b128 a[156:159], v89 offset:192
v_cvt_pk_bf16_f32 v114, v118, v114
v_mfma_f32_16x16x32_bf16 v[84:87], a[124:127], a[76:79], v[84:87]
ds_read_b128 a[172:175], v89 offset:704
v_lshlrev_b32 v119, 16, v115
v_mfma_f32_16x16x32_bf16 v[68:71], a[140:143], a[76:79], v[64:67]
ds_read_b128 a[168:171], v89 offset:640
v_and_b32 v115, s36, v115
v_mfma_f32_16x16x32_bf16 v[68:71], a[136:139], a[72:75], v[68:71]
ds_read_b128 a[164:167], v89 offset:576
v_mul_f32 v119, s38, v119
v_mfma_f32_16x16x32_bf16 v[68:71], a[132:135], a[68:71], v[68:71]
ds_read_b128 a[160:163], v89 offset:512
v_mul_f32 v115, s38, v115
v_mfma_f32_16x16x32_bf16 v[68:71], a[128:131], a[64:67], v[68:71]
ds_read_b128 a[112:115], v88 offset:0
v_cvt_pk_bf16_f32 v115, v119, v115
v_mfma_f32_16x16x32_bf16 v[224:227], a[208:211], v[36:39], v[224:227]
v_exp_f32 v84, v84
v_mfma_f32_16x16x32_bf16 v[224:227], a[176:179], v[32:35], v[224:227]
v_exp_f32 v85, v85
v_mfma_f32_16x16x32_bf16 v[228:231], a[180:183], v[32:35], v[228:231]
ds_read_b128 a[116:119], v88 offset:64
v_cvt_pk_bf16_f32 v40, v84, v85
v_mfma_f32_16x16x32_bf16 v[228:231], a[212:215], v[36:39], v[228:231]
v_exp_f32 v86, v86
v_mfma_f32_16x16x32_bf16 v[232:235], a[216:219], v[36:39], v[232:235]
v_exp_f32 v87, v87
v_mfma_f32_16x16x32_bf16 v[232:235], a[184:187], v[32:35], v[232:235]
s_xor_b32 s21, s23, 148480
ds_read_b128 a[120:123], v88 offset:128
v_cvt_pk_bf16_f32 v41, v86, v87
v_mfma_f32_16x16x32_bf16 v[236:239], a[188:191], v[32:35], v[236:239]
s_add_u32 m0, s22, 67584
v_exp_f32 v68, v68
v_mfma_f32_16x16x32_bf16 v[236:239], a[220:223], v[36:39], v[236:239]
v_exp_f32 v69, v69
v_mfma_f32_16x16x32_bf16 v[240:243], a[224:227], v[36:39], v[240:243]
buffer_load_dwordx4 v97, s[12:15], s21 offen offset:0 nt lds
v_mfma_f32_16x16x32_bf16 v[240:243], a[192:195], v[32:35], v[240:243]
ds_read_b128 a[124:127], v88 offset:192
v_cvt_pk_bf16_f32 v42, v68, v69
v_mfma_f32_16x16x32_bf16 v[244:247], a[196:199], v[32:35], v[244:247]
v_exp_f32 v70, v70
v_mfma_f32_16x16x32_bf16 v[244:247], a[228:231], v[36:39], v[244:247]
v_exp_f32 v71, v71
v_mfma_f32_16x16x32_bf16 v[248:251], a[232:235], v[36:39], v[248:251]
ds_read_b128 a[140:143], v88 offset:704
v_cvt_pk_bf16_f32 v43, v70, v71
v_mfma_f32_16x16x32_bf16 v[248:251], a[200:203], v[32:35], v[248:251]
ds_read_b64_tr_b16 a[208:209], v91 offset:0
ds_read_b64_tr_b16 a[210:211], v91 offset:512
v_mfma_f32_16x16x32_bf16 v[252:255], a[204:207], v[32:35], v[252:255]
ds_write_b128 v99, v[108:111] offset:4352
v_mfma_f32_16x16x32_bf16 v[252:255], a[236:239], v[36:39], v[252:255]
ds_read_b64_tr_b16 a[212:213], v91 offset:32
ds_read_b64_tr_b16 a[214:215], v91 offset:544
v_smfmac_f32_16x16x64_bf16 a[244:247], a[252:255], v[32:39], v92
s_waitcnt lgkmcnt(7)
ds_read_b128 a[136:139], v88 offset:640
v_mfma_f32_16x16x32_bf16 v[72:75], a[144:147], a[0:3], v[48:51]
ds_write_b128 v99, v[112:115] offset:5408
v_mfma_f32_16x16x32_bf16 v[72:75], a[148:151], a[4:7], v[72:75]
ds_read_b128 a[132:135], v88 offset:576
v_mfma_f32_16x16x32_bf16 v[72:75], a[152:155], a[8:11], v[72:75]
ds_read_b128 a[128:131], v88 offset:512
v_mfma_f32_16x16x32_bf16 v[72:75], a[156:159], a[12:15], v[72:75]
ds_read_b64_tr_b16 a[216:217], v91 offset:64
ds_read_b64_tr_b16 a[218:219], v91 offset:576
v_mfma_f32_16x16x32_bf16 v[76:79], a[172:175], a[12:15], v[48:51]
ds_read_b64_tr_b16 a[220:221], v91 offset:96
v_mfma_f32_16x16x32_bf16 v[76:79], a[168:171], a[8:11], v[76:79]
s_xor_b32 s21, s23, 152576
ds_read_b64_tr_b16 a[222:223], v91 offset:608
ds_read_b64_tr_b16 a[224:225], v91 offset:128
v_mfma_f32_16x16x32_bf16 v[76:79], a[164:167], a[4:7], v[76:79]
s_add_u32 m0, s22, 68640
ds_read_b64_tr_b16 a[226:227], v91 offset:640
v_mfma_f32_16x16x32_bf16 v[76:79], a[160:163], a[0:3], v[76:79]
v_exp_f32 v72, v72
v_mfma_f32_16x16x32_bf16 v[80:83], a[112:115], a[0:3], v[48:51]
buffer_load_dwordx4 v97, s[12:15], s21 offen offset:0 nt lds
v_mfma_f32_16x16x32_bf16 v[80:83], a[116:119], a[4:7], v[80:83]
v_exp_f32 v73, v73
v_mfma_f32_16x16x32_bf16 v[80:83], a[120:123], a[8:11], v[80:83]
s_waitcnt lgkmcnt(6)
v_exp_f32 v74, v74
v_mfma_f32_16x16x32_bf16 v[80:83], a[124:127], a[12:15], v[80:83]
v_exp_f32 v75, v75
v_mfma_f32_16x16x32_bf16 v[84:87], a[140:143], a[12:15], v[48:51]
v_cvt_pk_bf16_f32 v36, v72, v73
v_cvt_pk_bf16_f32 v37, v74, v75
v_mfma_f32_16x16x32_bf16 v[84:87], a[136:139], a[8:11], v[84:87]
v_exp_f32 v76, v76
v_mfma_f32_16x16x32_bf16 v[84:87], a[132:135], a[4:7], v[84:87]
v_exp_f32 v77, v77
v_mfma_f32_16x16x32_bf16 v[84:87], a[128:131], a[0:3], v[84:87]
v_exp_f32 v78, v78
v_mfma_f32_16x16x32_bf16 v[104:107], a[248:251], v[40:43], v[104:107]
v_exp_f32 v79, v79
v_mfma_f32_16x16x32_bf16 a[80:83], a[176:179], v[40:43], a[80:83]
v_cvt_pk_bf16_f32 v38, v76, v77
v_cvt_pk_bf16_f32 v39, v78, v79
v_mfma_f32_16x16x32_bf16 a[84:87], a[180:183], v[40:43], a[84:87]
v_exp_f32 v80, v80
v_mfma_f32_16x16x32_bf16 a[88:91], a[184:187], v[40:43], a[88:91]
v_exp_f32 v81, v81
v_mfma_f32_16x16x32_bf16 a[92:95], a[188:191], v[40:43], a[92:95]
v_exp_f32 v82, v82
v_mfma_f32_16x16x32_bf16 a[96:99], a[192:195], v[40:43], a[96:99]
v_exp_f32 v83, v83
v_mfma_f32_16x16x32_bf16 a[100:103], a[196:199], v[40:43], a[100:103]
ds_read_b64_tr_b16 a[176:177], v90 offset:0
ds_read_b64_tr_b16 a[178:179], v90 offset:512
v_mfma_f32_16x16x32_bf16 a[104:107], a[200:203], v[40:43], a[104:107]
s_xor_b32 s21, s23, 156672
v_cvt_pk_bf16_f32 v32, v80, v81
v_cvt_pk_bf16_f32 v33, v82, v83
v_mfma_f32_16x16x32_bf16 a[108:111], a[204:207], v[40:43], a[108:111]
s_add_u32 m0, s22, 69696
ds_read_b64_tr_b16 a[180:181], v90 offset:32
ds_read_b64_tr_b16 a[182:183], v90 offset:544
v_mfma_f32_16x16x32_bf16 v[68:71], a[144:147], a[16:19], v[52:55]
v_exp_f32 v84, v84
v_mfma_f32_16x16x32_bf16 v[68:71], a[148:151], a[20:23], v[68:71]
buffer_load_dwordx4 v97, s[12:15], s21 offen offset:0 nt lds
v_mfma_f32_16x16x32_bf16 v[68:71], a[152:155], a[24:27], v[68:71]
v_exp_f32 v85, v85
v_mfma_f32_16x16x32_bf16 v[68:71], a[156:159], a[28:31], v[68:71]
v_exp_f32 v86, v86
v_mfma_f32_16x16x32_bf16 v[72:75], a[172:175], a[28:31], v[52:55]
v_exp_f32 v87, v87
v_mfma_f32_16x16x32_bf16 v[72:75], a[168:171], a[24:27], v[72:75]
ds_read_b64_tr_b16 a[184:185], v90 offset:64
ds_read_b64_tr_b16 a[186:187], v90 offset:576
v_mfma_f32_16x16x32_bf16 v[72:75], a[164:167], a[20:23], v[72:75]
v_cvt_pk_bf16_f32 v34, v84, v85
v_cvt_pk_bf16_f32 v35, v86, v87
v_mfma_f32_16x16x32_bf16 v[72:75], a[160:163], a[16:19], v[72:75]
ds_read_b64_tr_b16 a[188:189], v90 offset:96
ds_read_b64_tr_b16 a[190:191], v90 offset:608
v_mfma_f32_16x16x32_bf16 v[76:79], a[112:115], a[16:19], v[52:55]
v_exp_f32 v68, v68
v_mfma_f32_16x16x32_bf16 v[76:79], a[116:119], a[20:23], v[76:79]
ds_read_b64_tr_b16 a[192:193], v90 offset:128
ds_read_b64_tr_b16 a[194:195], v90 offset:640
v_mfma_f32_16x16x32_bf16 v[76:79], a[120:123], a[24:27], v[76:79]
v_exp_f32 v69, v69
v_mfma_f32_16x16x32_bf16 v[76:79], a[124:127], a[28:31], v[76:79]
ds_read_b64_tr_b16 a[196:197], v90 offset:160
ds_read_b64_tr_b16 a[198:199], v90 offset:672
v_mfma_f32_16x16x32_bf16 v[80:83], a[140:143], a[28:31], v[52:55]
ds_read_b64_tr_b16 a[228:229], v91 offset:160
v_cvt_pk_bf16_f32 v44, v68, v69
v_mfma_f32_16x16x32_bf16 v[80:83], a[136:139], a[24:27], v[80:83]
ds_read_b64_tr_b16 a[230:231], v91 offset:672
ds_read_b64_tr_b16 a[232:233], v91 offset:192
v_mfma_f32_16x16x32_bf16 v[80:83], a[132:135], a[20:23], v[80:83]
v_exp_f32 v70, v70
v_mfma_f32_16x16x32_bf16 v[80:83], a[128:131], a[16:19], v[80:83]
s_xor_b32 s21, s23, 160768
ds_read_b64_tr_b16 a[234:235], v91 offset:704
ds_read_b64_tr_b16 a[200:201], v90 offset:192
v_mfma_f32_16x16x32_bf16 v[128:131], a[208:211], v[36:39], v[128:131]
s_add_u32 m0, s22, 70752
v_exp_f32 v71, v71
s_waitcnt lgkmcnt(9)
v_mfma_f32_16x16x32_bf16 v[128:131], a[176:179], v[32:35], v[128:131]
ds_read_b64_tr_b16 a[202:203], v90 offset:704
ds_read_b64_tr_b16 a[204:205], v90 offset:224
v_mfma_f32_16x16x32_bf16 v[132:135], a[180:183], v[32:35], v[132:135]
ds_read_b64_tr_b16 a[206:207], v90 offset:736
v_cvt_pk_bf16_f32 v45, v70, v71
v_mfma_f32_16x16x32_bf16 v[132:135], a[212:215], v[36:39], v[132:135]
buffer_load_dwordx4 v97, s[12:15], s21 offen offset:0 nt lds
v_mfma_f32_16x16x32_bf16 v[136:139], a[216:219], v[36:39], v[136:139]
ds_read_b64_tr_b16 a[236:237], v91 offset:224
ds_read_b64_tr_b16 a[238:239], v91 offset:736
v_mfma_f32_16x16x32_bf16 v[136:139], a[184:187], v[32:35], v[136:139]
v_exp_f32 v72, v72
v_mfma_f32_16x16x32_bf16 v[140:143], a[188:191], v[32:35], v[140:143]
v_exp_f32 v73, v73
v_mfma_f32_16x16x32_bf16 v[140:143], a[220:223], v[36:39], v[140:143]
v_exp_f32 v74, v74
v_mfma_f32_16x16x32_bf16 v[144:147], a[224:227], v[36:39], v[144:147]
s_waitcnt lgkmcnt(5)
v_exp_f32 v75, v75
v_mfma_f32_16x16x32_bf16 v[144:147], a[192:195], v[32:35], v[144:147]
v_cvt_pk_bf16_f32 v46, v72, v73
v_cvt_pk_bf16_f32 v47, v74, v75
v_mfma_f32_16x16x32_bf16 v[148:151], a[196:199], v[32:35], v[148:151]
v_exp_f32 v76, v76
v_mfma_f32_16x16x32_bf16 v[148:151], a[228:231], v[36:39], v[148:151]
v_exp_f32 v77, v77
v_mfma_f32_16x16x32_bf16 v[152:155], a[232:235], v[36:39], v[152:155]
s_waitcnt lgkmcnt(0)
v_exp_f32 v78, v78
v_mfma_f32_16x16x32_bf16 v[152:155], a[200:203], v[32:35], v[152:155]
v_exp_f32 v79, v79
v_mfma_f32_16x16x32_bf16 v[156:159], a[204:207], v[32:35], v[156:159]
v_cvt_pk_bf16_f32 v40, v76, v77
v_cvt_pk_bf16_f32 v41, v78, v79
v_mfma_f32_16x16x32_bf16 v[156:159], a[236:239], v[36:39], v[156:159]
v_exp_f32 v80, v80
v_smfmac_f32_16x16x64_bf16 a[240:243], a[248:251], v[32:39], v92
ds_read_b128 v[108:111], v99 offset:6464
v_mfma_f32_16x16x32_bf16 v[84:87], a[144:147], a[32:35], v[56:59]
s_xor_b32 s21, s23, 149504
v_exp_f32 v81, v81
v_mfma_f32_16x16x32_bf16 v[84:87], a[148:151], a[36:39], v[84:87]
s_add_u32 m0, s22, 33792
v_exp_f32 v82, v82
v_mfma_f32_16x16x32_bf16 v[84:87], a[152:155], a[40:43], v[84:87]
v_exp_f32 v83, v83
v_mfma_f32_16x16x32_bf16 v[84:87], a[156:159], a[44:47], v[84:87]
buffer_load_dwordx4 v97, s[8:11], s21 offen offset:0 nt lds
v_mfma_f32_16x16x32_bf16 v[68:71], a[172:175], a[44:47], v[56:59]
v_cvt_pk_bf16_f32 v42, v80, v81
v_cvt_pk_bf16_f32 v43, v82, v83
v_mfma_f32_16x16x32_bf16 v[68:71], a[168:171], a[40:43], v[68:71]
ds_read_b128 v[112:115], v99 offset:7520
v_mfma_f32_16x16x32_bf16 v[68:71], a[164:167], a[36:39], v[68:71]
s_waitcnt lgkmcnt(1)
v_lshlrev_b32 v116, 16, v108
v_and_b32 v108, s36, v108
v_mfma_f32_16x16x32_bf16 v[68:71], a[160:163], a[32:35], v[68:71]
v_exp_f32 v84, v84
v_mfma_f32_16x16x32_bf16 v[72:75], a[112:115], a[32:35], v[56:59]
v_exp_f32 v85, v85
v_mfma_f32_16x16x32_bf16 v[72:75], a[116:119], a[36:39], v[72:75]
v_exp_f32 v86, v86
v_mfma_f32_16x16x32_bf16 v[72:75], a[120:123], a[40:43], v[72:75]
v_exp_f32 v87, v87
v_mfma_f32_16x16x32_bf16 v[72:75], a[124:127], a[44:47], v[72:75]
v_cvt_pk_bf16_f32 v36, v84, v85
v_cvt_pk_bf16_f32 v37, v86, v87
v_mfma_f32_16x16x32_bf16 v[76:79], a[140:143], a[44:47], v[56:59]
v_exp_f32 v68, v68
v_mfma_f32_16x16x32_bf16 v[76:79], a[136:139], a[40:43], v[76:79]
v_exp_f32 v69, v69
v_mfma_f32_16x16x32_bf16 v[76:79], a[132:135], a[36:39], v[76:79]
v_exp_f32 v70, v70
v_mfma_f32_16x16x32_bf16 v[76:79], a[128:131], a[32:35], v[76:79]
v_exp_f32 v71, v71
v_mfma_f32_16x16x32_bf16 v[160:163], a[208:211], v[44:47], v[160:163]
v_cvt_pk_bf16_f32 v38, v68, v69
v_cvt_pk_bf16_f32 v39, v70, v71
v_mfma_f32_16x16x32_bf16 v[160:163], a[176:179], v[40:43], v[160:163]
s_xor_b32 s21, s23, 153600
v_exp_f32 v72, v72
v_mfma_f32_16x16x32_bf16 v[164:167], a[180:183], v[40:43], v[164:167]
s_add_u32 m0, s22, 34848
v_exp_f32 v73, v73
v_mfma_f32_16x16x32_bf16 v[164:167], a[212:215], v[44:47], v[164:167]
v_exp_f32 v74, v74
v_mfma_f32_16x16x32_bf16 v[168:171], a[216:219], v[44:47], v[168:171]
buffer_load_dwordx4 v97, s[8:11], s21 offen offset:0 nt lds
v_mfma_f32_16x16x32_bf16 v[168:171], a[184:187], v[40:43], v[168:171]
v_exp_f32 v75, v75
v_mfma_f32_16x16x32_bf16 v[172:175], a[188:191], v[40:43], v[172:175]
v_cvt_pk_bf16_f32 v32, v72, v73
v_cvt_pk_bf16_f32 v33, v74, v75
v_mfma_f32_16x16x32_bf16 v[172:175], a[220:223], v[44:47], v[172:175]
v_exp_f32 v76, v76
v_mfma_f32_16x16x32_bf16 v[176:179], a[224:227], v[44:47], v[176:179]
v_exp_f32 v77, v77
v_mfma_f32_16x16x32_bf16 v[176:179], a[192:195], v[40:43], v[176:179]
v_exp_f32 v78, v78
v_mfma_f32_16x16x32_bf16 v[180:183], a[196:199], v[40:43], v[180:183]
v_exp_f32 v79, v79
v_mfma_f32_16x16x32_bf16 v[180:183], a[228:231], v[44:47], v[180:183]
v_cvt_pk_bf16_f32 v34, v76, v77
v_cvt_pk_bf16_f32 v35, v78, v79
v_mfma_f32_16x16x32_bf16 v[184:187], a[232:235], v[44:47], v[184:187]
v_mul_f32 v116, s38, v116
v_mul_f32 v108, s38, v108
v_mfma_f32_16x16x32_bf16 v[184:187], a[200:203], v[40:43], v[184:187]
v_cvt_pk_bf16_f32 v108, v116, v108
v_lshlrev_b32 v117, 16, v109
v_mfma_f32_16x16x32_bf16 v[188:191], a[204:207], v[40:43], v[188:191]
v_and_b32 v109, s36, v109
v_mul_f32 v117, s38, v117
v_mfma_f32_16x16x32_bf16 v[188:191], a[236:239], v[44:47], v[188:191]
v_mul_f32 v109, s38, v109
v_cvt_pk_bf16_f32 v109, v117, v109
v_smfmac_f32_16x16x64_bf16 a[240:243], a[252:255], v[40:47], v92
v_lshlrev_b32 v118, 16, v110
v_mfma_f32_16x16x32_bf16 v[80:83], a[144:147], a[48:51], v[60:63]
v_and_b32 v110, s36, v110
v_mul_f32 v118, s38, v118
v_mfma_f32_16x16x32_bf16 v[80:83], a[148:151], a[52:55], v[80:83]
v_mul_f32 v110, s38, v110
v_cvt_pk_bf16_f32 v110, v118, v110
v_mfma_f32_16x16x32_bf16 v[80:83], a[152:155], a[56:59], v[80:83]
s_xor_b32 s21, s23, 157696
v_lshlrev_b32 v119, 16, v111
v_and_b32 v111, s36, v111
v_mfma_f32_16x16x32_bf16 v[80:83], a[156:159], a[60:63], v[80:83]
s_add_u32 m0, s22, 35904
v_mul_f32 v119, s38, v119
v_mul_f32 v111, s38, v111
v_mfma_f32_16x16x32_bf16 v[84:87], a[172:175], a[60:63], v[60:63]
s_waitcnt lgkmcnt(0)
v_cvt_pk_bf16_f32 v111, v119, v111
v_lshlrev_b32 v116, 16, v112
v_mfma_f32_16x16x32_bf16 v[84:87], a[168:171], a[56:59], v[84:87]
buffer_load_dwordx4 v97, s[8:11], s21 offen offset:0 nt lds
v_mfma_f32_16x16x32_bf16 v[84:87], a[164:167], a[52:55], v[84:87]
v_and_b32 v112, s36, v112
v_mul_f32 v116, s38, v116
v_mfma_f32_16x16x32_bf16 v[84:87], a[160:163], a[48:51], v[84:87]
v_exp_f32 v80, v80
v_mfma_f32_16x16x32_bf16 v[68:71], a[112:115], a[48:51], v[60:63]
v_exp_f32 v81, v81
v_mfma_f32_16x16x32_bf16 v[68:71], a[116:119], a[52:55], v[68:71]
v_exp_f32 v82, v82
v_mfma_f32_16x16x32_bf16 v[68:71], a[120:123], a[56:59], v[68:71]
v_exp_f32 v83, v83
v_mfma_f32_16x16x32_bf16 v[68:71], a[124:127], a[60:63], v[68:71]
v_cvt_pk_bf16_f32 v44, v80, v81
v_cvt_pk_bf16_f32 v45, v82, v83
v_mfma_f32_16x16x32_bf16 v[72:75], a[140:143], a[60:63], v[60:63]
v_exp_f32 v84, v84
v_mfma_f32_16x16x32_bf16 v[72:75], a[136:139], a[56:59], v[72:75]
v_exp_f32 v85, v85
v_mfma_f32_16x16x32_bf16 v[72:75], a[132:135], a[52:55], v[72:75]
v_exp_f32 v86, v86
v_mfma_f32_16x16x32_bf16 v[72:75], a[128:131], a[48:51], v[72:75]
v_exp_f32 v87, v87
v_mfma_f32_16x16x32_bf16 v[192:195], a[208:211], v[36:39], v[192:195]
v_cvt_pk_bf16_f32 v46, v84, v85
v_cvt_pk_bf16_f32 v47, v86, v87
v_mfma_f32_16x16x32_bf16 v[192:195], a[176:179], v[32:35], v[192:195]
v_exp_f32 v68, v68
v_mfma_f32_16x16x32_bf16 v[196:199], a[180:183], v[32:35], v[196:199]
v_exp_f32 v69, v69
v_mfma_f32_16x16x32_bf16 v[196:199], a[212:215], v[36:39], v[196:199]
s_xor_b32 s21, s23, 161792
v_exp_f32 v70, v70
v_mfma_f32_16x16x32_bf16 v[200:203], a[216:219], v[36:39], v[200:203]
s_add_u32 m0, s22, 36960
v_exp_f32 v71, v71
v_mfma_f32_16x16x32_bf16 v[200:203], a[184:187], v[32:35], v[200:203]
v_exp_f32 v72, v72
v_mfma_f32_16x16x32_bf16 v[204:207], a[188:191], v[32:35], v[204:207]
buffer_load_dwordx4 v97, s[8:11], s21 offen offset:0 nt lds
v_mfma_f32_16x16x32_bf16 v[204:207], a[220:223], v[36:39], v[204:207]
v_exp_f32 v73, v73
v_mfma_f32_16x16x32_bf16 v[208:211], a[224:227], v[36:39], v[208:211]
v_exp_f32 v74, v74
v_mfma_f32_16x16x32_bf16 v[208:211], a[192:195], v[32:35], v[208:211]
v_exp_f32 v75, v75
v_mfma_f32_16x16x32_bf16 v[212:215], a[196:199], v[32:35], v[212:215]
v_cvt_pk_bf16_f32 v40, v68, v69
v_cvt_pk_bf16_f32 v41, v70, v71
v_mfma_f32_16x16x32_bf16 v[212:215], a[228:231], v[36:39], v[212:215]
v_cvt_pk_bf16_f32 v42, v72, v73
v_cvt_pk_bf16_f32 v43, v74, v75
v_mfma_f32_16x16x32_bf16 v[216:219], a[232:235], v[36:39], v[216:219]
v_mul_f32 v112, s38, v112
v_cvt_pk_bf16_f32 v112, v116, v112
v_mfma_f32_16x16x32_bf16 v[216:219], a[200:203], v[32:35], v[216:219]
v_lshlrev_b32 v117, 16, v113
v_and_b32 v113, s36, v113
v_mfma_f32_16x16x32_bf16 v[220:223], a[204:207], v[32:35], v[220:223]
s_waitcnt vmcnt(4)
s_barrier
v_mfma_f32_16x16x32_bf16 v[220:223], a[236:239], v[36:39], v[220:223]
ds_read_b128 a[144:147], v89 offset:16896
v_mul_f32 v117, s38, v117
v_smfmac_f32_16x16x64_bf16 a[244:247], a[248:251], v[32:39], v92
ds_read_b128 a[148:151], v89 offset:16960
v_mfma_f32_16x16x32_bf16 v[76:79], a[112:115], a[64:67], v[64:67]
ds_read_b128 a[152:155], v89 offset:17024
v_mul_f32 v113, s38, v113
v_mfma_f32_16x16x32_bf16 v[76:79], a[116:119], a[68:71], v[76:79]
ds_read_b128 a[156:159], v89 offset:17088
v_cvt_pk_bf16_f32 v113, v117, v113
v_mfma_f32_16x16x32_bf16 v[76:79], a[120:123], a[72:75], v[76:79]
ds_read_b128 a[172:175], v89 offset:17600
v_lshlrev_b32 v118, 16, v114
v_mfma_f32_16x16x32_bf16 v[76:79], a[124:127], a[76:79], v[76:79]
s_xor_b32 s21, s23, 149504
ds_read_b128 a[168:171], v89 offset:17536
v_and_b32 v114, s36, v114
v_mfma_f32_16x16x32_bf16 v[80:83], a[140:143], a[76:79], v[64:67]
s_add_u32 m0, s22, 84480
ds_read_b128 a[164:167], v89 offset:17472
v_mul_f32 v118, s38, v118
v_mfma_f32_16x16x32_bf16 v[80:83], a[136:139], a[72:75], v[80:83]
ds_read_b128 a[160:163], v89 offset:17408
v_mul_f32 v114, s38, v114
v_mfma_f32_16x16x32_bf16 v[80:83], a[132:135], a[68:71], v[80:83]
buffer_load_dwordx4 v97, s[12:15], s21 offen offset:0 nt lds
v_mfma_f32_16x16x32_bf16 v[80:83], a[128:131], a[64:67], v[80:83]
ds_read_b128 a[112:115], v88 offset:16896
v_cvt_pk_bf16_f32 v114, v118, v114
v_mfma_f32_16x16x32_bf16 v[224:227], a[208:211], v[44:47], v[224:227]
ds_read_b128 a[116:119], v88 offset:16960
v_lshlrev_b32 v119, 16, v115
v_mfma_f32_16x16x32_bf16 v[224:227], a[176:179], v[40:43], v[224:227]
ds_read_b128 a[120:123], v88 offset:17024
v_and_b32 v115, s36, v115
v_mfma_f32_16x16x32_bf16 v[228:231], a[180:183], v[40:43], v[228:231]
ds_read_b128 a[124:127], v88 offset:17088
v_mul_f32 v119, s38, v119
v_mfma_f32_16x16x32_bf16 v[228:231], a[212:215], v[44:47], v[228:231]
ds_read_b128 a[140:143], v88 offset:17600
v_mul_f32 v115, s38, v115
v_mfma_f32_16x16x32_bf16 v[232:235], a[216:219], v[44:47], v[232:235]
ds_read_b128 a[136:139], v88 offset:17536
v_cvt_pk_bf16_f32 v115, v119, v115
v_mfma_f32_16x16x32_bf16 v[232:235], a[184:187], v[40:43], v[232:235]
v_exp_f32 v76, v76
v_mfma_f32_16x16x32_bf16 v[236:239], a[188:191], v[40:43], v[236:239]
v_exp_f32 v77, v77
v_mfma_f32_16x16x32_bf16 v[236:239], a[220:223], v[44:47], v[236:239]
ds_read_b128 a[132:135], v88 offset:17472
v_cvt_pk_bf16_f32 v32, v76, v77
v_mfma_f32_16x16x32_bf16 v[240:243], a[224:227], v[44:47], v[240:243]
v_exp_f32 v78, v78
v_mfma_f32_16x16x32_bf16 v[240:243], a[192:195], v[40:43], v[240:243]
v_exp_f32 v79, v79
v_mfma_f32_16x16x32_bf16 v[244:247], a[196:199], v[40:43], v[244:247]
ds_read_b128 a[128:131], v88 offset:17408
v_cvt_pk_bf16_f32 v33, v78, v79
v_mfma_f32_16x16x32_bf16 v[244:247], a[228:231], v[44:47], v[244:247]
v_exp_f32 v80, v80
v_mfma_f32_16x16x32_bf16 v[248:251], a[232:235], v[44:47], v[248:251]
v_exp_f32 v81, v81
v_mfma_f32_16x16x32_bf16 v[248:251], a[200:203], v[40:43], v[248:251]
s_xor_b32 s21, s23, 153600
v_exp_f32 v82, v82
v_mfma_f32_16x16x32_bf16 v[252:255], a[204:207], v[40:43], v[252:255]
s_add_u32 m0, s22, 85536
v_exp_f32 v83, v83
v_mfma_f32_16x16x32_bf16 v[252:255], a[236:239], v[44:47], v[252:255]
v_cvt_pk_bf16_f32 v34, v80, v81
v_cvt_pk_bf16_f32 v35, v82, v83
v_smfmac_f32_16x16x64_bf16 a[244:247], a[252:255], v[40:47], v92
s_waitcnt lgkmcnt(1)
ds_read_b64_tr_b16 a[208:209], v91 offset:16896
v_mfma_f32_16x16x32_bf16 v[84:87], a[144:147], a[0:3], v[48:51]
buffer_load_dwordx4 v97, s[12:15], s21 offen offset:0 nt lds
v_mfma_f32_16x16x32_bf16 v[84:87], a[148:151], a[4:7], v[84:87]
ds_read_b64_tr_b16 a[210:211], v91 offset:17408
ds_read_b64_tr_b16 a[212:213], v91 offset:16928
v_mfma_f32_16x16x32_bf16 v[84:87], a[152:155], a[8:11], v[84:87]
ds_write_b128 v99, v[108:111] offset:6464
v_mfma_f32_16x16x32_bf16 v[84:87], a[156:159], a[12:15], v[84:87]
ds_read_b64_tr_b16 a[214:215], v91 offset:17440
ds_read_b64_tr_b16 a[216:217], v91 offset:16960
v_mfma_f32_16x16x32_bf16 v[68:71], a[172:175], a[12:15], v[48:51]
ds_write_b128 v99, v[112:115] offset:7520
v_mfma_f32_16x16x32_bf16 v[68:71], a[168:171], a[8:11], v[68:71]
ds_read_b64_tr_b16 a[218:219], v91 offset:17472
ds_read_b64_tr_b16 a[220:221], v91 offset:16992
v_mfma_f32_16x16x32_bf16 v[68:71], a[164:167], a[4:7], v[68:71]
ds_read_b64_tr_b16 a[222:223], v91 offset:17504
v_mfma_f32_16x16x32_bf16 v[68:71], a[160:163], a[0:3], v[68:71]
v_exp_f32 v84, v84
v_mfma_f32_16x16x32_bf16 v[72:75], a[112:115], a[0:3], v[48:51]
v_exp_f32 v85, v85
v_mfma_f32_16x16x32_bf16 v[72:75], a[116:119], a[4:7], v[72:75]
v_exp_f32 v86, v86
v_mfma_f32_16x16x32_bf16 v[72:75], a[120:123], a[8:11], v[72:75]
v_exp_f32 v87, v87
v_mfma_f32_16x16x32_bf16 v[72:75], a[124:127], a[12:15], v[72:75]
v_cvt_pk_bf16_f32 v44, v84, v85
v_cvt_pk_bf16_f32 v45, v86, v87
v_mfma_f32_16x16x32_bf16 v[76:79], a[140:143], a[12:15], v[48:51]
v_exp_f32 v68, v68
v_mfma_f32_16x16x32_bf16 v[76:79], a[136:139], a[8:11], v[76:79]
s_xor_b32 s21, s23, 157696
v_exp_f32 v69, v69
v_mfma_f32_16x16x32_bf16 v[76:79], a[132:135], a[4:7], v[76:79]
s_add_u32 m0, s22, 86592
v_exp_f32 v70, v70
s_waitcnt lgkmcnt(0)
v_mfma_f32_16x16x32_bf16 v[76:79], a[128:131], a[0:3], v[76:79]
v_exp_f32 v71, v71
v_mfma_f32_16x16x32_bf16 v[104:107], a[248:251], v[32:35], v[104:107]
buffer_load_dwordx4 v97, s[12:15], s21 offen offset:0 nt lds
v_mfma_f32_16x16x32_bf16 a[80:83], a[176:179], v[32:35], a[80:83]
v_cvt_pk_bf16_f32 v46, v68, v69
v_cvt_pk_bf16_f32 v47, v70, v71
v_mfma_f32_16x16x32_bf16 a[84:87], a[180:183], v[32:35], a[84:87]
v_exp_f32 v72, v72
v_mfma_f32_16x16x32_bf16 a[88:91], a[184:187], v[32:35], a[88:91]
v_exp_f32 v73, v73
v_mfma_f32_16x16x32_bf16 a[92:95], a[188:191], v[32:35], a[92:95]
v_exp_f32 v74, v74
v_mfma_f32_16x16x32_bf16 a[96:99], a[192:195], v[32:35], a[96:99]
v_exp_f32 v75, v75
v_mfma_f32_16x16x32_bf16 a[100:103], a[196:199], v[32:35], a[100:103]
ds_read_b64_tr_b16 a[176:177], v90 offset:16896
ds_read_b64_tr_b16 a[178:179], v90 offset:17408
v_mfma_f32_16x16x32_bf16 a[104:107], a[200:203], v[32:35], a[104:107]
v_cvt_pk_bf16_f32 v40, v72, v73
v_cvt_pk_bf16_f32 v41, v74, v75
v_mfma_f32_16x16x32_bf16 a[108:111], a[204:207], v[32:35], a[108:111]
ds_read_b64_tr_b16 a[180:181], v90 offset:16928
ds_read_b64_tr_b16 a[182:183], v90 offset:17440
v_mfma_f32_16x16x32_bf16 v[80:83], a[144:147], a[16:19], v[52:55]
v_exp_f32 v76, v76
v_mfma_f32_16x16x32_bf16 v[80:83], a[148:151], a[20:23], v[80:83]
v_exp_f32 v77, v77
v_mfma_f32_16x16x32_bf16 v[80:83], a[152:155], a[24:27], v[80:83]
v_exp_f32 v78, v78
v_mfma_f32_16x16x32_bf16 v[80:83], a[156:159], a[28:31], v[80:83]
v_exp_f32 v79, v79
v_mfma_f32_16x16x32_bf16 v[84:87], a[172:175], a[28:31], v[52:55]
ds_read_b64_tr_b16 a[184:185], v90 offset:16960
ds_read_b64_tr_b16 a[186:187], v90 offset:17472
v_mfma_f32_16x16x32_bf16 v[84:87], a[168:171], a[24:27], v[84:87]
v_cvt_pk_bf16_f32 v42, v76, v77
v_cvt_pk_bf16_f32 v43, v78, v79
v_mfma_f32_16x16x32_bf16 v[84:87], a[164:167], a[20:23], v[84:87]
s_xor_b32 s21, s23, 161792
ds_read_b64_tr_b16 a[188:189], v90 offset:16992
ds_read_b64_tr_b16 a[190:191], v90 offset:17504
v_mfma_f32_16x16x32_bf16 v[84:87], a[160:163], a[16:19], v[84:87]
s_add_u32 m0, s22, 87648
v_exp_f32 v80, v80
v_mfma_f32_16x16x32_bf16 v[68:71], a[112:115], a[16:19], v[52:55]
ds_read_b64_tr_b16 a[224:225], v91 offset:17024
ds_read_b64_tr_b16 a[226:227], v91 offset:17536
v_mfma_f32_16x16x32_bf16 v[68:71], a[116:119], a[20:23], v[68:71]
buffer_load_dwordx4 v97, s[12:15], s21 offen offset:0 nt lds
v_mfma_f32_16x16x32_bf16 v[68:71], a[120:123], a[24:27], v[68:71]
ds_read_b64_tr_b16 a[192:193], v90 offset:17024
ds_read_b64_tr_b16 a[194:195], v90 offset:17536
v_mfma_f32_16x16x32_bf16 v[68:71], a[124:127], a[28:31], v[68:71]
v_exp_f32 v81, v81
v_mfma_f32_16x16x32_bf16 v[72:75], a[140:143], a[28:31], v[52:55]
ds_read_b64_tr_b16 a[196:197], v90 offset:17056
ds_read_b64_tr_b16 a[198:199], v90 offset:17568
v_mfma_f32_16x16x32_bf16 v[72:75], a[136:139], a[24:27], v[72:75]
ds_read_b64_tr_b16 a[228:229], v91 offset:17056
v_cvt_pk_bf16_f32 v36, v80, v81
v_mfma_f32_16x16x32_bf16 v[72:75], a[132:135], a[20:23], v[72:75]
ds_read_b64_tr_b16 a[230:231], v91 offset:17568
ds_read_b64_tr_b16 a[232:233], v91 offset:17088
v_mfma_f32_16x16x32_bf16 v[72:75], a[128:131], a[16:19], v[72:75]
v_exp_f32 v82, v82
v_mfma_f32_16x16x32_bf16 v[128:131], a[208:211], v[44:47], v[128:131]
s_waitcnt lgkmcnt(7)
ds_read_b64_tr_b16 a[234:235], v91 offset:17600
ds_read_b64_tr_b16 a[200:201], v90 offset:17088
v_mfma_f32_16x16x32_bf16 v[128:131], a[176:179], v[40:43], v[128:131]
v_exp_f32 v83, v83
v_mfma_f32_16x16x32_bf16 v[132:135], a[180:183], v[40:43], v[132:135]
ds_read_b64_tr_b16 a[202:203], v90 offset:17600
ds_read_b64_tr_b16 a[204:205], v90 offset:17120
v_mfma_f32_16x16x32_bf16 v[132:135], a[212:215], v[44:47], v[132:135]
ds_read_b64_tr_b16 a[206:207], v90 offset:17632
v_cvt_pk_bf16_f32 v37, v82, v83
v_mfma_f32_16x16x32_bf16 v[136:139], a[216:219], v[44:47], v[136:139]
ds_read_b64_tr_b16 a[236:237], v91 offset:17120
ds_read_b64_tr_b16 a[238:239], v91 offset:17632
v_mfma_f32_16x16x32_bf16 v[136:139], a[184:187], v[40:43], v[136:139]
v_exp_f32 v84, v84
v_mfma_f32_16x16x32_bf16 v[140:143], a[188:191], v[40:43], v[140:143]
v_exp_f32 v85, v85
v_mfma_f32_16x16x32_bf16 v[140:143], a[220:223], v[44:47], v[140:143]
s_xor_b32 s21, s23, 150528
v_exp_f32 v86, v86
v_mfma_f32_16x16x32_bf16 v[144:147], a[224:227], v[44:47], v[144:147]
s_add_u32 m0, s22, 0
v_exp_f32 v87, v87
s_waitcnt lgkmcnt(5)
v_mfma_f32_16x16x32_bf16 v[144:147], a[192:195], v[40:43], v[144:147]
v_cvt_pk_bf16_f32 v38, v84, v85
v_cvt_pk_bf16_f32 v39, v86, v87
v_mfma_f32_16x16x32_bf16 v[148:151], a[196:199], v[40:43], v[148:151]
buffer_load_dwordx4 v97, s[8:11], s21 offen offset:0 nt lds
v_mfma_f32_16x16x32_bf16 v[148:151], a[228:231], v[44:47], v[148:151]
v_exp_f32 v68, v68
v_mfma_f32_16x16x32_bf16 v[152:155], a[232:235], v[44:47], v[152:155]
s_waitcnt lgkmcnt(0)
v_exp_f32 v69, v69
v_mfma_f32_16x16x32_bf16 v[152:155], a[200:203], v[40:43], v[152:155]
v_exp_f32 v70, v70
v_mfma_f32_16x16x32_bf16 v[156:159], a[204:207], v[40:43], v[156:159]
v_exp_f32 v71, v71
v_mfma_f32_16x16x32_bf16 v[156:159], a[236:239], v[44:47], v[156:159]
v_cvt_pk_bf16_f32 v32, v68, v69
v_cvt_pk_bf16_f32 v33, v70, v71
v_smfmac_f32_16x16x64_bf16 a[240:243], a[248:251], v[40:47], v92
ds_read_b128 v[108:111], v99 offset:8704
v_mfma_f32_16x16x32_bf16 v[76:79], a[144:147], a[32:35], v[56:59]
v_exp_f32 v72, v72
v_mfma_f32_16x16x32_bf16 v[76:79], a[148:151], a[36:39], v[76:79]
v_exp_f32 v73, v73
v_mfma_f32_16x16x32_bf16 v[76:79], a[152:155], a[40:43], v[76:79]
v_exp_f32 v74, v74
v_mfma_f32_16x16x32_bf16 v[76:79], a[156:159], a[44:47], v[76:79]
v_exp_f32 v75, v75
v_mfma_f32_16x16x32_bf16 v[80:83], a[172:175], a[44:47], v[56:59]
v_cvt_pk_bf16_f32 v34, v72, v73
v_cvt_pk_bf16_f32 v35, v74, v75
v_mfma_f32_16x16x32_bf16 v[80:83], a[168:171], a[40:43], v[80:83]
ds_read_b128 v[112:115], v99 offset:9760
v_mfma_f32_16x16x32_bf16 v[80:83], a[164:167], a[36:39], v[80:83]
s_waitcnt lgkmcnt(1)
v_lshlrev_b32 v116, 16, v108
v_and_b32 v108, s36, v108
v_mfma_f32_16x16x32_bf16 v[80:83], a[160:163], a[32:35], v[80:83]
s_xor_b32 s21, s23, 154624
v_exp_f32 v76, v76
v_mfma_f32_16x16x32_bf16 v[84:87], a[112:115], a[32:35], v[56:59]
s_add_u32 m0, s22, 1056
v_exp_f32 v77, v77
v_mfma_f32_16x16x32_bf16 v[84:87], a[116:119], a[36:39], v[84:87]
v_exp_f32 v78, v78
v_mfma_f32_16x16x32_bf16 v[84:87], a[120:123], a[40:43], v[84:87]
buffer_load_dwordx4 v97, s[8:11], s21 offen offset:0 nt lds
v_mfma_f32_16x16x32_bf16 v[84:87], a[124:127], a[44:47], v[84:87]
v_exp_f32 v79, v79
v_mfma_f32_16x16x32_bf16 v[68:71], a[140:143], a[44:47], v[56:59]
v_cvt_pk_bf16_f32 v44, v76, v77
v_cvt_pk_bf16_f32 v45, v78, v79
v_mfma_f32_16x16x32_bf16 v[68:71], a[136:139], a[40:43], v[68:71]
v_exp_f32 v80, v80
v_mfma_f32_16x16x32_bf16 v[68:71], a[132:135], a[36:39], v[68:71]
v_exp_f32 v81, v81
v_mfma_f32_16x16x32_bf16 v[68:71], a[128:131], a[32:35], v[68:71]
v_exp_f32 v82, v82
v_mfma_f32_16x16x32_bf16 v[160:163], a[208:211], v[36:39], v[160:163]
v_exp_f32 v83, v83
v_mfma_f32_16x16x32_bf16 v[160:163], a[176:179], v[32:35], v[160:163]
v_cvt_pk_bf16_f32 v46, v80, v81
v_cvt_pk_bf16_f32 v47, v82, v83
v_mfma_f32_16x16x32_bf16 v[164:167], a[180:183], v[32:35], v[164:167]
v_exp_f32 v84, v84
v_mfma_f32_16x16x32_bf16 v[164:167], a[212:215], v[36:39], v[164:167]
v_exp_f32 v85, v85
v_mfma_f32_16x16x32_bf16 v[168:171], a[216:219], v[36:39], v[168:171]
v_exp_f32 v86, v86
v_mfma_f32_16x16x32_bf16 v[168:171], a[184:187], v[32:35], v[168:171]
v_exp_f32 v87, v87
v_mfma_f32_16x16x32_bf16 v[172:175], a[188:191], v[32:35], v[172:175]
v_cvt_pk_bf16_f32 v40, v84, v85
v_cvt_pk_bf16_f32 v41, v86, v87
v_mfma_f32_16x16x32_bf16 v[172:175], a[220:223], v[36:39], v[172:175]
v_exp_f32 v68, v68
v_mfma_f32_16x16x32_bf16 v[176:179], a[224:227], v[36:39], v[176:179]
v_exp_f32 v69, v69
v_mfma_f32_16x16x32_bf16 v[176:179], a[192:195], v[32:35], v[176:179]
s_xor_b32 s21, s23, 158720
v_exp_f32 v70, v70
v_mfma_f32_16x16x32_bf16 v[180:183], a[196:199], v[32:35], v[180:183]
s_add_u32 m0, s22, 2112
v_exp_f32 v71, v71
v_mfma_f32_16x16x32_bf16 v[180:183], a[228:231], v[36:39], v[180:183]
v_cvt_pk_bf16_f32 v42, v68, v69
v_cvt_pk_bf16_f32 v43, v70, v71
v_mfma_f32_16x16x32_bf16 v[184:187], a[232:235], v[36:39], v[184:187]
buffer_load_dwordx4 v97, s[8:11], s21 offen offset:0 nt lds
v_mfma_f32_16x16x32_bf16 v[184:187], a[200:203], v[32:35], v[184:187]
v_mul_f32 v116, s38, v116
v_mul_f32 v108, s38, v108
v_mfma_f32_16x16x32_bf16 v[188:191], a[204:207], v[32:35], v[188:191]
v_cvt_pk_bf16_f32 v108, v116, v108
v_lshlrev_b32 v117, 16, v109
v_mfma_f32_16x16x32_bf16 v[188:191], a[236:239], v[36:39], v[188:191]
v_and_b32 v109, s36, v109
v_mul_f32 v117, s38, v117
v_smfmac_f32_16x16x64_bf16 a[240:243], a[252:255], v[32:39], v92
v_mul_f32 v109, s38, v109
v_mfma_f32_16x16x32_bf16 v[72:75], a[144:147], a[48:51], v[60:63]
v_cvt_pk_bf16_f32 v109, v117, v109
v_lshlrev_b32 v118, 16, v110
v_mfma_f32_16x16x32_bf16 v[72:75], a[148:151], a[52:55], v[72:75]
v_and_b32 v110, s36, v110
v_mul_f32 v118, s38, v118
v_mfma_f32_16x16x32_bf16 v[72:75], a[152:155], a[56:59], v[72:75]
v_mul_f32 v110, s38, v110
v_cvt_pk_bf16_f32 v110, v118, v110
v_mfma_f32_16x16x32_bf16 v[72:75], a[156:159], a[60:63], v[72:75]
v_lshlrev_b32 v119, 16, v111
v_and_b32 v111, s36, v111
v_mfma_f32_16x16x32_bf16 v[76:79], a[172:175], a[60:63], v[60:63]
v_mul_f32 v119, s38, v119
v_mul_f32 v111, s38, v111
v_mfma_f32_16x16x32_bf16 v[76:79], a[168:171], a[56:59], v[76:79]
s_waitcnt lgkmcnt(0)
v_cvt_pk_bf16_f32 v111, v119, v111
v_lshlrev_b32 v116, 16, v112
v_mfma_f32_16x16x32_bf16 v[76:79], a[164:167], a[52:55], v[76:79]
v_and_b32 v112, s36, v112
v_mul_f32 v116, s38, v116
v_mfma_f32_16x16x32_bf16 v[76:79], a[160:163], a[48:51], v[76:79]
v_exp_f32 v72, v72
v_mfma_f32_16x16x32_bf16 v[80:83], a[112:115], a[48:51], v[60:63]
v_exp_f32 v73, v73
v_mfma_f32_16x16x32_bf16 v[80:83], a[116:119], a[52:55], v[80:83]
s_xor_b32 s21, s23, 162816
v_exp_f32 v74, v74
v_mfma_f32_16x16x32_bf16 v[80:83], a[120:123], a[56:59], v[80:83]
s_add_u32 m0, s22, 3168
v_exp_f32 v75, v75
v_mfma_f32_16x16x32_bf16 v[80:83], a[124:127], a[60:63], v[80:83]
v_cvt_pk_bf16_f32 v36, v72, v73
v_cvt_pk_bf16_f32 v37, v74, v75
v_mfma_f32_16x16x32_bf16 v[84:87], a[140:143], a[60:63], v[60:63]
buffer_load_dwordx4 v97, s[8:11], s21 offen offset:0 nt lds
v_mfma_f32_16x16x32_bf16 v[84:87], a[136:139], a[56:59], v[84:87]
v_exp_f32 v76, v76
v_mfma_f32_16x16x32_bf16 v[84:87], a[132:135], a[52:55], v[84:87]
v_exp_f32 v77, v77
v_mfma_f32_16x16x32_bf16 v[84:87], a[128:131], a[48:51], v[84:87]
v_exp_f32 v78, v78
v_mfma_f32_16x16x32_bf16 v[192:195], a[208:211], v[44:47], v[192:195]
v_exp_f32 v79, v79
v_mfma_f32_16x16x32_bf16 v[192:195], a[176:179], v[40:43], v[192:195]
v_cvt_pk_bf16_f32 v38, v76, v77
v_cvt_pk_bf16_f32 v39, v78, v79
v_mfma_f32_16x16x32_bf16 v[196:199], a[180:183], v[40:43], v[196:199]
v_exp_f32 v80, v80
v_mfma_f32_16x16x32_bf16 v[196:199], a[212:215], v[44:47], v[196:199]
v_exp_f32 v81, v81
v_mfma_f32_16x16x32_bf16 v[200:203], a[216:219], v[44:47], v[200:203]
v_exp_f32 v82, v82
v_mfma_f32_16x16x32_bf16 v[200:203], a[184:187], v[40:43], v[200:203]
v_exp_f32 v83, v83
v_mfma_f32_16x16x32_bf16 v[204:207], a[188:191], v[40:43], v[204:207]
v_exp_f32 v84, v84
v_mfma_f32_16x16x32_bf16 v[204:207], a[220:223], v[44:47], v[204:207]
v_exp_f32 v85, v85
v_mfma_f32_16x16x32_bf16 v[208:211], a[224:227], v[44:47], v[208:211]
v_exp_f32 v86, v86
v_mfma_f32_16x16x32_bf16 v[208:211], a[192:195], v[40:43], v[208:211]
v_exp_f32 v87, v87
v_mfma_f32_16x16x32_bf16 v[212:215], a[196:199], v[40:43], v[212:215]
v_cvt_pk_bf16_f32 v32, v80, v81
v_cvt_pk_bf16_f32 v33, v82, v83
v_mfma_f32_16x16x32_bf16 v[212:215], a[228:231], v[44:47], v[212:215]
s_xor_b32 s21, s23, 150528
v_cvt_pk_bf16_f32 v34, v84, v85
v_cvt_pk_bf16_f32 v35, v86, v87
v_mfma_f32_16x16x32_bf16 v[216:219], a[232:235], v[44:47], v[216:219]
s_add_u32 m0, s22, 50688
v_mul_f32 v112, s38, v112
v_cvt_pk_bf16_f32 v112, v116, v112
v_mfma_f32_16x16x32_bf16 v[216:219], a[200:203], v[40:43], v[216:219]
v_lshlrev_b32 v117, 16, v113
v_and_b32 v113, s36, v113
v_mfma_f32_16x16x32_bf16 v[220:223], a[204:207], v[40:43], v[220:223]
s_waitcnt vmcnt(4)
s_barrier
v_mfma_f32_16x16x32_bf16 v[220:223], a[236:239], v[44:47], v[220:223]
buffer_load_dwordx4 v97, s[12:15], s21 offen offset:0 nt lds
v_smfmac_f32_16x16x64_bf16 a[244:247], a[248:251], v[40:47], v92
ds_read_b128 a[144:147], v89 offset:33792
v_mfma_f32_16x16x32_bf16 v[68:71], a[112:115], a[64:67], v[64:67]
ds_read_b128 a[148:151], v89 offset:33856
v_mul_f32 v117, s38, v117
v_mfma_f32_16x16x32_bf16 v[68:71], a[116:119], a[68:71], v[68:71]
ds_read_b128 a[152:155], v89 offset:33920
v_mul_f32 v113, s38, v113
v_mfma_f32_16x16x32_bf16 v[68:71], a[120:123], a[72:75], v[68:71]
ds_read_b128 a[156:159], v89 offset:33984
v_cvt_pk_bf16_f32 v113, v117, v113
v_mfma_f32_16x16x32_bf16 v[68:71], a[124:127], a[76:79], v[68:71]
ds_read_b128 a[172:175], v89 offset:34496
v_lshlrev_b32 v118, 16, v114
v_mfma_f32_16x16x32_bf16 v[72:75], a[140:143], a[76:79], v[64:67]
ds_read_b128 a[168:171], v89 offset:34432
v_and_b32 v114, s36, v114
v_mfma_f32_16x16x32_bf16 v[72:75], a[136:139], a[72:75], v[72:75]
ds_read_b128 a[164:167], v89 offset:34368
v_mul_f32 v118, s38, v118
v_mfma_f32_16x16x32_bf16 v[72:75], a[132:135], a[68:71], v[72:75]
ds_read_b128 a[160:163], v89 offset:34304
v_mul_f32 v114, s38, v114
v_mfma_f32_16x16x32_bf16 v[72:75], a[128:131], a[64:67], v[72:75]
ds_read_b128 a[112:115], v88 offset:33792
v_cvt_pk_bf16_f32 v114, v118, v114
v_mfma_f32_16x16x32_bf16 v[224:227], a[208:211], v[36:39], v[224:227]
ds_read_b128 a[116:119], v88 offset:33856
v_lshlrev_b32 v119, 16, v115
v_mfma_f32_16x16x32_bf16 v[224:227], a[176:179], v[32:35], v[224:227]
ds_read_b128 a[120:123], v88 offset:33920
v_and_b32 v115, s36, v115
v_mfma_f32_16x16x32_bf16 v[228:231], a[180:183], v[32:35], v[228:231]
ds_read_b128 a[124:127], v88 offset:33984
v_mul_f32 v119, s38, v119
v_mfma_f32_16x16x32_bf16 v[228:231], a[212:215], v[36:39], v[228:231]
s_xor_b32 s21, s23, 154624
ds_read_b128 a[140:143], v88 offset:34496
v_mul_f32 v115, s38, v115
v_mfma_f32_16x16x32_bf16 v[232:235], a[216:219], v[36:39], v[232:235]
s_add_u32 m0, s22, 51744
ds_read_b128 a[136:139], v88 offset:34432
v_cvt_pk_bf16_f32 v115, v119, v115
v_mfma_f32_16x16x32_bf16 v[232:235], a[184:187], v[32:35], v[232:235]
v_exp_f32 v68, v68
v_mfma_f32_16x16x32_bf16 v[236:239], a[188:191], v[32:35], v[236:239]
buffer_load_dwordx4 v97, s[12:15], s21 offen offset:0 nt lds
v_mfma_f32_16x16x32_bf16 v[236:239], a[220:223], v[36:39], v[236:239]
v_exp_f32 v69, v69
v_mfma_f32_16x16x32_bf16 v[240:243], a[224:227], v[36:39], v[240:243]
ds_read_b128 a[132:135], v88 offset:34368
v_cvt_pk_bf16_f32 v40, v68, v69
v_mfma_f32_16x16x32_bf16 v[240:243], a[192:195], v[32:35], v[240:243]
v_exp_f32 v70, v70
v_mfma_f32_16x16x32_bf16 v[244:247], a[196:199], v[32:35], v[244:247]
v_exp_f32 v71, v71
v_mfma_f32_16x16x32_bf16 v[244:247], a[228:231], v[36:39], v[244:247]
ds_read_b128 a[128:131], v88 offset:34304
v_cvt_pk_bf16_f32 v41, v70, v71
v_mfma_f32_16x16x32_bf16 v[248:251], a[232:235], v[36:39], v[248:251]
v_exp_f32 v72, v72
v_mfma_f32_16x16x32_bf16 v[248:251], a[200:203], v[32:35], v[248:251]
v_exp_f32 v73, v73
v_mfma_f32_16x16x32_bf16 v[252:255], a[204:207], v[32:35], v[252:255]
v_exp_f32 v74, v74
v_mfma_f32_16x16x32_bf16 v[252:255], a[236:239], v[36:39], v[252:255]
v_exp_f32 v75, v75
v_smfmac_f32_16x16x64_bf16 a[244:247], a[252:255], v[32:39], v92
s_waitcnt lgkmcnt(1)
v_cvt_pk_bf16_f32 v42, v72, v73
v_mfma_f32_16x16x32_bf16 v[76:79], a[144:147], a[0:3], v[48:51]
ds_read_b64_tr_b16 a[208:209], v91 offset:33792
v_cvt_pk_bf16_f32 v43, v74, v75
v_mfma_f32_16x16x32_bf16 v[76:79], a[148:151], a[4:7], v[76:79]
ds_read_b64_tr_b16 a[210:211], v91 offset:34304
ds_read_b64_tr_b16 a[212:213], v91 offset:33824
v_mfma_f32_16x16x32_bf16 v[76:79], a[152:155], a[8:11], v[76:79]
ds_write_b128 v99, v[108:111] offset:8704
v_mfma_f32_16x16x32_bf16 v[76:79], a[156:159], a[12:15], v[76:79]
s_xor_b32 s21, s23, 158720
ds_read_b64_tr_b16 a[214:215], v91 offset:34336
ds_read_b64_tr_b16 a[216:217], v91 offset:33856
v_mfma_f32_16x16x32_bf16 v[80:83], a[172:175], a[12:15], v[48:51]
s_add_u32 m0, s22, 52800
v_mfma_f32_16x16x32_bf16 v[80:83], a[168:171], a[8:11], v[80:83]
ds_read_b64_tr_b16 a[218:219], v91 offset:34368
ds_read_b64_tr_b16 a[220:221], v91 offset:33888
v_mfma_f32_16x16x32_bf16 v[80:83], a[164:167], a[4:7], v[80:83]
buffer_load_dwordx4 v97, s[12:15], s21 offen offset:0 nt lds
v_mfma_f32_16x16x32_bf16 v[80:83], a[160:163], a[0:3], v[80:83]
v_exp_f32 v76, v76
v_mfma_f32_16x16x32_bf16 v[84:87], a[112:115], a[0:3], v[48:51]
v_exp_f32 v77, v77
v_mfma_f32_16x16x32_bf16 v[84:87], a[116:119], a[4:7], v[84:87]
v_exp_f32 v78, v78
v_mfma_f32_16x16x32_bf16 v[84:87], a[120:123], a[8:11], v[84:87]
v_exp_f32 v79, v79
v_mfma_f32_16x16x32_bf16 v[84:87], a[124:127], a[12:15], v[84:87]
v_cvt_pk_bf16_f32 v36, v76, v77
v_cvt_pk_bf16_f32 v37, v78, v79
v_mfma_f32_16x16x32_bf16 v[68:71], a[140:143], a[12:15], v[48:51]
v_exp_f32 v80, v80
v_mfma_f32_16x16x32_bf16 v[68:71], a[136:139], a[8:11], v[68:71]
v_exp_f32 v81, v81
v_mfma_f32_16x16x32_bf16 v[68:71], a[132:135], a[4:7], v[68:71]
s_waitcnt lgkmcnt(0)
v_exp_f32 v82, v82
v_mfma_f32_16x16x32_bf16 v[68:71], a[128:131], a[0:3], v[68:71]
v_exp_f32 v83, v83
v_mfma_f32_16x16x32_bf16 v[104:107], a[248:251], v[40:43], v[104:107]
v_cvt_pk_bf16_f32 v38, v80, v81
v_cvt_pk_bf16_f32 v39, v82, v83
v_mfma_f32_16x16x32_bf16 a[80:83], a[176:179], v[40:43], a[80:83]
v_exp_f32 v84, v84
v_mfma_f32_16x16x32_bf16 a[84:87], a[180:183], v[40:43], a[84:87]
v_exp_f32 v85, v85
v_mfma_f32_16x16x32_bf16 a[88:91], a[184:187], v[40:43], a[88:91]
v_exp_f32 v86, v86
v_mfma_f32_16x16x32_bf16 a[92:95], a[188:191], v[40:43], a[92:95]
v_exp_f32 v87, v87
v_mfma_f32_16x16x32_bf16 a[96:99], a[192:195], v[40:43], a[96:99]
s_xor_b32 s21, s23, 162816
ds_read_b64_tr_b16 a[176:177], v90 offset:33792
ds_read_b64_tr_b16 a[178:179], v90 offset:34304
v_mfma_f32_16x16x32_bf16 a[100:103], a[196:199], v[40:43], a[100:103]
s_add_u32 m0, s22, 53856
v_cvt_pk_bf16_f32 v32, v84, v85
v_cvt_pk_bf16_f32 v33, v86, v87
v_mfma_f32_16x16x32_bf16 a[104:107], a[200:203], v[40:43], a[104:107]
ds_read_b64_tr_b16 a[180:181], v90 offset:33824
ds_read_b64_tr_b16 a[182:183], v90 offset:34336
v_mfma_f32_16x16x32_bf16 a[108:111], a[204:207], v[40:43], a[108:111]
buffer_load_dwordx4 v97, s[12:15], s21 offen offset:0 nt lds
v_mfma_f32_16x16x32_bf16 v[72:75], a[144:147], a[16:19], v[52:55]
v_exp_f32 v68, v68
v_mfma_f32_16x16x32_bf16 v[72:75], a[148:151], a[20:23], v[72:75]
v_exp_f32 v69, v69
v_mfma_f32_16x16x32_bf16 v[72:75], a[152:155], a[24:27], v[72:75]
v_exp_f32 v70, v70
v_mfma_f32_16x16x32_bf16 v[72:75], a[156:159], a[28:31], v[72:75]
v_exp_f32 v71, v71
v_mfma_f32_16x16x32_bf16 v[76:79], a[172:175], a[28:31], v[52:55]
ds_read_b64_tr_b16 a[184:185], v90 offset:33856
ds_read_b64_tr_b16 a[186:187], v90 offset:34368
v_mfma_f32_16x16x32_bf16 v[76:79], a[168:171], a[24:27], v[76:79]
v_cvt_pk_bf16_f32 v34, v68, v69
v_cvt_pk_bf16_f32 v35, v70, v71
v_mfma_f32_16x16x32_bf16 v[76:79], a[164:167], a[20:23], v[76:79]
ds_read_b64_tr_b16 a[188:189], v90 offset:33888
ds_read_b64_tr_b16 a[190:191], v90 offset:34400
v_mfma_f32_16x16x32_bf16 v[76:79], a[160:163], a[16:19], v[76:79]
v_exp_f32 v72, v72
v_mfma_f32_16x16x32_bf16 v[80:83], a[112:115], a[16:19], v[52:55]
ds_read_b64_tr_b16 a[222:223], v91 offset:34400
ds_read_b64_tr_b16 a[224:225], v91 offset:33920
v_mfma_f32_16x16x32_bf16 v[80:83], a[116:119], a[20:23], v[80:83]
v_exp_f32 v73, v73
v_mfma_f32_16x16x32_bf16 v[80:83], a[120:123], a[24:27], v[80:83]
ds_read_b64_tr_b16 a[226:227], v91 offset:34432
ds_read_b64_tr_b16 a[192:193], v90 offset:33920
v_mfma_f32_16x16x32_bf16 v[80:83], a[124:127], a[28:31], v[80:83]
ds_read_b64_tr_b16 a[194:195], v90 offset:34432
v_cvt_pk_bf16_f32 v44, v72, v73
v_mfma_f32_16x16x32_bf16 v[84:87], a[140:143], a[28:31], v[52:55]
ds_read_b64_tr_b16 a[196:197], v90 offset:33952
ds_read_b64_tr_b16 a[198:199], v90 offset:34464
v_mfma_f32_16x16x32_bf16 v[84:87], a[136:139], a[24:27], v[84:87]
s_xor_b32 s21, s23, 262144
v_exp_f32 v74, v74
v_mfma_f32_16x16x32_bf16 v[84:87], a[132:135], a[20:23], v[84:87]
s_add_u32 m0, s22, 16896
ds_read_b64_tr_b16 a[228:229], v91 offset:33952
ds_read_b64_tr_b16 a[230:231], v91 offset:34464
v_mfma_f32_16x16x32_bf16 v[84:87], a[128:131], a[16:19], v[84:87]
v_exp_f32 v75, v75
v_mfma_f32_16x16x32_bf16 v[128:131], a[208:211], v[36:39], v[128:131]
s_waitcnt lgkmcnt(7)
ds_read_b64_tr_b16 a[232:233], v91 offset:33984
ds_read_b64_tr_b16 a[234:235], v91 offset:34496
v_mfma_f32_16x16x32_bf16 v[128:131], a[176:179], v[32:35], v[128:131]
buffer_load_dwordx4 v97, s[8:11], s21 offen offset:0 nt lds
v_mfma_f32_16x16x32_bf16 v[132:135], a[180:183], v[32:35], v[132:135]
ds_read_b64_tr_b16 a[200:201], v90 offset:33984
ds_read_b64_tr_b16 a[202:203], v90 offset:34496
v_mfma_f32_16x16x32_bf16 v[132:135], a[212:215], v[36:39], v[132:135]
ds_read_b64_tr_b16 a[204:205], v90 offset:34016
v_cvt_pk_bf16_f32 v45, v74, v75
v_mfma_f32_16x16x32_bf16 v[136:139], a[216:219], v[36:39], v[136:139]
ds_read_b64_tr_b16 a[206:207], v90 offset:34528
ds_read_b64_tr_b16 a[236:237], v91 offset:34016
v_mfma_f32_16x16x32_bf16 v[136:139], a[184:187], v[32:35], v[136:139]
v_exp_f32 v76, v76
v_mfma_f32_16x16x32_bf16 v[140:143], a[188:191], v[32:35], v[140:143]
v_exp_f32 v77, v77
v_mfma_f32_16x16x32_bf16 v[140:143], a[220:223], v[36:39], v[140:143]
s_waitcnt lgkmcnt(7)
ds_read_b64_tr_b16 a[238:239], v91 offset:34528
v_cvt_pk_bf16_f32 v46, v76, v77
v_mfma_f32_16x16x32_bf16 v[144:147], a[224:227], v[36:39], v[144:147]
v_exp_f32 v78, v78
v_mfma_f32_16x16x32_bf16 v[144:147], a[192:195], v[32:35], v[144:147]
v_exp_f32 v79, v79
v_mfma_f32_16x16x32_bf16 v[148:151], a[196:199], v[32:35], v[148:151]
ds_read_b128 v[108:111], v99 offset:10816
v_cvt_pk_bf16_f32 v47, v78, v79
v_mfma_f32_16x16x32_bf16 v[148:151], a[228:231], v[36:39], v[148:151]
s_waitcnt lgkmcnt(4)
v_exp_f32 v80, v80
v_mfma_f32_16x16x32_bf16 v[152:155], a[232:235], v[36:39], v[152:155]
v_exp_f32 v81, v81
v_mfma_f32_16x16x32_bf16 v[152:155], a[200:203], v[32:35], v[152:155]
s_waitcnt lgkmcnt(1)
v_exp_f32 v82, v82
v_mfma_f32_16x16x32_bf16 v[156:159], a[204:207], v[32:35], v[156:159]
s_xor_b32 s21, s23, 266240
v_exp_f32 v83, v83
v_mfma_f32_16x16x32_bf16 v[156:159], a[236:239], v[36:39], v[156:159]
s_add_u32 m0, s22, 17952
v_cvt_pk_bf16_f32 v40, v80, v81
v_cvt_pk_bf16_f32 v41, v82, v83
v_smfmac_f32_16x16x64_bf16 a[240:243], a[248:251], v[32:39], v92
v_mfma_f32_16x16x32_bf16 v[68:71], a[144:147], a[32:35], v[56:59]
buffer_load_dwordx4 v97, s[8:11], s21 offen offset:0 nt lds
v_mfma_f32_16x16x32_bf16 v[68:71], a[148:151], a[36:39], v[68:71]
v_exp_f32 v84, v84
v_mfma_f32_16x16x32_bf16 v[68:71], a[152:155], a[40:43], v[68:71]
v_exp_f32 v85, v85
v_mfma_f32_16x16x32_bf16 v[68:71], a[156:159], a[44:47], v[68:71]
v_exp_f32 v86, v86
v_mfma_f32_16x16x32_bf16 v[72:75], a[172:175], a[44:47], v[56:59]
v_exp_f32 v87, v87
v_mfma_f32_16x16x32_bf16 v[72:75], a[168:171], a[40:43], v[72:75]
v_cvt_pk_bf16_f32 v42, v84, v85
v_cvt_pk_bf16_f32 v43, v86, v87
v_mfma_f32_16x16x32_bf16 v[72:75], a[164:167], a[36:39], v[72:75]
ds_write_b128 v99, v[112:115] offset:9760
v_mfma_f32_16x16x32_bf16 v[72:75], a[160:163], a[32:35], v[72:75]
v_exp_f32 v68, v68
v_mfma_f32_16x16x32_bf16 v[76:79], a[112:115], a[32:35], v[56:59]
v_exp_f32 v69, v69
v_mfma_f32_16x16x32_bf16 v[76:79], a[116:119], a[36:39], v[76:79]
v_exp_f32 v70, v70
v_mfma_f32_16x16x32_bf16 v[76:79], a[120:123], a[40:43], v[76:79]
v_exp_f32 v71, v71
v_mfma_f32_16x16x32_bf16 v[76:79], a[124:127], a[44:47], v[76:79]
v_cvt_pk_bf16_f32 v36, v68, v69
v_cvt_pk_bf16_f32 v37, v70, v71
v_mfma_f32_16x16x32_bf16 v[80:83], a[140:143], a[44:47], v[56:59]
v_exp_f32 v72, v72
v_mfma_f32_16x16x32_bf16 v[80:83], a[136:139], a[40:43], v[80:83]
v_exp_f32 v73, v73
v_mfma_f32_16x16x32_bf16 v[80:83], a[132:135], a[36:39], v[80:83]
v_exp_f32 v74, v74
v_mfma_f32_16x16x32_bf16 v[80:83], a[128:131], a[32:35], v[80:83]
s_xor_b32 s21, s23, 270336
v_exp_f32 v75, v75
v_mfma_f32_16x16x32_bf16 v[160:163], a[208:211], v[44:47], v[160:163]
s_add_u32 m0, s22, 19008
v_cvt_pk_bf16_f32 v38, v72, v73
v_cvt_pk_bf16_f32 v39, v74, v75
v_mfma_f32_16x16x32_bf16 v[160:163], a[176:179], v[40:43], v[160:163]
v_exp_f32 v76, v76
v_mfma_f32_16x16x32_bf16 v[164:167], a[180:183], v[40:43], v[164:167]
buffer_load_dwordx4 v97, s[8:11], s21 offen offset:0 nt lds
v_mfma_f32_16x16x32_bf16 v[164:167], a[212:215], v[44:47], v[164:167]
v_exp_f32 v77, v77
v_mfma_f32_16x16x32_bf16 v[168:171], a[216:219], v[44:47], v[168:171]
v_exp_f32 v78, v78
v_mfma_f32_16x16x32_bf16 v[168:171], a[184:187], v[40:43], v[168:171]
v_exp_f32 v79, v79
v_mfma_f32_16x16x32_bf16 v[172:175], a[188:191], v[40:43], v[172:175]
v_cvt_pk_bf16_f32 v32, v76, v77
v_cvt_pk_bf16_f32 v33, v78, v79
v_mfma_f32_16x16x32_bf16 v[172:175], a[220:223], v[44:47], v[172:175]
v_exp_f32 v80, v80
v_mfma_f32_16x16x32_bf16 v[176:179], a[224:227], v[44:47], v[176:179]
v_exp_f32 v81, v81
v_mfma_f32_16x16x32_bf16 v[176:179], a[192:195], v[40:43], v[176:179]
v_exp_f32 v82, v82
v_mfma_f32_16x16x32_bf16 v[180:183], a[196:199], v[40:43], v[180:183]
v_exp_f32 v83, v83
v_mfma_f32_16x16x32_bf16 v[180:183], a[228:231], v[44:47], v[180:183]
v_cvt_pk_bf16_f32 v34, v80, v81
v_cvt_pk_bf16_f32 v35, v82, v83
v_mfma_f32_16x16x32_bf16 v[184:187], a[232:235], v[44:47], v[184:187]
s_waitcnt lgkmcnt(0)
ds_read_b128 v[112:115], v99 offset:11872
v_lshlrev_b32 v116, 16, v108
v_mfma_f32_16x16x32_bf16 v[184:187], a[200:203], v[40:43], v[184:187]
v_and_b32 v108, s36, v108
v_mul_f32 v116, s38, v116
v_mfma_f32_16x16x32_bf16 v[188:191], a[204:207], v[40:43], v[188:191]
v_mul_f32 v108, s38, v108
v_cvt_pk_bf16_f32 v108, v116, v108
v_mfma_f32_16x16x32_bf16 v[188:191], a[236:239], v[44:47], v[188:191]
v_lshlrev_b32 v117, 16, v109
v_and_b32 v109, s36, v109
v_smfmac_f32_16x16x64_bf16 a[240:243], a[252:255], v[40:47], v92
s_xor_b32 s21, s23, 274432
v_mul_f32 v117, s38, v117
v_mfma_f32_16x16x32_bf16 v[84:87], a[144:147], a[48:51], v[60:63]
s_add_u32 m0, s22, 20064
v_mul_f32 v109, s38, v109
v_cvt_pk_bf16_f32 v109, v117, v109
v_mfma_f32_16x16x32_bf16 v[84:87], a[148:151], a[52:55], v[84:87]
v_lshlrev_b32 v118, 16, v110
v_and_b32 v110, s36, v110
v_mfma_f32_16x16x32_bf16 v[84:87], a[152:155], a[56:59], v[84:87]
buffer_load_dwordx4 v97, s[8:11], s21 offen offset:0 nt lds
v_mfma_f32_16x16x32_bf16 v[84:87], a[156:159], a[60:63], v[84:87]
v_mul_f32 v118, s38, v118
v_mul_f32 v110, s38, v110
v_mfma_f32_16x16x32_bf16 v[68:71], a[172:175], a[60:63], v[60:63]
v_cvt_pk_bf16_f32 v110, v118, v110
v_lshlrev_b32 v119, 16, v111
v_mfma_f32_16x16x32_bf16 v[68:71], a[168:171], a[56:59], v[68:71]
v_and_b32 v111, s36, v111
v_mul_f32 v119, s38, v119
v_mfma_f32_16x16x32_bf16 v[68:71], a[164:167], a[52:55], v[68:71]
v_mul_f32 v111, s38, v111
v_cvt_pk_bf16_f32 v111, v119, v111
v_mfma_f32_16x16x32_bf16 v[68:71], a[160:163], a[48:51], v[68:71]
v_exp_f32 v84, v84
v_mfma_f32_16x16x32_bf16 v[72:75], a[112:115], a[48:51], v[60:63]
v_exp_f32 v85, v85
v_mfma_f32_16x16x32_bf16 v[72:75], a[116:119], a[52:55], v[72:75]
v_exp_f32 v86, v86
v_mfma_f32_16x16x32_bf16 v[72:75], a[120:123], a[56:59], v[72:75]
v_exp_f32 v87, v87
v_mfma_f32_16x16x32_bf16 v[72:75], a[124:127], a[60:63], v[72:75]
v_cvt_pk_bf16_f32 v44, v84, v85
v_cvt_pk_bf16_f32 v45, v86, v87
v_mfma_f32_16x16x32_bf16 v[76:79], a[140:143], a[60:63], v[60:63]
v_exp_f32 v68, v68
v_mfma_f32_16x16x32_bf16 v[76:79], a[136:139], a[56:59], v[76:79]
v_exp_f32 v69, v69
v_mfma_f32_16x16x32_bf16 v[76:79], a[132:135], a[52:55], v[76:79]
v_exp_f32 v70, v70
v_mfma_f32_16x16x32_bf16 v[76:79], a[128:131], a[48:51], v[76:79]
v_exp_f32 v71, v71
v_mfma_f32_16x16x32_bf16 v[192:195], a[208:211], v[36:39], v[192:195]
s_xor_b32 s21, s23, 262144
v_cvt_pk_bf16_f32 v46, v68, v69
v_cvt_pk_bf16_f32 v47, v70, v71
v_mfma_f32_16x16x32_bf16 v[192:195], a[176:179], v[32:35], v[192:195]
s_add_u32 m0, s22, 67584
v_exp_f32 v72, v72
v_mfma_f32_16x16x32_bf16 v[196:199], a[180:183], v[32:35], v[196:199]
v_exp_f32 v73, v73
v_mfma_f32_16x16x32_bf16 v[196:199], a[212:215], v[36:39], v[196:199]
buffer_load_dwordx4 v97, s[12:15], s21 offen offset:0 nt lds
v_mfma_f32_16x16x32_bf16 v[200:203], a[216:219], v[36:39], v[200:203]
v_exp_f32 v74, v74
v_mfma_f32_16x16x32_bf16 v[200:203], a[184:187], v[32:35], v[200:203]
v_exp_f32 v75, v75
v_mfma_f32_16x16x32_bf16 v[204:207], a[188:191], v[32:35], v[204:207]
v_exp_f32 v76, v76
v_mfma_f32_16x16x32_bf16 v[204:207], a[220:223], v[36:39], v[204:207]
v_exp_f32 v77, v77
v_mfma_f32_16x16x32_bf16 v[208:211], a[224:227], v[36:39], v[208:211]
v_exp_f32 v78, v78
v_mfma_f32_16x16x32_bf16 v[208:211], a[192:195], v[32:35], v[208:211]
v_exp_f32 v79, v79
v_mfma_f32_16x16x32_bf16 v[212:215], a[196:199], v[32:35], v[212:215]
v_cvt_pk_bf16_f32 v40, v72, v73
v_cvt_pk_bf16_f32 v41, v74, v75
v_mfma_f32_16x16x32_bf16 v[212:215], a[228:231], v[36:39], v[212:215]
v_cvt_pk_bf16_f32 v42, v76, v77
v_cvt_pk_bf16_f32 v43, v78, v79
v_mfma_f32_16x16x32_bf16 v[216:219], a[232:235], v[36:39], v[216:219]
s_waitcnt lgkmcnt(0)
v_lshlrev_b32 v116, 16, v112
v_and_b32 v112, s36, v112
v_mfma_f32_16x16x32_bf16 v[216:219], a[200:203], v[32:35], v[216:219]
v_mul_f32 v116, s38, v116
v_mul_f32 v112, s38, v112
v_mfma_f32_16x16x32_bf16 v[220:223], a[204:207], v[32:35], v[220:223]
s_waitcnt vmcnt(5)
s_barrier
v_mfma_f32_16x16x32_bf16 v[220:223], a[236:239], v[36:39], v[220:223]
ds_read_b128 a[144:147], v89 offset:0
v_cvt_pk_bf16_f32 v112, v116, v112
v_smfmac_f32_16x16x64_bf16 a[244:247], a[248:251], v[32:39], v92
ds_read_b128 a[148:151], v89 offset:64
v_mfma_f32_16x16x32_bf16 v[80:83], a[112:115], a[64:67], v[64:67]
ds_read_b128 a[152:155], v89 offset:128
v_lshlrev_b32 v117, 16, v113
v_mfma_f32_16x16x32_bf16 v[80:83], a[116:119], a[68:71], v[80:83]
s_xor_b32 s21, s23, 266240
ds_read_b128 a[156:159], v89 offset:192
v_and_b32 v113, s36, v113
v_mfma_f32_16x16x32_bf16 v[80:83], a[120:123], a[72:75], v[80:83]
s_add_u32 m0, s22, 68640
ds_read_b128 a[172:175], v89 offset:704
v_mul_f32 v117, s38, v117
v_mfma_f32_16x16x32_bf16 v[80:83], a[124:127], a[76:79], v[80:83]
ds_read_b128 a[168:171], v89 offset:640
v_mul_f32 v113, s38, v113
v_mfma_f32_16x16x32_bf16 v[84:87], a[140:143], a[76:79], v[64:67]
buffer_load_dwordx4 v97, s[12:15], s21 offen offset:0 nt lds
v_mfma_f32_16x16x32_bf16 v[84:87], a[136:139], a[72:75], v[84:87]
ds_read_b128 a[164:167], v89 offset:576
v_cvt_pk_bf16_f32 v113, v117, v113
v_mfma_f32_16x16x32_bf16 v[84:87], a[132:135], a[68:71], v[84:87]
ds_read_b128 a[160:163], v89 offset:512
v_lshlrev_b32 v118, 16, v114
v_mfma_f32_16x16x32_bf16 v[84:87], a[128:131], a[64:67], v[84:87]
ds_read_b128 a[112:115], v88 offset:0
v_and_b32 v114, s36, v114
v_mfma_f32_16x16x32_bf16 v[224:227], a[208:211], v[44:47], v[224:227]
ds_read_b128 a[116:119], v88 offset:64
v_mul_f32 v118, s38, v118
v_mfma_f32_16x16x32_bf16 v[224:227], a[176:179], v[40:43], v[224:227]
ds_read_b128 a[120:123], v88 offset:128
v_mul_f32 v114, s38, v114
v_mfma_f32_16x16x32_bf16 v[228:231], a[180:183], v[40:43], v[228:231]
ds_read_b128 a[124:127], v88 offset:192
v_cvt_pk_bf16_f32 v114, v118, v114
v_mfma_f32_16x16x32_bf16 v[228:231], a[212:215], v[44:47], v[228:231]
ds_read_b128 a[140:143], v88 offset:704
v_lshlrev_b32 v119, 16, v115
v_mfma_f32_16x16x32_bf16 v[232:235], a[216:219], v[44:47], v[232:235]
ds_read_b128 a[136:139], v88 offset:640
v_and_b32 v115, s36, v115
v_mfma_f32_16x16x32_bf16 v[232:235], a[184:187], v[40:43], v[232:235]
ds_read_b128 a[132:135], v88 offset:576
v_mul_f32 v119, s38, v119
v_mfma_f32_16x16x32_bf16 v[236:239], a[188:191], v[40:43], v[236:239]
ds_read_b128 a[128:131], v88 offset:512
v_mul_f32 v115, s38, v115
v_mfma_f32_16x16x32_bf16 v[236:239], a[220:223], v[44:47], v[236:239]
v_exp_f32 v80, v80
v_mfma_f32_16x16x32_bf16 v[240:243], a[224:227], v[44:47], v[240:243]
v_exp_f32 v81, v81
v_mfma_f32_16x16x32_bf16 v[240:243], a[192:195], v[40:43], v[240:243]
v_exp_f32 v82, v82
v_mfma_f32_16x16x32_bf16 v[244:247], a[196:199], v[40:43], v[244:247]
s_xor_b32 s21, s23, 270336
v_exp_f32 v83, v83
v_mfma_f32_16x16x32_bf16 v[244:247], a[228:231], v[44:47], v[244:247]
s_add_u32 m0, s22, 69696
v_cvt_pk_bf16_f32 v32, v80, v81
v_cvt_pk_bf16_f32 v33, v82, v83
v_mfma_f32_16x16x32_bf16 v[248:251], a[232:235], v[44:47], v[248:251]
v_exp_f32 v84, v84
v_mfma_f32_16x16x32_bf16 v[248:251], a[200:203], v[40:43], v[248:251]
buffer_load_dwordx4 v97, s[12:15], s21 offen offset:0 nt lds
v_mfma_f32_16x16x32_bf16 v[252:255], a[204:207], v[40:43], v[252:255]
v_exp_f32 v85, v85
v_mfma_f32_16x16x32_bf16 v[252:255], a[236:239], v[44:47], v[252:255]
v_exp_f32 v86, v86
v_smfmac_f32_16x16x64_bf16 a[244:247], a[252:255], v[40:47], v92
s_waitcnt lgkmcnt(0)
v_cvt_pk_bf16_f32 v34, v84, v85
v_mfma_f32_16x16x32_bf16 v[68:71], a[144:147], a[0:3], v[48:51]
v_exp_f32 v87, v87
v_mfma_f32_16x16x32_bf16 v[68:71], a[148:151], a[4:7], v[68:71]
ds_read_b64_tr_b16 a[208:209], v91 offset:0
v_cvt_pk_bf16_f32 v35, v86, v87
v_mfma_f32_16x16x32_bf16 v[68:71], a[152:155], a[8:11], v[68:71]
ds_read_b64_tr_b16 a[210:211], v91 offset:512
ds_read_b64_tr_b16 a[212:213], v91 offset:32
v_mfma_f32_16x16x32_bf16 v[68:71], a[156:159], a[12:15], v[68:71]
ds_read_b64_tr_b16 a[214:215], v91 offset:544
v_cvt_pk_bf16_f32 v115, v119, v115
v_mfma_f32_16x16x32_bf16 v[72:75], a[172:175], a[12:15], v[48:51]
ds_read_b64_tr_b16 a[216:217], v91 offset:64
ds_read_b64_tr_b16 a[218:219], v91 offset:576
v_mfma_f32_16x16x32_bf16 v[72:75], a[168:171], a[8:11], v[72:75]
ds_write_b128 v99, v[108:111] offset:10816
v_mfma_f32_16x16x32_bf16 v[72:75], a[164:167], a[4:7], v[72:75]
ds_read_b64_tr_b16 a[220:221], v91 offset:96
ds_read_b64_tr_b16 a[222:223], v91 offset:608
v_mfma_f32_16x16x32_bf16 v[72:75], a[160:163], a[0:3], v[72:75]
v_exp_f32 v68, v68
v_mfma_f32_16x16x32_bf16 v[76:79], a[112:115], a[0:3], v[48:51]
v_exp_f32 v69, v69
v_mfma_f32_16x16x32_bf16 v[76:79], a[116:119], a[4:7], v[76:79]
v_exp_f32 v70, v70
v_mfma_f32_16x16x32_bf16 v[76:79], a[120:123], a[8:11], v[76:79]
s_xor_b32 s21, s23, 274432
v_exp_f32 v71, v71
v_mfma_f32_16x16x32_bf16 v[76:79], a[124:127], a[12:15], v[76:79]
s_add_u32 m0, s22, 70752
v_cvt_pk_bf16_f32 v44, v68, v69
v_cvt_pk_bf16_f32 v45, v70, v71
v_mfma_f32_16x16x32_bf16 v[80:83], a[140:143], a[12:15], v[48:51]
v_exp_f32 v72, v72
v_mfma_f32_16x16x32_bf16 v[80:83], a[136:139], a[8:11], v[80:83]
buffer_load_dwordx4 v97, s[12:15], s21 offen offset:0 nt lds
v_mfma_f32_16x16x32_bf16 v[80:83], a[132:135], a[4:7], v[80:83]
v_exp_f32 v73, v73
v_mfma_f32_16x16x32_bf16 v[80:83], a[128:131], a[0:3], v[80:83]
v_exp_f32 v74, v74
v_mfma_f32_16x16x32_bf16 v[104:107], a[248:251], v[32:35], v[104:107]
v_exp_f32 v75, v75
v_mfma_f32_16x16x32_bf16 a[80:83], a[176:179], v[32:35], a[80:83]
v_cvt_pk_bf16_f32 v46, v72, v73
v_cvt_pk_bf16_f32 v47, v74, v75
v_mfma_f32_16x16x32_bf16 a[84:87], a[180:183], v[32:35], a[84:87]
v_exp_f32 v76, v76
v_mfma_f32_16x16x32_bf16 a[88:91], a[184:187], v[32:35], a[88:91]
v_exp_f32 v77, v77
v_mfma_f32_16x16x32_bf16 a[92:95], a[188:191], v[32:35], a[92:95]
v_exp_f32 v78, v78
v_mfma_f32_16x16x32_bf16 a[96:99], a[192:195], v[32:35], a[96:99]
v_exp_f32 v79, v79
v_mfma_f32_16x16x32_bf16 a[100:103], a[196:199], v[32:35], a[100:103]
v_cvt_pk_bf16_f32 v40, v76, v77
v_cvt_pk_bf16_f32 v41, v78, v79
v_mfma_f32_16x16x32_bf16 a[104:107], a[200:203], v[32:35], a[104:107]
ds_read_b64_tr_b16 a[176:177], v90 offset:0
ds_read_b64_tr_b16 a[178:179], v90 offset:512
v_mfma_f32_16x16x32_bf16 a[108:111], a[204:207], v[32:35], a[108:111]
v_exp_f32 v80, v80
v_mfma_f32_16x16x32_bf16 v[84:87], a[144:147], a[16:19], v[52:55]
ds_read_b64_tr_b16 a[180:181], v90 offset:32
ds_read_b64_tr_b16 a[182:183], v90 offset:544
v_mfma_f32_16x16x32_bf16 v[84:87], a[148:151], a[20:23], v[84:87]
v_exp_f32 v81, v81
v_mfma_f32_16x16x32_bf16 v[84:87], a[152:155], a[24:27], v[84:87]
v_exp_f32 v82, v82
v_mfma_f32_16x16x32_bf16 v[84:87], a[156:159], a[28:31], v[84:87]
s_xor_b32 s21, s23, 263168
v_exp_f32 v83, v83
v_mfma_f32_16x16x32_bf16 v[68:71], a[172:175], a[28:31], v[52:55]
s_add_u32 m0, s22, 33792
v_cvt_pk_bf16_f32 v42, v80, v81
v_cvt_pk_bf16_f32 v43, v82, v83
v_mfma_f32_16x16x32_bf16 v[68:71], a[168:171], a[24:27], v[68:71]
ds_read_b64_tr_b16 a[184:185], v90 offset:64
ds_read_b64_tr_b16 a[186:187], v90 offset:576
v_mfma_f32_16x16x32_bf16 v[68:71], a[164:167], a[20:23], v[68:71]
buffer_load_dwordx4 v97, s[8:11], s21 offen offset:0 nt lds
v_mfma_f32_16x16x32_bf16 v[68:71], a[160:163], a[16:19], v[68:71]
ds_read_b64_tr_b16 a[188:189], v90 offset:96
ds_read_b64_tr_b16 a[190:191], v90 offset:608
v_mfma_f32_16x16x32_bf16 v[72:75], a[112:115], a[16:19], v[52:55]
v_exp_f32 v84, v84
v_mfma_f32_16x16x32_bf16 v[72:75], a[116:119], a[20:23], v[72:75]
ds_read_b64_tr_b16 a[224:225], v91 offset:128
ds_read_b64_tr_b16 a[226:227], v91 offset:640
v_mfma_f32_16x16x32_bf16 v[72:75], a[120:123], a[24:27], v[72:75]
v_exp_f32 v85, v85
v_mfma_f32_16x16x32_bf16 v[72:75], a[124:127], a[28:31], v[72:75]
ds_read_b64_tr_b16 a[192:193], v90 offset:128
ds_read_b64_tr_b16 a[194:195], v90 offset:640
v_mfma_f32_16x16x32_bf16 v[76:79], a[140:143], a[28:31], v[52:55]
ds_read_b128 a[0:3], v93 offset:0
v_cvt_pk_bf16_f32 v36, v84, v85
v_mfma_f32_16x16x32_bf16 v[76:79], a[136:139], a[24:27], v[76:79]
v_exp_f32 v86, v86
v_mfma_f32_16x16x32_bf16 v[76:79], a[132:135], a[20:23], v[76:79]
ds_read_b64_tr_b16 a[196:197], v90 offset:160
ds_read_b64_tr_b16 a[198:199], v90 offset:672
v_mfma_f32_16x16x32_bf16 v[76:79], a[128:131], a[16:19], v[76:79]
v_exp_f32 v87, v87
v_smfmac_f32_16x16x64_bf16 a[240:243], a[248:251], v[40:47], v92
s_waitcnt lgkmcnt(7)
ds_read_b128 a[4:7], v93 offset:64
v_mfma_f32_16x16x32_bf16 v[128:131], a[208:211], v[44:47], v[128:131]
ds_read_b128 a[8:11], v93 offset:128
v_cvt_pk_bf16_f32 v37, v86, v87
v_mfma_f32_16x16x32_bf16 v[128:131], a[176:179], v[40:43], v[128:131]
ds_read_b64_tr_b16 a[228:229], v91 offset:160
ds_read_b64_tr_b16 a[230:231], v91 offset:672
v_mfma_f32_16x16x32_bf16 v[132:135], a[180:183], v[40:43], v[132:135]
v_exp_f32 v68, v68
v_mfma_f32_16x16x32_bf16 v[132:135], a[212:215], v[44:47], v[132:135]
s_xor_b32 s21, s23, 267264
ds_read_b128 a[12:15], v93 offset:192
v_accvgpr_read_b32 v125, a240
v_mfma_f32_16x16x32_bf16 v[136:139], a[216:219], v[44:47], v[136:139]
s_add_u32 m0, s22, 34848
ds_read_b64_tr_b16 a[232:233], v91 offset:192
ds_read_b64_tr_b16 a[234:235], v91 offset:704
v_mfma_f32_16x16x32_bf16 v[136:139], a[184:187], v[40:43], v[136:139]
ds_read_b64_tr_b16 a[200:201], v90 offset:192
v_accvgpr_read_b32 v124, a241
v_mfma_f32_16x16x32_bf16 v[140:143], a[188:191], v[40:43], v[140:143]
ds_read_b64_tr_b16 a[202:203], v90 offset:704
ds_read_b64_tr_b16 a[204:205], v90 offset:224
v_mfma_f32_16x16x32_bf16 v[140:143], a[220:223], v[44:47], v[140:143]
s_waitcnt lgkmcnt(9)
ds_read_b64_tr_b16 a[206:207], v90 offset:736
v_add_f32 v125, v125, v124
v_mfma_f32_16x16x32_bf16 v[144:147], a[224:227], v[44:47], v[144:147]
ds_read_b64_tr_b16 a[236:237], v91 offset:224
ds_read_b64_tr_b16 a[238:239], v91 offset:736
v_mfma_f32_16x16x32_bf16 v[144:147], a[192:195], v[40:43], v[144:147]
buffer_load_dwordx4 v97, s[8:11], s21 offen offset:0 nt lds
v_mfma_f32_16x16x32_bf16 v[148:151], a[196:199], v[40:43], v[148:151]
s_waitcnt lgkmcnt(9)
v_rcp_f32 v124, v125
v_mfma_f32_16x16x32_bf16 v[148:151], a[228:231], v[44:47], v[148:151]
s_waitcnt lgkmcnt(6)
v_exp_f32 v69, v69
v_mfma_f32_16x16x32_bf16 v[152:155], a[232:235], v[44:47], v[152:155]
s_waitcnt lgkmcnt(4)
v_exp_f32 v70, v70
v_mfma_f32_16x16x32_bf16 v[152:155], a[200:203], v[40:43], v[152:155]
s_waitcnt lgkmcnt(2)
v_exp_f32 v71, v71
v_mfma_f32_16x16x32_bf16 v[156:159], a[204:207], v[40:43], v[156:159]
s_waitcnt lgkmcnt(0)
v_cvt_pk_bf16_f32 v38, v68, v69
v_cvt_pk_bf16_f32 v39, v70, v71
v_mfma_f32_16x16x32_bf16 v[156:159], a[236:239], v[44:47], v[156:159]
v_exp_f32 v72, v72
v_mfma_f32_16x16x32_bf16 v[80:83], a[144:147], a[32:35], v[56:59]
v_exp_f32 v73, v73
v_mfma_f32_16x16x32_bf16 v[80:83], a[148:151], a[36:39], v[80:83]
v_exp_f32 v74, v74
v_mfma_f32_16x16x32_bf16 v[80:83], a[152:155], a[40:43], v[80:83]
v_exp_f32 v75, v75
v_mfma_f32_16x16x32_bf16 v[80:83], a[156:159], a[44:47], v[80:83]
v_cvt_pk_bf16_f32 v32, v72, v73
v_cvt_pk_bf16_f32 v33, v74, v75
v_mfma_f32_16x16x32_bf16 v[84:87], a[172:175], a[44:47], v[56:59]
s_xor_b32 s21, s23, 271360
v_pk_mul_f32 v[128:129], v[128:129], v[124:125] op_sel_hi:[1,0]
v_pk_mul_f32 v[130:131], v[130:131], v[124:125] op_sel_hi:[1,0]
v_pk_mul_f32 v[132:133], v[132:133], v[124:125] op_sel_hi:[1,0]
v_pk_mul_f32 v[134:135], v[134:135], v[124:125] op_sel_hi:[1,0]
v_pk_mul_f32 v[136:137], v[136:137], v[124:125] op_sel_hi:[1,0]
v_pk_mul_f32 v[138:139], v[138:139], v[124:125] op_sel_hi:[1,0]
v_pk_mul_f32 v[140:141], v[140:141], v[124:125] op_sel_hi:[1,0]
v_pk_mul_f32 v[142:143], v[142:143], v[124:125] op_sel_hi:[1,0]
v_pk_mul_f32 v[144:145], v[144:145], v[124:125] op_sel_hi:[1,0]
v_pk_mul_f32 v[146:147], v[146:147], v[124:125] op_sel_hi:[1,0]
v_pk_mul_f32 v[148:149], v[148:149], v[124:125] op_sel_hi:[1,0]
v_pk_mul_f32 v[150:151], v[150:151], v[124:125] op_sel_hi:[1,0]
v_pk_mul_f32 v[152:153], v[152:153], v[124:125] op_sel_hi:[1,0]
v_pk_mul_f32 v[154:155], v[154:155], v[124:125] op_sel_hi:[1,0]
v_pk_mul_f32 v[156:157], v[156:157], v[124:125] op_sel_hi:[1,0]
v_pk_mul_f32 v[158:159], v[158:159], v[124:125] op_sel_hi:[1,0]
v_mfma_f32_16x16x32_bf16 v[84:87], a[168:171], a[40:43], v[84:87]
s_add_u32 m0, s22, 35904
ds_read_b128 a[16:19], v93 offset:4352
v_add_f32 v100, v100, v125
v_mfma_f32_16x16x32_bf16 v[84:87], a[164:167], a[36:39], v[84:87]
ds_read_b128 a[20:23], v93 offset:4416
v_cvt_pk_bf16_f32 v128, v128, v129
v_mfma_f32_16x16x32_bf16 v[84:87], a[160:163], a[32:35], v[84:87]
ds_read_b128 a[24:27], v93 offset:4480
v_cvt_pk_bf16_f32 v129, v130, v131
v_mfma_f32_16x16x32_bf16 v[68:71], a[112:115], a[32:35], v[56:59]
ds_read_b128 a[28:31], v93 offset:4544
v_cvt_pk_bf16_f32 v132, v132, v133
v_mfma_f32_16x16x32_bf16 v[68:71], a[116:119], a[36:39], v[68:71]
buffer_load_dwordx4 v97, s[8:11], s21 offen offset:0 nt lds
v_mfma_f32_16x16x32_bf16 v[68:71], a[120:123], a[40:43], v[68:71]
v_exp_f32 v76, v76
v_mfma_f32_16x16x32_bf16 v[68:71], a[124:127], a[44:47], v[68:71]
v_exp_f32 v77, v77
v_mfma_f32_16x16x32_bf16 v[72:75], a[140:143], a[44:47], v[56:59]
v_exp_f32 v78, v78
v_mfma_f32_16x16x32_bf16 v[72:75], a[136:139], a[40:43], v[72:75]
v_exp_f32 v79, v79
v_mfma_f32_16x16x32_bf16 v[72:75], a[132:135], a[36:39], v[72:75]
v_cvt_pk_bf16_f32 v34, v76, v77
v_cvt_pk_bf16_f32 v35, v78, v79
v_mfma_f32_16x16x32_bf16 v[72:75], a[128:131], a[32:35], v[72:75]
v_exp_f32 v80, v80
v_smfmac_f32_16x16x64_bf16 a[240:243], a[252:255], v[32:39], v92
v_cvt_pk_bf16_f32 v133, v134, v135
v_mfma_f32_16x16x32_bf16 v[160:163], a[208:211], v[36:39], v[160:163]
v_exp_f32 v81, v81
v_mfma_f32_16x16x32_bf16 v[160:163], a[176:179], v[32:35], v[160:163]
v_exp_f32 v82, v82
v_mfma_f32_16x16x32_bf16 v[164:167], a[180:183], v[32:35], v[164:167]
v_exp_f32 v83, v83
v_mfma_f32_16x16x32_bf16 v[164:167], a[212:215], v[36:39], v[164:167]
v_cvt_pk_bf16_f32 v44, v80, v81
v_cvt_pk_bf16_f32 v45, v82, v83
v_mfma_f32_16x16x32_bf16 v[168:171], a[216:219], v[36:39], v[168:171]
s_xor_b32 s21, s23, 275456
v_accvgpr_read_b32 v127, a242
v_accvgpr_read_b32 v126, a243
v_mfma_f32_16x16x32_bf16 v[168:171], a[184:187], v[32:35], v[168:171]
s_add_u32 m0, s22, 36960
v_add_f32 v127, v127, v126
v_cvt_pk_bf16_f32 v136, v136, v137
v_mfma_f32_16x16x32_bf16 v[172:175], a[188:191], v[32:35], v[172:175]
v_rcp_f32 v126, v127
v_mfma_f32_16x16x32_bf16 v[172:175], a[220:223], v[36:39], v[172:175]
buffer_load_dwordx4 v97, s[8:11], s21 offen offset:0 nt lds
v_mfma_f32_16x16x32_bf16 v[176:179], a[224:227], v[36:39], v[176:179]
v_exp_f32 v84, v84
v_mfma_f32_16x16x32_bf16 v[176:179], a[192:195], v[32:35], v[176:179]
v_exp_f32 v85, v85
v_mfma_f32_16x16x32_bf16 v[180:183], a[196:199], v[32:35], v[180:183]
v_exp_f32 v86, v86
v_mfma_f32_16x16x32_bf16 v[180:183], a[228:231], v[36:39], v[180:183]
v_exp_f32 v87, v87
v_mfma_f32_16x16x32_bf16 v[184:187], a[232:235], v[36:39], v[184:187]
v_cvt_pk_bf16_f32 v46, v84, v85
v_cvt_pk_bf16_f32 v47, v86, v87
v_mfma_f32_16x16x32_bf16 v[184:187], a[200:203], v[32:35], v[184:187]
v_exp_f32 v68, v68
v_mfma_f32_16x16x32_bf16 v[188:191], a[204:207], v[32:35], v[188:191]
v_exp_f32 v69, v69
v_mfma_f32_16x16x32_bf16 v[188:191], a[236:239], v[36:39], v[188:191]
v_exp_f32 v70, v70
v_mfma_f32_16x16x32_bf16 v[76:79], a[144:147], a[48:51], v[60:63]
v_exp_f32 v71, v71
v_mfma_f32_16x16x32_bf16 v[76:79], a[148:151], a[52:55], v[76:79]
v_cvt_pk_bf16_f32 v40, v68, v69
v_cvt_pk_bf16_f32 v41, v70, v71
v_mfma_f32_16x16x32_bf16 v[76:79], a[152:155], a[56:59], v[76:79]
ds_write_b128 v99, v[112:115] offset:11872
v_mfma_f32_16x16x32_bf16 v[76:79], a[156:159], a[60:63], v[76:79]
ds_read_b128 a[32:35], v93 offset:8704
v_cvt_pk_bf16_f32 v137, v138, v139
v_mfma_f32_16x16x32_bf16 v[80:83], a[172:175], a[60:63], v[60:63]
v_pk_mul_f32 v[160:161], v[160:161], v[126:127] op_sel_hi:[1,0]
v_pk_mul_f32 v[162:163], v[162:163], v[126:127] op_sel_hi:[1,0]
v_pk_mul_f32 v[164:165], v[164:165], v[126:127] op_sel_hi:[1,0]
v_pk_mul_f32 v[166:167], v[166:167], v[126:127] op_sel_hi:[1,0]
v_pk_mul_f32 v[168:169], v[168:169], v[126:127] op_sel_hi:[1,0]
v_pk_mul_f32 v[170:171], v[170:171], v[126:127] op_sel_hi:[1,0]
v_pk_mul_f32 v[172:173], v[172:173], v[126:127] op_sel_hi:[1,0]
v_pk_mul_f32 v[174:175], v[174:175], v[126:127] op_sel_hi:[1,0]
v_pk_mul_f32 v[176:177], v[176:177], v[126:127] op_sel_hi:[1,0]
v_pk_mul_f32 v[178:179], v[178:179], v[126:127] op_sel_hi:[1,0]
v_pk_mul_f32 v[180:181], v[180:181], v[126:127] op_sel_hi:[1,0]
v_pk_mul_f32 v[182:183], v[182:183], v[126:127] op_sel_hi:[1,0]
v_pk_mul_f32 v[184:185], v[184:185], v[126:127] op_sel_hi:[1,0]
v_pk_mul_f32 v[186:187], v[186:187], v[126:127] op_sel_hi:[1,0]
v_pk_mul_f32 v[188:189], v[188:189], v[126:127] op_sel_hi:[1,0]
v_pk_mul_f32 v[190:191], v[190:191], v[126:127] op_sel_hi:[1,0]
v_mfma_f32_16x16x32_bf16 v[80:83], a[168:171], a[56:59], v[80:83]
ds_read_b128 a[36:39], v93 offset:8768
v_add_f32 v100, v100, v127
v_mfma_f32_16x16x32_bf16 v[80:83], a[164:167], a[52:55], v[80:83]
s_xor_b32 s21, s23, 263168
ds_read_b128 a[40:43], v93 offset:8832
v_cvt_pk_bf16_f32 v140, v140, v141
v_mfma_f32_16x16x32_bf16 v[80:83], a[160:163], a[48:51], v[80:83]
s_add_u32 m0, s22, 84480
ds_read_b128 a[44:47], v93 offset:8896
v_cvt_pk_bf16_f32 v141, v142, v143
v_mfma_f32_16x16x32_bf16 v[84:87], a[112:115], a[48:51], v[60:63]
v_exp_f32 v72, v72
v_mfma_f32_16x16x32_bf16 v[84:87], a[116:119], a[52:55], v[84:87]
v_exp_f32 v73, v73
v_mfma_f32_16x16x32_bf16 v[84:87], a[120:123], a[56:59], v[84:87]
v_exp_f32 v74, v74
v_mfma_f32_16x16x32_bf16 v[84:87], a[124:127], a[60:63], v[84:87]
v_exp_f32 v75, v75
v_mfma_f32_16x16x32_bf16 v[68:71], a[140:143], a[60:63], v[60:63]
v_cvt_pk_bf16_f32 v42, v72, v73
v_cvt_pk_bf16_f32 v43, v74, v75
v_mfma_f32_16x16x32_bf16 v[68:71], a[136:139], a[56:59], v[68:71]
buffer_load_dwordx4 v97, s[12:15], s21 offen offset:0 nt lds
v_mfma_f32_16x16x32_bf16 v[68:71], a[132:135], a[52:55], v[68:71]
v_exp_f32 v76, v76
v_mfma_f32_16x16x32_bf16 v[68:71], a[128:131], a[48:51], v[68:71]
v_exp_f32 v77, v77
v_smfmac_f32_16x16x64_bf16 a[244:247], a[248:251], v[40:47], v92
v_cvt_pk_bf16_f32 v36, v76, v77
v_mfma_f32_16x16x32_bf16 v[192:195], a[208:211], v[44:47], v[192:195]
v_exp_f32 v78, v78
v_mfma_f32_16x16x32_bf16 v[192:195], a[176:179], v[40:43], v[192:195]
v_exp_f32 v79, v79
v_mfma_f32_16x16x32_bf16 v[196:199], a[180:183], v[40:43], v[196:199]
v_cvt_pk_bf16_f32 v37, v78, v79
v_cvt_pk_bf16_f32 v144, v144, v145
v_mfma_f32_16x16x32_bf16 v[196:199], a[212:215], v[44:47], v[196:199]
v_accvgpr_read_b32 v125, a244
v_accvgpr_read_b32 v124, a245
v_mfma_f32_16x16x32_bf16 v[200:203], a[216:219], v[44:47], v[200:203]
v_add_f32 v125, v125, v124
v_cvt_pk_bf16_f32 v145, v146, v147
v_mfma_f32_16x16x32_bf16 v[200:203], a[184:187], v[40:43], v[200:203]
v_rcp_f32 v124, v125
v_mfma_f32_16x16x32_bf16 v[204:207], a[188:191], v[40:43], v[204:207]
s_xor_b32 s21, s23, 267264
v_exp_f32 v80, v80
v_mfma_f32_16x16x32_bf16 v[204:207], a[220:223], v[44:47], v[204:207]
s_add_u32 m0, s22, 85536
v_exp_f32 v81, v81
v_mfma_f32_16x16x32_bf16 v[208:211], a[224:227], v[44:47], v[208:211]
v_exp_f32 v82, v82
v_mfma_f32_16x16x32_bf16 v[208:211], a[192:195], v[40:43], v[208:211]
buffer_load_dwordx4 v97, s[12:15], s21 offen offset:0 nt lds
v_mfma_f32_16x16x32_bf16 v[212:215], a[196:199], v[40:43], v[212:215]
v_exp_f32 v83, v83
v_mfma_f32_16x16x32_bf16 v[212:215], a[228:231], v[44:47], v[212:215]
v_exp_f32 v84, v84
v_mfma_f32_16x16x32_bf16 v[216:219], a[232:235], v[44:47], v[216:219]
v_exp_f32 v85, v85
v_mfma_f32_16x16x32_bf16 v[216:219], a[200:203], v[40:43], v[216:219]
s_waitcnt vmcnt(6)
s_barrier
v_mfma_f32_16x16x32_bf16 v[220:223], a[204:207], v[40:43], v[220:223]
v_exp_f32 v86, v86
v_mfma_f32_16x16x32_bf16 v[220:223], a[236:239], v[44:47], v[220:223]
v_exp_f32 v87, v87
v_mfma_f32_16x16x32_bf16 v[72:75], a[112:115], a[64:67], v[64:67]
v_exp_f32 v68, v68
v_mfma_f32_16x16x32_bf16 v[72:75], a[116:119], a[68:71], v[72:75]
v_exp_f32 v69, v69
v_mfma_f32_16x16x32_bf16 v[72:75], a[120:123], a[72:75], v[72:75]
v_exp_f32 v70, v70
v_mfma_f32_16x16x32_bf16 v[72:75], a[124:127], a[76:79], v[72:75]
v_exp_f32 v71, v71
v_mfma_f32_16x16x32_bf16 v[76:79], a[140:143], a[76:79], v[64:67]
v_pk_mul_f32 v[192:193], v[192:193], v[124:125] op_sel_hi:[1,0]
v_pk_mul_f32 v[194:195], v[194:195], v[124:125] op_sel_hi:[1,0]
v_pk_mul_f32 v[196:197], v[196:197], v[124:125] op_sel_hi:[1,0]
v_pk_mul_f32 v[198:199], v[198:199], v[124:125] op_sel_hi:[1,0]
v_pk_mul_f32 v[200:201], v[200:201], v[124:125] op_sel_hi:[1,0]
v_pk_mul_f32 v[202:203], v[202:203], v[124:125] op_sel_hi:[1,0]
v_pk_mul_f32 v[204:205], v[204:205], v[124:125] op_sel_hi:[1,0]
v_pk_mul_f32 v[206:207], v[206:207], v[124:125] op_sel_hi:[1,0]
v_pk_mul_f32 v[208:209], v[208:209], v[124:125] op_sel_hi:[1,0]
v_pk_mul_f32 v[210:211], v[210:211], v[124:125] op_sel_hi:[1,0]
v_pk_mul_f32 v[212:213], v[212:213], v[124:125] op_sel_hi:[1,0]
v_pk_mul_f32 v[214:215], v[214:215], v[124:125] op_sel_hi:[1,0]
v_pk_mul_f32 v[216:217], v[216:217], v[124:125] op_sel_hi:[1,0]
v_pk_mul_f32 v[218:219], v[218:219], v[124:125] op_sel_hi:[1,0]
v_pk_mul_f32 v[220:221], v[220:221], v[124:125] op_sel_hi:[1,0]
v_pk_mul_f32 v[222:223], v[222:223], v[124:125] op_sel_hi:[1,0]
v_mfma_f32_16x16x32_bf16 v[76:79], a[136:139], a[72:75], v[76:79]
v_cvt_pk_bf16_f32 v38, v80, v81
v_cvt_pk_bf16_f32 v39, v82, v83
v_mfma_f32_16x16x32_bf16 v[76:79], a[132:135], a[68:71], v[76:79]
v_cvt_pk_bf16_f32 v32, v84, v85
v_cvt_pk_bf16_f32 v33, v86, v87
v_cvt_pk_bf16_f32 v34, v68, v69
v_cvt_pk_bf16_f32 v35, v70, v71
v_mfma_f32_16x16x32_bf16 v[76:79], a[128:131], a[64:67], v[76:79]
s_xor_b32 s21, s23, 271360
ds_read_b128 a[112:115], v88 offset:16896
v_cvt_pk_bf16_f32 v148, v148, v149
v_smfmac_f32_16x16x64_bf16 a[244:247], a[252:255], v[32:39], v92
s_add_u32 m0, s22, 86592
ds_read_b128 a[116:119], v88 offset:16960
v_mfma_f32_16x16x32_bf16 v[224:227], a[208:211], v[36:39], v[224:227]
ds_read_b128 a[120:123], v88 offset:17024
v_cvt_pk_bf16_f32 v149, v150, v151
v_mfma_f32_16x16x32_bf16 v[224:227], a[176:179], v[32:35], v[224:227]
buffer_load_dwordx4 v97, s[12:15], s21 offen offset:0 nt lds
v_mfma_f32_16x16x32_bf16 v[228:231], a[180:183], v[32:35], v[228:231]
ds_read_b128 a[124:127], v88 offset:17088
v_cvt_pk_bf16_f32 v152, v152, v153
v_mfma_f32_16x16x32_bf16 v[228:231], a[212:215], v[36:39], v[228:231]
ds_write_b64 v94, v[128:129] offset:0
v_mfma_f32_16x16x32_bf16 v[232:235], a[216:219], v[36:39], v[232:235]
ds_write_b64 v94, v[132:133] offset:32
v_mfma_f32_16x16x32_bf16 v[232:235], a[184:187], v[32:35], v[232:235]
ds_write_b64 v94, v[136:137] offset:64
v_mfma_f32_16x16x32_bf16 v[236:239], a[188:191], v[32:35], v[236:239]
v_accvgpr_read_b32 v127, a246
v_accvgpr_read_b32 v126, a247
v_mfma_f32_16x16x32_bf16 v[236:239], a[220:223], v[36:39], v[236:239]
ds_read_b128 a[144:147], v89 offset:16896
v_add_f32 v127, v127, v126
v_mfma_f32_16x16x32_bf16 v[240:243], a[224:227], v[36:39], v[240:243]
v_rcp_f32 v126, v127
v_mfma_f32_16x16x32_bf16 v[240:243], a[192:195], v[32:35], v[240:243]
ds_write_b64 v94, v[140:141] offset:96
v_mfma_f32_16x16x32_bf16 v[244:247], a[196:199], v[32:35], v[244:247]
ds_write_b64 v94, v[144:145] offset:128
v_mfma_f32_16x16x32_bf16 v[244:247], a[228:231], v[36:39], v[244:247]
ds_write_b64 v94, v[148:149] offset:160
v_mfma_f32_16x16x32_bf16 v[248:251], a[232:235], v[36:39], v[248:251]
ds_read_b128 a[148:151], v89 offset:16960
v_cvt_pk_bf16_f32 v153, v154, v155
v_mfma_f32_16x16x32_bf16 v[248:251], a[200:203], v[32:35], v[248:251]
ds_write_b64 v94, v[152:153] offset:192
v_mfma_f32_16x16x32_bf16 v[252:255], a[204:207], v[32:35], v[252:255]
s_waitcnt lgkmcnt(6)
ds_read_b128 a[152:155], v89 offset:17024
v_cvt_pk_bf16_f32 v156, v156, v157
v_mfma_f32_16x16x32_bf16 v[252:255], a[236:239], v[36:39], v[252:255]
s_xor_b32 s21, s23, 275456
ds_read_b128 a[156:159], v89 offset:17088
v_cvt_pk_bf16_f32 v157, v158, v159
v_mfma_f32_16x16x32_bf16 v[48:51], a[112:115], a[0:3], 0
s_add_u32 m0, s22, 87648
ds_read_b128 a[172:175], v89 offset:17600
v_cvt_pk_bf16_f32 v160, v160, v161
v_mfma_f32_16x16x32_bf16 v[48:51], a[116:119], a[4:7], v[48:51]
ds_write_b64 v94, v[156:157] offset:224
v_mfma_f32_16x16x32_bf16 v[48:51], a[120:123], a[8:11], v[48:51]
buffer_load_dwordx4 v97, s[12:15], s21 offen offset:0 nt lds
v_mfma_f32_16x16x32_bf16 v[48:51], a[124:127], a[12:15], v[48:51]
ds_read_b128 a[168:171], v89 offset:17536
v_cvt_pk_bf16_f32 v161, v162, v163
v_mfma_f32_16x16x32_bf16 v[52:55], a[112:115], a[16:19], 0
v_pk_mul_f32 v[224:225], v[224:225], v[126:127] op_sel_hi:[1,0]
v_pk_mul_f32 v[226:227], v[226:227], v[126:127] op_sel_hi:[1,0]
v_pk_mul_f32 v[228:229], v[228:229], v[126:127] op_sel_hi:[1,0]
v_pk_mul_f32 v[230:231], v[230:231], v[126:127] op_sel_hi:[1,0]
v_pk_mul_f32 v[232:233], v[232:233], v[126:127] op_sel_hi:[1,0]
v_pk_mul_f32 v[234:235], v[234:235], v[126:127] op_sel_hi:[1,0]
v_pk_mul_f32 v[236:237], v[236:237], v[126:127] op_sel_hi:[1,0]
v_pk_mul_f32 v[238:239], v[238:239], v[126:127] op_sel_hi:[1,0]
v_pk_mul_f32 v[240:241], v[240:241], v[126:127] op_sel_hi:[1,0]
v_pk_mul_f32 v[242:243], v[242:243], v[126:127] op_sel_hi:[1,0]
v_pk_mul_f32 v[244:245], v[244:245], v[126:127] op_sel_hi:[1,0]
v_pk_mul_f32 v[246:247], v[246:247], v[126:127] op_sel_hi:[1,0]
v_pk_mul_f32 v[248:249], v[248:249], v[126:127] op_sel_hi:[1,0]
v_pk_mul_f32 v[250:251], v[250:251], v[126:127] op_sel_hi:[1,0]
v_pk_mul_f32 v[252:253], v[252:253], v[126:127] op_sel_hi:[1,0]
v_pk_mul_f32 v[254:255], v[254:255], v[126:127] op_sel_hi:[1,0]
v_mfma_f32_16x16x32_bf16 v[52:55], a[116:119], a[20:23], v[52:55]
ds_read_b128 a[164:167], v89 offset:17472
v_cvt_pk_bf16_f32 v164, v164, v165
v_mfma_f32_16x16x32_bf16 v[52:55], a[120:123], a[24:27], v[52:55]
ds_read_b128 a[160:163], v89 offset:17408
v_cvt_pk_bf16_f32 v165, v166, v167
v_mfma_f32_16x16x32_bf16 v[52:55], a[124:127], a[28:31], v[52:55]
v_max3_f32 v48, v48, v49, v50
v_max_f32 v48, v48, v51
v_mfma_f32_16x16x32_bf16 v[56:59], a[112:115], a[32:35], 0
ds_read_b128 a[140:143], v88 offset:17600
v_mov_b32 v49, v48
v_mfma_f32_16x16x32_bf16 v[56:59], a[116:119], a[36:39], v[56:59]
s_nop 0
v_permlane16_swap_b32 v48, v49
v_mfma_f32_16x16x32_bf16 v[56:59], a[120:123], a[40:43], v[56:59]
v_max_f32 v48, v48, v49
v_mov_b32 v49, v48
v_mfma_f32_16x16x32_bf16 v[56:59], a[124:127], a[44:47], v[56:59]
s_nop 0
v_permlane32_swap_b32 v48, v49
v_mfma_f32_16x16x32_bf16 v[60:63], a[112:115], v[0:3], 0
v_min_f32_e64 v50, -v48, -v49
v_min_f32_e64 v51, -v48, -v49
v_mfma_f32_16x16x32_bf16 v[60:63], a[116:119], v[4:7], v[60:63]
v_mov_b32 v48, v50
v_mov_b32 v49, v50
v_mfma_f32_16x16x32_bf16 v[60:63], a[120:123], v[8:11], v[60:63]
ds_read_b128 a[136:139], v88 offset:17536
v_max3_f32 v52, v52, v53, v54
v_mfma_f32_16x16x32_bf16 v[60:63], a[124:127], v[12:15], v[60:63]
ds_read_b128 a[132:135], v88 offset:17472
v_max_f32 v52, v52, v55
v_mfma_f32_16x16x32_bf16 v[64:67], a[112:115], v[16:19], 0
ds_read_b128 a[128:131], v88 offset:17408
v_mov_b32 v53, v52
v_mfma_f32_16x16x32_bf16 v[64:67], a[116:119], v[20:23], v[64:67]
s_xor_b32 s21, s23, 264192
v_exp_f32 v72, v72
v_mfma_f32_16x16x32_bf16 v[64:67], a[120:123], v[24:27], v[64:67]
s_add_u32 m0, s22, 0
v_exp_f32 v73, v73
v_mfma_f32_16x16x32_bf16 v[64:67], a[124:127], v[28:31], v[64:67]
s_waitcnt lgkmcnt(3)
v_exp_f32 v74, v74
v_mfma_f32_16x16x32_bf16 v[80:83], a[144:147], a[0:3], v[48:51]
buffer_load_dwordx4 v97, s[8:11], s21 offen offset:0 nt lds
v_mfma_f32_16x16x32_bf16 v[80:83], a[148:151], a[4:7], v[80:83]
v_exp_f32 v75, v75
v_mfma_f32_16x16x32_bf16 v[80:83], a[152:155], a[8:11], v[80:83]
v_cvt_pk_bf16_f32 v40, v72, v73
v_cvt_pk_bf16_f32 v41, v74, v75
v_mfma_f32_16x16x32_bf16 v[80:83], a[156:159], a[12:15], v[80:83]
v_exp_f32 v76, v76
v_mfma_f32_16x16x32_bf16 v[84:87], a[172:175], a[12:15], v[48:51]
v_exp_f32 v77, v77
v_mfma_f32_16x16x32_bf16 v[84:87], a[168:171], a[8:11], v[84:87]
v_exp_f32 v78, v78
v_mfma_f32_16x16x32_bf16 v[84:87], a[164:167], a[4:7], v[84:87]
v_exp_f32 v79, v79
v_mfma_f32_16x16x32_bf16 v[84:87], a[160:163], a[0:3], v[84:87]
v_cvt_pk_bf16_f32 v42, v76, v77
v_cvt_pk_bf16_f32 v43, v78, v79
v_mfma_f32_16x16x32_bf16 v[68:71], a[112:115], a[0:3], v[48:51]
v_permlane16_swap_b32 v52, v53
v_mfma_f32_16x16x32_bf16 v[68:71], a[116:119], a[4:7], v[68:71]
v_max_f32 v52, v52, v53
v_mov_b32 v53, v52
v_mfma_f32_16x16x32_bf16 v[68:71], a[120:123], a[8:11], v[68:71]
s_nop 0
v_permlane32_swap_b32 v52, v53
v_mfma_f32_16x16x32_bf16 v[68:71], a[124:127], a[12:15], v[68:71]
v_min_f32_e64 v54, -v52, -v53
v_min_f32_e64 v55, -v52, -v53
v_mfma_f32_16x16x32_bf16 v[72:75], a[140:143], a[12:15], v[48:51]
s_waitcnt lgkmcnt(0)
v_mov_b32 v52, v54
v_mov_b32 v53, v54
v_mfma_f32_16x16x32_bf16 v[72:75], a[136:139], a[8:11], v[72:75]
v_exp_f32 v80, v80
v_mfma_f32_16x16x32_bf16 v[72:75], a[132:135], a[4:7], v[72:75]
s_xor_b32 s21, s23, 268288
v_exp_f32 v81, v81
v_mfma_f32_16x16x32_bf16 v[72:75], a[128:131], a[0:3], v[72:75]
s_add_u32 m0, s22, 1056
v_exp_f32 v82, v82
v_mfma_f32_16x16x32_bf16 v[104:107], a[248:251], v[40:43], v[104:107]
v_exp_f32 v83, v83
v_mfma_f32_16x16x32_bf16 a[80:83], a[176:179], v[40:43], a[80:83]
buffer_load_dwordx4 v97, s[8:11], s21 offen offset:0 nt lds
v_mfma_f32_16x16x32_bf16 a[84:87], a[180:183], v[40:43], a[84:87]
v_cvt_pk_bf16_f32 v36, v80, v81
v_cvt_pk_bf16_f32 v37, v82, v83
v_mfma_f32_16x16x32_bf16 a[88:91], a[184:187], v[40:43], a[88:91]
v_exp_f32 v84, v84
v_mfma_f32_16x16x32_bf16 a[92:95], a[188:191], v[40:43], a[92:95]
v_exp_f32 v85, v85
v_mfma_f32_16x16x32_bf16 a[96:99], a[192:195], v[40:43], a[96:99]
v_exp_f32 v86, v86
v_mfma_f32_16x16x32_bf16 a[100:103], a[196:199], v[40:43], a[100:103]
v_exp_f32 v87, v87
v_mfma_f32_16x16x32_bf16 a[104:107], a[200:203], v[40:43], a[104:107]
v_cvt_pk_bf16_f32 v38, v84, v85
v_cvt_pk_bf16_f32 v39, v86, v87
v_mfma_f32_16x16x32_bf16 a[108:111], a[204:207], v[40:43], a[108:111]
ds_read_b128 v[112:115], v95 offset:0
v_max3_f32 v56, v56, v57, v58
v_mfma_f32_16x16x32_bf16 v[76:79], a[144:147], a[16:19], v[52:55]
ds_read_b64_tr_b16 a[208:209], v91 offset:16896
ds_read_b64_tr_b16 a[210:211], v91 offset:17408
v_mfma_f32_16x16x32_bf16 v[76:79], a[148:151], a[20:23], v[76:79]
v_exp_f32 v68, v68
v_mfma_f32_16x16x32_bf16 v[76:79], a[152:155], a[24:27], v[76:79]
v_exp_f32 v69, v69
v_mfma_f32_16x16x32_bf16 v[76:79], a[156:159], a[28:31], v[76:79]
v_exp_f32 v70, v70
v_mfma_f32_16x16x32_bf16 v[80:83], a[172:175], a[28:31], v[52:55]
v_exp_f32 v71, v71
v_mfma_f32_16x16x32_bf16 v[80:83], a[168:171], a[24:27], v[80:83]
s_add_u32 s33, s31, 0
ds_read_b64_tr_b16 a[176:177], v90 offset:16896
ds_read_b64_tr_b16 a[178:179], v90 offset:17408
v_mfma_f32_16x16x32_bf16 v[80:83], a[164:167], a[20:23], v[80:83]
v_cvt_pk_bf16_f32 v32, v68, v69
v_cvt_pk_bf16_f32 v33, v70, v71
v_mfma_f32_16x16x32_bf16 v[80:83], a[160:163], a[16:19], v[80:83]
ds_read_b64_tr_b16 a[180:181], v90 offset:16928
ds_read_b64_tr_b16 a[182:183], v90 offset:17440
v_mfma_f32_16x16x32_bf16 v[84:87], a[112:115], a[16:19], v[52:55]
ds_read_b64_tr_b16 a[212:213], v91 offset:16928
v_max_f32 v56, v56, v59
v_mfma_f32_16x16x32_bf16 v[84:87], a[116:119], a[20:23], v[84:87]
ds_read_b64_tr_b16 a[214:215], v91 offset:17440
ds_read_b64_tr_b16 a[216:217], v91 offset:16960
v_mfma_f32_16x16x32_bf16 v[84:87], a[120:123], a[24:27], v[84:87]
ds_read_b64_tr_b16 a[218:219], v91 offset:17472
v_mov_b32 v57, v56
v_mfma_f32_16x16x32_bf16 v[84:87], a[124:127], a[28:31], v[84:87]
v_exp_f32 v72, v72
v_mfma_f32_16x16x32_bf16 v[68:71], a[140:143], a[28:31], v[52:55]
v_exp_f32 v73, v73
v_mfma_f32_16x16x32_bf16 v[68:71], a[136:139], a[24:27], v[68:71]
v_exp_f32 v74, v74
v_mfma_f32_16x16x32_bf16 v[68:71], a[132:135], a[20:23], v[68:71]
ds_read_b64_tr_b16 a[184:185], v90 offset:16960
ds_read_b64_tr_b16 a[186:187], v90 offset:17472
v_exp_f32 v75, v75
v_mfma_f32_16x16x32_bf16 v[68:71], a[128:131], a[16:19], v[68:71]
s_waitcnt lgkmcnt(6)
buffer_store_dwordx4 v[112:115], v96, s[16:19], s33 offen offset:0 nt
ds_read_b64_tr_b16 a[188:189], v90 offset:16992
ds_read_b64_tr_b16 a[190:191], v90 offset:17504
v_cvt_pk_bf16_f32 v34, v72, v73
v_cvt_pk_bf16_f32 v35, v74, v75
v_mfma_f32_16x16x32_bf16 v[128:131], a[208:211], v[36:39], 0
ds_read_b64_tr_b16 a[220:221], v91 offset:16992
ds_read_b64_tr_b16 a[222:223], v91 offset:17504
v_mfma_f32_16x16x32_bf16 v[128:131], a[176:179], v[32:35], v[128:131]
ds_read_b64_tr_b16 a[224:225], v91 offset:17024
ds_read_b64_tr_b16 a[226:227], v91 offset:17536
v_mfma_f32_16x16x32_bf16 v[132:135], a[180:183], v[32:35], 0
s_waitcnt lgkmcnt(8)
ds_read_b64_tr_b16 a[192:193], v90 offset:17024
ds_read_b64_tr_b16 a[194:195], v90 offset:17536
v_mfma_f32_16x16x32_bf16 v[132:135], a[212:215], v[36:39], v[132:135]
ds_read_b64_tr_b16 a[196:197], v90 offset:17056
ds_read_b64_tr_b16 a[198:199], v90 offset:17568
v_mfma_f32_16x16x32_bf16 v[136:139], a[216:219], v[36:39], 0
s_waitcnt lgkmcnt(10)
ds_read_b64_tr_b16 a[228:229], v91 offset:17056
ds_read_b64_tr_b16 a[230:231], v91 offset:17568
v_mfma_f32_16x16x32_bf16 v[136:139], a[184:187], v[32:35], v[136:139]
s_waitcnt lgkmcnt(10)
ds_read_b64_tr_b16 a[232:233], v91 offset:17088
ds_read_b64_tr_b16 a[234:235], v91 offset:17600
v_mfma_f32_16x16x32_bf16 v[140:143], a[188:191], v[32:35], 0
s_waitcnt lgkmcnt(8)
ds_read_b64_tr_b16 a[200:201], v90 offset:17088
ds_read_b64_tr_b16 a[202:203], v90 offset:17600
v_mfma_f32_16x16x32_bf16 v[140:143], a[220:223], v[36:39], v[140:143]
s_xor_b32 s21, s23, 272384
ds_read_b64_tr_b16 a[204:205], v90 offset:17120
ds_read_b64_tr_b16 a[206:207], v90 offset:17632
v_mfma_f32_16x16x32_bf16 v[144:147], a[224:227], v[36:39], 0
s_add_u32 m0, s22, 2112
ds_read_b64_tr_b16 a[236:237], v91 offset:17120
ds_read_b64_tr_b16 a[238:239], v91 offset:17632
s_waitcnt lgkmcnt(12)
v_mfma_f32_16x16x32_bf16 v[144:147], a[192:195], v[32:35], v[144:147]
s_waitcnt lgkmcnt(10)
v_permlane16_swap_b32 v56, v57
v_mfma_f32_16x16x32_bf16 v[148:151], a[196:199], v[32:35], 0
s_waitcnt lgkmcnt(8)
v_max_f32 v56, v56, v57
v_mov_b32 v57, v56
v_mfma_f32_16x16x32_bf16 v[148:151], a[228:231], v[36:39], v[148:151]
s_waitcnt lgkmcnt(6)
v_permlane32_swap_b32 v56, v57
v_mfma_f32_16x16x32_bf16 v[152:155], a[232:235], v[36:39], 0
s_waitcnt lgkmcnt(4)
v_accvgpr_write_b32 a240, 0
v_accvgpr_write_b32 a241, 0
v_mfma_f32_16x16x32_bf16 v[152:155], a[200:203], v[32:35], v[152:155]
s_waitcnt lgkmcnt(2)
v_accvgpr_write_b32 a242, 0
v_accvgpr_write_b32 a243, 0
v_mfma_f32_16x16x32_bf16 v[156:159], a[204:207], v[32:35], 0
s_waitcnt lgkmcnt(0)
v_min_f32_e64 v58, -v56, -v57
v_min_f32_e64 v59, -v56, -v57
v_mfma_f32_16x16x32_bf16 v[156:159], a[236:239], v[36:39], v[156:159]
v_mov_b32 v56, v58
v_mov_b32 v57, v58
v_smfmac_f32_16x16x64_bf16 a[240:243], a[248:251], v[32:39], v92
buffer_load_dwordx4 v97, s[8:11], s21 offen offset:0 nt lds
v_mfma_f32_16x16x32_bf16 v[72:75], a[144:147], a[32:35], v[56:59]
v_exp_f32 v76, v76
v_mfma_f32_16x16x32_bf16 v[72:75], a[148:151], a[36:39], v[72:75]
v_exp_f32 v77, v77
v_mfma_f32_16x16x32_bf16 v[72:75], a[152:155], a[40:43], v[72:75]
v_exp_f32 v78, v78
v_exp_f32 v79, v79
v_mfma_f32_16x16x32_bf16 v[72:75], a[156:159], a[44:47], v[72:75]
v_cvt_pk_bf16_f32 v44, v76, v77
v_cvt_pk_bf16_f32 v45, v78, v79
v_mfma_f32_16x16x32_bf16 v[76:79], a[172:175], a[44:47], v[56:59]
v_exp_f32 v80, v80
v_mfma_f32_16x16x32_bf16 v[76:79], a[168:171], a[40:43], v[76:79]
v_exp_f32 v81, v81
v_mfma_f32_16x16x32_bf16 v[76:79], a[164:167], a[36:39], v[76:79]
v_exp_f32 v82, v82
v_exp_f32 v83, v83
v_mfma_f32_16x16x32_bf16 v[76:79], a[160:163], a[32:35], v[76:79]
s_xor_b32 s21, s23, 276480
v_cvt_pk_bf16_f32 v46, v80, v81
v_cvt_pk_bf16_f32 v47, v82, v83
v_mfma_f32_16x16x32_bf16 v[80:83], a[112:115], a[32:35], v[56:59]
s_add_u32 m0, s22, 3168
v_exp_f32 v84, v84
v_mfma_f32_16x16x32_bf16 v[80:83], a[116:119], a[36:39], v[80:83]
v_exp_f32 v85, v85
v_mfma_f32_16x16x32_bf16 v[80:83], a[120:123], a[40:43], v[80:83]
v_exp_f32 v86, v86
v_exp_f32 v87, v87
v_mfma_f32_16x16x32_bf16 v[80:83], a[124:127], a[44:47], v[80:83]
v_cvt_pk_bf16_f32 v40, v84, v85
v_cvt_pk_bf16_f32 v41, v86, v87
v_mfma_f32_16x16x32_bf16 v[84:87], a[140:143], a[44:47], v[56:59]
v_exp_f32 v68, v68
v_mfma_f32_16x16x32_bf16 v[84:87], a[136:139], a[40:43], v[84:87]
v_exp_f32 v69, v69
v_mfma_f32_16x16x32_bf16 v[84:87], a[132:135], a[36:39], v[84:87]
v_exp_f32 v70, v70
v_exp_f32 v71, v71
v_mfma_f32_16x16x32_bf16 v[84:87], a[128:131], a[32:35], v[84:87]
ds_write_b64 v94, v[160:161] offset:4352
v_cvt_pk_bf16_f32 v42, v68, v69
v_cvt_pk_bf16_f32 v43, v70, v71
v_mfma_f32_16x16x32_bf16 v[160:163], a[208:211], v[44:47], 0
buffer_load_dwordx4 v97, s[8:11], s21 offen offset:0 nt lds
v_mfma_f32_16x16x32_bf16 v[160:163], a[176:179], v[40:43], v[160:163]
ds_write_b64 v94, v[164:165] offset:4384
v_mfma_f32_16x16x32_bf16 v[164:167], a[180:183], v[40:43], 0
v_cvt_pk_bf16_f32 v168, v168, v169
v_cvt_pk_bf16_f32 v169, v170, v171
v_mfma_f32_16x16x32_bf16 v[164:167], a[212:215], v[44:47], v[164:167]
ds_write_b64 v94, v[168:169] offset:4416
v_mfma_f32_16x16x32_bf16 v[168:171], a[216:219], v[44:47], 0
v_cvt_pk_bf16_f32 v172, v172, v173
v_cvt_pk_bf16_f32 v173, v174, v175
v_mfma_f32_16x16x32_bf16 v[168:171], a[184:187], v[40:43], v[168:171]
ds_write_b64 v94, v[172:173] offset:4448
v_mfma_f32_16x16x32_bf16 v[172:175], a[188:191], v[40:43], 0
v_cvt_pk_bf16_f32 v176, v176, v177
v_cvt_pk_bf16_f32 v177, v178, v179
v_mfma_f32_16x16x32_bf16 v[172:175], a[220:223], v[44:47], v[172:175]
ds_write_b64 v94, v[176:177] offset:4480
v_mfma_f32_16x16x32_bf16 v[176:179], a[224:227], v[44:47], 0
s_xor_b32 s21, s23, 264192
v_cvt_pk_bf16_f32 v180, v180, v181
v_cvt_pk_bf16_f32 v181, v182, v183
v_mfma_f32_16x16x32_bf16 v[176:179], a[192:195], v[40:43], v[176:179]
ds_write_b64 v94, v[180:181] offset:4512
v_mfma_f32_16x16x32_bf16 v[180:183], a[196:199], v[40:43], 0
s_add_u32 m0, s22, 50688
v_cvt_pk_bf16_f32 v184, v184, v185
v_cvt_pk_bf16_f32 v185, v186, v187
v_mfma_f32_16x16x32_bf16 v[180:183], a[228:231], v[44:47], v[180:183]
ds_write_b64 v94, v[184:185] offset:4544
v_max3_f32 v60, v60, v61, v62
v_max_f32 v60, v60, v63
v_mov_b32 v61, v60
v_mfma_f32_16x16x32_bf16 v[184:187], a[232:235], v[44:47], 0
v_cvt_pk_bf16_f32 v188, v188, v189
v_cvt_pk_bf16_f32 v189, v190, v191
v_permlane16_swap_b32 v60, v61
v_mfma_f32_16x16x32_bf16 v[184:187], a[200:203], v[40:43], v[184:187]
ds_write_b64 v94, v[188:189] offset:4576
v_max_f32 v60, v60, v61
v_mov_b32 v61, v60
v_mfma_f32_16x16x32_bf16 v[188:191], a[204:207], v[40:43], 0
s_nop 0
v_permlane32_swap_b32 v60, v61
v_mfma_f32_16x16x32_bf16 v[188:191], a[236:239], v[44:47], v[188:191]
v_min_f32_e64 v62, -v60, -v61
v_min_f32_e64 v63, -v60, -v61
v_mov_b32 v60, v62
v_mov_b32 v61, v62
v_smfmac_f32_16x16x64_bf16 a[240:243], a[252:255], v[40:47], v92
v_cvt_pk_bf16_f32 v192, v192, v193
v_mfma_f32_16x16x32_bf16 v[68:71], a[144:147], v[0:3], v[60:63]
buffer_load_dwordx4 v97, s[12:15], s21 offen offset:0 nt lds
v_mfma_f32_16x16x32_bf16 v[68:71], a[148:151], v[4:7], v[68:71]
v_exp_f32 v72, v72
v_mfma_f32_16x16x32_bf16 v[68:71], a[152:155], v[8:11], v[68:71]
v_exp_f32 v73, v73
v_exp_f32 v74, v74
v_exp_f32 v75, v75
v_mfma_f32_16x16x32_bf16 v[68:71], a[156:159], v[12:15], v[68:71]
v_cvt_pk_bf16_f32 v36, v72, v73
v_cvt_pk_bf16_f32 v37, v74, v75
v_mfma_f32_16x16x32_bf16 v[72:75], a[172:175], v[12:15], v[60:63]
v_exp_f32 v76, v76
v_mfma_f32_16x16x32_bf16 v[72:75], a[168:171], v[8:11], v[72:75]
v_exp_f32 v77, v77
v_mfma_f32_16x16x32_bf16 v[72:75], a[164:167], v[4:7], v[72:75]
v_exp_f32 v78, v78
v_exp_f32 v79, v79
v_mfma_f32_16x16x32_bf16 v[72:75], a[160:163], v[0:3], v[72:75]
s_xor_b32 s21, s23, 268288
v_cvt_pk_bf16_f32 v38, v76, v77
v_cvt_pk_bf16_f32 v39, v78, v79
v_mfma_f32_16x16x32_bf16 v[76:79], a[112:115], v[0:3], v[60:63]
s_add_u32 m0, s22, 51744
v_exp_f32 v80, v80
v_mfma_f32_16x16x32_bf16 v[76:79], a[116:119], v[4:7], v[76:79]
v_exp_f32 v81, v81
v_mfma_f32_16x16x32_bf16 v[76:79], a[120:123], v[8:11], v[76:79]
v_exp_f32 v82, v82
v_exp_f32 v83, v83
v_mfma_f32_16x16x32_bf16 v[76:79], a[124:127], v[12:15], v[76:79]
v_cvt_pk_bf16_f32 v32, v80, v81
v_cvt_pk_bf16_f32 v33, v82, v83
v_mfma_f32_16x16x32_bf16 v[80:83], a[140:143], v[12:15], v[60:63]
v_cvt_pk_bf16_f32 v193, v194, v195
v_cvt_pk_bf16_f32 v196, v196, v197
v_mfma_f32_16x16x32_bf16 v[80:83], a[136:139], v[8:11], v[80:83]
v_exp_f32 v84, v84
v_mfma_f32_16x16x32_bf16 v[80:83], a[132:135], v[4:7], v[80:83]
v_exp_f32 v85, v85
v_exp_f32 v86, v86
v_exp_f32 v87, v87
v_mfma_f32_16x16x32_bf16 v[80:83], a[128:131], v[0:3], v[80:83]
ds_write_b64 v94, v[192:193] offset:8704
v_cvt_pk_bf16_f32 v34, v84, v85
v_cvt_pk_bf16_f32 v35, v86, v87
v_mfma_f32_16x16x32_bf16 v[192:195], a[208:211], v[36:39], 0
buffer_load_dwordx4 v97, s[12:15], s21 offen offset:0 nt lds
v_cvt_pk_bf16_f32 v197, v198, v199
v_mfma_f32_16x16x32_bf16 v[192:195], a[176:179], v[32:35], v[192:195]
ds_write_b64 v94, v[196:197] offset:8736
v_mfma_f32_16x16x32_bf16 v[196:199], a[180:183], v[32:35], 0
v_cvt_pk_bf16_f32 v200, v200, v201
v_cvt_pk_bf16_f32 v201, v202, v203
v_mfma_f32_16x16x32_bf16 v[196:199], a[212:215], v[36:39], v[196:199]
ds_write_b64 v94, v[200:201] offset:8768
v_mfma_f32_16x16x32_bf16 v[200:203], a[216:219], v[36:39], 0
v_cvt_pk_bf16_f32 v204, v204, v205
v_cvt_pk_bf16_f32 v205, v206, v207
v_mfma_f32_16x16x32_bf16 v[200:203], a[184:187], v[32:35], v[200:203]
ds_write_b64 v94, v[204:205] offset:8800
v_mfma_f32_16x16x32_bf16 v[204:207], a[188:191], v[32:35], 0
v_cvt_pk_bf16_f32 v208, v208, v209
v_cvt_pk_bf16_f32 v209, v210, v211
v_mfma_f32_16x16x32_bf16 v[204:207], a[220:223], v[36:39], v[204:207]
ds_write_b64 v94, v[208:209] offset:8832
v_mfma_f32_16x16x32_bf16 v[208:211], a[224:227], v[36:39], 0
s_xor_b32 s21, s23, 272384
v_cvt_pk_bf16_f32 v212, v212, v213
v_cvt_pk_bf16_f32 v213, v214, v215
v_mfma_f32_16x16x32_bf16 v[208:211], a[192:195], v[32:35], v[208:211]
ds_write_b64 v94, v[212:213] offset:8864
v_mfma_f32_16x16x32_bf16 v[212:215], a[196:199], v[32:35], 0
s_add_u32 m0, s22, 52800
v_cvt_pk_bf16_f32 v216, v216, v217
v_cvt_pk_bf16_f32 v217, v218, v219
v_mfma_f32_16x16x32_bf16 v[212:215], a[228:231], v[36:39], v[212:215]
ds_write_b64 v94, v[216:217] offset:8896
v_max3_f32 v64, v64, v65, v66
v_max_f32 v64, v64, v67
v_mov_b32 v65, v64
v_mfma_f32_16x16x32_bf16 v[216:219], a[232:235], v[36:39], 0
v_cvt_pk_bf16_f32 v220, v220, v221
v_cvt_pk_bf16_f32 v221, v222, v223
v_permlane16_swap_b32 v64, v65
v_mfma_f32_16x16x32_bf16 v[216:219], a[200:203], v[32:35], v[216:219]
ds_write_b64 v94, v[220:221] offset:8928
v_max_f32 v64, v64, v65
v_mov_b32 v65, v64
v_mfma_f32_16x16x32_bf16 v[220:223], a[204:207], v[32:35], 0
s_nop 0
v_permlane32_swap_b32 v64, v65
v_accvgpr_write_b32 a244, 0
v_accvgpr_write_b32 a245, 0
v_accvgpr_write_b32 a246, 0
v_accvgpr_write_b32 a247, 0
v_mfma_f32_16x16x32_bf16 v[220:223], a[236:239], v[36:39], v[220:223]
v_min_f32_e64 v66, -v64, -v65
v_min_f32_e64 v67, -v64, -v65
v_mov_b32 v64, v66
v_mov_b32 v65, v66
v_smfmac_f32_16x16x64_bf16 a[244:247], a[248:251], v[32:39], v92
s_waitcnt vmcnt(7)
s_barrier
v_mfma_f32_16x16x32_bf16 v[84:87], a[112:115], v[16:19], v[64:67]
buffer_load_dwordx4 v97, s[12:15], s21 offen offset:0 nt lds
v_mfma_f32_16x16x32_bf16 v[84:87], a[116:119], v[20:23], v[84:87]
v_exp_f32 v68, v68
v_mfma_f32_16x16x32_bf16 v[84:87], a[120:123], v[24:27], v[84:87]
v_exp_f32 v69, v69
v_exp_f32 v70, v70
v_exp_f32 v71, v71
v_mfma_f32_16x16x32_bf16 v[84:87], a[124:127], v[28:31], v[84:87]
v_cvt_pk_bf16_f32 v44, v68, v69
v_cvt_pk_bf16_f32 v45, v70, v71
v_mfma_f32_16x16x32_bf16 v[68:71], a[140:143], v[28:31], v[64:67]
v_exp_f32 v72, v72
v_mfma_f32_16x16x32_bf16 v[68:71], a[136:139], v[24:27], v[68:71]
v_exp_f32 v73, v73
v_exp_f32 v74, v74
v_exp_f32 v75, v75
v_mfma_f32_16x16x32_bf16 v[68:71], a[132:135], v[20:23], v[68:71]
v_cvt_pk_bf16_f32 v224, v224, v225
v_cvt_pk_bf16_f32 v225, v226, v227
v_cvt_pk_bf16_f32 v46, v72, v73
v_cvt_pk_bf16_f32 v47, v74, v75
v_exp_f32 v76, v76
v_exp_f32 v77, v77
v_exp_f32 v78, v78
v_exp_f32 v79, v79
v_exp_f32 v80, v80
v_exp_f32 v81, v81
v_exp_f32 v82, v82
v_exp_f32 v83, v83
v_mfma_f32_16x16x32_bf16 v[68:71], a[128:131], v[16:19], v[68:71]
ds_read_b128 v[116:119], v95 offset:1088
ds_read_b128 v[120:123], v95 offset:2176
ds_read_b128 v[108:111], v95 offset:3264
ds_write_b64 v94, v[224:225] offset:0
v_cvt_pk_bf16_f32 v40, v76, v77
v_cvt_pk_bf16_f32 v41, v78, v79
v_cvt_pk_bf16_f32 v42, v80, v81
v_cvt_pk_bf16_f32 v43, v82, v83
v_mfma_f32_16x16x32_bf16 v[224:227], a[208:211], v[44:47], 0
s_xor_b32 s21, s23, 276480
v_cvt_pk_bf16_f32 v228, v228, v229
v_cvt_pk_bf16_f32 v229, v230, v231
v_mfma_f32_16x16x32_bf16 v[224:227], a[176:179], v[40:43], v[224:227]
ds_write_b64 v94, v[228:229] offset:32
v_mfma_f32_16x16x32_bf16 v[228:231], a[180:183], v[40:43], 0
s_add_u32 m0, s22, 53856
v_cvt_pk_bf16_f32 v232, v232, v233
v_cvt_pk_bf16_f32 v233, v234, v235
v_mfma_f32_16x16x32_bf16 v[228:231], a[212:215], v[44:47], v[228:231]
ds_write_b64 v94, v[232:233] offset:64
v_mfma_f32_16x16x32_bf16 v[232:235], a[216:219], v[44:47], 0
v_cvt_pk_bf16_f32 v236, v236, v237
v_cvt_pk_bf16_f32 v237, v238, v239
v_mfma_f32_16x16x32_bf16 v[232:235], a[184:187], v[40:43], v[232:235]
ds_write_b64 v94, v[236:237] offset:96
v_mfma_f32_16x16x32_bf16 v[236:239], a[188:191], v[40:43], 0
v_cvt_pk_bf16_f32 v240, v240, v241
v_cvt_pk_bf16_f32 v241, v242, v243
v_mfma_f32_16x16x32_bf16 v[236:239], a[220:223], v[44:47], v[236:239]
ds_write_b64 v94, v[240:241] offset:128
v_mfma_f32_16x16x32_bf16 v[240:243], a[224:227], v[44:47], 0
v_cvt_pk_bf16_f32 v244, v244, v245
v_cvt_pk_bf16_f32 v245, v246, v247
v_mfma_f32_16x16x32_bf16 v[240:243], a[192:195], v[40:43], v[240:243]
ds_write_b64 v94, v[244:245] offset:160
buffer_load_dwordx4 v97, s[12:15], s21 offen offset:0 nt lds
v_mfma_f32_16x16x32_bf16 v[244:247], a[196:199], v[40:43], 0
ds_read_b128 a[144:147], v89 offset:33792
v_cvt_pk_bf16_f32 v248, v248, v249
v_cvt_pk_bf16_f32 v249, v250, v251
v_mfma_f32_16x16x32_bf16 v[244:247], a[228:231], v[44:47], v[244:247]
ds_write_b64 v94, v[248:249] offset:192
ds_read_b128 a[148:151], v89 offset:33856
v_mfma_f32_16x16x32_bf16 v[248:251], a[232:235], v[44:47], 0
ds_read_b128 a[152:155], v89 offset:33920
v_cvt_pk_bf16_f32 v252, v252, v253
v_cvt_pk_bf16_f32 v253, v254, v255
v_mfma_f32_16x16x32_bf16 v[248:251], a[200:203], v[40:43], v[248:251]
ds_write_b64 v94, v[252:253] offset:224
ds_read_b128 a[156:159], v89 offset:33984
v_mfma_f32_16x16x32_bf16 v[252:255], a[204:207], v[40:43], 0
ds_read_b128 a[172:175], v89 offset:34496
v_mov_b32 v102, v104
v_mfma_f32_16x16x32_bf16 v[252:255], a[236:239], v[44:47], v[252:255]
ds_read_b128 a[168:171], v89 offset:34432
v_add_f32 v100, v100, v125
v_smfmac_f32_16x16x64_bf16 a[244:247], a[252:255], v[40:47], v92
s_waitcnt lgkmcnt(7)
ds_read_b128 a[164:167], v89 offset:34368
v_mfma_f32_16x16x32_bf16 v[72:75], a[144:147], a[0:3], v[48:51]
s_waitcnt lgkmcnt(6)
ds_read_b128 a[160:163], v89 offset:34304
v_add_f32 v100, v100, v127
v_mfma_f32_16x16x32_bf16 v[72:75], a[148:151], a[4:7], v[72:75]
s_waitcnt lgkmcnt(6)
ds_read_b128 a[112:115], v88 offset:33792
v_mfma_f32_16x16x32_bf16 v[72:75], a[152:155], a[8:11], v[72:75]
s_waitcnt lgkmcnt(5)
ds_read_b128 a[116:119], v88 offset:33856
v_mfma_f32_16x16x32_bf16 v[72:75], a[156:159], a[12:15], v[72:75]
s_waitcnt lgkmcnt(5)
ds_read_b128 a[120:123], v88 offset:33920
v_mfma_f32_16x16x32_bf16 v[76:79], a[172:175], a[12:15], v[48:51]
s_waitcnt lgkmcnt(5)
ds_read_b128 a[124:127], v88 offset:33984
v_mfma_f32_16x16x32_bf16 v[76:79], a[168:171], a[8:11], v[76:79]
s_waitcnt lgkmcnt(5)
ds_read_b128 a[140:143], v88 offset:34496
v_mfma_f32_16x16x32_bf16 v[76:79], a[164:167], a[4:7], v[76:79]
s_waitcnt lgkmcnt(5)
ds_read_b128 a[136:139], v88 offset:34432
v_mfma_f32_16x16x32_bf16 v[76:79], a[160:163], a[0:3], v[76:79]
s_waitcnt lgkmcnt(4)
ds_read_b128 a[132:135], v88 offset:34368
v_mfma_f32_16x16x32_bf16 v[80:83], a[112:115], a[0:3], v[48:51]
buffer_store_dwordx4 v[116:119], v96, s[16:19], s33 offen offset:1024 nt
ds_read_b128 a[128:131], v88 offset:34304
v_mfma_f32_16x16x32_bf16 v[80:83], a[116:119], a[4:7], v[80:83]
s_waitcnt lgkmcnt(4)
v_exp_f32 v84, v84
v_mfma_f32_16x16x32_bf16 v[80:83], a[120:123], a[8:11], v[80:83]
v_exp_f32 v85, v85
v_exp_f32 v86, v86
v_exp_f32 v87, v87
v_mfma_f32_16x16x32_bf16 v[80:83], a[124:127], a[12:15], v[80:83]
v_mov_b32 v103, v84
v_add_f32 v103, v103, v85
v_cvt_pk_bf16_f32 v32, v84, v85
v_add_f32 v103, v103, v86
v_add_f32 v103, v103, v87
v_cvt_pk_bf16_f32 v33, v86, v87
s_waitcnt lgkmcnt(3)
v_mfma_f32_16x16x32_bf16 v[84:87], a[140:143], a[12:15], v[48:51]
s_waitcnt lgkmcnt(1)
v_exp_f32 v68, v68
v_mfma_f32_16x16x32_bf16 v[84:87], a[136:139], a[8:11], v[84:87]
v_exp_f32 v69, v69
v_exp_f32 v70, v70
v_exp_f32 v71, v71
v_mfma_f32_16x16x32_bf16 v[84:87], a[132:135], a[4:7], v[84:87]
s_waitcnt lgkmcnt(0)
v_cvt_pk_bf16_f32 v34, v68, v69
v_cvt_pk_bf16_f32 v35, v70, v71
v_mfma_f32_16x16x32_bf16 v[84:87], a[128:131], a[0:3], v[84:87]
v_add_f32 v103, v103, v68
v_add_f32 v103, v103, v69
v_mfma_f32_16x16x32_bf16 a[48:51], a[176:179], v[32:35], 0
s_xor_b32 s21, s23, 265216
v_add_f32 v103, v103, v70
v_add_f32 v103, v103, v71
v_mfma_f32_16x16x32_bf16 a[52:55], a[180:183], v[32:35], 0
s_add_u32 m0, s22, 16896
v_exp_f32 v72, v72
v_mfma_f32_16x16x32_bf16 a[56:59], a[184:187], v[32:35], 0
v_exp_f32 v73, v73
v_mfma_f32_16x16x32_bf16 a[60:63], a[188:191], v[32:35], 0
buffer_load_dwordx4 v97, s[8:11], s21 offen offset:0 nt lds
v_mfma_f32_16x16x32_bf16 a[64:67], a[192:195], v[32:35], 0
v_exp_f32 v74, v74
v_mfma_f32_16x16x32_bf16 a[68:71], a[196:199], v[32:35], 0
v_exp_f32 v75, v75
v_mfma_f32_16x16x32_bf16 a[72:75], a[200:203], v[32:35], 0
v_cvt_pk_bf16_f32 v44, v72, v73
v_cvt_pk_bf16_f32 v45, v74, v75
v_mfma_f32_16x16x32_bf16 a[76:79], a[204:207], v[32:35], 0
v_exp_f32 v76, v76
v_mfma_f32_16x16x32_bf16 v[68:71], a[144:147], a[16:19], v[52:55]
v_exp_f32 v77, v77
v_mfma_f32_16x16x32_bf16 v[68:71], a[148:151], a[20:23], v[68:71]
v_exp_f32 v78, v78
v_mfma_f32_16x16x32_bf16 v[68:71], a[152:155], a[24:27], v[68:71]
v_exp_f32 v79, v79
v_mfma_f32_16x16x32_bf16 v[68:71], a[156:159], a[28:31], v[68:71]
v_cvt_pk_bf16_f32 v46, v76, v77
v_cvt_pk_bf16_f32 v47, v78, v79
v_mfma_f32_16x16x32_bf16 v[72:75], a[172:175], a[28:31], v[52:55]
ds_read_b64_tr_b16 a[208:209], v91 offset:33792
ds_read_b64_tr_b16 a[210:211], v91 offset:34304
v_mfma_f32_16x16x32_bf16 v[72:75], a[168:171], a[24:27], v[72:75]
v_exp_f32 v80, v80
v_mfma_f32_16x16x32_bf16 v[72:75], a[164:167], a[20:23], v[72:75]
v_exp_f32 v81, v81
v_mfma_f32_16x16x32_bf16 v[72:75], a[160:163], a[16:19], v[72:75]
v_exp_f32 v82, v82
v_mfma_f32_16x16x32_bf16 v[76:79], a[112:115], a[16:19], v[52:55]
v_exp_f32 v83, v83
v_mfma_f32_16x16x32_bf16 v[76:79], a[116:119], a[20:23], v[76:79]
s_xor_b32 s21, s23, 269312
ds_read_b64_tr_b16 a[176:177], v90 offset:33792
ds_read_b64_tr_b16 a[178:179], v90 offset:34304
v_mfma_f32_16x16x32_bf16 v[76:79], a[120:123], a[24:27], v[76:79]
s_add_u32 m0, s22, 17952
v_cvt_pk_bf16_f32 v40, v80, v81
v_cvt_pk_bf16_f32 v41, v82, v83
v_mfma_f32_16x16x32_bf16 v[76:79], a[124:127], a[28:31], v[76:79]
ds_read_b64_tr_b16 a[180:181], v90 offset:33824
ds_read_b64_tr_b16 a[182:183], v90 offset:34336
v_mfma_f32_16x16x32_bf16 v[80:83], a[140:143], a[28:31], v[52:55]
ds_read_b64_tr_b16 a[212:213], v91 offset:33824
ds_read_b64_tr_b16 a[214:215], v91 offset:34336
v_mfma_f32_16x16x32_bf16 v[80:83], a[136:139], a[24:27], v[80:83]
ds_read_b64_tr_b16 a[216:217], v91 offset:33856
ds_read_b64_tr_b16 a[218:219], v91 offset:34368
v_mfma_f32_16x16x32_bf16 v[80:83], a[132:135], a[20:23], v[80:83]
ds_read_b64_tr_b16 a[184:185], v90 offset:33856
ds_read_b64_tr_b16 a[186:187], v90 offset:34368
v_exp_f32 v84, v84
v_exp_f32 v85, v85
v_exp_f32 v86, v86
v_exp_f32 v87, v87
v_mfma_f32_16x16x32_bf16 v[80:83], a[128:131], a[16:19], v[80:83]
ds_read_b64_tr_b16 a[188:189], v90 offset:33888
ds_read_b64_tr_b16 a[190:191], v90 offset:34400
v_cvt_pk_bf16_f32 v42, v84, v85
v_cvt_pk_bf16_f32 v43, v86, v87
s_waitcnt lgkmcnt(12)
v_mfma_f32_16x16x32_bf16 v[128:131], a[208:211], v[44:47], v[128:131]
s_waitcnt lgkmcnt(10)
ds_read_b64_tr_b16 a[220:221], v91 offset:33888
ds_read_b64_tr_b16 a[222:223], v91 offset:34400
v_mfma_f32_16x16x32_bf16 v[128:131], a[176:179], v[40:43], v[128:131]
s_waitcnt lgkmcnt(8)
ds_read_b64_tr_b16 a[224:225], v91 offset:33920
ds_read_b64_tr_b16 a[226:227], v91 offset:34432
v_mfma_f32_16x16x32_bf16 v[132:135], a[180:183], v[40:43], v[132:135]
buffer_load_dwordx4 v97, s[8:11], s21 offen offset:0 nt lds
ds_read_b64_tr_b16 a[192:193], v90 offset:33920
ds_read_b64_tr_b16 a[194:195], v90 offset:34432
v_mfma_f32_16x16x32_bf16 v[132:135], a[212:215], v[44:47], v[132:135]
s_waitcnt lgkmcnt(10)
ds_read_b64_tr_b16 a[196:197], v90 offset:33952
ds_read_b64_tr_b16 a[198:199], v90 offset:34464
v_mfma_f32_16x16x32_bf16 v[136:139], a[216:219], v[44:47], v[136:139]
s_waitcnt lgkmcnt(10)
ds_read_b64_tr_b16 a[228:229], v91 offset:33952
ds_read_b64_tr_b16 a[230:231], v91 offset:34464
v_mfma_f32_16x16x32_bf16 v[136:139], a[184:187], v[40:43], v[136:139]
s_waitcnt lgkmcnt(10)
ds_read_b64_tr_b16 a[232:233], v91 offset:33984
ds_read_b64_tr_b16 a[234:235], v91 offset:34496
v_mfma_f32_16x16x32_bf16 v[140:143], a[188:191], v[40:43], v[140:143]
s_waitcnt lgkmcnt(10)
ds_read_b64_tr_b16 a[200:201], v90 offset:33984
ds_read_b64_tr_b16 a[202:203], v90 offset:34496
v_mfma_f32_16x16x32_bf16 v[140:143], a[220:223], v[44:47], v[140:143]
s_waitcnt lgkmcnt(10)
ds_read_b64_tr_b16 a[204:205], v90 offset:34016
ds_read_b64_tr_b16 a[206:207], v90 offset:34528
v_mfma_f32_16x16x32_bf16 v[144:147], a[224:227], v[44:47], v[144:147]
s_waitcnt lgkmcnt(10)
ds_read_b64_tr_b16 a[236:237], v91 offset:34016
ds_read_b64_tr_b16 a[238:239], v91 offset:34528
v_mfma_f32_16x16x32_bf16 v[144:147], a[192:195], v[40:43], v[144:147]
s_waitcnt lgkmcnt(8)
v_exp_f32 v68, v68
v_mfma_f32_16x16x32_bf16 v[148:151], a[196:199], v[40:43], v[148:151]
s_xor_b32 s21, s23, 273408
v_exp_f32 v69, v69
v_mfma_f32_16x16x32_bf16 v[148:151], a[228:231], v[44:47], v[148:151]
s_add_u32 m0, s22, 19008
v_exp_f32 v70, v70
s_waitcnt lgkmcnt(6)
v_mfma_f32_16x16x32_bf16 v[152:155], a[232:235], v[44:47], v[152:155]
s_waitcnt lgkmcnt(2)
v_exp_f32 v71, v71
v_mfma_f32_16x16x32_bf16 v[152:155], a[200:203], v[40:43], v[152:155]
buffer_load_dwordx4 v97, s[8:11], s21 offen offset:0 nt lds
v_mfma_f32_16x16x32_bf16 v[156:159], a[204:207], v[40:43], v[156:159]
s_waitcnt lgkmcnt(0)
v_cvt_pk_bf16_f32 v36, v68, v69
v_cvt_pk_bf16_f32 v37, v70, v71
v_mfma_f32_16x16x32_bf16 v[156:159], a[236:239], v[44:47], v[156:159]
v_exp_f32 v72, v72
v_smfmac_f32_16x16x64_bf16 a[240:243], a[248:251], v[40:47], v92
v_mfma_f32_16x16x32_bf16 v[84:87], a[144:147], a[32:35], v[56:59]
v_exp_f32 v73, v73
v_mfma_f32_16x16x32_bf16 v[84:87], a[148:151], a[36:39], v[84:87]
v_exp_f32 v74, v74
v_mfma_f32_16x16x32_bf16 v[84:87], a[152:155], a[40:43], v[84:87]
v_exp_f32 v75, v75
v_mfma_f32_16x16x32_bf16 v[84:87], a[156:159], a[44:47], v[84:87]
v_cvt_pk_bf16_f32 v38, v72, v73
v_cvt_pk_bf16_f32 v39, v74, v75
v_mfma_f32_16x16x32_bf16 v[68:71], a[172:175], a[44:47], v[56:59]
v_exp_f32 v76, v76
v_mfma_f32_16x16x32_bf16 v[68:71], a[168:171], a[40:43], v[68:71]
v_exp_f32 v77, v77
v_mfma_f32_16x16x32_bf16 v[68:71], a[164:167], a[36:39], v[68:71]
v_exp_f32 v78, v78
v_mfma_f32_16x16x32_bf16 v[68:71], a[160:163], a[32:35], v[68:71]
v_exp_f32 v79, v79
v_mfma_f32_16x16x32_bf16 v[72:75], a[112:115], a[32:35], v[56:59]
v_cvt_pk_bf16_f32 v32, v76, v77
v_cvt_pk_bf16_f32 v33, v78, v79
v_mfma_f32_16x16x32_bf16 v[72:75], a[116:119], a[36:39], v[72:75]
s_xor_b32 s21, s23, 277504
v_exp_f32 v80, v80
v_mfma_f32_16x16x32_bf16 v[72:75], a[120:123], a[40:43], v[72:75]
s_add_u32 m0, s22, 20064
v_exp_f32 v81, v81
v_mfma_f32_16x16x32_bf16 v[72:75], a[124:127], a[44:47], v[72:75]
v_exp_f32 v82, v82
v_mfma_f32_16x16x32_bf16 v[76:79], a[140:143], a[44:47], v[56:59]
v_exp_f32 v83, v83
v_mfma_f32_16x16x32_bf16 v[76:79], a[136:139], a[40:43], v[76:79]
v_cvt_pk_bf16_f32 v34, v80, v81
v_cvt_pk_bf16_f32 v35, v82, v83
v_mfma_f32_16x16x32_bf16 v[76:79], a[132:135], a[36:39], v[76:79]
buffer_load_dwordx4 v97, s[8:11], s21 offen offset:0 nt lds
v_mfma_f32_16x16x32_bf16 v[76:79], a[128:131], a[32:35], v[76:79]
v_exp_f32 v84, v84
v_mfma_f32_16x16x32_bf16 v[160:163], a[208:211], v[36:39], v[160:163]
v_exp_f32 v85, v85
v_mfma_f32_16x16x32_bf16 v[160:163], a[176:179], v[32:35], v[160:163]
v_exp_f32 v86, v86
v_mfma_f32_16x16x32_bf16 v[164:167], a[180:183], v[32:35], v[164:167]
v_exp_f32 v87, v87
v_mfma_f32_16x16x32_bf16 v[164:167], a[212:215], v[36:39], v[164:167]
v_cvt_pk_bf16_f32 v44, v84, v85
v_cvt_pk_bf16_f32 v45, v86, v87
v_mfma_f32_16x16x32_bf16 v[168:171], a[216:219], v[36:39], v[168:171]
v_exp_f32 v68, v68
v_mfma_f32_16x16x32_bf16 v[168:171], a[184:187], v[32:35], v[168:171]
v_exp_f32 v69, v69
v_mfma_f32_16x16x32_bf16 v[172:175], a[188:191], v[32:35], v[172:175]
v_exp_f32 v70, v70
v_mfma_f32_16x16x32_bf16 v[172:175], a[220:223], v[36:39], v[172:175]
v_exp_f32 v71, v71
v_mfma_f32_16x16x32_bf16 v[176:179], a[224:227], v[36:39], v[176:179]
v_cvt_pk_bf16_f32 v46, v68, v69
v_cvt_pk_bf16_f32 v47, v70, v71
v_mfma_f32_16x16x32_bf16 v[176:179], a[192:195], v[32:35], v[176:179]
v_exp_f32 v72, v72
v_mfma_f32_16x16x32_bf16 v[180:183], a[196:199], v[32:35], v[180:183]
s_xor_b32 s21, s23, 265216
v_exp_f32 v73, v73
v_mfma_f32_16x16x32_bf16 v[180:183], a[228:231], v[36:39], v[180:183]
s_add_u32 m0, s22, 67584
v_exp_f32 v74, v74
v_mfma_f32_16x16x32_bf16 v[184:187], a[232:235], v[36:39], v[184:187]
v_exp_f32 v75, v75
v_mfma_f32_16x16x32_bf16 v[184:187], a[200:203], v[32:35], v[184:187]
buffer_load_dwordx4 v97, s[12:15], s21 offen offset:0 nt lds
v_mfma_f32_16x16x32_bf16 v[188:191], a[204:207], v[32:35], v[188:191]
v_cvt_pk_bf16_f32 v40, v72, v73
v_cvt_pk_bf16_f32 v41, v74, v75
v_mfma_f32_16x16x32_bf16 v[188:191], a[236:239], v[36:39], v[188:191]
v_exp_f32 v76, v76
v_smfmac_f32_16x16x64_bf16 a[240:243], a[252:255], v[32:39], v92
v_mfma_f32_16x16x32_bf16 v[80:83], a[144:147], v[0:3], v[60:63]
v_exp_f32 v77, v77
v_mfma_f32_16x16x32_bf16 v[80:83], a[148:151], v[4:7], v[80:83]
v_exp_f32 v78, v78
v_mfma_f32_16x16x32_bf16 v[80:83], a[152:155], v[8:11], v[80:83]
v_exp_f32 v79, v79
v_mfma_f32_16x16x32_bf16 v[80:83], a[156:159], v[12:15], v[80:83]
v_cvt_pk_bf16_f32 v42, v76, v77
v_cvt_pk_bf16_f32 v43, v78, v79
v_mfma_f32_16x16x32_bf16 v[84:87], a[172:175], v[12:15], v[60:63]
v_mfma_f32_16x16x32_bf16 v[84:87], a[168:171], v[8:11], v[84:87]
v_mfma_f32_16x16x32_bf16 v[84:87], a[164:167], v[4:7], v[84:87]
v_mfma_f32_16x16x32_bf16 v[84:87], a[160:163], v[0:3], v[84:87]
v_mfma_f32_16x16x32_bf16 v[68:71], a[112:115], v[0:3], v[60:63]
v_mfma_f32_16x16x32_bf16 v[68:71], a[116:119], v[4:7], v[68:71]
v_exp_f32 v80, v80
v_mfma_f32_16x16x32_bf16 v[68:71], a[120:123], v[8:11], v[68:71]
s_xor_b32 s21, s23, 269312
v_exp_f32 v81, v81
v_mfma_f32_16x16x32_bf16 v[68:71], a[124:127], v[12:15], v[68:71]
s_add_u32 m0, s22, 68640
v_exp_f32 v82, v82
v_mfma_f32_16x16x32_bf16 v[72:75], a[140:143], v[12:15], v[60:63]
v_exp_f32 v83, v83
v_mfma_f32_16x16x32_bf16 v[72:75], a[136:139], v[8:11], v[72:75]
buffer_load_dwordx4 v97, s[12:15], s21 offen offset:0 nt lds
v_mfma_f32_16x16x32_bf16 v[72:75], a[132:135], v[4:7], v[72:75]
v_cvt_pk_bf16_f32 v36, v80, v81
v_cvt_pk_bf16_f32 v37, v82, v83
v_mfma_f32_16x16x32_bf16 v[72:75], a[128:131], v[0:3], v[72:75]
v_exp_f32 v84, v84
v_mfma_f32_16x16x32_bf16 v[192:195], a[208:211], v[44:47], v[192:195]
v_exp_f32 v85, v85
v_mfma_f32_16x16x32_bf16 v[192:195], a[176:179], v[40:43], v[192:195]
v_exp_f32 v86, v86
v_mfma_f32_16x16x32_bf16 v[196:199], a[180:183], v[40:43], v[196:199]
v_exp_f32 v87, v87
v_mfma_f32_16x16x32_bf16 v[196:199], a[212:215], v[44:47], v[196:199]
v_cvt_pk_bf16_f32 v38, v84, v85
v_cvt_pk_bf16_f32 v39, v86, v87
v_mfma_f32_16x16x32_bf16 v[200:203], a[216:219], v[44:47], v[200:203]
v_exp_f32 v68, v68
v_mfma_f32_16x16x32_bf16 v[200:203], a[184:187], v[40:43], v[200:203]
v_exp_f32 v69, v69
v_mfma_f32_16x16x32_bf16 v[204:207], a[188:191], v[40:43], v[204:207]
v_exp_f32 v70, v70
v_mfma_f32_16x16x32_bf16 v[204:207], a[220:223], v[44:47], v[204:207]
v_exp_f32 v71, v71
v_mfma_f32_16x16x32_bf16 v[208:211], a[224:227], v[44:47], v[208:211]
v_exp_f32 v72, v72
v_mfma_f32_16x16x32_bf16 v[208:211], a[192:195], v[40:43], v[208:211]
v_exp_f32 v73, v73
v_mfma_f32_16x16x32_bf16 v[212:215], a[196:199], v[40:43], v[212:215]
s_xor_b32 s21, s23, 273408
v_exp_f32 v74, v74
v_mfma_f32_16x16x32_bf16 v[212:215], a[228:231], v[44:47], v[212:215]
s_add_u32 m0, s22, 69696
v_exp_f32 v75, v75
v_mfma_f32_16x16x32_bf16 v[216:219], a[232:235], v[44:47], v[216:219]
v_cvt_pk_bf16_f32 v32, v68, v69
v_cvt_pk_bf16_f32 v33, v70, v71
v_mfma_f32_16x16x32_bf16 v[216:219], a[200:203], v[40:43], v[216:219]
buffer_load_dwordx4 v97, s[12:15], s21 offen offset:0 nt lds
v_mfma_f32_16x16x32_bf16 v[220:223], a[204:207], v[40:43], v[220:223]
s_waitcnt vmcnt(8)
s_barrier
v_mfma_f32_16x16x32_bf16 v[220:223], a[236:239], v[44:47], v[220:223]
v_cvt_pk_bf16_f32 v34, v72, v73
v_cvt_pk_bf16_f32 v35, v74, v75
v_smfmac_f32_16x16x64_bf16 a[244:247], a[248:251], v[40:47], v92
ds_read_b128 a[144:147], v89 offset:0
v_mfma_f32_16x16x32_bf16 v[76:79], a[112:115], v[16:19], v[64:67]
ds_read_b128 a[148:151], v89 offset:64
v_mfma_f32_16x16x32_bf16 v[76:79], a[116:119], v[20:23], v[76:79]
ds_read_b128 a[152:155], v89 offset:128
v_mfma_f32_16x16x32_bf16 v[76:79], a[120:123], v[24:27], v[76:79]
ds_read_b128 a[156:159], v89 offset:192
v_mfma_f32_16x16x32_bf16 v[76:79], a[124:127], v[28:31], v[76:79]
ds_read_b128 a[172:175], v89 offset:704
v_mfma_f32_16x16x32_bf16 v[80:83], a[140:143], v[28:31], v[64:67]
ds_read_b128 a[168:171], v89 offset:640
v_mfma_f32_16x16x32_bf16 v[80:83], a[136:139], v[24:27], v[80:83]
ds_read_b128 a[164:167], v89 offset:576
v_mfma_f32_16x16x32_bf16 v[80:83], a[132:135], v[20:23], v[80:83]
ds_read_b128 a[160:163], v89 offset:512
v_mfma_f32_16x16x32_bf16 v[80:83], a[128:131], v[16:19], v[80:83]
v_exp_f32 v76, v76
v_mfma_f32_16x16x32_bf16 v[224:227], a[208:211], v[36:39], v[224:227]
ds_read_b128 a[112:115], v88 offset:0
v_add_f32 v103, v103, v76
v_mfma_f32_16x16x32_bf16 v[224:227], a[176:179], v[32:35], v[224:227]
v_exp_f32 v77, v77
v_mfma_f32_16x16x32_bf16 v[228:231], a[180:183], v[32:35], v[228:231]
s_xor_b32 s21, s23, 277504
ds_read_b128 a[116:119], v88 offset:64
v_add_f32 v103, v103, v77
v_mfma_f32_16x16x32_bf16 v[228:231], a[212:215], v[36:39], v[228:231]
s_add_u32 m0, s22, 70752
ds_read_b128 a[120:123], v88 offset:128
v_cvt_pk_bf16_f32 v40, v76, v77
v_mfma_f32_16x16x32_bf16 v[232:235], a[216:219], v[36:39], v[232:235]
v_exp_f32 v78, v78
v_mfma_f32_16x16x32_bf16 v[232:235], a[184:187], v[32:35], v[232:235]
buffer_load_dwordx4 v97, s[12:15], s21 offen offset:0 nt lds
v_mfma_f32_16x16x32_bf16 v[236:239], a[188:191], v[32:35], v[236:239]
ds_read_b128 a[124:127], v88 offset:192
v_add_f32 v103, v103, v78
v_mfma_f32_16x16x32_bf16 v[236:239], a[220:223], v[36:39], v[236:239]
v_exp_f32 v79, v79
v_mfma_f32_16x16x32_bf16 v[240:243], a[224:227], v[36:39], v[240:243]
ds_read_b128 a[140:143], v88 offset:704
v_add_f32 v103, v103, v79
v_mfma_f32_16x16x32_bf16 v[240:243], a[192:195], v[32:35], v[240:243]
ds_read_b128 a[136:139], v88 offset:640
v_cvt_pk_bf16_f32 v41, v78, v79
v_mfma_f32_16x16x32_bf16 v[244:247], a[196:199], v[32:35], v[244:247]
v_exp_f32 v80, v80
v_mfma_f32_16x16x32_bf16 v[244:247], a[228:231], v[36:39], v[244:247]
ds_read_b128 a[132:135], v88 offset:576
v_add_f32 v103, v103, v80
v_mfma_f32_16x16x32_bf16 v[248:251], a[232:235], v[36:39], v[248:251]
v_exp_f32 v81, v81
v_mfma_f32_16x16x32_bf16 v[248:251], a[200:203], v[32:35], v[248:251]
ds_read_b128 a[128:131], v88 offset:512
v_cvt_pk_bf16_f32 v42, v80, v81
v_mfma_f32_16x16x32_bf16 v[252:255], a[204:207], v[32:35], v[252:255]
v_exp_f32 v82, v82
v_mfma_f32_16x16x32_bf16 v[252:255], a[236:239], v[36:39], v[252:255]
v_exp_f32 v83, v83
v_smfmac_f32_16x16x64_bf16 a[244:247], a[252:255], v[32:39], v92
s_waitcnt lgkmcnt(3)
v_cvt_pk_bf16_f32 v43, v82, v83
v_mfma_f32_16x16x32_bf16 v[84:87], a[144:147], a[0:3], v[48:51]
v_add_f32 v103, v103, v81
v_add_f32 v103, v103, v82
v_mfma_f32_16x16x32_bf16 v[84:87], a[148:151], a[4:7], v[84:87]
ds_read_b64_tr_b16 a[208:209], v91 offset:0
v_add_f32 v103, v103, v83
v_mfma_f32_16x16x32_bf16 v[84:87], a[152:155], a[8:11], v[84:87]
ds_read_b64_tr_b16 a[210:211], v91 offset:512
ds_read_b64_tr_b16 a[212:213], v91 offset:32
v_mfma_f32_16x16x32_bf16 v[84:87], a[156:159], a[12:15], v[84:87]
ds_read_b64_tr_b16 a[214:215], v91 offset:544
v_mfma_f32_16x16x32_bf16 v[68:71], a[172:175], a[12:15], v[48:51]
ds_read_b64_tr_b16 a[216:217], v91 offset:64
ds_read_b64_tr_b16 a[218:219], v91 offset:576
v_mfma_f32_16x16x32_bf16 v[68:71], a[168:171], a[8:11], v[68:71]
buffer_store_dwordx4 v[120:123], v96, s[16:19], s33 offen offset:2048 nt
v_mfma_f32_16x16x32_bf16 v[68:71], a[164:167], a[4:7], v[68:71]
ds_read_b64_tr_b16 a[220:221], v91 offset:96
ds_read_b64_tr_b16 a[222:223], v91 offset:608
v_mfma_f32_16x16x32_bf16 v[68:71], a[160:163], a[0:3], v[68:71]
v_exp_f32 v84, v84
v_mfma_f32_16x16x32_bf16 v[72:75], a[112:115], a[0:3], v[48:51]
v_exp_f32 v85, v85
v_mfma_f32_16x16x32_bf16 v[72:75], a[116:119], a[4:7], v[72:75]
v_exp_f32 v86, v86
v_mfma_f32_16x16x32_bf16 v[72:75], a[120:123], a[8:11], v[72:75]
v_exp_f32 v87, v87
v_mfma_f32_16x16x32_bf16 v[72:75], a[124:127], a[12:15], v[72:75]
v_cvt_pk_bf16_f32 v36, v84, v85
v_cvt_pk_bf16_f32 v37, v86, v87
v_mfma_f32_16x16x32_bf16 v[76:79], a[140:143], a[12:15], v[48:51]
s_waitcnt lgkmcnt(2)
v_exp_f32 v68, v68
v_mfma_f32_16x16x32_bf16 v[76:79], a[136:139], a[8:11], v[76:79]
v_exp_f32 v69, v69
v_mfma_f32_16x16x32_bf16 v[76:79], a[132:135], a[4:7], v[76:79]
v_exp_f32 v70, v70
v_mfma_f32_16x16x32_bf16 v[76:79], a[128:131], a[0:3], v[76:79]
v_exp_f32 v71, v71
v_mfma_f32_16x16x32_bf16 a[48:51], a[176:179], v[40:43], a[48:51]
v_cvt_pk_bf16_f32 v38, v68, v69
v_cvt_pk_bf16_f32 v39, v70, v71
v_mfma_f32_16x16x32_bf16 a[52:55], a[180:183], v[40:43], a[52:55]
v_exp_f32 v72, v72
v_mfma_f32_16x16x32_bf16 a[56:59], a[184:187], v[40:43], a[56:59]
s_xor_b32 s21, s23, 278528
v_exp_f32 v73, v73
v_mfma_f32_16x16x32_bf16 a[60:63], a[188:191], v[40:43], a[60:63]
s_add_u32 m0, s22, 33792
v_exp_f32 v74, v74
v_mfma_f32_16x16x32_bf16 a[64:67], a[192:195], v[40:43], a[64:67]
v_exp_f32 v75, v75
v_mfma_f32_16x16x32_bf16 a[68:71], a[196:199], v[40:43], a[68:71]
buffer_load_dwordx4 v97, s[8:11], s21 offen offset:0 nt lds
v_mfma_f32_16x16x32_bf16 a[72:75], a[200:203], v[40:43], a[72:75]
ds_read_b64_tr_b16 a[176:177], v90 offset:0
ds_read_b64_tr_b16 a[178:179], v90 offset:512
v_mfma_f32_16x16x32_bf16 a[76:79], a[204:207], v[40:43], a[76:79]
v_cvt_pk_bf16_f32 v32, v72, v73
v_cvt_pk_bf16_f32 v33, v74, v75
v_mfma_f32_16x16x32_bf16 v[80:83], a[144:147], a[16:19], v[52:55]
ds_read_b64_tr_b16 a[180:181], v90 offset:32
ds_read_b64_tr_b16 a[182:183], v90 offset:544
v_mfma_f32_16x16x32_bf16 v[80:83], a[148:151], a[20:23], v[80:83]
v_exp_f32 v76, v76
v_mfma_f32_16x16x32_bf16 v[80:83], a[152:155], a[24:27], v[80:83]
v_exp_f32 v77, v77
v_mfma_f32_16x16x32_bf16 v[80:83], a[156:159], a[28:31], v[80:83]
v_exp_f32 v78, v78
v_mfma_f32_16x16x32_bf16 v[84:87], a[172:175], a[28:31], v[52:55]
v_exp_f32 v79, v79
v_mfma_f32_16x16x32_bf16 v[84:87], a[168:171], a[24:27], v[84:87]
ds_read_b64_tr_b16 a[184:185], v90 offset:64
ds_read_b64_tr_b16 a[186:187], v90 offset:576
v_mfma_f32_16x16x32_bf16 v[84:87], a[164:167], a[20:23], v[84:87]
v_cvt_pk_bf16_f32 v34, v76, v77
v_cvt_pk_bf16_f32 v35, v78, v79
v_mfma_f32_16x16x32_bf16 v[84:87], a[160:163], a[16:19], v[84:87]
ds_read_b64_tr_b16 a[188:189], v90 offset:96
ds_read_b64_tr_b16 a[190:191], v90 offset:608
v_mfma_f32_16x16x32_bf16 v[68:71], a[112:115], a[16:19], v[52:55]
v_exp_f32 v80, v80
v_mfma_f32_16x16x32_bf16 v[68:71], a[116:119], a[20:23], v[68:71]
ds_read_b64_tr_b16 a[224:225], v91 offset:128
ds_read_b64_tr_b16 a[226:227], v91 offset:640
v_mfma_f32_16x16x32_bf16 v[68:71], a[120:123], a[24:27], v[68:71]
v_exp_f32 v81, v81
v_mfma_f32_16x16x32_bf16 v[68:71], a[124:127], a[28:31], v[68:71]
s_xor_b32 s21, s23, 282624
ds_read_b64_tr_b16 a[192:193], v90 offset:128
ds_read_b64_tr_b16 a[194:195], v90 offset:640
v_mfma_f32_16x16x32_bf16 v[72:75], a[140:143], a[28:31], v[52:55]
s_add_u32 m0, s22, 34848
ds_read_b64_tr_b16 a[196:197], v90 offset:160
v_cvt_pk_bf16_f32 v44, v80, v81
v_mfma_f32_16x16x32_bf16 v[72:75], a[136:139], a[24:27], v[72:75]
ds_read_b64_tr_b16 a[198:199], v90 offset:672
ds_read_b64_tr_b16 a[228:229], v91 offset:160
v_mfma_f32_16x16x32_bf16 v[72:75], a[132:135], a[20:23], v[72:75]
buffer_load_dwordx4 v97, s[8:11], s21 offen offset:0 nt lds
v_mfma_f32_16x16x32_bf16 v[72:75], a[128:131], a[16:19], v[72:75]
ds_read_b64_tr_b16 a[230:231], v91 offset:672
ds_read_b64_tr_b16 a[232:233], v91 offset:192
v_mfma_f32_16x16x32_bf16 v[128:131], a[208:211], v[36:39], v[128:131]
s_waitcnt lgkmcnt(9)
v_exp_f32 v82, v82
v_mfma_f32_16x16x32_bf16 v[128:131], a[176:179], v[32:35], v[128:131]
ds_read_b64_tr_b16 a[234:235], v91 offset:704
ds_read_b64_tr_b16 a[200:201], v90 offset:192
v_mfma_f32_16x16x32_bf16 v[132:135], a[180:183], v[32:35], v[132:135]
v_exp_f32 v83, v83
v_mfma_f32_16x16x32_bf16 v[132:135], a[212:215], v[36:39], v[132:135]
ds_read_b64_tr_b16 a[202:203], v90 offset:704
ds_read_b64_tr_b16 a[204:205], v90 offset:224
v_mfma_f32_16x16x32_bf16 v[136:139], a[216:219], v[36:39], v[136:139]
ds_read_b64_tr_b16 a[206:207], v90 offset:736
v_cvt_pk_bf16_f32 v45, v82, v83
v_mfma_f32_16x16x32_bf16 v[136:139], a[184:187], v[32:35], v[136:139]
ds_read_b64_tr_b16 a[236:237], v91 offset:224
ds_read_b64_tr_b16 a[238:239], v91 offset:736
v_mfma_f32_16x16x32_bf16 v[140:143], a[188:191], v[32:35], v[140:143]
v_exp_f32 v84, v84
v_mfma_f32_16x16x32_bf16 v[140:143], a[220:223], v[36:39], v[140:143]
s_waitcnt lgkmcnt(7)
v_exp_f32 v85, v85
v_mfma_f32_16x16x32_bf16 v[144:147], a[224:227], v[36:39], v[144:147]
v_exp_f32 v86, v86
v_mfma_f32_16x16x32_bf16 v[144:147], a[192:195], v[32:35], v[144:147]
v_exp_f32 v87, v87
v_mfma_f32_16x16x32_bf16 v[148:151], a[196:199], v[32:35], v[148:151]
v_cvt_pk_bf16_f32 v46, v84, v85
v_cvt_pk_bf16_f32 v47, v86, v87
v_mfma_f32_16x16x32_bf16 v[148:151], a[228:231], v[36:39], v[148:151]
s_waitcnt lgkmcnt(3)
v_exp_f32 v68, v68
v_mfma_f32_16x16x32_bf16 v[152:155], a[232:235], v[36:39], v[152:155]
s_xor_b32 s21, s23, 286720
v_exp_f32 v69, v69
v_mfma_f32_16x16x32_bf16 v[152:155], a[200:203], v[32:35], v[152:155]
s_add_u32 m0, s22, 35904
v_exp_f32 v70, v70
s_waitcnt lgkmcnt(0)
v_mfma_f32_16x16x32_bf16 v[156:159], a[204:207], v[32:35], v[156:159]
v_exp_f32 v71, v71
v_mfma_f32_16x16x32_bf16 v[156:159], a[236:239], v[36:39], v[156:159]
buffer_load_dwordx4 v97, s[8:11], s21 offen offset:0 nt lds
v_smfmac_f32_16x16x64_bf16 a[240:243], a[248:251], v[32:39], v92
v_cvt_pk_bf16_f32 v40, v68, v69
v_mfma_f32_16x16x32_bf16 v[76:79], a[144:147], a[32:35], v[56:59]
v_exp_f32 v72, v72
v_mfma_f32_16x16x32_bf16 v[76:79], a[148:151], a[36:39], v[76:79]
v_exp_f32 v73, v73
v_mfma_f32_16x16x32_bf16 v[76:79], a[152:155], a[40:43], v[76:79]
v_cvt_pk_bf16_f32 v41, v70, v71
v_cvt_pk_bf16_f32 v42, v72, v73
v_mfma_f32_16x16x32_bf16 v[76:79], a[156:159], a[44:47], v[76:79]
v_exp_f32 v74, v74
v_mfma_f32_16x16x32_bf16 v[80:83], a[172:175], a[44:47], v[56:59]
v_exp_f32 v75, v75
v_mfma_f32_16x16x32_bf16 v[80:83], a[168:171], a[40:43], v[80:83]
v_cvt_pk_bf16_f32 v43, v74, v75
v_mfma_f32_16x16x32_bf16 v[80:83], a[164:167], a[36:39], v[80:83]
v_mfma_f32_16x16x32_bf16 v[80:83], a[160:163], a[32:35], v[80:83]
v_mfma_f32_16x16x32_bf16 v[84:87], a[112:115], a[32:35], v[56:59]
v_exp_f32 v76, v76
v_mfma_f32_16x16x32_bf16 v[84:87], a[116:119], a[36:39], v[84:87]
v_exp_f32 v77, v77
v_mfma_f32_16x16x32_bf16 v[84:87], a[120:123], a[40:43], v[84:87]
v_exp_f32 v78, v78
v_mfma_f32_16x16x32_bf16 v[84:87], a[124:127], a[44:47], v[84:87]
s_xor_b32 s21, s23, 290816
v_exp_f32 v79, v79
v_mfma_f32_16x16x32_bf16 v[68:71], a[140:143], a[44:47], v[56:59]
s_add_u32 m0, s22, 36960
v_cvt_pk_bf16_f32 v36, v76, v77
v_cvt_pk_bf16_f32 v37, v78, v79
v_mfma_f32_16x16x32_bf16 v[68:71], a[136:139], a[40:43], v[68:71]
v_exp_f32 v80, v80
v_mfma_f32_16x16x32_bf16 v[68:71], a[132:135], a[36:39], v[68:71]
buffer_load_dwordx4 v97, s[8:11], s21 offen offset:0 nt lds
v_mfma_f32_16x16x32_bf16 v[68:71], a[128:131], a[32:35], v[68:71]
v_exp_f32 v81, v81
v_mfma_f32_16x16x32_bf16 v[160:163], a[208:211], v[44:47], v[160:163]
v_exp_f32 v82, v82
v_mfma_f32_16x16x32_bf16 v[160:163], a[176:179], v[40:43], v[160:163]
v_exp_f32 v83, v83
v_mfma_f32_16x16x32_bf16 v[164:167], a[180:183], v[40:43], v[164:167]
v_cvt_pk_bf16_f32 v38, v80, v81
v_cvt_pk_bf16_f32 v39, v82, v83
v_mfma_f32_16x16x32_bf16 v[164:167], a[212:215], v[44:47], v[164:167]
v_exp_f32 v84, v84
v_mfma_f32_16x16x32_bf16 v[168:171], a[216:219], v[44:47], v[168:171]
v_exp_f32 v85, v85
v_mfma_f32_16x16x32_bf16 v[168:171], a[184:187], v[40:43], v[168:171]
v_exp_f32 v86, v86
v_mfma_f32_16x16x32_bf16 v[172:175], a[188:191], v[40:43], v[172:175]
v_exp_f32 v87, v87
v_mfma_f32_16x16x32_bf16 v[172:175], a[220:223], v[44:47], v[172:175]
v_cvt_pk_bf16_f32 v32, v84, v85
v_cvt_pk_bf16_f32 v33, v86, v87
v_mfma_f32_16x16x32_bf16 v[176:179], a[224:227], v[44:47], v[176:179]
v_exp_f32 v68, v68
v_mfma_f32_16x16x32_bf16 v[176:179], a[192:195], v[40:43], v[176:179]
v_exp_f32 v69, v69
v_mfma_f32_16x16x32_bf16 v[180:183], a[196:199], v[40:43], v[180:183]
v_exp_f32 v70, v70
v_mfma_f32_16x16x32_bf16 v[180:183], a[228:231], v[44:47], v[180:183]
v_exp_f32 v71, v71
v_mfma_f32_16x16x32_bf16 v[184:187], a[232:235], v[44:47], v[184:187]
s_xor_b32 s21, s23, 278528
v_cvt_pk_bf16_f32 v34, v68, v69
v_cvt_pk_bf16_f32 v35, v70, v71
v_mfma_f32_16x16x32_bf16 v[184:187], a[200:203], v[40:43], v[184:187]
s_add_u32 m0, s22, 84480
v_mfma_f32_16x16x32_bf16 v[188:191], a[204:207], v[40:43], v[188:191]
v_mfma_f32_16x16x32_bf16 v[188:191], a[236:239], v[44:47], v[188:191]
buffer_load_dwordx4 v97, s[12:15], s21 offen offset:0 nt lds
v_smfmac_f32_16x16x64_bf16 a[240:243], a[252:255], v[40:47], v92
v_mfma_f32_16x16x32_bf16 v[72:75], a[144:147], v[0:3], v[60:63]
v_mfma_f32_16x16x32_bf16 v[72:75], a[148:151], v[4:7], v[72:75]
v_mfma_f32_16x16x32_bf16 v[72:75], a[152:155], v[8:11], v[72:75]
v_mfma_f32_16x16x32_bf16 v[72:75], a[156:159], v[12:15], v[72:75]
v_mfma_f32_16x16x32_bf16 v[76:79], a[172:175], v[12:15], v[60:63]
v_mfma_f32_16x16x32_bf16 v[76:79], a[168:171], v[8:11], v[76:79]
v_mfma_f32_16x16x32_bf16 v[76:79], a[164:167], v[4:7], v[76:79]
v_mfma_f32_16x16x32_bf16 v[76:79], a[160:163], v[0:3], v[76:79]
v_mfma_f32_16x16x32_bf16 v[80:83], a[112:115], v[0:3], v[60:63]
v_mfma_f32_16x16x32_bf16 v[80:83], a[116:119], v[4:7], v[80:83]
v_mfma_f32_16x16x32_bf16 v[80:83], a[120:123], v[8:11], v[80:83]
v_mfma_f32_16x16x32_bf16 v[80:83], a[124:127], v[12:15], v[80:83]
s_xor_b32 s21, s23, 282624
v_exp_f32 v72, v72
v_mfma_f32_16x16x32_bf16 v[84:87], a[140:143], v[12:15], v[60:63]
s_add_u32 m0, s22, 85536
v_exp_f32 v73, v73
v_mfma_f32_16x16x32_bf16 v[84:87], a[136:139], v[8:11], v[84:87]
v_exp_f32 v74, v74
v_mfma_f32_16x16x32_bf16 v[84:87], a[132:135], v[4:7], v[84:87]
buffer_load_dwordx4 v97, s[12:15], s21 offen offset:0 nt lds
v_mfma_f32_16x16x32_bf16 v[84:87], a[128:131], v[0:3], v[84:87]
v_exp_f32 v75, v75
v_mfma_f32_16x16x32_bf16 v[192:195], a[208:211], v[36:39], v[192:195]
v_cvt_pk_bf16_f32 v44, v72, v73
v_cvt_pk_bf16_f32 v45, v74, v75
v_mfma_f32_16x16x32_bf16 v[192:195], a[176:179], v[32:35], v[192:195]
v_exp_f32 v76, v76
v_mfma_f32_16x16x32_bf16 v[196:199], a[180:183], v[32:35], v[196:199]
v_exp_f32 v77, v77
v_mfma_f32_16x16x32_bf16 v[196:199], a[212:215], v[36:39], v[196:199]
v_exp_f32 v78, v78
v_mfma_f32_16x16x32_bf16 v[200:203], a[216:219], v[36:39], v[200:203]
v_exp_f32 v79, v79
v_mfma_f32_16x16x32_bf16 v[200:203], a[184:187], v[32:35], v[200:203]
v_cvt_pk_bf16_f32 v46, v76, v77
v_cvt_pk_bf16_f32 v47, v78, v79
v_mfma_f32_16x16x32_bf16 v[204:207], a[188:191], v[32:35], v[204:207]
v_exp_f32 v80, v80
v_mfma_f32_16x16x32_bf16 v[204:207], a[220:223], v[36:39], v[204:207]
v_exp_f32 v81, v81
v_mfma_f32_16x16x32_bf16 v[208:211], a[224:227], v[36:39], v[208:211]
v_exp_f32 v82, v82
v_mfma_f32_16x16x32_bf16 v[208:211], a[192:195], v[32:35], v[208:211]
v_exp_f32 v83, v83
v_mfma_f32_16x16x32_bf16 v[212:215], a[196:199], v[32:35], v[212:215]
v_exp_f32 v84, v84
v_mfma_f32_16x16x32_bf16 v[212:215], a[228:231], v[36:39], v[212:215]
v_exp_f32 v85, v85
v_mfma_f32_16x16x32_bf16 v[216:219], a[232:235], v[36:39], v[216:219]
s_xor_b32 s21, s23, 286720
v_exp_f32 v86, v86
v_mfma_f32_16x16x32_bf16 v[216:219], a[200:203], v[32:35], v[216:219]
s_add_u32 m0, s22, 86592
v_exp_f32 v87, v87
v_mfma_f32_16x16x32_bf16 v[220:223], a[204:207], v[32:35], v[220:223]
s_waitcnt vmcnt(7)
s_barrier
v_mfma_f32_16x16x32_bf16 v[220:223], a[236:239], v[36:39], v[220:223]
buffer_load_dwordx4 v97, s[12:15], s21 offen offset:0 nt lds
v_smfmac_f32_16x16x64_bf16 a[244:247], a[248:251], v[32:39], v92
v_cvt_pk_bf16_f32 v40, v80, v81
v_mfma_f32_16x16x32_bf16 v[68:71], a[112:115], v[16:19], v[64:67]
v_cvt_pk_bf16_f32 v41, v82, v83
v_cvt_pk_bf16_f32 v42, v84, v85
v_mfma_f32_16x16x32_bf16 v[68:71], a[116:119], v[20:23], v[68:71]
ds_read_b128 a[144:147], v89 offset:16896
v_cvt_pk_bf16_f32 v43, v86, v87
v_mfma_f32_16x16x32_bf16 v[68:71], a[120:123], v[24:27], v[68:71]
ds_read_b128 a[148:151], v89 offset:16960
v_mfma_f32_16x16x32_bf16 v[68:71], a[124:127], v[28:31], v[68:71]
ds_read_b128 a[152:155], v89 offset:17024
v_mfma_f32_16x16x32_bf16 v[72:75], a[140:143], v[28:31], v[64:67]
ds_read_b128 a[156:159], v89 offset:17088
v_mfma_f32_16x16x32_bf16 v[72:75], a[136:139], v[24:27], v[72:75]
ds_read_b128 a[172:175], v89 offset:17600
v_mfma_f32_16x16x32_bf16 v[72:75], a[132:135], v[20:23], v[72:75]
ds_read_b128 a[168:171], v89 offset:17536
v_mfma_f32_16x16x32_bf16 v[72:75], a[128:131], v[16:19], v[72:75]
v_exp_f32 v68, v68
v_mfma_f32_16x16x32_bf16 v[224:227], a[208:211], v[44:47], v[224:227]
ds_read_b128 a[164:167], v89 offset:17472
v_add_f32 v103, v103, v68
v_mfma_f32_16x16x32_bf16 v[224:227], a[176:179], v[40:43], v[224:227]
v_exp_f32 v69, v69
v_mfma_f32_16x16x32_bf16 v[228:231], a[180:183], v[40:43], v[228:231]
ds_read_b128 a[160:163], v89 offset:17408
v_add_f32 v103, v103, v69
v_mfma_f32_16x16x32_bf16 v[228:231], a[212:215], v[44:47], v[228:231]
ds_read_b128 a[112:115], v88 offset:16896
v_cvt_pk_bf16_f32 v32, v68, v69
v_mfma_f32_16x16x32_bf16 v[232:235], a[216:219], v[44:47], v[232:235]
s_xor_b32 s21, s23, 290816
v_exp_f32 v70, v70
v_mfma_f32_16x16x32_bf16 v[232:235], a[184:187], v[40:43], v[232:235]
s_add_u32 m0, s22, 87648
ds_read_b128 a[116:119], v88 offset:16960
v_add_f32 v103, v103, v70
v_mfma_f32_16x16x32_bf16 v[236:239], a[188:191], v[40:43], v[236:239]
v_exp_f32 v71, v71
v_mfma_f32_16x16x32_bf16 v[236:239], a[220:223], v[44:47], v[236:239]
buffer_load_dwordx4 v97, s[12:15], s21 offen offset:0 nt lds
v_mfma_f32_16x16x32_bf16 v[240:243], a[224:227], v[44:47], v[240:243]
ds_read_b128 a[120:123], v88 offset:17024
v_add_f32 v103, v103, v71
v_mfma_f32_16x16x32_bf16 v[240:243], a[192:195], v[40:43], v[240:243]
ds_read_b128 a[124:127], v88 offset:17088
v_cvt_pk_bf16_f32 v33, v70, v71
v_mfma_f32_16x16x32_bf16 v[244:247], a[196:199], v[40:43], v[244:247]
v_exp_f32 v72, v72
v_mfma_f32_16x16x32_bf16 v[244:247], a[228:231], v[44:47], v[244:247]
ds_read_b128 a[140:143], v88 offset:17600
v_add_f32 v103, v103, v72
v_mfma_f32_16x16x32_bf16 v[248:251], a[232:235], v[44:47], v[248:251]
v_exp_f32 v73, v73
v_mfma_f32_16x16x32_bf16 v[248:251], a[200:203], v[40:43], v[248:251]
ds_read_b128 a[136:139], v88 offset:17536
v_cvt_pk_bf16_f32 v34, v72, v73
v_mfma_f32_16x16x32_bf16 v[252:255], a[204:207], v[40:43], v[252:255]
ds_read_b128 a[132:135], v88 offset:17472
v_add_f32 v103, v103, v73
v_mfma_f32_16x16x32_bf16 v[252:255], a[236:239], v[44:47], v[252:255]
v_exp_f32 v74, v74
v_smfmac_f32_16x16x64_bf16 a[244:247], a[252:255], v[40:47], v92
s_waitcnt lgkmcnt(4)
ds_read_b128 a[128:131], v88 offset:17408
v_mfma_f32_16x16x32_bf16 v[76:79], a[144:147], a[0:3], v[48:51]
v_exp_f32 v75, v75
v_mfma_f32_16x16x32_bf16 v[76:79], a[148:151], a[4:7], v[76:79]
v_cvt_pk_bf16_f32 v35, v74, v75
v_add_f32 v103, v103, v74
v_mfma_f32_16x16x32_bf16 v[76:79], a[152:155], a[8:11], v[76:79]
ds_read_b64_tr_b16 a[208:209], v91 offset:16896
v_add_f32 v103, v103, v75
v_mfma_f32_16x16x32_bf16 v[76:79], a[156:159], a[12:15], v[76:79]
ds_read_b64_tr_b16 a[210:211], v91 offset:17408
ds_read_b64_tr_b16 a[212:213], v91 offset:16928
v_mfma_f32_16x16x32_bf16 v[80:83], a[172:175], a[12:15], v[48:51]
ds_read_b64_tr_b16 a[214:215], v91 offset:17440
v_mfma_f32_16x16x32_bf16 v[80:83], a[168:171], a[8:11], v[80:83]
ds_read_b64_tr_b16 a[216:217], v91 offset:16960
ds_read_b64_tr_b16 a[218:219], v91 offset:17472
v_mfma_f32_16x16x32_bf16 v[80:83], a[164:167], a[4:7], v[80:83]
buffer_store_dwordx4 v[108:111], v96, s[16:19], s33 offen offset:3072 nt
v_mfma_f32_16x16x32_bf16 v[80:83], a[160:163], a[0:3], v[80:83]
v_exp_f32 v76, v76
v_mfma_f32_16x16x32_bf16 v[84:87], a[112:115], a[0:3], v[48:51]
v_exp_f32 v77, v77
v_mfma_f32_16x16x32_bf16 v[84:87], a[116:119], a[4:7], v[84:87]
v_exp_f32 v78, v78
v_mfma_f32_16x16x32_bf16 v[84:87], a[120:123], a[8:11], v[84:87]
s_waitcnt lgkmcnt(5)
v_exp_f32 v79, v79
v_mfma_f32_16x16x32_bf16 v[84:87], a[124:127], a[12:15], v[84:87]
v_cvt_pk_bf16_f32 v44, v76, v77
v_cvt_pk_bf16_f32 v45, v78, v79
v_mfma_f32_16x16x32_bf16 v[68:71], a[140:143], a[12:15], v[48:51]
v_exp_f32 v80, v80
v_mfma_f32_16x16x32_bf16 v[68:71], a[136:139], a[8:11], v[68:71]
v_exp_f32 v81, v81
v_mfma_f32_16x16x32_bf16 v[68:71], a[132:135], a[4:7], v[68:71]
v_exp_f32 v82, v82
v_mfma_f32_16x16x32_bf16 v[68:71], a[128:131], a[0:3], v[68:71]
v_exp_f32 v83, v83
v_mfma_f32_16x16x32_bf16 a[48:51], a[176:179], v[32:35], a[48:51]
v_cvt_pk_bf16_f32 v46, v80, v81
v_cvt_pk_bf16_f32 v47, v82, v83
v_mfma_f32_16x16x32_bf16 a[52:55], a[180:183], v[32:35], a[52:55]
v_exp_f32 v84, v84
v_mfma_f32_16x16x32_bf16 a[56:59], a[184:187], v[32:35], a[56:59]
v_exp_f32 v85, v85
v_mfma_f32_16x16x32_bf16 a[60:63], a[188:191], v[32:35], a[60:63]
v_exp_f32 v86, v86
v_mfma_f32_16x16x32_bf16 a[64:67], a[192:195], v[32:35], a[64:67]
s_xor_b32 s21, s23, 279552
v_exp_f32 v87, v87
v_mfma_f32_16x16x32_bf16 a[68:71], a[196:199], v[32:35], a[68:71]
s_add_u32 m0, s22, 0
ds_read_b64_tr_b16 a[176:177], v90 offset:16896
ds_read_b64_tr_b16 a[178:179], v90 offset:17408
v_mfma_f32_16x16x32_bf16 a[72:75], a[200:203], v[32:35], a[72:75]
v_cvt_pk_bf16_f32 v40, v84, v85
v_cvt_pk_bf16_f32 v41, v86, v87
v_mfma_f32_16x16x32_bf16 a[76:79], a[204:207], v[32:35], a[76:79]
buffer_load_dwordx4 v97, s[8:11], s21 offen offset:0 nt lds
v_mfma_f32_16x16x32_bf16 v[72:75], a[144:147], a[16:19], v[52:55]
ds_read_b64_tr_b16 a[180:181], v90 offset:16928
ds_read_b64_tr_b16 a[182:183], v90 offset:17440
v_mfma_f32_16x16x32_bf16 v[72:75], a[148:151], a[20:23], v[72:75]
v_exp_f32 v68, v68
v_mfma_f32_16x16x32_bf16 v[72:75], a[152:155], a[24:27], v[72:75]
v_exp_f32 v69, v69
v_mfma_f32_16x16x32_bf16 v[72:75], a[156:159], a[28:31], v[72:75]
v_exp_f32 v70, v70
v_mfma_f32_16x16x32_bf16 v[76:79], a[172:175], a[28:31], v[52:55]
v_exp_f32 v71, v71
v_mfma_f32_16x16x32_bf16 v[76:79], a[168:171], a[24:27], v[76:79]
ds_read_b64_tr_b16 a[184:185], v90 offset:16960
ds_read_b64_tr_b16 a[186:187], v90 offset:17472
v_mfma_f32_16x16x32_bf16 v[76:79], a[164:167], a[20:23], v[76:79]
v_cvt_pk_bf16_f32 v42, v68, v69
v_cvt_pk_bf16_f32 v43, v70, v71
v_mfma_f32_16x16x32_bf16 v[76:79], a[160:163], a[16:19], v[76:79]
ds_read_b64_tr_b16 a[188:189], v90 offset:16992
ds_read_b64_tr_b16 a[190:191], v90 offset:17504
v_mfma_f32_16x16x32_bf16 v[80:83], a[112:115], a[16:19], v[52:55]
v_exp_f32 v72, v72
v_mfma_f32_16x16x32_bf16 v[80:83], a[116:119], a[20:23], v[80:83]
ds_read_b64_tr_b16 a[220:221], v91 offset:16992
ds_read_b64_tr_b16 a[222:223], v91 offset:17504
v_mfma_f32_16x16x32_bf16 v[80:83], a[120:123], a[24:27], v[80:83]
v_exp_f32 v73, v73
v_mfma_f32_16x16x32_bf16 v[80:83], a[124:127], a[28:31], v[80:83]
ds_read_b64_tr_b16 a[224:225], v91 offset:17024
ds_read_b64_tr_b16 a[226:227], v91 offset:17536
v_mfma_f32_16x16x32_bf16 v[84:87], a[140:143], a[28:31], v[52:55]
ds_read_b64_tr_b16 a[192:193], v90 offset:17024
v_cvt_pk_bf16_f32 v36, v72, v73
v_mfma_f32_16x16x32_bf16 v[84:87], a[136:139], a[24:27], v[84:87]
s_xor_b32 s21, s23, 283648
ds_read_b64_tr_b16 a[194:195], v90 offset:17536
ds_read_b64_tr_b16 a[196:197], v90 offset:17056
v_mfma_f32_16x16x32_bf16 v[84:87], a[132:135], a[20:23], v[84:87]
s_add_u32 m0, s22, 1056
v_exp_f32 v74, v74
v_mfma_f32_16x16x32_bf16 v[84:87], a[128:131], a[16:19], v[84:87]
s_waitcnt lgkmcnt(7)
ds_read_b64_tr_b16 a[198:199], v90 offset:17568
ds_read_b64_tr_b16 a[228:229], v91 offset:17056
v_mfma_f32_16x16x32_bf16 v[128:131], a[208:211], v[44:47], v[128:131]
buffer_load_dwordx4 v97, s[8:11], s21 offen offset:0 nt lds
v_mfma_f32_16x16x32_bf16 v[128:131], a[176:179], v[40:43], v[128:131]
ds_read_b64_tr_b16 a[230:231], v91 offset:17568
ds_read_b64_tr_b16 a[232:233], v91 offset:17088
v_mfma_f32_16x16x32_bf16 v[132:135], a[180:183], v[40:43], v[132:135]
v_exp_f32 v75, v75
v_mfma_f32_16x16x32_bf16 v[132:135], a[212:215], v[44:47], v[132:135]
ds_read_b64_tr_b16 a[234:235], v91 offset:17600
ds_read_b64_tr_b16 a[200:201], v90 offset:17088
v_mfma_f32_16x16x32_bf16 v[136:139], a[216:219], v[44:47], v[136:139]
ds_read_b64_tr_b16 a[202:203], v90 offset:17600
v_cvt_pk_bf16_f32 v37, v74, v75
v_mfma_f32_16x16x32_bf16 v[136:139], a[184:187], v[40:43], v[136:139]
ds_read_b64_tr_b16 a[204:205], v90 offset:17120
ds_read_b64_tr_b16 a[206:207], v90 offset:17632
v_mfma_f32_16x16x32_bf16 v[140:143], a[188:191], v[40:43], v[140:143]
s_waitcnt lgkmcnt(9)
v_exp_f32 v76, v76
v_mfma_f32_16x16x32_bf16 v[140:143], a[220:223], v[44:47], v[140:143]
ds_read_b64_tr_b16 a[236:237], v91 offset:17120
ds_read_b64_tr_b16 a[238:239], v91 offset:17632
v_mfma_f32_16x16x32_bf16 v[144:147], a[224:227], v[44:47], v[144:147]
v_exp_f32 v77, v77
v_mfma_f32_16x16x32_bf16 v[144:147], a[192:195], v[40:43], v[144:147]
s_waitcnt lgkmcnt(7)
v_exp_f32 v78, v78
v_mfma_f32_16x16x32_bf16 v[148:151], a[196:199], v[40:43], v[148:151]
v_exp_f32 v79, v79
v_mfma_f32_16x16x32_bf16 v[148:151], a[228:231], v[44:47], v[148:151]
s_waitcnt lgkmcnt(5)
v_cvt_pk_bf16_f32 v38, v76, v77
v_cvt_pk_bf16_f32 v39, v78, v79
v_mfma_f32_16x16x32_bf16 v[152:155], a[232:235], v[44:47], v[152:155]
s_waitcnt lgkmcnt(2)
v_exp_f32 v80, v80
v_mfma_f32_16x16x32_bf16 v[152:155], a[200:203], v[40:43], v[152:155]
s_xor_b32 s21, s23, 287744
v_exp_f32 v81, v81
v_mfma_f32_16x16x32_bf16 v[156:159], a[204:207], v[40:43], v[156:159]
s_add_u32 m0, s22, 2112
v_exp_f32 v82, v82
s_waitcnt lgkmcnt(0)
v_mfma_f32_16x16x32_bf16 v[156:159], a[236:239], v[44:47], v[156:159]
v_exp_f32 v83, v83
v_smfmac_f32_16x16x64_bf16 a[240:243], a[248:251], v[40:47], v92
v_cvt_pk_bf16_f32 v32, v80, v81
v_mfma_f32_16x16x32_bf16 v[68:71], a[144:147], a[32:35], v[56:59]
buffer_load_dwordx4 v97, s[8:11], s21 offen offset:0 nt lds
v_mfma_f32_16x16x32_bf16 v[68:71], a[148:151], a[36:39], v[68:71]
v_exp_f32 v84, v84
v_mfma_f32_16x16x32_bf16 v[68:71], a[152:155], a[40:43], v[68:71]
v_exp_f32 v85, v85
v_mfma_f32_16x16x32_bf16 v[68:71], a[156:159], a[44:47], v[68:71]
v_cvt_pk_bf16_f32 v33, v82, v83
v_cvt_pk_bf16_f32 v34, v84, v85
v_mfma_f32_16x16x32_bf16 v[72:75], a[172:175], a[44:47], v[56:59]
v_exp_f32 v86, v86
v_mfma_f32_16x16x32_bf16 v[72:75], a[168:171], a[40:43], v[72:75]
v_exp_f32 v87, v87
v_mfma_f32_16x16x32_bf16 v[72:75], a[164:167], a[36:39], v[72:75]
v_cvt_pk_bf16_f32 v35, v86, v87
v_mfma_f32_16x16x32_bf16 v[72:75], a[160:163], a[32:35], v[72:75]
v_exp_f32 v68, v68
v_mfma_f32_16x16x32_bf16 v[76:79], a[112:115], a[32:35], v[56:59]
v_exp_f32 v69, v69
v_mfma_f32_16x16x32_bf16 v[76:79], a[116:119], a[36:39], v[76:79]
v_exp_f32 v70, v70
v_mfma_f32_16x16x32_bf16 v[76:79], a[120:123], a[40:43], v[76:79]
v_exp_f32 v71, v71
v_mfma_f32_16x16x32_bf16 v[76:79], a[124:127], a[44:47], v[76:79]
v_cvt_pk_bf16_f32 v44, v68, v69
v_cvt_pk_bf16_f32 v45, v70, v71
v_mfma_f32_16x16x32_bf16 v[80:83], a[140:143], a[44:47], v[56:59]
v_exp_f32 v72, v72
v_mfma_f32_16x16x32_bf16 v[80:83], a[136:139], a[40:43], v[80:83]
s_xor_b32 s21, s23, 291840
v_exp_f32 v73, v73
v_mfma_f32_16x16x32_bf16 v[80:83], a[132:135], a[36:39], v[80:83]
s_add_u32 m0, s22, 3168
v_exp_f32 v74, v74
v_mfma_f32_16x16x32_bf16 v[80:83], a[128:131], a[32:35], v[80:83]
v_exp_f32 v75, v75
v_mfma_f32_16x16x32_bf16 v[160:163], a[208:211], v[36:39], v[160:163]
buffer_load_dwordx4 v97, s[8:11], s21 offen offset:0 nt lds
v_mfma_f32_16x16x32_bf16 v[160:163], a[176:179], v[32:35], v[160:163]
v_cvt_pk_bf16_f32 v46, v72, v73
v_cvt_pk_bf16_f32 v47, v74, v75
v_mfma_f32_16x16x32_bf16 v[164:167], a[180:183], v[32:35], v[164:167]
v_exp_f32 v76, v76
v_mfma_f32_16x16x32_bf16 v[164:167], a[212:215], v[36:39], v[164:167]
v_exp_f32 v77, v77
v_mfma_f32_16x16x32_bf16 v[168:171], a[216:219], v[36:39], v[168:171]
v_exp_f32 v78, v78
v_mfma_f32_16x16x32_bf16 v[168:171], a[184:187], v[32:35], v[168:171]
v_exp_f32 v79, v79
v_mfma_f32_16x16x32_bf16 v[172:175], a[188:191], v[32:35], v[172:175]
v_cvt_pk_bf16_f32 v40, v76, v77
v_cvt_pk_bf16_f32 v41, v78, v79
v_mfma_f32_16x16x32_bf16 v[172:175], a[220:223], v[36:39], v[172:175]
v_exp_f32 v80, v80
v_mfma_f32_16x16x32_bf16 v[176:179], a[224:227], v[36:39], v[176:179]
v_exp_f32 v81, v81
v_mfma_f32_16x16x32_bf16 v[176:179], a[192:195], v[32:35], v[176:179]
v_exp_f32 v82, v82
v_mfma_f32_16x16x32_bf16 v[180:183], a[196:199], v[32:35], v[180:183]
v_exp_f32 v83, v83
v_mfma_f32_16x16x32_bf16 v[180:183], a[228:231], v[36:39], v[180:183]
v_cvt_pk_bf16_f32 v42, v80, v81
v_cvt_pk_bf16_f32 v43, v82, v83
v_mfma_f32_16x16x32_bf16 v[184:187], a[232:235], v[36:39], v[184:187]
v_mfma_f32_16x16x32_bf16 v[184:187], a[200:203], v[32:35], v[184:187]
v_mfma_f32_16x16x32_bf16 v[188:191], a[204:207], v[32:35], v[188:191]
s_xor_b32 s21, s23, 279552
v_mfma_f32_16x16x32_bf16 v[188:191], a[236:239], v[36:39], v[188:191]
s_add_u32 m0, s22, 50688
v_smfmac_f32_16x16x64_bf16 a[240:243], a[252:255], v[32:39], v92
v_mfma_f32_16x16x32_bf16 v[84:87], a[144:147], v[0:3], v[60:63]
buffer_load_dwordx4 v97, s[12:15], s21 offen offset:0 nt lds
v_mfma_f32_16x16x32_bf16 v[84:87], a[148:151], v[4:7], v[84:87]
v_mfma_f32_16x16x32_bf16 v[84:87], a[152:155], v[8:11], v[84:87]
v_mfma_f32_16x16x32_bf16 v[84:87], a[156:159], v[12:15], v[84:87]
v_mfma_f32_16x16x32_bf16 v[68:71], a[172:175], v[12:15], v[60:63]
v_mfma_f32_16x16x32_bf16 v[68:71], a[168:171], v[8:11], v[68:71]
v_mfma_f32_16x16x32_bf16 v[68:71], a[164:167], v[4:7], v[68:71]
v_mfma_f32_16x16x32_bf16 v[68:71], a[160:163], v[0:3], v[68:71]
v_mfma_f32_16x16x32_bf16 v[72:75], a[112:115], v[0:3], v[60:63]
v_mfma_f32_16x16x32_bf16 v[72:75], a[116:119], v[4:7], v[72:75]
v_mfma_f32_16x16x32_bf16 v[72:75], a[120:123], v[8:11], v[72:75]
v_mfma_f32_16x16x32_bf16 v[72:75], a[124:127], v[12:15], v[72:75]
v_exp_f32 v84, v84
v_mfma_f32_16x16x32_bf16 v[76:79], a[140:143], v[12:15], v[60:63]
v_exp_f32 v85, v85
v_mfma_f32_16x16x32_bf16 v[76:79], a[136:139], v[8:11], v[76:79]
s_xor_b32 s21, s23, 283648
v_exp_f32 v86, v86
v_mfma_f32_16x16x32_bf16 v[76:79], a[132:135], v[4:7], v[76:79]
s_add_u32 m0, s22, 51744
v_exp_f32 v87, v87
v_mfma_f32_16x16x32_bf16 v[76:79], a[128:131], v[0:3], v[76:79]
v_cvt_pk_bf16_f32 v36, v84, v85
v_cvt_pk_bf16_f32 v37, v86, v87
v_mfma_f32_16x16x32_bf16 v[192:195], a[208:211], v[44:47], v[192:195]
buffer_load_dwordx4 v97, s[12:15], s21 offen offset:0 nt lds
v_mfma_f32_16x16x32_bf16 v[192:195], a[176:179], v[40:43], v[192:195]
v_exp_f32 v68, v68
v_mfma_f32_16x16x32_bf16 v[196:199], a[180:183], v[40:43], v[196:199]
v_exp_f32 v69, v69
v_mfma_f32_16x16x32_bf16 v[196:199], a[212:215], v[44:47], v[196:199]
v_exp_f32 v70, v70
v_mfma_f32_16x16x32_bf16 v[200:203], a[216:219], v[44:47], v[200:203]
v_exp_f32 v71, v71
v_mfma_f32_16x16x32_bf16 v[200:203], a[184:187], v[40:43], v[200:203]
v_cvt_pk_bf16_f32 v38, v68, v69
v_cvt_pk_bf16_f32 v39, v70, v71
v_mfma_f32_16x16x32_bf16 v[204:207], a[188:191], v[40:43], v[204:207]
v_exp_f32 v72, v72
v_mfma_f32_16x16x32_bf16 v[204:207], a[220:223], v[44:47], v[204:207]
v_exp_f32 v73, v73
v_mfma_f32_16x16x32_bf16 v[208:211], a[224:227], v[44:47], v[208:211]
v_exp_f32 v74, v74
v_mfma_f32_16x16x32_bf16 v[208:211], a[192:195], v[40:43], v[208:211]
v_exp_f32 v75, v75
v_mfma_f32_16x16x32_bf16 v[212:215], a[196:199], v[40:43], v[212:215]
v_exp_f32 v76, v76
v_mfma_f32_16x16x32_bf16 v[212:215], a[228:231], v[44:47], v[212:215]
v_exp_f32 v77, v77
v_mfma_f32_16x16x32_bf16 v[216:219], a[232:235], v[44:47], v[216:219]
v_exp_f32 v78, v78
v_mfma_f32_16x16x32_bf16 v[216:219], a[200:203], v[40:43], v[216:219]
v_exp_f32 v79, v79
v_mfma_f32_16x16x32_bf16 v[220:223], a[204:207], v[40:43], v[220:223]
s_waitcnt vmcnt(7)
s_barrier
v_mfma_f32_16x16x32_bf16 v[220:223], a[236:239], v[44:47], v[220:223]
s_xor_b32 s21, s23, 287744
v_cvt_pk_bf16_f32 v32, v72, v73
v_cvt_pk_bf16_f32 v33, v74, v75
v_smfmac_f32_16x16x64_bf16 a[244:247], a[248:251], v[40:47], v92
s_add_u32 m0, s22, 52800
v_cvt_pk_bf16_f32 v34, v76, v77
v_mfma_f32_16x16x32_bf16 v[80:83], a[112:115], v[16:19], v[64:67]
buffer_load_dwordx4 v97, s[12:15], s21 offen offset:0 nt lds
v_mfma_f32_16x16x32_bf16 v[80:83], a[116:119], v[20:23], v[80:83]
ds_read_b128 a[144:147], v89 offset:33792
v_cvt_pk_bf16_f32 v35, v78, v79
v_mfma_f32_16x16x32_bf16 v[80:83], a[120:123], v[24:27], v[80:83]
ds_read_b128 a[148:151], v89 offset:33856
v_mfma_f32_16x16x32_bf16 v[80:83], a[124:127], v[28:31], v[80:83]
ds_read_b128 a[152:155], v89 offset:33920
v_mfma_f32_16x16x32_bf16 v[84:87], a[140:143], v[28:31], v[64:67]
ds_read_b128 a[156:159], v89 offset:33984
v_mfma_f32_16x16x32_bf16 v[84:87], a[136:139], v[24:27], v[84:87]
ds_read_b128 a[172:175], v89 offset:34496
v_mfma_f32_16x16x32_bf16 v[84:87], a[132:135], v[20:23], v[84:87]
ds_read_b128 a[168:171], v89 offset:34432
v_mfma_f32_16x16x32_bf16 v[84:87], a[128:131], v[16:19], v[84:87]
v_exp_f32 v80, v80
v_mfma_f32_16x16x32_bf16 v[224:227], a[208:211], v[36:39], v[224:227]
ds_read_b128 a[164:167], v89 offset:34368
v_add_f32 v103, v103, v80
v_mfma_f32_16x16x32_bf16 v[224:227], a[176:179], v[32:35], v[224:227]
v_exp_f32 v81, v81
v_mfma_f32_16x16x32_bf16 v[228:231], a[180:183], v[32:35], v[228:231]
ds_read_b128 a[160:163], v89 offset:34304
v_add_f32 v103, v103, v81
v_mfma_f32_16x16x32_bf16 v[228:231], a[212:215], v[36:39], v[228:231]
ds_read_b128 a[112:115], v88 offset:33792
v_cvt_pk_bf16_f32 v40, v80, v81
v_mfma_f32_16x16x32_bf16 v[232:235], a[216:219], v[36:39], v[232:235]
v_exp_f32 v82, v82
v_mfma_f32_16x16x32_bf16 v[232:235], a[184:187], v[32:35], v[232:235]
ds_read_b128 a[116:119], v88 offset:33856
v_add_f32 v103, v103, v82
v_mfma_f32_16x16x32_bf16 v[236:239], a[188:191], v[32:35], v[236:239]
s_xor_b32 s21, s23, 291840
v_exp_f32 v83, v83
v_mfma_f32_16x16x32_bf16 v[236:239], a[220:223], v[36:39], v[236:239]
s_add_u32 m0, s22, 53856
ds_read_b128 a[120:123], v88 offset:33920
v_add_f32 v103, v103, v83
v_mfma_f32_16x16x32_bf16 v[240:243], a[224:227], v[36:39], v[240:243]
ds_read_b128 a[124:127], v88 offset:33984
v_cvt_pk_bf16_f32 v41, v82, v83
v_mfma_f32_16x16x32_bf16 v[240:243], a[192:195], v[32:35], v[240:243]
buffer_load_dwordx4 v97, s[12:15], s21 offen offset:0 nt lds
v_mfma_f32_16x16x32_bf16 v[244:247], a[196:199], v[32:35], v[244:247]
v_exp_f32 v84, v84
v_mfma_f32_16x16x32_bf16 v[244:247], a[228:231], v[36:39], v[244:247]
ds_read_b128 a[140:143], v88 offset:34496
v_add_f32 v103, v103, v84
v_mfma_f32_16x16x32_bf16 v[248:251], a[232:235], v[36:39], v[248:251]
v_exp_f32 v85, v85
v_mfma_f32_16x16x32_bf16 v[248:251], a[200:203], v[32:35], v[248:251]
ds_read_b128 a[136:139], v88 offset:34432
v_cvt_pk_bf16_f32 v42, v84, v85
v_mfma_f32_16x16x32_bf16 v[252:255], a[204:207], v[32:35], v[252:255]
ds_read_b128 v[112:115], v95 offset:4352
v_add_f32 v103, v103, v85
v_mfma_f32_16x16x32_bf16 v[252:255], a[236:239], v[36:39], v[252:255]
v_exp_f32 v86, v86
v_smfmac_f32_16x16x64_bf16 a[244:247], a[252:255], v[32:39], v92
s_waitcnt lgkmcnt(3)
ds_read_b128 a[132:135], v88 offset:34368
v_mfma_f32_16x16x32_bf16 v[68:71], a[144:147], a[0:3], v[48:51]
ds_read_b128 a[128:131], v88 offset:34304
v_add_f32 v103, v103, v86
v_mfma_f32_16x16x32_bf16 v[68:71], a[148:151], a[4:7], v[68:71]
v_exp_f32 v87, v87
v_mfma_f32_16x16x32_bf16 v[68:71], a[152:155], a[8:11], v[68:71]
v_cvt_pk_bf16_f32 v43, v86, v87
v_add_f32 v103, v103, v87
v_mfma_f32_16x16x32_bf16 v[68:71], a[156:159], a[12:15], v[68:71]
ds_read_b64_tr_b16 a[208:209], v91 offset:33792
ds_read_b64_tr_b16 a[210:211], v91 offset:34304
v_mfma_f32_16x16x32_bf16 v[72:75], a[172:175], a[12:15], v[48:51]
s_add_u32 s33, s31, 4096
ds_read_b64_tr_b16 a[212:213], v91 offset:33824
v_mfma_f32_16x16x32_bf16 v[72:75], a[168:171], a[8:11], v[72:75]
ds_read_b64_tr_b16 a[214:215], v91 offset:34336
ds_read_b64_tr_b16 a[216:217], v91 offset:33856
v_mfma_f32_16x16x32_bf16 v[72:75], a[164:167], a[4:7], v[72:75]
ds_read_b64_tr_b16 a[218:219], v91 offset:34368
v_mfma_f32_16x16x32_bf16 v[72:75], a[160:163], a[0:3], v[72:75]
s_waitcnt lgkmcnt(7)
v_exp_f32 v68, v68
v_mfma_f32_16x16x32_bf16 v[76:79], a[112:115], a[0:3], v[48:51]
buffer_store_dwordx4 v[112:115], v96, s[16:19], s33 offen offset:0 nt
v_mfma_f32_16x16x32_bf16 v[76:79], a[116:119], a[4:7], v[76:79]
v_exp_f32 v69, v69
v_mfma_f32_16x16x32_bf16 v[76:79], a[120:123], a[8:11], v[76:79]
v_exp_f32 v70, v70
v_mfma_f32_16x16x32_bf16 v[76:79], a[124:127], a[12:15], v[76:79]
v_exp_f32 v71, v71
v_mfma_f32_16x16x32_bf16 v[80:83], a[140:143], a[12:15], v[48:51]
v_cvt_pk_bf16_f32 v36, v68, v69
v_cvt_pk_bf16_f32 v37, v70, v71
v_mfma_f32_16x16x32_bf16 v[80:83], a[136:139], a[8:11], v[80:83]
v_exp_f32 v72, v72
v_mfma_f32_16x16x32_bf16 v[80:83], a[132:135], a[4:7], v[80:83]
s_waitcnt lgkmcnt(0)
v_exp_f32 v73, v73
v_mfma_f32_16x16x32_bf16 v[80:83], a[128:131], a[0:3], v[80:83]
v_exp_f32 v74, v74
v_mfma_f32_16x16x32_bf16 a[48:51], a[176:179], v[40:43], a[48:51]
v_exp_f32 v75, v75
v_mfma_f32_16x16x32_bf16 a[52:55], a[180:183], v[40:43], a[52:55]
v_cvt_pk_bf16_f32 v38, v72, v73
v_cvt_pk_bf16_f32 v39, v74, v75
v_mfma_f32_16x16x32_bf16 a[56:59], a[184:187], v[40:43], a[56:59]
v_exp_f32 v76, v76
v_mfma_f32_16x16x32_bf16 a[60:63], a[188:191], v[40:43], a[60:63]
v_exp_f32 v77, v77
v_mfma_f32_16x16x32_bf16 a[64:67], a[192:195], v[40:43], a[64:67]
v_exp_f32 v78, v78
v_mfma_f32_16x16x32_bf16 a[68:71], a[196:199], v[40:43], a[68:71]
v_exp_f32 v79, v79
v_mfma_f32_16x16x32_bf16 a[72:75], a[200:203], v[40:43], a[72:75]
s_xor_b32 s21, s23, 280576
ds_read_b64_tr_b16 a[176:177], v90 offset:33792
ds_read_b64_tr_b16 a[178:179], v90 offset:34304
v_mfma_f32_16x16x32_bf16 a[76:79], a[204:207], v[40:43], a[76:79]
s_add_u32 m0, s22, 16896
v_cvt_pk_bf16_f32 v32, v76, v77
v_cvt_pk_bf16_f32 v33, v78, v79
v_mfma_f32_16x16x32_bf16 v[84:87], a[144:147], a[16:19], v[52:55]
ds_read_b64_tr_b16 a[180:181], v90 offset:33824
ds_read_b64_tr_b16 a[182:183], v90 offset:34336
v_mfma_f32_16x16x32_bf16 v[84:87], a[148:151], a[20:23], v[84:87]
buffer_load_dwordx4 v97, s[8:11], s21 offen offset:0 nt lds
v_mfma_f32_16x16x32_bf16 v[84:87], a[152:155], a[24:27], v[84:87]
v_exp_f32 v80, v80
v_mfma_f32_16x16x32_bf16 v[84:87], a[156:159], a[28:31], v[84:87]
v_exp_f32 v81, v81
v_mfma_f32_16x16x32_bf16 v[68:71], a[172:175], a[28:31], v[52:55]
v_exp_f32 v82, v82
v_mfma_f32_16x16x32_bf16 v[68:71], a[168:171], a[24:27], v[68:71]
v_exp_f32 v83, v83
v_mfma_f32_16x16x32_bf16 v[68:71], a[164:167], a[20:23], v[68:71]
ds_read_b64_tr_b16 a[184:185], v90 offset:33856
ds_read_b64_tr_b16 a[186:187], v90 offset:34368
v_mfma_f32_16x16x32_bf16 v[68:71], a[160:163], a[16:19], v[68:71]
v_cvt_pk_bf16_f32 v34, v80, v81
v_cvt_pk_bf16_f32 v35, v82, v83
v_mfma_f32_16x16x32_bf16 v[72:75], a[112:115], a[16:19], v[52:55]
ds_read_b64_tr_b16 a[188:189], v90 offset:33888
ds_read_b64_tr_b16 a[190:191], v90 offset:34400
v_mfma_f32_16x16x32_bf16 v[72:75], a[116:119], a[20:23], v[72:75]
v_exp_f32 v84, v84
v_mfma_f32_16x16x32_bf16 v[72:75], a[120:123], a[24:27], v[72:75]
ds_read_b64_tr_b16 a[220:221], v91 offset:33888
ds_read_b64_tr_b16 a[222:223], v91 offset:34400
v_mfma_f32_16x16x32_bf16 v[72:75], a[124:127], a[28:31], v[72:75]
v_exp_f32 v85, v85
v_mfma_f32_16x16x32_bf16 v[76:79], a[140:143], a[28:31], v[52:55]
ds_read_b64_tr_b16 a[224:225], v91 offset:33920
ds_read_b64_tr_b16 a[226:227], v91 offset:34432
v_mfma_f32_16x16x32_bf16 v[76:79], a[136:139], a[24:27], v[76:79]
ds_read_b64_tr_b16 a[192:193], v90 offset:33920
v_cvt_pk_bf16_f32 v44, v84, v85
v_mfma_f32_16x16x32_bf16 v[76:79], a[132:135], a[20:23], v[76:79]
s_xor_b32 s21, s23, 284672
ds_read_b64_tr_b16 a[194:195], v90 offset:34432
ds_read_b64_tr_b16 a[196:197], v90 offset:33952
v_mfma_f32_16x16x32_bf16 v[76:79], a[128:131], a[16:19], v[76:79]
s_add_u32 m0, s22, 17952
v_exp_f32 v86, v86
v_mfma_f32_16x16x32_bf16 v[128:131], a[208:211], v[36:39], v[128:131]
s_waitcnt lgkmcnt(7)
ds_read_b64_tr_b16 a[198:199], v90 offset:34464
ds_read_b64_tr_b16 a[228:229], v91 offset:33952
v_mfma_f32_16x16x32_bf16 v[128:131], a[176:179], v[32:35], v[128:131]
buffer_load_dwordx4 v97, s[8:11], s21 offen offset:0 nt lds
v_mfma_f32_16x16x32_bf16 v[132:135], a[180:183], v[32:35], v[132:135]
ds_read_b64_tr_b16 a[230:231], v91 offset:34464
ds_read_b64_tr_b16 a[232:233], v91 offset:33984
v_mfma_f32_16x16x32_bf16 v[132:135], a[212:215], v[36:39], v[132:135]
v_exp_f32 v87, v87
v_mfma_f32_16x16x32_bf16 v[136:139], a[216:219], v[36:39], v[136:139]
ds_read_b64_tr_b16 a[234:235], v91 offset:34496
ds_read_b64_tr_b16 a[200:201], v90 offset:33984
v_mfma_f32_16x16x32_bf16 v[136:139], a[184:187], v[32:35], v[136:139]
ds_read_b64_tr_b16 a[202:203], v90 offset:34496
v_cvt_pk_bf16_f32 v45, v86, v87
v_mfma_f32_16x16x32_bf16 v[140:143], a[188:191], v[32:35], v[140:143]
s_waitcnt lgkmcnt(7)
ds_read_b64_tr_b16 a[204:205], v90 offset:34016
ds_read_b64_tr_b16 a[206:207], v90 offset:34528
v_mfma_f32_16x16x32_bf16 v[140:143], a[220:223], v[36:39], v[140:143]
v_exp_f32 v68, v68
v_mfma_f32_16x16x32_bf16 v[144:147], a[224:227], v[36:39], v[144:147]
ds_read_b64_tr_b16 a[236:237], v91 offset:34016
ds_read_b64_tr_b16 a[238:239], v91 offset:34528
v_mfma_f32_16x16x32_bf16 v[144:147], a[192:195], v[32:35], v[144:147]
s_waitcnt lgkmcnt(9)
v_exp_f32 v69, v69
v_mfma_f32_16x16x32_bf16 v[148:151], a[196:199], v[32:35], v[148:151]
s_waitcnt lgkmcnt(7)
v_exp_f32 v70, v70
v_mfma_f32_16x16x32_bf16 v[148:151], a[228:231], v[36:39], v[148:151]
s_waitcnt lgkmcnt(6)
v_exp_f32 v71, v71
v_mfma_f32_16x16x32_bf16 v[152:155], a[232:235], v[36:39], v[152:155]
s_waitcnt lgkmcnt(4)
v_cvt_pk_bf16_f32 v46, v68, v69
v_cvt_pk_bf16_f32 v47, v70, v71
v_mfma_f32_16x16x32_bf16 v[152:155], a[200:203], v[32:35], v[152:155]
s_waitcnt lgkmcnt(2)
v_exp_f32 v72, v72
v_mfma_f32_16x16x32_bf16 v[156:159], a[204:207], v[32:35], v[156:159]
s_waitcnt lgkmcnt(0)
v_exp_f32 v73, v73
v_mfma_f32_16x16x32_bf16 v[156:159], a[236:239], v[36:39], v[156:159]
s_xor_b32 s21, s23, 288768
v_exp_f32 v74, v74
v_smfmac_f32_16x16x64_bf16 a[240:243], a[248:251], v[32:39], v92
s_add_u32 m0, s22, 19008
v_cvt_pk_bf16_f32 v40, v72, v73
v_mfma_f32_16x16x32_bf16 v[80:83], a[144:147], a[32:35], v[56:59]
v_exp_f32 v75, v75
v_mfma_f32_16x16x32_bf16 v[80:83], a[148:151], a[36:39], v[80:83]
buffer_load_dwordx4 v97, s[8:11], s21 offen offset:0 nt lds
v_mfma_f32_16x16x32_bf16 v[80:83], a[152:155], a[40:43], v[80:83]
v_exp_f32 v76, v76
v_mfma_f32_16x16x32_bf16 v[80:83], a[156:159], a[44:47], v[80:83]
v_exp_f32 v77, v77
v_mfma_f32_16x16x32_bf16 v[84:87], a[172:175], a[44:47], v[56:59]
v_cvt_pk_bf16_f32 v41, v74, v75
v_cvt_pk_bf16_f32 v42, v76, v77
v_mfma_f32_16x16x32_bf16 v[84:87], a[168:171], a[40:43], v[84:87]
v_exp_f32 v78, v78
v_mfma_f32_16x16x32_bf16 v[84:87], a[164:167], a[36:39], v[84:87]
v_exp_f32 v79, v79
v_mfma_f32_16x16x32_bf16 v[84:87], a[160:163], a[32:35], v[84:87]
v_exp_f32 v80, v80
v_mfma_f32_16x16x32_bf16 v[68:71], a[112:115], a[32:35], v[56:59]
v_exp_f32 v81, v81
v_mfma_f32_16x16x32_bf16 v[68:71], a[116:119], a[36:39], v[68:71]
v_cvt_pk_bf16_f32 v43, v78, v79
v_cvt_pk_bf16_f32 v36, v80, v81
v_mfma_f32_16x16x32_bf16 v[68:71], a[120:123], a[40:43], v[68:71]
v_exp_f32 v82, v82
v_mfma_f32_16x16x32_bf16 v[68:71], a[124:127], a[44:47], v[68:71]
v_exp_f32 v83, v83
v_mfma_f32_16x16x32_bf16 v[72:75], a[140:143], a[44:47], v[56:59]
v_exp_f32 v84, v84
v_mfma_f32_16x16x32_bf16 v[72:75], a[136:139], a[40:43], v[72:75]
v_exp_f32 v85, v85
v_mfma_f32_16x16x32_bf16 v[72:75], a[132:135], a[36:39], v[72:75]
v_cvt_pk_bf16_f32 v37, v82, v83
v_cvt_pk_bf16_f32 v38, v84, v85
v_mfma_f32_16x16x32_bf16 v[72:75], a[128:131], a[32:35], v[72:75]
s_xor_b32 s21, s23, 292864
v_exp_f32 v86, v86
v_mfma_f32_16x16x32_bf16 v[160:163], a[208:211], v[44:47], v[160:163]
s_add_u32 m0, s22, 20064
v_exp_f32 v87, v87
v_mfma_f32_16x16x32_bf16 v[160:163], a[176:179], v[40:43], v[160:163]
v_exp_f32 v68, v68
v_mfma_f32_16x16x32_bf16 v[164:167], a[180:183], v[40:43], v[164:167]
buffer_load_dwordx4 v97, s[8:11], s21 offen offset:0 nt lds
v_mfma_f32_16x16x32_bf16 v[164:167], a[212:215], v[44:47], v[164:167]
v_exp_f32 v69, v69
v_mfma_f32_16x16x32_bf16 v[168:171], a[216:219], v[44:47], v[168:171]
v_cvt_pk_bf16_f32 v39, v86, v87
v_cvt_pk_bf16_f32 v32, v68, v69
v_mfma_f32_16x16x32_bf16 v[168:171], a[184:187], v[40:43], v[168:171]
v_exp_f32 v70, v70
v_mfma_f32_16x16x32_bf16 v[172:175], a[188:191], v[40:43], v[172:175]
v_exp_f32 v71, v71
v_mfma_f32_16x16x32_bf16 v[172:175], a[220:223], v[44:47], v[172:175]
v_exp_f32 v72, v72
v_mfma_f32_16x16x32_bf16 v[176:179], a[224:227], v[44:47], v[176:179]
v_exp_f32 v73, v73
v_mfma_f32_16x16x32_bf16 v[176:179], a[192:195], v[40:43], v[176:179]
v_cvt_pk_bf16_f32 v33, v70, v71
v_cvt_pk_bf16_f32 v34, v72, v73
v_mfma_f32_16x16x32_bf16 v[180:183], a[196:199], v[40:43], v[180:183]
v_exp_f32 v74, v74
v_mfma_f32_16x16x32_bf16 v[180:183], a[228:231], v[44:47], v[180:183]
v_exp_f32 v75, v75
v_mfma_f32_16x16x32_bf16 v[184:187], a[232:235], v[44:47], v[184:187]
v_cvt_pk_bf16_f32 v35, v74, v75
v_mfma_f32_16x16x32_bf16 v[184:187], a[200:203], v[40:43], v[184:187]
v_mfma_f32_16x16x32_bf16 v[188:191], a[204:207], v[40:43], v[188:191]
v_mfma_f32_16x16x32_bf16 v[188:191], a[236:239], v[44:47], v[188:191]
s_xor_b32 s21, s23, 280576
v_smfmac_f32_16x16x64_bf16 a[240:243], a[252:255], v[40:47], v92
s_add_u32 m0, s22, 67584
v_mfma_f32_16x16x32_bf16 v[76:79], a[144:147], v[0:3], v[60:63]
v_mfma_f32_16x16x32_bf16 v[76:79], a[148:151], v[4:7], v[76:79]
buffer_load_dwordx4 v97, s[12:15], s21 offen offset:0 nt lds
v_mfma_f32_16x16x32_bf16 v[76:79], a[152:155], v[8:11], v[76:79]
v_mfma_f32_16x16x32_bf16 v[76:79], a[156:159], v[12:15], v[76:79]
v_mfma_f32_16x16x32_bf16 v[80:83], a[172:175], v[12:15], v[60:63]
v_mfma_f32_16x16x32_bf16 v[80:83], a[168:171], v[8:11], v[80:83]
v_mfma_f32_16x16x32_bf16 v[80:83], a[164:167], v[4:7], v[80:83]
v_mfma_f32_16x16x32_bf16 v[80:83], a[160:163], v[0:3], v[80:83]
v_mfma_f32_16x16x32_bf16 v[84:87], a[112:115], v[0:3], v[60:63]
v_mfma_f32_16x16x32_bf16 v[84:87], a[116:119], v[4:7], v[84:87]
v_mfma_f32_16x16x32_bf16 v[84:87], a[120:123], v[8:11], v[84:87]
v_mfma_f32_16x16x32_bf16 v[84:87], a[124:127], v[12:15], v[84:87]
v_exp_f32 v76, v76
v_mfma_f32_16x16x32_bf16 v[68:71], a[140:143], v[12:15], v[60:63]
v_exp_f32 v77, v77
v_mfma_f32_16x16x32_bf16 v[68:71], a[136:139], v[8:11], v[68:71]
v_exp_f32 v78, v78
v_mfma_f32_16x16x32_bf16 v[68:71], a[132:135], v[4:7], v[68:71]
v_exp_f32 v79, v79
v_mfma_f32_16x16x32_bf16 v[68:71], a[128:131], v[0:3], v[68:71]
s_xor_b32 s21, s23, 284672
v_cvt_pk_bf16_f32 v44, v76, v77
v_cvt_pk_bf16_f32 v45, v78, v79
v_mfma_f32_16x16x32_bf16 v[192:195], a[208:211], v[36:39], v[192:195]
s_add_u32 m0, s22, 68640
v_exp_f32 v80, v80
v_mfma_f32_16x16x32_bf16 v[192:195], a[176:179], v[32:35], v[192:195]
v_exp_f32 v81, v81
v_mfma_f32_16x16x32_bf16 v[196:199], a[180:183], v[32:35], v[196:199]
buffer_load_dwordx4 v97, s[12:15], s21 offen offset:0 nt lds
v_mfma_f32_16x16x32_bf16 v[196:199], a[212:215], v[36:39], v[196:199]
v_exp_f32 v82, v82
v_mfma_f32_16x16x32_bf16 v[200:203], a[216:219], v[36:39], v[200:203]
v_exp_f32 v83, v83
v_mfma_f32_16x16x32_bf16 v[200:203], a[184:187], v[32:35], v[200:203]
v_cvt_pk_bf16_f32 v46, v80, v81
v_cvt_pk_bf16_f32 v47, v82, v83
v_mfma_f32_16x16x32_bf16 v[204:207], a[188:191], v[32:35], v[204:207]
v_exp_f32 v84, v84
v_mfma_f32_16x16x32_bf16 v[204:207], a[220:223], v[36:39], v[204:207]
v_exp_f32 v85, v85
v_mfma_f32_16x16x32_bf16 v[208:211], a[224:227], v[36:39], v[208:211]
v_exp_f32 v86, v86
v_mfma_f32_16x16x32_bf16 v[208:211], a[192:195], v[32:35], v[208:211]
v_exp_f32 v87, v87
v_mfma_f32_16x16x32_bf16 v[212:215], a[196:199], v[32:35], v[212:215]
v_exp_f32 v68, v68
v_mfma_f32_16x16x32_bf16 v[212:215], a[228:231], v[36:39], v[212:215]
v_exp_f32 v69, v69
v_mfma_f32_16x16x32_bf16 v[216:219], a[232:235], v[36:39], v[216:219]
v_exp_f32 v70, v70
v_mfma_f32_16x16x32_bf16 v[216:219], a[200:203], v[32:35], v[216:219]
v_exp_f32 v71, v71
v_mfma_f32_16x16x32_bf16 v[220:223], a[204:207], v[32:35], v[220:223]
s_waitcnt vmcnt(7)
s_barrier
v_mfma_f32_16x16x32_bf16 v[220:223], a[236:239], v[36:39], v[220:223]
s_xor_b32 s21, s23, 288768
v_cvt_pk_bf16_f32 v40, v84, v85
v_cvt_pk_bf16_f32 v41, v86, v87
v_smfmac_f32_16x16x64_bf16 a[244:247], a[248:251], v[32:39], v92
s_add_u32 m0, s22, 69696
v_cvt_pk_bf16_f32 v42, v68, v69
v_mfma_f32_16x16x32_bf16 v[72:75], a[112:115], v[16:19], v[64:67]
ds_read_b128 a[144:147], v89 offset:0
v_cvt_pk_bf16_f32 v43, v70, v71
v_mfma_f32_16x16x32_bf16 v[72:75], a[116:119], v[20:23], v[72:75]
buffer_load_dwordx4 v97, s[12:15], s21 offen offset:0 nt lds
v_mfma_f32_16x16x32_bf16 v[72:75], a[120:123], v[24:27], v[72:75]
ds_read_b128 a[148:151], v89 offset:64
v_mfma_f32_16x16x32_bf16 v[72:75], a[124:127], v[28:31], v[72:75]
ds_read_b128 a[152:155], v89 offset:128
v_mfma_f32_16x16x32_bf16 v[76:79], a[140:143], v[28:31], v[64:67]
ds_read_b128 a[156:159], v89 offset:192
v_mfma_f32_16x16x32_bf16 v[76:79], a[136:139], v[24:27], v[76:79]
ds_read_b128 a[172:175], v89 offset:704
v_mfma_f32_16x16x32_bf16 v[76:79], a[132:135], v[20:23], v[76:79]
ds_read_b128 a[168:171], v89 offset:640
v_mfma_f32_16x16x32_bf16 v[76:79], a[128:131], v[16:19], v[76:79]
v_exp_f32 v72, v72
v_mfma_f32_16x16x32_bf16 v[224:227], a[208:211], v[44:47], v[224:227]
ds_read_b128 a[164:167], v89 offset:576
v_add_f32 v103, v103, v72
v_mfma_f32_16x16x32_bf16 v[224:227], a[176:179], v[40:43], v[224:227]
v_exp_f32 v73, v73
v_mfma_f32_16x16x32_bf16 v[228:231], a[180:183], v[40:43], v[228:231]
ds_read_b128 a[160:163], v89 offset:512
v_add_f32 v103, v103, v73
v_mfma_f32_16x16x32_bf16 v[228:231], a[212:215], v[44:47], v[228:231]
ds_read_b128 a[112:115], v88 offset:0
v_cvt_pk_bf16_f32 v32, v72, v73
v_mfma_f32_16x16x32_bf16 v[232:235], a[216:219], v[44:47], v[232:235]
v_exp_f32 v74, v74
v_mfma_f32_16x16x32_bf16 v[232:235], a[184:187], v[40:43], v[232:235]
ds_read_b128 a[116:119], v88 offset:64
v_add_f32 v103, v103, v74
v_mfma_f32_16x16x32_bf16 v[236:239], a[188:191], v[40:43], v[236:239]
v_exp_f32 v75, v75
v_mfma_f32_16x16x32_bf16 v[236:239], a[220:223], v[44:47], v[236:239]
s_xor_b32 s21, s23, 292864
ds_read_b128 a[120:123], v88 offset:128
v_add_f32 v103, v103, v75
v_mfma_f32_16x16x32_bf16 v[240:243], a[224:227], v[44:47], v[240:243]
s_add_u32 m0, s22, 70752
ds_read_b128 a[124:127], v88 offset:192
v_cvt_pk_bf16_f32 v33, v74, v75
v_mfma_f32_16x16x32_bf16 v[240:243], a[192:195], v[40:43], v[240:243]
v_exp_f32 v76, v76
v_mfma_f32_16x16x32_bf16 v[244:247], a[196:199], v[40:43], v[244:247]
buffer_load_dwordx4 v97, s[12:15], s21 offen offset:0 nt lds
v_mfma_f32_16x16x32_bf16 v[244:247], a[228:231], v[44:47], v[244:247]
ds_read_b128 a[140:143], v88 offset:704
v_add_f32 v103, v103, v76
v_mfma_f32_16x16x32_bf16 v[248:251], a[232:235], v[44:47], v[248:251]
v_exp_f32 v77, v77
v_mfma_f32_16x16x32_bf16 v[248:251], a[200:203], v[40:43], v[248:251]
ds_read_b128 a[136:139], v88 offset:640
v_cvt_pk_bf16_f32 v34, v76, v77
v_mfma_f32_16x16x32_bf16 v[252:255], a[204:207], v[40:43], v[252:255]
ds_read_b128 a[132:135], v88 offset:576
v_add_f32 v103, v103, v77
v_mfma_f32_16x16x32_bf16 v[252:255], a[236:239], v[44:47], v[252:255]
v_exp_f32 v78, v78
v_smfmac_f32_16x16x64_bf16 a[244:247], a[252:255], v[40:47], v92
s_waitcnt lgkmcnt(3)
ds_read_b128 a[128:131], v88 offset:512
v_mfma_f32_16x16x32_bf16 v[80:83], a[144:147], a[0:3], v[48:51]
ds_read_b128 v[108:111], v95 offset:5440
v_add_f32 v103, v103, v78
v_mfma_f32_16x16x32_bf16 v[80:83], a[148:151], a[4:7], v[80:83]
v_exp_f32 v79, v79
v_mfma_f32_16x16x32_bf16 v[80:83], a[152:155], a[8:11], v[80:83]
v_cvt_pk_bf16_f32 v35, v78, v79
v_add_f32 v103, v103, v79
v_mfma_f32_16x16x32_bf16 v[80:83], a[156:159], a[12:15], v[80:83]
ds_read_b64_tr_b16 a[208:209], v91 offset:0
ds_read_b64_tr_b16 a[210:211], v91 offset:512
v_mfma_f32_16x16x32_bf16 v[84:87], a[172:175], a[12:15], v[48:51]
ds_read_b64_tr_b16 a[212:213], v91 offset:32
v_mfma_f32_16x16x32_bf16 v[84:87], a[168:171], a[8:11], v[84:87]
ds_read_b64_tr_b16 a[214:215], v91 offset:544
ds_read_b64_tr_b16 a[216:217], v91 offset:64
v_mfma_f32_16x16x32_bf16 v[84:87], a[164:167], a[4:7], v[84:87]
ds_read_b64_tr_b16 a[218:219], v91 offset:576
v_mfma_f32_16x16x32_bf16 v[84:87], a[160:163], a[0:3], v[84:87]
v_exp_f32 v80, v80
v_mfma_f32_16x16x32_bf16 v[68:71], a[112:115], a[0:3], v[48:51]
v_exp_f32 v81, v81
v_mfma_f32_16x16x32_bf16 v[68:71], a[116:119], a[4:7], v[68:71]
s_waitcnt lgkmcnt(6)
v_exp_f32 v82, v82
v_mfma_f32_16x16x32_bf16 v[68:71], a[120:123], a[8:11], v[68:71]
buffer_store_dwordx4 v[108:111], v96, s[16:19], s33 offen offset:1024 nt
v_mfma_f32_16x16x32_bf16 v[68:71], a[124:127], a[12:15], v[68:71]
v_exp_f32 v83, v83
v_mfma_f32_16x16x32_bf16 v[72:75], a[140:143], a[12:15], v[48:51]
v_cvt_pk_bf16_f32 v44, v80, v81
v_cvt_pk_bf16_f32 v45, v82, v83
v_mfma_f32_16x16x32_bf16 v[72:75], a[136:139], a[8:11], v[72:75]
v_exp_f32 v84, v84
v_mfma_f32_16x16x32_bf16 v[72:75], a[132:135], a[4:7], v[72:75]
v_exp_f32 v85, v85
v_mfma_f32_16x16x32_bf16 v[72:75], a[128:131], a[0:3], v[72:75]
v_exp_f32 v86, v86
v_mfma_f32_16x16x32_bf16 a[48:51], a[176:179], v[32:35], a[48:51]
v_exp_f32 v87, v87
v_mfma_f32_16x16x32_bf16 a[52:55], a[180:183], v[32:35], a[52:55]
v_cvt_pk_bf16_f32 v46, v84, v85
v_cvt_pk_bf16_f32 v47, v86, v87
v_mfma_f32_16x16x32_bf16 a[56:59], a[184:187], v[32:35], a[56:59]
v_exp_f32 v68, v68
v_mfma_f32_16x16x32_bf16 a[60:63], a[188:191], v[32:35], a[60:63]
v_exp_f32 v69, v69
v_mfma_f32_16x16x32_bf16 a[64:67], a[192:195], v[32:35], a[64:67]
v_exp_f32 v70, v70
v_mfma_f32_16x16x32_bf16 a[68:71], a[196:199], v[32:35], a[68:71]
v_exp_f32 v71, v71
v_mfma_f32_16x16x32_bf16 a[72:75], a[200:203], v[32:35], a[72:75]
ds_read_b64_tr_b16 a[176:177], v90 offset:0
ds_read_b64_tr_b16 a[178:179], v90 offset:512
v_mfma_f32_16x16x32_bf16 a[76:79], a[204:207], v[32:35], a[76:79]
s_xor_b32 s21, s23, 281600
v_cvt_pk_bf16_f32 v40, v68, v69
v_cvt_pk_bf16_f32 v41, v70, v71
v_mfma_f32_16x16x32_bf16 v[76:79], a[144:147], a[16:19], v[52:55]
s_add_u32 m0, s22, 33792
ds_read_b64_tr_b16 a[180:181], v90 offset:32
ds_read_b64_tr_b16 a[182:183], v90 offset:544
v_mfma_f32_16x16x32_bf16 v[76:79], a[148:151], a[20:23], v[76:79]
v_exp_f32 v72, v72
v_mfma_f32_16x16x32_bf16 v[76:79], a[152:155], a[24:27], v[76:79]
buffer_load_dwordx4 v97, s[8:11], s21 offen offset:0 nt lds
v_mfma_f32_16x16x32_bf16 v[76:79], a[156:159], a[28:31], v[76:79]
v_exp_f32 v73, v73
v_mfma_f32_16x16x32_bf16 v[80:83], a[172:175], a[28:31], v[52:55]
v_exp_f32 v74, v74
v_mfma_f32_16x16x32_bf16 v[80:83], a[168:171], a[24:27], v[80:83]
v_exp_f32 v75, v75
v_mfma_f32_16x16x32_bf16 v[80:83], a[164:167], a[20:23], v[80:83]
ds_read_b64_tr_b16 a[184:185], v90 offset:64
ds_read_b64_tr_b16 a[186:187], v90 offset:576
v_mfma_f32_16x16x32_bf16 v[80:83], a[160:163], a[16:19], v[80:83]
v_cvt_pk_bf16_f32 v42, v72, v73
v_cvt_pk_bf16_f32 v43, v74, v75
v_mfma_f32_16x16x32_bf16 v[84:87], a[112:115], a[16:19], v[52:55]
ds_read_b64_tr_b16 a[188:189], v90 offset:96
ds_read_b64_tr_b16 a[190:191], v90 offset:608
v_mfma_f32_16x16x32_bf16 v[84:87], a[116:119], a[20:23], v[84:87]
v_exp_f32 v76, v76
v_mfma_f32_16x16x32_bf16 v[84:87], a[120:123], a[24:27], v[84:87]
ds_read_b64_tr_b16 a[220:221], v91 offset:96
ds_read_b64_tr_b16 a[222:223], v91 offset:608
v_mfma_f32_16x16x32_bf16 v[84:87], a[124:127], a[28:31], v[84:87]
v_exp_f32 v77, v77
v_mfma_f32_16x16x32_bf16 v[68:71], a[140:143], a[28:31], v[52:55]
ds_read_b64_tr_b16 a[224:225], v91 offset:128
ds_read_b64_tr_b16 a[226:227], v91 offset:640
v_mfma_f32_16x16x32_bf16 v[68:71], a[136:139], a[24:27], v[68:71]
ds_read_b64_tr_b16 a[192:193], v90 offset:128
v_cvt_pk_bf16_f32 v36, v76, v77
v_mfma_f32_16x16x32_bf16 v[68:71], a[132:135], a[20:23], v[68:71]
ds_read_b64_tr_b16 a[194:195], v90 offset:640
ds_read_b64_tr_b16 a[196:197], v90 offset:160
v_mfma_f32_16x16x32_bf16 v[68:71], a[128:131], a[16:19], v[68:71]
s_waitcnt lgkmcnt(9)
v_exp_f32 v78, v78
v_mfma_f32_16x16x32_bf16 v[128:131], a[208:211], v[44:47], v[128:131]
s_xor_b32 s21, s23, 285696
ds_read_b64_tr_b16 a[198:199], v90 offset:672
ds_read_b64_tr_b16 a[228:229], v91 offset:160
v_mfma_f32_16x16x32_bf16 v[128:131], a[176:179], v[40:43], v[128:131]
s_add_u32 m0, s22, 34848
v_exp_f32 v79, v79
v_mfma_f32_16x16x32_bf16 v[132:135], a[180:183], v[40:43], v[132:135]
ds_read_b64_tr_b16 a[230:231], v91 offset:672
ds_read_b64_tr_b16 a[232:233], v91 offset:192
v_mfma_f32_16x16x32_bf16 v[132:135], a[212:215], v[44:47], v[132:135]
ds_read_b64_tr_b16 a[234:235], v91 offset:704
v_cvt_pk_bf16_f32 v37, v78, v79
v_mfma_f32_16x16x32_bf16 v[136:139], a[216:219], v[44:47], v[136:139]
s_waitcnt lgkmcnt(8)
ds_read_b64_tr_b16 a[200:201], v90 offset:192
ds_read_b64_tr_b16 a[202:203], v90 offset:704
v_mfma_f32_16x16x32_bf16 v[136:139], a[184:187], v[40:43], v[136:139]
buffer_load_dwordx4 v97, s[8:11], s21 offen offset:0 nt lds
v_mfma_f32_16x16x32_bf16 v[140:143], a[188:191], v[40:43], v[140:143]
ds_read_b64_tr_b16 a[204:205], v90 offset:224
ds_read_b64_tr_b16 a[206:207], v90 offset:736
v_mfma_f32_16x16x32_bf16 v[140:143], a[220:223], v[44:47], v[140:143]
v_exp_f32 v80, v80
v_mfma_f32_16x16x32_bf16 v[144:147], a[224:227], v[44:47], v[144:147]
s_waitcnt lgkmcnt(7)
ds_read_b64_tr_b16 a[236:237], v91 offset:224
ds_read_b64_tr_b16 a[238:239], v91 offset:736
v_mfma_f32_16x16x32_bf16 v[144:147], a[192:195], v[40:43], v[144:147]
v_exp_f32 v81, v81
v_mfma_f32_16x16x32_bf16 v[148:151], a[196:199], v[40:43], v[148:151]
s_waitcnt lgkmcnt(7)
v_exp_f32 v82, v82
v_mfma_f32_16x16x32_bf16 v[148:151], a[228:231], v[44:47], v[148:151]
s_waitcnt lgkmcnt(6)
v_exp_f32 v83, v83
v_mfma_f32_16x16x32_bf16 v[152:155], a[232:235], v[44:47], v[152:155]
s_waitcnt lgkmcnt(4)
v_cvt_pk_bf16_f32 v38, v80, v81
v_cvt_pk_bf16_f32 v39, v82, v83
v_mfma_f32_16x16x32_bf16 v[152:155], a[200:203], v[40:43], v[152:155]
s_waitcnt lgkmcnt(2)
v_exp_f32 v84, v84
v_mfma_f32_16x16x32_bf16 v[156:159], a[204:207], v[40:43], v[156:159]
s_waitcnt lgkmcnt(0)
v_exp_f32 v85, v85
v_mfma_f32_16x16x32_bf16 v[156:159], a[236:239], v[44:47], v[156:159]
v_exp_f32 v86, v86
v_smfmac_f32_16x16x64_bf16 a[240:243], a[248:251], v[40:47], v92
s_xor_b32 s21, s23, 289792
v_cvt_pk_bf16_f32 v32, v84, v85
v_mfma_f32_16x16x32_bf16 v[72:75], a[144:147], a[32:35], v[56:59]
s_add_u32 m0, s22, 35904
v_exp_f32 v87, v87
v_mfma_f32_16x16x32_bf16 v[72:75], a[148:151], a[36:39], v[72:75]
v_exp_f32 v68, v68
v_mfma_f32_16x16x32_bf16 v[72:75], a[152:155], a[40:43], v[72:75]
buffer_load_dwordx4 v97, s[8:11], s21 offen offset:0 nt lds
v_mfma_f32_16x16x32_bf16 v[72:75], a[156:159], a[44:47], v[72:75]
v_exp_f32 v69, v69
v_mfma_f32_16x16x32_bf16 v[76:79], a[172:175], a[44:47], v[56:59]
v_cvt_pk_bf16_f32 v33, v86, v87
v_cvt_pk_bf16_f32 v34, v68, v69
v_mfma_f32_16x16x32_bf16 v[76:79], a[168:171], a[40:43], v[76:79]
v_exp_f32 v70, v70
v_mfma_f32_16x16x32_bf16 v[76:79], a[164:167], a[36:39], v[76:79]
v_exp_f32 v71, v71
v_mfma_f32_16x16x32_bf16 v[76:79], a[160:163], a[32:35], v[76:79]
v_exp_f32 v72, v72
v_mfma_f32_16x16x32_bf16 v[80:83], a[112:115], a[32:35], v[56:59]
v_exp_f32 v73, v73
v_mfma_f32_16x16x32_bf16 v[80:83], a[116:119], a[36:39], v[80:83]
v_cvt_pk_bf16_f32 v35, v70, v71
v_cvt_pk_bf16_f32 v44, v72, v73
v_mfma_f32_16x16x32_bf16 v[80:83], a[120:123], a[40:43], v[80:83]
v_exp_f32 v74, v74
v_mfma_f32_16x16x32_bf16 v[80:83], a[124:127], a[44:47], v[80:83]
v_exp_f32 v75, v75
v_mfma_f32_16x16x32_bf16 v[84:87], a[140:143], a[44:47], v[56:59]
v_exp_f32 v76, v76
v_mfma_f32_16x16x32_bf16 v[84:87], a[136:139], a[40:43], v[84:87]
v_exp_f32 v77, v77
v_mfma_f32_16x16x32_bf16 v[84:87], a[132:135], a[36:39], v[84:87]
v_cvt_pk_bf16_f32 v45, v74, v75
v_cvt_pk_bf16_f32 v46, v76, v77
v_mfma_f32_16x16x32_bf16 v[84:87], a[128:131], a[32:35], v[84:87]
v_exp_f32 v78, v78
v_mfma_f32_16x16x32_bf16 v[160:163], a[208:211], v[36:39], v[160:163]
s_xor_b32 s21, s23, 293888
v_exp_f32 v79, v79
v_mfma_f32_16x16x32_bf16 v[160:163], a[176:179], v[32:35], v[160:163]
s_add_u32 m0, s22, 36960
v_exp_f32 v80, v80
v_mfma_f32_16x16x32_bf16 v[164:167], a[180:183], v[32:35], v[164:167]
v_exp_f32 v81, v81
v_mfma_f32_16x16x32_bf16 v[164:167], a[212:215], v[36:39], v[164:167]
buffer_load_dwordx4 v97, s[8:11], s21 offen offset:0 nt lds
v_mfma_f32_16x16x32_bf16 v[168:171], a[216:219], v[36:39], v[168:171]
v_cvt_pk_bf16_f32 v47, v78, v79
v_cvt_pk_bf16_f32 v40, v80, v81
v_mfma_f32_16x16x32_bf16 v[168:171], a[184:187], v[32:35], v[168:171]
v_exp_f32 v82, v82
v_mfma_f32_16x16x32_bf16 v[172:175], a[188:191], v[32:35], v[172:175]
v_exp_f32 v83, v83
v_mfma_f32_16x16x32_bf16 v[172:175], a[220:223], v[36:39], v[172:175]
v_exp_f32 v84, v84
v_mfma_f32_16x16x32_bf16 v[176:179], a[224:227], v[36:39], v[176:179]
v_exp_f32 v85, v85
v_mfma_f32_16x16x32_bf16 v[176:179], a[192:195], v[32:35], v[176:179]
v_cvt_pk_bf16_f32 v41, v82, v83
v_cvt_pk_bf16_f32 v42, v84, v85
v_mfma_f32_16x16x32_bf16 v[180:183], a[196:199], v[32:35], v[180:183]
v_exp_f32 v86, v86
v_mfma_f32_16x16x32_bf16 v[180:183], a[228:231], v[36:39], v[180:183]
v_exp_f32 v87, v87
v_mfma_f32_16x16x32_bf16 v[184:187], a[232:235], v[36:39], v[184:187]
v_cvt_pk_bf16_f32 v43, v86, v87
v_mfma_f32_16x16x32_bf16 v[184:187], a[200:203], v[32:35], v[184:187]
v_mfma_f32_16x16x32_bf16 v[188:191], a[204:207], v[32:35], v[188:191]
v_mfma_f32_16x16x32_bf16 v[188:191], a[236:239], v[36:39], v[188:191]
v_smfmac_f32_16x16x64_bf16 a[240:243], a[252:255], v[32:39], v92
v_mfma_f32_16x16x32_bf16 v[68:71], a[144:147], v[0:3], v[60:63]
s_xor_b32 s21, s23, 281600
v_mfma_f32_16x16x32_bf16 v[68:71], a[148:151], v[4:7], v[68:71]
s_add_u32 m0, s22, 84480
v_mfma_f32_16x16x32_bf16 v[68:71], a[152:155], v[8:11], v[68:71]
v_mfma_f32_16x16x32_bf16 v[68:71], a[156:159], v[12:15], v[68:71]
buffer_load_dwordx4 v97, s[12:15], s21 offen offset:0 nt lds
v_mfma_f32_16x16x32_bf16 v[72:75], a[172:175], v[12:15], v[60:63]
v_mfma_f32_16x16x32_bf16 v[72:75], a[168:171], v[8:11], v[72:75]
v_mfma_f32_16x16x32_bf16 v[72:75], a[164:167], v[4:7], v[72:75]
v_mfma_f32_16x16x32_bf16 v[72:75], a[160:163], v[0:3], v[72:75]
v_mfma_f32_16x16x32_bf16 v[76:79], a[112:115], v[0:3], v[60:63]
v_mfma_f32_16x16x32_bf16 v[76:79], a[116:119], v[4:7], v[76:79]
v_mfma_f32_16x16x32_bf16 v[76:79], a[120:123], v[8:11], v[76:79]
v_exp_f32 v68, v68
v_mfma_f32_16x16x32_bf16 v[76:79], a[124:127], v[12:15], v[76:79]
v_exp_f32 v69, v69
v_mfma_f32_16x16x32_bf16 v[80:83], a[140:143], v[12:15], v[60:63]
v_exp_f32 v70, v70
v_mfma_f32_16x16x32_bf16 v[80:83], a[136:139], v[8:11], v[80:83]
v_exp_f32 v71, v71
v_mfma_f32_16x16x32_bf16 v[80:83], a[132:135], v[4:7], v[80:83]
v_cvt_pk_bf16_f32 v36, v68, v69
v_cvt_pk_bf16_f32 v37, v70, v71
v_mfma_f32_16x16x32_bf16 v[80:83], a[128:131], v[0:3], v[80:83]
v_exp_f32 v72, v72
v_mfma_f32_16x16x32_bf16 v[192:195], a[208:211], v[44:47], v[192:195]
s_xor_b32 s21, s23, 285696
v_exp_f32 v73, v73
v_mfma_f32_16x16x32_bf16 v[192:195], a[176:179], v[40:43], v[192:195]
s_add_u32 m0, s22, 85536
v_exp_f32 v74, v74
v_mfma_f32_16x16x32_bf16 v[196:199], a[180:183], v[40:43], v[196:199]
v_exp_f32 v75, v75
v_mfma_f32_16x16x32_bf16 v[196:199], a[212:215], v[44:47], v[196:199]
buffer_load_dwordx4 v97, s[12:15], s21 offen offset:0 nt lds
v_mfma_f32_16x16x32_bf16 v[200:203], a[216:219], v[44:47], v[200:203]
v_cvt_pk_bf16_f32 v38, v72, v73
v_cvt_pk_bf16_f32 v39, v74, v75
v_mfma_f32_16x16x32_bf16 v[200:203], a[184:187], v[40:43], v[200:203]
v_exp_f32 v76, v76
v_mfma_f32_16x16x32_bf16 v[204:207], a[188:191], v[40:43], v[204:207]
v_exp_f32 v77, v77
v_mfma_f32_16x16x32_bf16 v[204:207], a[220:223], v[44:47], v[204:207]
v_exp_f32 v78, v78
v_mfma_f32_16x16x32_bf16 v[208:211], a[224:227], v[44:47], v[208:211]
v_exp_f32 v79, v79
v_mfma_f32_16x16x32_bf16 v[208:211], a[192:195], v[40:43], v[208:211]
v_exp_f32 v80, v80
v_mfma_f32_16x16x32_bf16 v[212:215], a[196:199], v[40:43], v[212:215]
v_exp_f32 v81, v81
v_mfma_f32_16x16x32_bf16 v[212:215], a[228:231], v[44:47], v[212:215]
v_exp_f32 v82, v82
v_mfma_f32_16x16x32_bf16 v[216:219], a[232:235], v[44:47], v[216:219]
v_exp_f32 v83, v83
v_mfma_f32_16x16x32_bf16 v[216:219], a[200:203], v[40:43], v[216:219]
v_cvt_pk_bf16_f32 v32, v76, v77
v_cvt_pk_bf16_f32 v33, v78, v79
v_mfma_f32_16x16x32_bf16 v[220:223], a[204:207], v[40:43], v[220:223]
s_waitcnt vmcnt(7)
s_barrier
v_mfma_f32_16x16x32_bf16 v[220:223], a[236:239], v[44:47], v[220:223]
v_cvt_pk_bf16_f32 v34, v80, v81
v_cvt_pk_bf16_f32 v35, v82, v83
v_smfmac_f32_16x16x64_bf16 a[244:247], a[248:251], v[40:47], v92
ds_read_b128 a[144:147], v89 offset:16896
v_mfma_f32_16x16x32_bf16 v[84:87], a[112:115], v[16:19], v[64:67]
s_xor_b32 s21, s23, 289792
ds_read_b128 a[148:151], v89 offset:16960
v_mfma_f32_16x16x32_bf16 v[84:87], a[116:119], v[20:23], v[84:87]
s_add_u32 m0, s22, 86592
ds_read_b128 a[152:155], v89 offset:17024
v_mfma_f32_16x16x32_bf16 v[84:87], a[120:123], v[24:27], v[84:87]
ds_read_b128 a[156:159], v89 offset:17088
v_mfma_f32_16x16x32_bf16 v[84:87], a[124:127], v[28:31], v[84:87]
buffer_load_dwordx4 v97, s[12:15], s21 offen offset:0 nt lds
v_mfma_f32_16x16x32_bf16 v[68:71], a[140:143], v[28:31], v[64:67]
ds_read_b128 a[172:175], v89 offset:17600
v_mfma_f32_16x16x32_bf16 v[68:71], a[136:139], v[24:27], v[68:71]
ds_read_b128 a[168:171], v89 offset:17536
v_mfma_f32_16x16x32_bf16 v[68:71], a[132:135], v[20:23], v[68:71]
ds_read_b128 a[164:167], v89 offset:17472
v_mfma_f32_16x16x32_bf16 v[68:71], a[128:131], v[16:19], v[68:71]
v_exp_f32 v84, v84
v_mfma_f32_16x16x32_bf16 v[224:227], a[208:211], v[36:39], v[224:227]
ds_read_b128 a[160:163], v89 offset:17408
v_add_f32 v103, v103, v84
v_mfma_f32_16x16x32_bf16 v[224:227], a[176:179], v[32:35], v[224:227]
v_exp_f32 v85, v85
v_mfma_f32_16x16x32_bf16 v[228:231], a[180:183], v[32:35], v[228:231]
ds_read_b128 a[112:115], v88 offset:16896
v_add_f32 v103, v103, v85
v_mfma_f32_16x16x32_bf16 v[228:231], a[212:215], v[36:39], v[228:231]
ds_read_b128 a[116:119], v88 offset:16960
v_cvt_pk_bf16_f32 v40, v84, v85
v_mfma_f32_16x16x32_bf16 v[232:235], a[216:219], v[36:39], v[232:235]
v_exp_f32 v86, v86
v_mfma_f32_16x16x32_bf16 v[232:235], a[184:187], v[32:35], v[232:235]
ds_read_b128 a[120:123], v88 offset:17024
v_add_f32 v103, v103, v86
v_mfma_f32_16x16x32_bf16 v[236:239], a[188:191], v[32:35], v[236:239]
v_exp_f32 v87, v87
v_mfma_f32_16x16x32_bf16 v[236:239], a[220:223], v[36:39], v[236:239]
ds_read_b128 a[124:127], v88 offset:17088
v_add_f32 v103, v103, v87
v_mfma_f32_16x16x32_bf16 v[240:243], a[224:227], v[36:39], v[240:243]
s_xor_b32 s21, s23, 293888
ds_read_b128 a[140:143], v88 offset:17600
v_cvt_pk_bf16_f32 v41, v86, v87
v_mfma_f32_16x16x32_bf16 v[240:243], a[192:195], v[32:35], v[240:243]
s_add_u32 m0, s22, 87648
v_exp_f32 v68, v68
v_mfma_f32_16x16x32_bf16 v[244:247], a[196:199], v[32:35], v[244:247]
ds_read_b128 a[136:139], v88 offset:17536
v_add_f32 v103, v103, v68
v_mfma_f32_16x16x32_bf16 v[244:247], a[228:231], v[36:39], v[244:247]
buffer_load_dwordx4 v97, s[12:15], s21 offen offset:0 nt lds
v_mfma_f32_16x16x32_bf16 v[248:251], a[232:235], v[36:39], v[248:251]
v_exp_f32 v69, v69
v_mfma_f32_16x16x32_bf16 v[248:251], a[200:203], v[32:35], v[248:251]
ds_read_b128 a[132:135], v88 offset:17472
v_cvt_pk_bf16_f32 v42, v68, v69
v_mfma_f32_16x16x32_bf16 v[252:255], a[204:207], v[32:35], v[252:255]
ds_read_b128 a[128:131], v88 offset:17408
v_add_f32 v103, v103, v69
v_mfma_f32_16x16x32_bf16 v[252:255], a[236:239], v[36:39], v[252:255]
v_exp_f32 v70, v70
v_smfmac_f32_16x16x64_bf16 a[244:247], a[252:255], v[32:39], v92
s_waitcnt lgkmcnt(3)
ds_read_b128 v[112:115], v95 offset:6528
v_mfma_f32_16x16x32_bf16 v[72:75], a[144:147], a[0:3], v[48:51]
v_exp_f32 v71, v71
v_mfma_f32_16x16x32_bf16 v[72:75], a[148:151], a[4:7], v[72:75]
v_cvt_pk_bf16_f32 v43, v70, v71
v_add_f32 v103, v103, v70
v_mfma_f32_16x16x32_bf16 v[72:75], a[152:155], a[8:11], v[72:75]
ds_read_b64_tr_b16 a[208:209], v91 offset:16896
v_add_f32 v103, v103, v71
v_mfma_f32_16x16x32_bf16 v[72:75], a[156:159], a[12:15], v[72:75]
ds_read_b64_tr_b16 a[210:211], v91 offset:17408
ds_read_b64_tr_b16 a[212:213], v91 offset:16928
v_mfma_f32_16x16x32_bf16 v[76:79], a[172:175], a[12:15], v[48:51]
ds_read_b64_tr_b16 a[214:215], v91 offset:17440
v_mfma_f32_16x16x32_bf16 v[76:79], a[168:171], a[8:11], v[76:79]
ds_read_b64_tr_b16 a[216:217], v91 offset:16960
ds_read_b64_tr_b16 a[218:219], v91 offset:17472
v_mfma_f32_16x16x32_bf16 v[76:79], a[164:167], a[4:7], v[76:79]
ds_read_b64_tr_b16 a[220:221], v91 offset:16992
v_mfma_f32_16x16x32_bf16 v[76:79], a[160:163], a[0:3], v[76:79]
v_exp_f32 v72, v72
v_mfma_f32_16x16x32_bf16 v[80:83], a[112:115], a[0:3], v[48:51]
v_exp_f32 v73, v73
v_mfma_f32_16x16x32_bf16 v[80:83], a[116:119], a[4:7], v[80:83]
v_exp_f32 v74, v74
v_mfma_f32_16x16x32_bf16 v[80:83], a[120:123], a[8:11], v[80:83]
s_waitcnt lgkmcnt(6)
v_exp_f32 v75, v75
v_mfma_f32_16x16x32_bf16 v[80:83], a[124:127], a[12:15], v[80:83]
buffer_store_dwordx4 v[112:115], v96, s[16:19], s33 offen offset:2048 nt
v_mfma_f32_16x16x32_bf16 v[84:87], a[140:143], a[12:15], v[48:51]
v_cvt_pk_bf16_f32 v36, v72, v73
v_cvt_pk_bf16_f32 v37, v74, v75
v_mfma_f32_16x16x32_bf16 v[84:87], a[136:139], a[8:11], v[84:87]
v_exp_f32 v76, v76
v_mfma_f32_16x16x32_bf16 v[84:87], a[132:135], a[4:7], v[84:87]
v_exp_f32 v77, v77
v_mfma_f32_16x16x32_bf16 v[84:87], a[128:131], a[0:3], v[84:87]
ds_read_b128 v[108:111], v95 offset:7616
v_cvt_pk_bf16_f32 v38, v76, v77
v_mfma_f32_16x16x32_bf16 a[48:51], a[176:179], v[40:43], a[48:51]
v_exp_f32 v78, v78
v_mfma_f32_16x16x32_bf16 a[52:55], a[180:183], v[40:43], a[52:55]
v_exp_f32 v79, v79
v_mfma_f32_16x16x32_bf16 a[56:59], a[184:187], v[40:43], a[56:59]
ds_read_b64_tr_b16 a[176:177], v90 offset:16896
v_cvt_pk_bf16_f32 v39, v78, v79
v_mfma_f32_16x16x32_bf16 a[60:63], a[188:191], v[40:43], a[60:63]
v_exp_f32 v80, v80
v_mfma_f32_16x16x32_bf16 a[64:67], a[192:195], v[40:43], a[64:67]
v_exp_f32 v81, v81
v_mfma_f32_16x16x32_bf16 a[68:71], a[196:199], v[40:43], a[68:71]
v_exp_f32 v82, v82
v_mfma_f32_16x16x32_bf16 a[72:75], a[200:203], v[40:43], a[72:75]
v_exp_f32 v83, v83
v_mfma_f32_16x16x32_bf16 a[76:79], a[204:207], v[40:43], a[76:79]
ds_read_b64_tr_b16 a[178:179], v90 offset:17408
v_cvt_pk_bf16_f32 v32, v80, v81
v_mfma_f32_16x16x32_bf16 v[68:71], a[144:147], a[16:19], v[52:55]
ds_read_b64_tr_b16 a[180:181], v90 offset:16928
v_cvt_pk_bf16_f32 v33, v82, v83
v_mfma_f32_16x16x32_bf16 v[68:71], a[148:151], a[20:23], v[68:71]
ds_read_b64_tr_b16 a[182:183], v90 offset:17440
ds_read_b64_tr_b16 a[184:185], v90 offset:16960
v_mfma_f32_16x16x32_bf16 v[68:71], a[152:155], a[24:27], v[68:71]
v_exp_f32 v84, v84
v_mfma_f32_16x16x32_bf16 v[68:71], a[156:159], a[28:31], v[68:71]
s_waitcnt lgkmcnt(4)
v_exp_f32 v85, v85
v_mfma_f32_16x16x32_bf16 v[72:75], a[172:175], a[28:31], v[52:55]
buffer_store_dwordx4 v[108:111], v96, s[16:19], s33 offen offset:3072 nt
v_mfma_f32_16x16x32_bf16 v[72:75], a[168:171], a[24:27], v[72:75]
v_exp_f32 v86, v86
v_mfma_f32_16x16x32_bf16 v[72:75], a[164:167], a[20:23], v[72:75]
v_exp_f32 v87, v87
v_mfma_f32_16x16x32_bf16 v[72:75], a[160:163], a[16:19], v[72:75]
ds_read_b64_tr_b16 a[186:187], v90 offset:17472
v_cvt_pk_bf16_f32 v34, v84, v85
v_mfma_f32_16x16x32_bf16 v[76:79], a[112:115], a[16:19], v[52:55]
ds_read_b64_tr_b16 a[188:189], v90 offset:16992
v_cvt_pk_bf16_f32 v35, v86, v87
v_mfma_f32_16x16x32_bf16 v[76:79], a[116:119], a[20:23], v[76:79]
ds_read_b64_tr_b16 a[190:191], v90 offset:17504
ds_read_b64_tr_b16 a[222:223], v91 offset:17504
v_mfma_f32_16x16x32_bf16 v[76:79], a[120:123], a[24:27], v[76:79]
v_exp_f32 v68, v68
v_mfma_f32_16x16x32_bf16 v[76:79], a[124:127], a[28:31], v[76:79]
ds_read_b64_tr_b16 a[224:225], v91 offset:17024
ds_read_b64_tr_b16 a[226:227], v91 offset:17536
v_mfma_f32_16x16x32_bf16 v[80:83], a[140:143], a[28:31], v[52:55]
v_exp_f32 v69, v69
v_mfma_f32_16x16x32_bf16 v[80:83], a[136:139], a[24:27], v[80:83]
ds_read_b64_tr_b16 a[192:193], v90 offset:17024
ds_read_b64_tr_b16 a[194:195], v90 offset:17536
v_mfma_f32_16x16x32_bf16 v[80:83], a[132:135], a[20:23], v[80:83]
ds_read_b64_tr_b16 a[196:197], v90 offset:17056
v_cvt_pk_bf16_f32 v44, v68, v69
v_mfma_f32_16x16x32_bf16 v[80:83], a[128:131], a[16:19], v[80:83]
ds_read_b64_tr_b16 a[198:199], v90 offset:17568
ds_read_b64_tr_b16 a[228:229], v91 offset:17056
v_mfma_f32_16x16x32_bf16 v[128:131], a[208:211], v[36:39], v[128:131]
s_waitcnt lgkmcnt(9)
v_exp_f32 v70, v70
v_mfma_f32_16x16x32_bf16 v[128:131], a[176:179], v[32:35], v[128:131]
s_xor_b32 s21, s23, 393216
ds_read_b64_tr_b16 a[230:231], v91 offset:17568
ds_read_b64_tr_b16 a[232:233], v91 offset:17088
v_mfma_f32_16x16x32_bf16 v[132:135], a[180:183], v[32:35], v[132:135]
s_add_u32 m0, s22, 0
v_exp_f32 v71, v71
v_mfma_f32_16x16x32_bf16 v[132:135], a[212:215], v[36:39], v[132:135]
ds_read_b64_tr_b16 a[234:235], v91 offset:17600
ds_read_b64_tr_b16 a[200:201], v90 offset:17088
v_mfma_f32_16x16x32_bf16 v[136:139], a[216:219], v[36:39], v[136:139]
ds_read_b64_tr_b16 a[202:203], v90 offset:17600
v_cvt_pk_bf16_f32 v45, v70, v71
v_mfma_f32_16x16x32_bf16 v[136:139], a[184:187], v[32:35], v[136:139]
s_waitcnt lgkmcnt(8)
ds_read_b64_tr_b16 a[204:205], v90 offset:17120
ds_read_b64_tr_b16 a[206:207], v90 offset:17632
v_mfma_f32_16x16x32_bf16 v[140:143], a[188:191], v[32:35], v[140:143]
buffer_load_dwordx4 v97, s[8:11], s21 offen offset:0 nt lds
v_mfma_f32_16x16x32_bf16 v[140:143], a[220:223], v[36:39], v[140:143]
ds_read_b64_tr_b16 a[236:237], v91 offset:17120
ds_read_b64_tr_b16 a[238:239], v91 offset:17632
v_mfma_f32_16x16x32_bf16 v[144:147], a[224:227], v[36:39], v[144:147]
v_exp_f32 v72, v72
v_mfma_f32_16x16x32_bf16 v[144:147], a[192:195], v[32:35], v[144:147]
s_waitcnt lgkmcnt(7)
v_exp_f32 v73, v73
v_mfma_f32_16x16x32_bf16 v[148:151], a[196:199], v[32:35], v[148:151]
v_exp_f32 v74, v74
v_mfma_f32_16x16x32_bf16 v[148:151], a[228:231], v[36:39], v[148:151]
s_waitcnt lgkmcnt(5)
v_exp_f32 v75, v75
v_mfma_f32_16x16x32_bf16 v[152:155], a[232:235], v[36:39], v[152:155]
s_waitcnt lgkmcnt(4)
v_cvt_pk_bf16_f32 v46, v72, v73
v_cvt_pk_bf16_f32 v47, v74, v75
v_mfma_f32_16x16x32_bf16 v[152:155], a[200:203], v[32:35], v[152:155]
s_waitcnt lgkmcnt(2)
v_exp_f32 v76, v76
v_mfma_f32_16x16x32_bf16 v[156:159], a[204:207], v[32:35], v[156:159]
s_waitcnt lgkmcnt(0)
v_exp_f32 v77, v77
v_mfma_f32_16x16x32_bf16 v[156:159], a[236:239], v[36:39], v[156:159]
v_exp_f32 v78, v78
v_smfmac_f32_16x16x64_bf16 a[240:243], a[248:251], v[32:39], v92
v_cvt_pk_bf16_f32 v40, v76, v77
v_mfma_f32_16x16x32_bf16 v[84:87], a[144:147], a[32:35], v[56:59]
v_exp_f32 v79, v79
v_mfma_f32_16x16x32_bf16 v[84:87], a[148:151], a[36:39], v[84:87]
s_xor_b32 s21, s23, 397312
v_exp_f32 v80, v80
v_mfma_f32_16x16x32_bf16 v[84:87], a[152:155], a[40:43], v[84:87]
s_add_u32 m0, s22, 1056
v_exp_f32 v81, v81
v_mfma_f32_16x16x32_bf16 v[84:87], a[156:159], a[44:47], v[84:87]
v_cvt_pk_bf16_f32 v41, v78, v79
v_cvt_pk_bf16_f32 v42, v80, v81
v_mfma_f32_16x16x32_bf16 v[68:71], a[172:175], a[44:47], v[56:59]
buffer_load_dwordx4 v97, s[8:11], s21 offen offset:0 nt lds
v_mfma_f32_16x16x32_bf16 v[68:71], a[168:171], a[40:43], v[68:71]
v_exp_f32 v82, v82
v_mfma_f32_16x16x32_bf16 v[68:71], a[164:167], a[36:39], v[68:71]
v_exp_f32 v83, v83
v_mfma_f32_16x16x32_bf16 v[68:71], a[160:163], a[32:35], v[68:71]
v_exp_f32 v84, v84
v_mfma_f32_16x16x32_bf16 v[72:75], a[112:115], a[32:35], v[56:59]
v_exp_f32 v85, v85
v_mfma_f32_16x16x32_bf16 v[72:75], a[116:119], a[36:39], v[72:75]
v_cvt_pk_bf16_f32 v43, v82, v83
v_cvt_pk_bf16_f32 v36, v84, v85
v_mfma_f32_16x16x32_bf16 v[72:75], a[120:123], a[40:43], v[72:75]
v_exp_f32 v86, v86
v_mfma_f32_16x16x32_bf16 v[72:75], a[124:127], a[44:47], v[72:75]
v_exp_f32 v87, v87
v_mfma_f32_16x16x32_bf16 v[76:79], a[140:143], a[44:47], v[56:59]
v_exp_f32 v68, v68
v_mfma_f32_16x16x32_bf16 v[76:79], a[136:139], a[40:43], v[76:79]
v_exp_f32 v69, v69
v_mfma_f32_16x16x32_bf16 v[76:79], a[132:135], a[36:39], v[76:79]
v_cvt_pk_bf16_f32 v37, v86, v87
v_cvt_pk_bf16_f32 v38, v68, v69
v_mfma_f32_16x16x32_bf16 v[76:79], a[128:131], a[32:35], v[76:79]
v_exp_f32 v70, v70
v_mfma_f32_16x16x32_bf16 v[160:163], a[208:211], v[44:47], v[160:163]
v_exp_f32 v71, v71
v_mfma_f32_16x16x32_bf16 v[160:163], a[176:179], v[40:43], v[160:163]
s_xor_b32 s21, s23, 401408
v_exp_f32 v72, v72
v_mfma_f32_16x16x32_bf16 v[164:167], a[180:183], v[40:43], v[164:167]
s_add_u32 m0, s22, 2112
v_exp_f32 v73, v73
v_mfma_f32_16x16x32_bf16 v[164:167], a[212:215], v[44:47], v[164:167]
v_cvt_pk_bf16_f32 v39, v70, v71
v_cvt_pk_bf16_f32 v32, v72, v73
v_mfma_f32_16x16x32_bf16 v[168:171], a[216:219], v[44:47], v[168:171]
buffer_load_dwordx4 v97, s[8:11], s21 offen offset:0 nt lds
v_mfma_f32_16x16x32_bf16 v[168:171], a[184:187], v[40:43], v[168:171]
v_exp_f32 v74, v74
v_mfma_f32_16x16x32_bf16 v[172:175], a[188:191], v[40:43], v[172:175]
v_exp_f32 v75, v75
v_mfma_f32_16x16x32_bf16 v[172:175], a[220:223], v[44:47], v[172:175]
v_exp_f32 v76, v76
v_mfma_f32_16x16x32_bf16 v[176:179], a[224:227], v[44:47], v[176:179]
v_exp_f32 v77, v77
v_mfma_f32_16x16x32_bf16 v[176:179], a[192:195], v[40:43], v[176:179]
v_cvt_pk_bf16_f32 v33, v74, v75
v_cvt_pk_bf16_f32 v34, v76, v77
v_mfma_f32_16x16x32_bf16 v[180:183], a[196:199], v[40:43], v[180:183]
v_exp_f32 v78, v78
v_mfma_f32_16x16x32_bf16 v[180:183], a[228:231], v[44:47], v[180:183]
v_exp_f32 v79, v79
v_mfma_f32_16x16x32_bf16 v[184:187], a[232:235], v[44:47], v[184:187]
v_cvt_pk_bf16_f32 v35, v78, v79
v_mfma_f32_16x16x32_bf16 v[184:187], a[200:203], v[40:43], v[184:187]
v_mfma_f32_16x16x32_bf16 v[188:191], a[204:207], v[40:43], v[188:191]
v_mfma_f32_16x16x32_bf16 v[188:191], a[236:239], v[44:47], v[188:191]
v_smfmac_f32_16x16x64_bf16 a[240:243], a[252:255], v[40:47], v92
v_mfma_f32_16x16x32_bf16 v[80:83], a[144:147], v[0:3], v[60:63]
v_mfma_f32_16x16x32_bf16 v[80:83], a[148:151], v[4:7], v[80:83]
s_xor_b32 s21, s23, 405504
v_mfma_f32_16x16x32_bf16 v[80:83], a[152:155], v[8:11], v[80:83]
s_add_u32 m0, s22, 3168
v_mfma_f32_16x16x32_bf16 v[80:83], a[156:159], v[12:15], v[80:83]
v_mfma_f32_16x16x32_bf16 v[84:87], a[172:175], v[12:15], v[60:63]
buffer_load_dwordx4 v97, s[8:11], s21 offen offset:0 nt lds
v_mfma_f32_16x16x32_bf16 v[84:87], a[168:171], v[8:11], v[84:87]
v_mfma_f32_16x16x32_bf16 v[84:87], a[164:167], v[4:7], v[84:87]
v_mfma_f32_16x16x32_bf16 v[84:87], a[160:163], v[0:3], v[84:87]
v_mfma_f32_16x16x32_bf16 v[68:71], a[112:115], v[0:3], v[60:63]
v_mfma_f32_16x16x32_bf16 v[68:71], a[116:119], v[4:7], v[68:71]
v_mfma_f32_16x16x32_bf16 v[68:71], a[120:123], v[8:11], v[68:71]
v_exp_f32 v80, v80
v_mfma_f32_16x16x32_bf16 v[68:71], a[124:127], v[12:15], v[68:71]
v_exp_f32 v81, v81
v_mfma_f32_16x16x32_bf16 v[72:75], a[140:143], v[12:15], v[60:63]
v_exp_f32 v82, v82
v_mfma_f32_16x16x32_bf16 v[72:75], a[136:139], v[8:11], v[72:75]
v_exp_f32 v83, v83
v_mfma_f32_16x16x32_bf16 v[72:75], a[132:135], v[4:7], v[72:75]
v_cvt_pk_bf16_f32 v44, v80, v81
v_cvt_pk_bf16_f32 v45, v82, v83
v_mfma_f32_16x16x32_bf16 v[72:75], a[128:131], v[0:3], v[72:75]
v_exp_f32 v84, v84
v_mfma_f32_16x16x32_bf16 v[192:195], a[208:211], v[36:39], v[192:195]
v_exp_f32 v85, v85
v_mfma_f32_16x16x32_bf16 v[192:195], a[176:179], v[32:35], v[192:195]
v_exp_f32 v86, v86
v_mfma_f32_16x16x32_bf16 v[196:199], a[180:183], v[32:35], v[196:199]
s_xor_b32 s21, s23, 393216
v_exp_f32 v87, v87
v_mfma_f32_16x16x32_bf16 v[196:199], a[212:215], v[36:39], v[196:199]
s_add_u32 m0, s22, 50688
v_cvt_pk_bf16_f32 v46, v84, v85
v_cvt_pk_bf16_f32 v47, v86, v87
v_mfma_f32_16x16x32_bf16 v[200:203], a[216:219], v[36:39], v[200:203]
v_exp_f32 v68, v68
v_mfma_f32_16x16x32_bf16 v[200:203], a[184:187], v[32:35], v[200:203]
buffer_load_dwordx4 v97, s[12:15], s21 offen offset:0 nt lds
v_mfma_f32_16x16x32_bf16 v[204:207], a[188:191], v[32:35], v[204:207]
v_exp_f32 v69, v69
v_mfma_f32_16x16x32_bf16 v[204:207], a[220:223], v[36:39], v[204:207]
v_exp_f32 v70, v70
v_mfma_f32_16x16x32_bf16 v[208:211], a[224:227], v[36:39], v[208:211]
v_exp_f32 v71, v71
v_mfma_f32_16x16x32_bf16 v[208:211], a[192:195], v[32:35], v[208:211]
v_exp_f32 v72, v72
v_mfma_f32_16x16x32_bf16 v[212:215], a[196:199], v[32:35], v[212:215]
v_exp_f32 v73, v73
v_mfma_f32_16x16x32_bf16 v[212:215], a[228:231], v[36:39], v[212:215]
v_exp_f32 v74, v74
v_mfma_f32_16x16x32_bf16 v[216:219], a[232:235], v[36:39], v[216:219]
v_exp_f32 v75, v75
v_mfma_f32_16x16x32_bf16 v[216:219], a[200:203], v[32:35], v[216:219]
v_cvt_pk_bf16_f32 v40, v68, v69
v_cvt_pk_bf16_f32 v41, v70, v71
v_mfma_f32_16x16x32_bf16 v[220:223], a[204:207], v[32:35], v[220:223]
s_waitcnt vmcnt(7)
s_barrier
v_mfma_f32_16x16x32_bf16 v[220:223], a[236:239], v[36:39], v[220:223]
v_cvt_pk_bf16_f32 v42, v72, v73
v_cvt_pk_bf16_f32 v43, v74, v75
v_smfmac_f32_16x16x64_bf16 a[244:247], a[248:251], v[32:39], v92
ds_read_b128 a[144:147], v89 offset:33792
v_mfma_f32_16x16x32_bf16 v[76:79], a[112:115], v[16:19], v[64:67]
ds_read_b128 a[148:151], v89 offset:33856
v_mfma_f32_16x16x32_bf16 v[76:79], a[116:119], v[20:23], v[76:79]
s_xor_b32 s21, s23, 397312
ds_read_b128 a[152:155], v89 offset:33920
v_mfma_f32_16x16x32_bf16 v[76:79], a[120:123], v[24:27], v[76:79]
s_add_u32 m0, s22, 51744
ds_read_b128 a[156:159], v89 offset:33984
v_mfma_f32_16x16x32_bf16 v[76:79], a[124:127], v[28:31], v[76:79]
ds_read_b128 a[172:175], v89 offset:34496
v_mfma_f32_16x16x32_bf16 v[80:83], a[140:143], v[28:31], v[64:67]
buffer_load_dwordx4 v97, s[12:15], s21 offen offset:0 nt lds
v_mfma_f32_16x16x32_bf16 v[80:83], a[136:139], v[24:27], v[80:83]
ds_read_b128 a[168:171], v89 offset:34432
v_mfma_f32_16x16x32_bf16 v[80:83], a[132:135], v[20:23], v[80:83]
ds_read_b128 a[164:167], v89 offset:34368
v_mfma_f32_16x16x32_bf16 v[80:83], a[128:131], v[16:19], v[80:83]
v_exp_f32 v76, v76
v_mfma_f32_16x16x32_bf16 v[224:227], a[208:211], v[44:47], v[224:227]
ds_read_b128 a[160:163], v89 offset:34304
v_add_f32 v103, v103, v76
v_mfma_f32_16x16x32_bf16 v[224:227], a[176:179], v[40:43], v[224:227]
v_exp_f32 v77, v77
v_mfma_f32_16x16x32_bf16 v[228:231], a[180:183], v[40:43], v[228:231]
ds_read_b128 a[112:115], v88 offset:33792
v_add_f32 v103, v103, v77
v_mfma_f32_16x16x32_bf16 v[228:231], a[212:215], v[44:47], v[228:231]
ds_read_b128 a[116:119], v88 offset:33856
v_cvt_pk_bf16_f32 v32, v76, v77
v_mfma_f32_16x16x32_bf16 v[232:235], a[216:219], v[44:47], v[232:235]
v_exp_f32 v78, v78
v_mfma_f32_16x16x32_bf16 v[232:235], a[184:187], v[40:43], v[232:235]
ds_read_b128 a[120:123], v88 offset:33920
v_add_f32 v103, v103, v78
v_mfma_f32_16x16x32_bf16 v[236:239], a[188:191], v[40:43], v[236:239]
v_exp_f32 v79, v79
v_mfma_f32_16x16x32_bf16 v[236:239], a[220:223], v[44:47], v[236:239]
ds_read_b128 a[124:127], v88 offset:33984
v_add_f32 v103, v103, v79
v_mfma_f32_16x16x32_bf16 v[240:243], a[224:227], v[44:47], v[240:243]
ds_read_b128 a[140:143], v88 offset:34496
v_cvt_pk_bf16_f32 v33, v78, v79
v_mfma_f32_16x16x32_bf16 v[240:243], a[192:195], v[40:43], v[240:243]
v_exp_f32 v80, v80
v_mfma_f32_16x16x32_bf16 v[244:247], a[196:199], v[40:43], v[244:247]
s_xor_b32 s21, s23, 401408
ds_read_b128 a[136:139], v88 offset:34432
v_add_f32 v103, v103, v80
v_mfma_f32_16x16x32_bf16 v[244:247], a[228:231], v[44:47], v[244:247]
s_add_u32 m0, s22, 52800
v_exp_f32 v81, v81
v_mfma_f32_16x16x32_bf16 v[248:251], a[232:235], v[44:47], v[248:251]
ds_read_b128 a[132:135], v88 offset:34368
v_cvt_pk_bf16_f32 v34, v80, v81
v_mfma_f32_16x16x32_bf16 v[248:251], a[200:203], v[40:43], v[248:251]
buffer_load_dwordx4 v97, s[12:15], s21 offen offset:0 nt lds
v_mfma_f32_16x16x32_bf16 v[252:255], a[204:207], v[40:43], v[252:255]
ds_read_b128 a[128:131], v88 offset:34304
v_add_f32 v103, v103, v81
v_mfma_f32_16x16x32_bf16 v[252:255], a[236:239], v[44:47], v[252:255]
v_exp_f32 v82, v82
v_smfmac_f32_16x16x64_bf16 a[244:247], a[252:255], v[40:47], v92
s_waitcnt lgkmcnt(3)
v_add_f32 v103, v103, v82
v_mfma_f32_16x16x32_bf16 v[84:87], a[144:147], a[0:3], v[48:51]
v_exp_f32 v83, v83
v_mfma_f32_16x16x32_bf16 v[84:87], a[148:151], a[4:7], v[84:87]
v_cvt_pk_bf16_f32 v35, v82, v83
v_add_f32 v103, v103, v83
v_mfma_f32_16x16x32_bf16 v[84:87], a[152:155], a[8:11], v[84:87]
ds_read_b64_tr_b16 a[208:209], v91 offset:33792
ds_read_b64_tr_b16 a[210:211], v91 offset:34304
v_mfma_f32_16x16x32_bf16 v[84:87], a[156:159], a[12:15], v[84:87]
ds_read_b64_tr_b16 a[212:213], v91 offset:33824
v_mfma_f32_16x16x32_bf16 v[68:71], a[172:175], a[12:15], v[48:51]
ds_read_b64_tr_b16 a[214:215], v91 offset:34336
ds_read_b64_tr_b16 a[216:217], v91 offset:33856
v_mfma_f32_16x16x32_bf16 v[68:71], a[168:171], a[8:11], v[68:71]
ds_read_b64_tr_b16 a[218:219], v91 offset:34368
v_mfma_f32_16x16x32_bf16 v[68:71], a[164:167], a[4:7], v[68:71]
ds_read_b64_tr_b16 a[220:221], v91 offset:33888
ds_read_b64_tr_b16 a[222:223], v91 offset:34400
v_mfma_f32_16x16x32_bf16 v[68:71], a[160:163], a[0:3], v[68:71]
v_exp_f32 v84, v84
v_mfma_f32_16x16x32_bf16 v[72:75], a[112:115], a[0:3], v[48:51]
v_exp_f32 v85, v85
v_mfma_f32_16x16x32_bf16 v[72:75], a[116:119], a[4:7], v[72:75]
s_xor_b32 s21, s23, 405504
v_exp_f32 v86, v86
v_mfma_f32_16x16x32_bf16 v[72:75], a[120:123], a[8:11], v[72:75]
s_add_u32 m0, s22, 53856
v_exp_f32 v87, v87
v_mfma_f32_16x16x32_bf16 v[72:75], a[124:127], a[12:15], v[72:75]
s_waitcnt lgkmcnt(5)
v_cvt_pk_bf16_f32 v44, v84, v85
v_cvt_pk_bf16_f32 v45, v86, v87
v_mfma_f32_16x16x32_bf16 v[76:79], a[140:143], a[12:15], v[48:51]
buffer_load_dwordx4 v97, s[12:15], s21 offen offset:0 nt lds
v_mfma_f32_16x16x32_bf16 v[76:79], a[136:139], a[8:11], v[76:79]
v_exp_f32 v68, v68
v_mfma_f32_16x16x32_bf16 v[76:79], a[132:135], a[4:7], v[76:79]
v_exp_f32 v69, v69
v_mfma_f32_16x16x32_bf16 v[76:79], a[128:131], a[0:3], v[76:79]
ds_read_b128 v[112:115], v95 offset:8704
v_cvt_pk_bf16_f32 v46, v68, v69
v_mfma_f32_16x16x32_bf16 a[48:51], a[176:179], v[32:35], a[48:51]
v_exp_f32 v70, v70
v_mfma_f32_16x16x32_bf16 a[52:55], a[180:183], v[32:35], a[52:55]
v_exp_f32 v71, v71
v_mfma_f32_16x16x32_bf16 a[56:59], a[184:187], v[32:35], a[56:59]
ds_read_b64_tr_b16 a[176:177], v90 offset:33792
v_cvt_pk_bf16_f32 v47, v70, v71
v_mfma_f32_16x16x32_bf16 a[60:63], a[188:191], v[32:35], a[60:63]
v_exp_f32 v72, v72
v_mfma_f32_16x16x32_bf16 a[64:67], a[192:195], v[32:35], a[64:67]
v_exp_f32 v73, v73
v_mfma_f32_16x16x32_bf16 a[68:71], a[196:199], v[32:35], a[68:71]
v_exp_f32 v74, v74
v_mfma_f32_16x16x32_bf16 a[72:75], a[200:203], v[32:35], a[72:75]
v_exp_f32 v75, v75
v_mfma_f32_16x16x32_bf16 a[76:79], a[204:207], v[32:35], a[76:79]
ds_read_b64_tr_b16 a[178:179], v90 offset:34304
v_cvt_pk_bf16_f32 v40, v72, v73
v_mfma_f32_16x16x32_bf16 v[80:83], a[144:147], a[16:19], v[52:55]
ds_read_b64_tr_b16 a[180:181], v90 offset:33824
v_cvt_pk_bf16_f32 v41, v74, v75
v_mfma_f32_16x16x32_bf16 v[80:83], a[148:151], a[20:23], v[80:83]
s_add_u32 s33, s31, 8192
ds_read_b64_tr_b16 a[182:183], v90 offset:34336
ds_read_b64_tr_b16 a[184:185], v90 offset:33856
v_mfma_f32_16x16x32_bf16 v[80:83], a[152:155], a[24:27], v[80:83]
v_exp_f32 v76, v76
v_mfma_f32_16x16x32_bf16 v[80:83], a[156:159], a[28:31], v[80:83]
v_exp_f32 v77, v77
v_mfma_f32_16x16x32_bf16 v[84:87], a[172:175], a[28:31], v[52:55]
s_waitcnt lgkmcnt(4)
v_exp_f32 v78, v78
v_mfma_f32_16x16x32_bf16 v[84:87], a[168:171], a[24:27], v[84:87]
buffer_store_dwordx4 v[112:115], v96, s[16:19], s33 offen offset:0 nt
v_mfma_f32_16x16x32_bf16 v[84:87], a[164:167], a[20:23], v[84:87]
v_exp_f32 v79, v79
v_mfma_f32_16x16x32_bf16 v[84:87], a[160:163], a[16:19], v[84:87]
ds_read_b64_tr_b16 a[186:187], v90 offset:34368
v_cvt_pk_bf16_f32 v42, v76, v77
v_mfma_f32_16x16x32_bf16 v[68:71], a[112:115], a[16:19], v[52:55]
ds_read_b64_tr_b16 a[188:189], v90 offset:33888
v_cvt_pk_bf16_f32 v43, v78, v79
v_mfma_f32_16x16x32_bf16 v[68:71], a[116:119], a[20:23], v[68:71]
ds_read_b64_tr_b16 a[190:191], v90 offset:34400
ds_read_b64_tr_b16 a[224:225], v91 offset:33920
v_mfma_f32_16x16x32_bf16 v[68:71], a[120:123], a[24:27], v[68:71]
v_exp_f32 v80, v80
v_mfma_f32_16x16x32_bf16 v[68:71], a[124:127], a[28:31], v[68:71]
ds_read_b64_tr_b16 a[226:227], v91 offset:34432
ds_read_b64_tr_b16 a[192:193], v90 offset:33920
v_mfma_f32_16x16x32_bf16 v[72:75], a[140:143], a[28:31], v[52:55]
v_exp_f32 v81, v81
v_mfma_f32_16x16x32_bf16 v[72:75], a[136:139], a[24:27], v[72:75]
ds_read_b64_tr_b16 a[194:195], v90 offset:34432
ds_read_b64_tr_b16 a[196:197], v90 offset:33952
v_mfma_f32_16x16x32_bf16 v[72:75], a[132:135], a[20:23], v[72:75]
ds_read_b64_tr_b16 a[198:199], v90 offset:34464
v_cvt_pk_bf16_f32 v36, v80, v81
v_mfma_f32_16x16x32_bf16 v[72:75], a[128:131], a[16:19], v[72:75]
ds_read_b64_tr_b16 a[228:229], v91 offset:33952
ds_read_b64_tr_b16 a[230:231], v91 offset:34464
v_mfma_f32_16x16x32_bf16 v[128:131], a[208:211], v[44:47], v[128:131]
s_waitcnt lgkmcnt(9)
v_exp_f32 v82, v82
v_mfma_f32_16x16x32_bf16 v[128:131], a[176:179], v[40:43], v[128:131]
ds_read_b64_tr_b16 a[232:233], v91 offset:33984
ds_read_b64_tr_b16 a[234:235], v91 offset:34496
v_mfma_f32_16x16x32_bf16 v[132:135], a[180:183], v[40:43], v[132:135]
s_xor_b32 s21, s23, 394240
v_exp_f32 v83, v83
v_mfma_f32_16x16x32_bf16 v[132:135], a[212:215], v[44:47], v[132:135]
s_add_u32 m0, s22, 16896
ds_read_b64_tr_b16 a[200:201], v90 offset:33984
ds_read_b64_tr_b16 a[202:203], v90 offset:34496
v_mfma_f32_16x16x32_bf16 v[136:139], a[216:219], v[44:47], v[136:139]
ds_read_b64_tr_b16 a[204:205], v90 offset:34016
v_cvt_pk_bf16_f32 v37, v82, v83
v_mfma_f32_16x16x32_bf16 v[136:139], a[184:187], v[40:43], v[136:139]
s_waitcnt lgkmcnt(8)
ds_read_b64_tr_b16 a[206:207], v90 offset:34528
ds_read_b64_tr_b16 a[236:237], v91 offset:34016
v_mfma_f32_16x16x32_bf16 v[140:143], a[188:191], v[40:43], v[140:143]
buffer_load_dwordx4 v97, s[8:11], s21 offen offset:0 nt lds
v_mfma_f32_16x16x32_bf16 v[140:143], a[220:223], v[44:47], v[140:143]
v_exp_f32 v84, v84
v_mfma_f32_16x16x32_bf16 v[144:147], a[224:227], v[44:47], v[144:147]
ds_read_b64_tr_b16 a[238:239], v91 offset:34528
v_mfma_f32_16x16x32_bf16 v[144:147], a[192:195], v[40:43], v[144:147]
s_waitcnt lgkmcnt(6)
v_exp_f32 v85, v85
v_mfma_f32_16x16x32_bf16 v[148:151], a[196:199], v[40:43], v[148:151]
v_exp_f32 v86, v86
v_mfma_f32_16x16x32_bf16 v[148:151], a[228:231], v[44:47], v[148:151]
v_exp_f32 v87, v87
v_mfma_f32_16x16x32_bf16 v[152:155], a[232:235], v[44:47], v[152:155]
s_waitcnt lgkmcnt(3)
v_cvt_pk_bf16_f32 v38, v84, v85
v_cvt_pk_bf16_f32 v39, v86, v87
v_mfma_f32_16x16x32_bf16 v[152:155], a[200:203], v[40:43], v[152:155]
s_waitcnt lgkmcnt(1)
v_exp_f32 v68, v68
v_mfma_f32_16x16x32_bf16 v[156:159], a[204:207], v[40:43], v[156:159]
s_waitcnt lgkmcnt(0)
v_exp_f32 v69, v69
v_mfma_f32_16x16x32_bf16 v[156:159], a[236:239], v[44:47], v[156:159]
v_exp_f32 v70, v70
v_smfmac_f32_16x16x64_bf16 a[240:243], a[248:251], v[40:47], v92
v_cvt_pk_bf16_f32 v32, v68, v69
v_mfma_f32_16x16x32_bf16 v[76:79], a[144:147], a[32:35], v[56:59]
v_exp_f32 v71, v71
v_mfma_f32_16x16x32_bf16 v[76:79], a[148:151], a[36:39], v[76:79]
v_exp_f32 v72, v72
v_mfma_f32_16x16x32_bf16 v[76:79], a[152:155], a[40:43], v[76:79]
s_xor_b32 s21, s23, 398336
v_exp_f32 v73, v73
v_mfma_f32_16x16x32_bf16 v[76:79], a[156:159], a[44:47], v[76:79]
s_add_u32 m0, s22, 17952
v_cvt_pk_bf16_f32 v33, v70, v71
v_cvt_pk_bf16_f32 v34, v72, v73
v_mfma_f32_16x16x32_bf16 v[80:83], a[172:175], a[44:47], v[56:59]
v_exp_f32 v74, v74
v_mfma_f32_16x16x32_bf16 v[80:83], a[168:171], a[40:43], v[80:83]
buffer_load_dwordx4 v97, s[8:11], s21 offen offset:0 nt lds
v_mfma_f32_16x16x32_bf16 v[80:83], a[164:167], a[36:39], v[80:83]
v_exp_f32 v75, v75
v_mfma_f32_16x16x32_bf16 v[80:83], a[160:163], a[32:35], v[80:83]
v_exp_f32 v76, v76
v_mfma_f32_16x16x32_bf16 v[84:87], a[112:115], a[32:35], v[56:59]
v_exp_f32 v77, v77
v_mfma_f32_16x16x32_bf16 v[84:87], a[116:119], a[36:39], v[84:87]
v_cvt_pk_bf16_f32 v35, v74, v75
v_cvt_pk_bf16_f32 v44, v76, v77
v_mfma_f32_16x16x32_bf16 v[84:87], a[120:123], a[40:43], v[84:87]
v_exp_f32 v78, v78
v_mfma_f32_16x16x32_bf16 v[84:87], a[124:127], a[44:47], v[84:87]
v_exp_f32 v79, v79
v_mfma_f32_16x16x32_bf16 v[68:71], a[140:143], a[44:47], v[56:59]
v_exp_f32 v80, v80
v_mfma_f32_16x16x32_bf16 v[68:71], a[136:139], a[40:43], v[68:71]
v_exp_f32 v81, v81
v_mfma_f32_16x16x32_bf16 v[68:71], a[132:135], a[36:39], v[68:71]
v_cvt_pk_bf16_f32 v45, v78, v79
v_cvt_pk_bf16_f32 v46, v80, v81
v_mfma_f32_16x16x32_bf16 v[68:71], a[128:131], a[32:35], v[68:71]
v_exp_f32 v82, v82
v_mfma_f32_16x16x32_bf16 v[160:163], a[208:211], v[36:39], v[160:163]
v_exp_f32 v83, v83
v_mfma_f32_16x16x32_bf16 v[160:163], a[176:179], v[32:35], v[160:163]
v_exp_f32 v84, v84
v_mfma_f32_16x16x32_bf16 v[164:167], a[180:183], v[32:35], v[164:167]
v_exp_f32 v85, v85
v_mfma_f32_16x16x32_bf16 v[164:167], a[212:215], v[36:39], v[164:167]
s_xor_b32 s21, s23, 402432
v_cvt_pk_bf16_f32 v47, v82, v83
v_cvt_pk_bf16_f32 v40, v84, v85
v_mfma_f32_16x16x32_bf16 v[168:171], a[216:219], v[36:39], v[168:171]
s_add_u32 m0, s22, 19008
v_exp_f32 v86, v86
v_mfma_f32_16x16x32_bf16 v[168:171], a[184:187], v[32:35], v[168:171]
v_exp_f32 v87, v87
v_mfma_f32_16x16x32_bf16 v[172:175], a[188:191], v[32:35], v[172:175]
buffer_load_dwordx4 v97, s[8:11], s21 offen offset:0 nt lds
v_mfma_f32_16x16x32_bf16 v[172:175], a[220:223], v[36:39], v[172:175]
v_exp_f32 v68, v68
v_mfma_f32_16x16x32_bf16 v[176:179], a[224:227], v[36:39], v[176:179]
v_exp_f32 v69, v69
v_mfma_f32_16x16x32_bf16 v[176:179], a[192:195], v[32:35], v[176:179]
v_cvt_pk_bf16_f32 v41, v86, v87
v_cvt_pk_bf16_f32 v42, v68, v69
v_mfma_f32_16x16x32_bf16 v[180:183], a[196:199], v[32:35], v[180:183]
v_exp_f32 v70, v70
v_mfma_f32_16x16x32_bf16 v[180:183], a[228:231], v[36:39], v[180:183]
v_exp_f32 v71, v71
v_mfma_f32_16x16x32_bf16 v[184:187], a[232:235], v[36:39], v[184:187]
v_cvt_pk_bf16_f32 v43, v70, v71
v_mfma_f32_16x16x32_bf16 v[184:187], a[200:203], v[32:35], v[184:187]
v_mfma_f32_16x16x32_bf16 v[188:191], a[204:207], v[32:35], v[188:191]
v_mfma_f32_16x16x32_bf16 v[188:191], a[236:239], v[36:39], v[188:191]
v_smfmac_f32_16x16x64_bf16 a[240:243], a[252:255], v[32:39], v92
v_mfma_f32_16x16x32_bf16 v[72:75], a[144:147], v[0:3], v[60:63]
v_mfma_f32_16x16x32_bf16 v[72:75], a[148:151], v[4:7], v[72:75]
v_mfma_f32_16x16x32_bf16 v[72:75], a[152:155], v[8:11], v[72:75]
s_xor_b32 s21, s23, 406528
v_mfma_f32_16x16x32_bf16 v[72:75], a[156:159], v[12:15], v[72:75]
s_add_u32 m0, s22, 20064
v_mfma_f32_16x16x32_bf16 v[76:79], a[172:175], v[12:15], v[60:63]
v_mfma_f32_16x16x32_bf16 v[76:79], a[168:171], v[8:11], v[76:79]
buffer_load_dwordx4 v97, s[8:11], s21 offen offset:0 nt lds
v_mfma_f32_16x16x32_bf16 v[76:79], a[164:167], v[4:7], v[76:79]
v_mfma_f32_16x16x32_bf16 v[76:79], a[160:163], v[0:3], v[76:79]
v_mfma_f32_16x16x32_bf16 v[80:83], a[112:115], v[0:3], v[60:63]
v_mfma_f32_16x16x32_bf16 v[80:83], a[116:119], v[4:7], v[80:83]
v_exp_f32 v72, v72
v_mfma_f32_16x16x32_bf16 v[80:83], a[120:123], v[8:11], v[80:83]
v_exp_f32 v73, v73
v_mfma_f32_16x16x32_bf16 v[80:83], a[124:127], v[12:15], v[80:83]
v_exp_f32 v74, v74
v_mfma_f32_16x16x32_bf16 v[84:87], a[140:143], v[12:15], v[60:63]
v_exp_f32 v75, v75
v_mfma_f32_16x16x32_bf16 v[84:87], a[136:139], v[8:11], v[84:87]
v_cvt_pk_bf16_f32 v36, v72, v73
v_cvt_pk_bf16_f32 v37, v74, v75
v_mfma_f32_16x16x32_bf16 v[84:87], a[132:135], v[4:7], v[84:87]
v_exp_f32 v76, v76
v_mfma_f32_16x16x32_bf16 v[84:87], a[128:131], v[0:3], v[84:87]
v_exp_f32 v77, v77
v_mfma_f32_16x16x32_bf16 v[192:195], a[208:211], v[44:47], v[192:195]
v_exp_f32 v78, v78
v_mfma_f32_16x16x32_bf16 v[192:195], a[176:179], v[40:43], v[192:195]
v_exp_f32 v79, v79
v_mfma_f32_16x16x32_bf16 v[196:199], a[180:183], v[40:43], v[196:199]
v_cvt_pk_bf16_f32 v38, v76, v77
v_cvt_pk_bf16_f32 v39, v78, v79
v_mfma_f32_16x16x32_bf16 v[196:199], a[212:215], v[44:47], v[196:199]
s_xor_b32 s21, s23, 394240
v_exp_f32 v80, v80
v_mfma_f32_16x16x32_bf16 v[200:203], a[216:219], v[44:47], v[200:203]
s_add_u32 m0, s22, 67584
v_exp_f32 v81, v81
v_mfma_f32_16x16x32_bf16 v[200:203], a[184:187], v[40:43], v[200:203]
v_exp_f32 v82, v82
v_mfma_f32_16x16x32_bf16 v[204:207], a[188:191], v[40:43], v[204:207]
buffer_load_dwordx4 v97, s[12:15], s21 offen offset:0 nt lds
v_mfma_f32_16x16x32_bf16 v[204:207], a[220:223], v[44:47], v[204:207]
v_exp_f32 v83, v83
v_mfma_f32_16x16x32_bf16 v[208:211], a[224:227], v[44:47], v[208:211]
v_exp_f32 v84, v84
v_mfma_f32_16x16x32_bf16 v[208:211], a[192:195], v[40:43], v[208:211]
v_exp_f32 v85, v85
v_mfma_f32_16x16x32_bf16 v[212:215], a[196:199], v[40:43], v[212:215]
v_exp_f32 v86, v86
v_mfma_f32_16x16x32_bf16 v[212:215], a[228:231], v[44:47], v[212:215]
v_exp_f32 v87, v87
v_mfma_f32_16x16x32_bf16 v[216:219], a[232:235], v[44:47], v[216:219]
v_cvt_pk_bf16_f32 v32, v80, v81
v_cvt_pk_bf16_f32 v33, v82, v83
v_mfma_f32_16x16x32_bf16 v[216:219], a[200:203], v[40:43], v[216:219]
v_cvt_pk_bf16_f32 v34, v84, v85
v_cvt_pk_bf16_f32 v35, v86, v87
v_mfma_f32_16x16x32_bf16 v[220:223], a[204:207], v[40:43], v[220:223]
s_waitcnt vmcnt(6)
s_barrier
v_mfma_f32_16x16x32_bf16 v[220:223], a[236:239], v[44:47], v[220:223]
ds_read_b128 a[144:147], v89 offset:0
v_smfmac_f32_16x16x64_bf16 a[244:247], a[248:251], v[40:47], v92
ds_read_b128 a[148:151], v89 offset:64
v_mfma_f32_16x16x32_bf16 v[68:71], a[112:115], v[16:19], v[64:67]
ds_read_b128 a[152:155], v89 offset:128
v_mfma_f32_16x16x32_bf16 v[68:71], a[116:119], v[20:23], v[68:71]
ds_read_b128 a[156:159], v89 offset:192
v_mfma_f32_16x16x32_bf16 v[68:71], a[120:123], v[24:27], v[68:71]
s_xor_b32 s21, s23, 398336
ds_read_b128 a[172:175], v89 offset:704
v_mfma_f32_16x16x32_bf16 v[68:71], a[124:127], v[28:31], v[68:71]
s_add_u32 m0, s22, 68640
ds_read_b128 a[168:171], v89 offset:640
v_mfma_f32_16x16x32_bf16 v[72:75], a[140:143], v[28:31], v[64:67]
ds_read_b128 a[164:167], v89 offset:576
v_mfma_f32_16x16x32_bf16 v[72:75], a[136:139], v[24:27], v[72:75]
buffer_load_dwordx4 v97, s[12:15], s21 offen offset:0 nt lds
v_mfma_f32_16x16x32_bf16 v[72:75], a[132:135], v[20:23], v[72:75]
ds_read_b128 a[160:163], v89 offset:512
v_mfma_f32_16x16x32_bf16 v[72:75], a[128:131], v[16:19], v[72:75]
v_exp_f32 v68, v68
v_mfma_f32_16x16x32_bf16 v[224:227], a[208:211], v[36:39], v[224:227]
ds_read_b128 a[112:115], v88 offset:0
v_add_f32 v103, v103, v68
v_mfma_f32_16x16x32_bf16 v[224:227], a[176:179], v[32:35], v[224:227]
v_exp_f32 v69, v69
v_mfma_f32_16x16x32_bf16 v[228:231], a[180:183], v[32:35], v[228:231]
ds_read_b128 a[116:119], v88 offset:64
v_add_f32 v103, v103, v69
v_mfma_f32_16x16x32_bf16 v[228:231], a[212:215], v[36:39], v[228:231]
ds_read_b128 a[120:123], v88 offset:128
v_cvt_pk_bf16_f32 v40, v68, v69
v_mfma_f32_16x16x32_bf16 v[232:235], a[216:219], v[36:39], v[232:235]
v_exp_f32 v70, v70
v_mfma_f32_16x16x32_bf16 v[232:235], a[184:187], v[32:35], v[232:235]
ds_read_b128 a[124:127], v88 offset:192
v_add_f32 v103, v103, v70
v_mfma_f32_16x16x32_bf16 v[236:239], a[188:191], v[32:35], v[236:239]
v_exp_f32 v71, v71
v_mfma_f32_16x16x32_bf16 v[236:239], a[220:223], v[36:39], v[236:239]
ds_read_b128 a[140:143], v88 offset:704
v_add_f32 v103, v103, v71
v_mfma_f32_16x16x32_bf16 v[240:243], a[224:227], v[36:39], v[240:243]
ds_read_b128 a[136:139], v88 offset:640
v_cvt_pk_bf16_f32 v41, v70, v71
v_mfma_f32_16x16x32_bf16 v[240:243], a[192:195], v[32:35], v[240:243]
v_exp_f32 v72, v72
v_mfma_f32_16x16x32_bf16 v[244:247], a[196:199], v[32:35], v[244:247]
ds_read_b128 a[132:135], v88 offset:576
v_add_f32 v103, v103, v72
v_mfma_f32_16x16x32_bf16 v[244:247], a[228:231], v[36:39], v[244:247]
s_xor_b32 s21, s23, 402432
v_exp_f32 v73, v73
v_mfma_f32_16x16x32_bf16 v[248:251], a[232:235], v[36:39], v[248:251]
s_add_u32 m0, s22, 69696
ds_read_b128 a[128:131], v88 offset:512
v_cvt_pk_bf16_f32 v42, v72, v73
v_mfma_f32_16x16x32_bf16 v[248:251], a[200:203], v[32:35], v[248:251]
v_exp_f32 v74, v74
v_mfma_f32_16x16x32_bf16 v[252:255], a[204:207], v[32:35], v[252:255]
buffer_load_dwordx4 v97, s[12:15], s21 offen offset:0 nt lds
v_mfma_f32_16x16x32_bf16 v[252:255], a[236:239], v[36:39], v[252:255]
v_exp_f32 v75, v75
v_smfmac_f32_16x16x64_bf16 a[244:247], a[252:255], v[32:39], v92
s_waitcnt lgkmcnt(2)
v_cvt_pk_bf16_f32 v43, v74, v75
v_mfma_f32_16x16x32_bf16 v[76:79], a[144:147], a[0:3], v[48:51]
v_add_f32 v103, v103, v73
v_add_f32 v103, v103, v74
v_mfma_f32_16x16x32_bf16 v[76:79], a[148:151], a[4:7], v[76:79]
ds_read_b64_tr_b16 a[208:209], v91 offset:0
v_add_f32 v103, v103, v75
v_mfma_f32_16x16x32_bf16 v[76:79], a[152:155], a[8:11], v[76:79]
ds_read_b64_tr_b16 a[210:211], v91 offset:512
ds_read_b64_tr_b16 a[212:213], v91 offset:32
v_mfma_f32_16x16x32_bf16 v[76:79], a[156:159], a[12:15], v[76:79]
ds_read_b64_tr_b16 a[214:215], v91 offset:544
v_mfma_f32_16x16x32_bf16 v[80:83], a[172:175], a[12:15], v[48:51]
ds_read_b64_tr_b16 a[216:217], v91 offset:64
ds_read_b64_tr_b16 a[218:219], v91 offset:576
v_mfma_f32_16x16x32_bf16 v[80:83], a[168:171], a[8:11], v[80:83]
ds_read_b64_tr_b16 a[220:221], v91 offset:96
v_mfma_f32_16x16x32_bf16 v[80:83], a[164:167], a[4:7], v[80:83]
ds_read_b64_tr_b16 a[222:223], v91 offset:608
ds_read_b64_tr_b16 a[224:225], v91 offset:128
v_mfma_f32_16x16x32_bf16 v[80:83], a[160:163], a[0:3], v[80:83]
v_exp_f32 v76, v76
v_mfma_f32_16x16x32_bf16 v[84:87], a[112:115], a[0:3], v[48:51]
v_exp_f32 v77, v77
v_mfma_f32_16x16x32_bf16 v[84:87], a[116:119], a[4:7], v[84:87]
v_exp_f32 v78, v78
v_mfma_f32_16x16x32_bf16 v[84:87], a[120:123], a[8:11], v[84:87]
s_xor_b32 s21, s23, 406528
v_exp_f32 v79, v79
v_mfma_f32_16x16x32_bf16 v[84:87], a[124:127], a[12:15], v[84:87]
s_add_u32 m0, s22, 70752
v_cvt_pk_bf16_f32 v36, v76, v77
v_cvt_pk_bf16_f32 v37, v78, v79
v_mfma_f32_16x16x32_bf16 v[68:71], a[140:143], a[12:15], v[48:51]
s_waitcnt lgkmcnt(3)
v_exp_f32 v80, v80
v_mfma_f32_16x16x32_bf16 v[68:71], a[136:139], a[8:11], v[68:71]
buffer_load_dwordx4 v97, s[12:15], s21 offen offset:0 nt lds
v_mfma_f32_16x16x32_bf16 v[68:71], a[132:135], a[4:7], v[68:71]
v_exp_f32 v81, v81
v_mfma_f32_16x16x32_bf16 v[68:71], a[128:131], a[0:3], v[68:71]
v_exp_f32 v82, v82
v_mfma_f32_16x16x32_bf16 a[48:51], a[176:179], v[40:43], a[48:51]
ds_read_b128 v[108:111], v95 offset:9792
v_cvt_pk_bf16_f32 v38, v80, v81
v_mfma_f32_16x16x32_bf16 a[52:55], a[180:183], v[40:43], a[52:55]
v_exp_f32 v83, v83
v_mfma_f32_16x16x32_bf16 a[56:59], a[184:187], v[40:43], a[56:59]
ds_read_b64_tr_b16 a[176:177], v90 offset:0
v_cvt_pk_bf16_f32 v39, v82, v83
v_mfma_f32_16x16x32_bf16 a[60:63], a[188:191], v[40:43], a[60:63]
v_exp_f32 v84, v84
v_mfma_f32_16x16x32_bf16 a[64:67], a[192:195], v[40:43], a[64:67]
v_exp_f32 v85, v85
v_mfma_f32_16x16x32_bf16 a[68:71], a[196:199], v[40:43], a[68:71]
v_exp_f32 v86, v86
v_mfma_f32_16x16x32_bf16 a[72:75], a[200:203], v[40:43], a[72:75]
v_exp_f32 v87, v87
v_mfma_f32_16x16x32_bf16 a[76:79], a[204:207], v[40:43], a[76:79]
ds_read_b64_tr_b16 a[178:179], v90 offset:512
v_cvt_pk_bf16_f32 v32, v84, v85
v_mfma_f32_16x16x32_bf16 v[72:75], a[144:147], a[16:19], v[52:55]
ds_read_b64_tr_b16 a[180:181], v90 offset:32
v_cvt_pk_bf16_f32 v33, v86, v87
v_mfma_f32_16x16x32_bf16 v[72:75], a[148:151], a[20:23], v[72:75]
ds_read_b64_tr_b16 a[182:183], v90 offset:544
ds_read_b64_tr_b16 a[184:185], v90 offset:64
v_mfma_f32_16x16x32_bf16 v[72:75], a[152:155], a[24:27], v[72:75]
v_exp_f32 v68, v68
v_mfma_f32_16x16x32_bf16 v[72:75], a[156:159], a[28:31], v[72:75]
v_exp_f32 v69, v69
v_mfma_f32_16x16x32_bf16 v[76:79], a[172:175], a[28:31], v[52:55]
v_exp_f32 v70, v70
v_mfma_f32_16x16x32_bf16 v[76:79], a[168:171], a[24:27], v[76:79]
s_waitcnt lgkmcnt(4)
v_exp_f32 v71, v71
v_mfma_f32_16x16x32_bf16 v[76:79], a[164:167], a[20:23], v[76:79]
buffer_store_dwordx4 v[108:111], v96, s[16:19], s33 offen offset:1024 nt
v_mfma_f32_16x16x32_bf16 v[76:79], a[160:163], a[16:19], v[76:79]
ds_read_b64_tr_b16 a[186:187], v90 offset:576
v_cvt_pk_bf16_f32 v34, v68, v69
v_mfma_f32_16x16x32_bf16 v[80:83], a[112:115], a[16:19], v[52:55]
ds_read_b64_tr_b16 a[188:189], v90 offset:96
v_cvt_pk_bf16_f32 v35, v70, v71
v_mfma_f32_16x16x32_bf16 v[80:83], a[116:119], a[20:23], v[80:83]
ds_read_b64_tr_b16 a[190:191], v90 offset:608
ds_read_b64_tr_b16 a[226:227], v91 offset:640
v_mfma_f32_16x16x32_bf16 v[80:83], a[120:123], a[24:27], v[80:83]
v_exp_f32 v72, v72
v_mfma_f32_16x16x32_bf16 v[80:83], a[124:127], a[28:31], v[80:83]
ds_read_b64_tr_b16 a[192:193], v90 offset:128
ds_read_b64_tr_b16 a[194:195], v90 offset:640
v_mfma_f32_16x16x32_bf16 v[84:87], a[140:143], a[28:31], v[52:55]
v_exp_f32 v73, v73
v_mfma_f32_16x16x32_bf16 v[84:87], a[136:139], a[24:27], v[84:87]
ds_read_b64_tr_b16 a[196:197], v90 offset:160
ds_read_b64_tr_b16 a[198:199], v90 offset:672
v_mfma_f32_16x16x32_bf16 v[84:87], a[132:135], a[20:23], v[84:87]
ds_read_b64_tr_b16 a[228:229], v91 offset:160
v_cvt_pk_bf16_f32 v44, v72, v73
v_mfma_f32_16x16x32_bf16 v[84:87], a[128:131], a[16:19], v[84:87]
ds_read_b64_tr_b16 a[230:231], v91 offset:672
ds_read_b64_tr_b16 a[232:233], v91 offset:192
v_mfma_f32_16x16x32_bf16 v[128:131], a[208:211], v[36:39], v[128:131]
s_waitcnt lgkmcnt(9)
v_exp_f32 v74, v74
v_mfma_f32_16x16x32_bf16 v[128:131], a[176:179], v[32:35], v[128:131]
ds_read_b64_tr_b16 a[234:235], v91 offset:704
ds_read_b64_tr_b16 a[200:201], v90 offset:192
v_mfma_f32_16x16x32_bf16 v[132:135], a[180:183], v[32:35], v[132:135]
v_exp_f32 v75, v75
v_mfma_f32_16x16x32_bf16 v[132:135], a[212:215], v[36:39], v[132:135]
s_xor_b32 s21, s23, 395264
ds_read_b64_tr_b16 a[202:203], v90 offset:704
ds_read_b64_tr_b16 a[204:205], v90 offset:224
v_mfma_f32_16x16x32_bf16 v[136:139], a[216:219], v[36:39], v[136:139]
s_add_u32 m0, s22, 33792
ds_read_b64_tr_b16 a[206:207], v90 offset:736
v_cvt_pk_bf16_f32 v45, v74, v75
v_mfma_f32_16x16x32_bf16 v[136:139], a[184:187], v[32:35], v[136:139]
s_waitcnt lgkmcnt(8)
ds_read_b64_tr_b16 a[236:237], v91 offset:224
ds_read_b64_tr_b16 a[238:239], v91 offset:736
v_mfma_f32_16x16x32_bf16 v[140:143], a[188:191], v[32:35], v[140:143]
buffer_load_dwordx4 v97, s[8:11], s21 offen offset:0 nt lds
v_mfma_f32_16x16x32_bf16 v[140:143], a[220:223], v[36:39], v[140:143]
v_exp_f32 v76, v76
v_mfma_f32_16x16x32_bf16 v[144:147], a[224:227], v[36:39], v[144:147]
v_exp_f32 v77, v77
v_mfma_f32_16x16x32_bf16 v[144:147], a[192:195], v[32:35], v[144:147]
v_exp_f32 v78, v78
v_mfma_f32_16x16x32_bf16 v[148:151], a[196:199], v[32:35], v[148:151]
s_waitcnt lgkmcnt(5)
v_exp_f32 v79, v79
v_mfma_f32_16x16x32_bf16 v[148:151], a[228:231], v[36:39], v[148:151]
v_cvt_pk_bf16_f32 v46, v76, v77
v_cvt_pk_bf16_f32 v47, v78, v79
v_mfma_f32_16x16x32_bf16 v[152:155], a[232:235], v[36:39], v[152:155]
s_waitcnt lgkmcnt(2)
v_exp_f32 v80, v80
v_mfma_f32_16x16x32_bf16 v[152:155], a[200:203], v[32:35], v[152:155]
v_exp_f32 v81, v81
v_mfma_f32_16x16x32_bf16 v[156:159], a[204:207], v[32:35], v[156:159]
s_waitcnt lgkmcnt(0)
v_exp_f32 v82, v82
v_mfma_f32_16x16x32_bf16 v[156:159], a[236:239], v[36:39], v[156:159]
v_exp_f32 v83, v83
v_smfmac_f32_16x16x64_bf16 a[240:243], a[248:251], v[32:39], v92
v_cvt_pk_bf16_f32 v40, v80, v81
v_mfma_f32_16x16x32_bf16 v[68:71], a[144:147], a[32:35], v[56:59]
v_exp_f32 v84, v84
v_mfma_f32_16x16x32_bf16 v[68:71], a[148:151], a[36:39], v[68:71]
v_exp_f32 v85, v85
v_mfma_f32_16x16x32_bf16 v[68:71], a[152:155], a[40:43], v[68:71]
v_cvt_pk_bf16_f32 v41, v82, v83
v_cvt_pk_bf16_f32 v42, v84, v85
v_mfma_f32_16x16x32_bf16 v[68:71], a[156:159], a[44:47], v[68:71]
s_xor_b32 s21, s23, 399360
v_exp_f32 v86, v86
v_mfma_f32_16x16x32_bf16 v[72:75], a[172:175], a[44:47], v[56:59]
s_add_u32 m0, s22, 34848
v_exp_f32 v87, v87
v_mfma_f32_16x16x32_bf16 v[72:75], a[168:171], a[40:43], v[72:75]
v_cvt_pk_bf16_f32 v43, v86, v87
v_mfma_f32_16x16x32_bf16 v[72:75], a[164:167], a[36:39], v[72:75]
buffer_load_dwordx4 v97, s[8:11], s21 offen offset:0 nt lds
v_mfma_f32_16x16x32_bf16 v[72:75], a[160:163], a[32:35], v[72:75]
v_exp_f32 v68, v68
v_mfma_f32_16x16x32_bf16 v[76:79], a[112:115], a[32:35], v[56:59]
v_exp_f32 v69, v69
v_mfma_f32_16x16x32_bf16 v[76:79], a[116:119], a[36:39], v[76:79]
v_exp_f32 v70, v70
v_mfma_f32_16x16x32_bf16 v[76:79], a[120:123], a[40:43], v[76:79]
v_exp_f32 v71, v71
v_mfma_f32_16x16x32_bf16 v[76:79], a[124:127], a[44:47], v[76:79]
v_cvt_pk_bf16_f32 v36, v68, v69
v_cvt_pk_bf16_f32 v37, v70, v71
v_mfma_f32_16x16x32_bf16 v[80:83], a[140:143], a[44:47], v[56:59]
v_exp_f32 v72, v72
v_mfma_f32_16x16x32_bf16 v[80:83], a[136:139], a[40:43], v[80:83]
v_exp_f32 v73, v73
v_mfma_f32_16x16x32_bf16 v[80:83], a[132:135], a[36:39], v[80:83]
v_exp_f32 v74, v74
v_mfma_f32_16x16x32_bf16 v[80:83], a[128:131], a[32:35], v[80:83]
v_exp_f32 v75, v75
v_mfma_f32_16x16x32_bf16 v[160:163], a[208:211], v[44:47], v[160:163]
v_cvt_pk_bf16_f32 v38, v72, v73
v_cvt_pk_bf16_f32 v39, v74, v75
v_mfma_f32_16x16x32_bf16 v[160:163], a[176:179], v[40:43], v[160:163]
v_exp_f32 v76, v76
v_mfma_f32_16x16x32_bf16 v[164:167], a[180:183], v[40:43], v[164:167]
v_exp_f32 v77, v77
v_mfma_f32_16x16x32_bf16 v[164:167], a[212:215], v[44:47], v[164:167]
s_xor_b32 s21, s23, 403456
v_exp_f32 v78, v78
v_mfma_f32_16x16x32_bf16 v[168:171], a[216:219], v[44:47], v[168:171]
s_add_u32 m0, s22, 35904
v_exp_f32 v79, v79
v_mfma_f32_16x16x32_bf16 v[168:171], a[184:187], v[40:43], v[168:171]
v_cvt_pk_bf16_f32 v32, v76, v77
v_cvt_pk_bf16_f32 v33, v78, v79
v_mfma_f32_16x16x32_bf16 v[172:175], a[188:191], v[40:43], v[172:175]
buffer_load_dwordx4 v97, s[8:11], s21 offen offset:0 nt lds
v_mfma_f32_16x16x32_bf16 v[172:175], a[220:223], v[44:47], v[172:175]
v_exp_f32 v80, v80
v_mfma_f32_16x16x32_bf16 v[176:179], a[224:227], v[44:47], v[176:179]
v_exp_f32 v81, v81
v_mfma_f32_16x16x32_bf16 v[176:179], a[192:195], v[40:43], v[176:179]
v_exp_f32 v82, v82
v_mfma_f32_16x16x32_bf16 v[180:183], a[196:199], v[40:43], v[180:183]
v_exp_f32 v83, v83
v_mfma_f32_16x16x32_bf16 v[180:183], a[228:231], v[44:47], v[180:183]
v_cvt_pk_bf16_f32 v34, v80, v81
v_cvt_pk_bf16_f32 v35, v82, v83
v_mfma_f32_16x16x32_bf16 v[184:187], a[232:235], v[44:47], v[184:187]
v_mfma_f32_16x16x32_bf16 v[184:187], a[200:203], v[40:43], v[184:187]
v_mfma_f32_16x16x32_bf16 v[188:191], a[204:207], v[40:43], v[188:191]
v_mfma_f32_16x16x32_bf16 v[188:191], a[236:239], v[44:47], v[188:191]
v_smfmac_f32_16x16x64_bf16 a[240:243], a[252:255], v[40:47], v92
v_mfma_f32_16x16x32_bf16 v[84:87], a[144:147], v[0:3], v[60:63]
v_mfma_f32_16x16x32_bf16 v[84:87], a[148:151], v[4:7], v[84:87]
v_mfma_f32_16x16x32_bf16 v[84:87], a[152:155], v[8:11], v[84:87]
v_mfma_f32_16x16x32_bf16 v[84:87], a[156:159], v[12:15], v[84:87]
s_xor_b32 s21, s23, 407552
v_mfma_f32_16x16x32_bf16 v[68:71], a[172:175], v[12:15], v[60:63]
s_add_u32 m0, s22, 36960
v_mfma_f32_16x16x32_bf16 v[68:71], a[168:171], v[8:11], v[68:71]
v_mfma_f32_16x16x32_bf16 v[68:71], a[164:167], v[4:7], v[68:71]
buffer_load_dwordx4 v97, s[8:11], s21 offen offset:0 nt lds
v_mfma_f32_16x16x32_bf16 v[68:71], a[160:163], v[0:3], v[68:71]
v_mfma_f32_16x16x32_bf16 v[72:75], a[112:115], v[0:3], v[60:63]
v_exp_f32 v84, v84
v_mfma_f32_16x16x32_bf16 v[72:75], a[116:119], v[4:7], v[72:75]
v_exp_f32 v85, v85
v_mfma_f32_16x16x32_bf16 v[72:75], a[120:123], v[8:11], v[72:75]
v_exp_f32 v86, v86
v_mfma_f32_16x16x32_bf16 v[72:75], a[124:127], v[12:15], v[72:75]
v_exp_f32 v87, v87
v_mfma_f32_16x16x32_bf16 v[76:79], a[140:143], v[12:15], v[60:63]
v_cvt_pk_bf16_f32 v44, v84, v85
v_cvt_pk_bf16_f32 v45, v86, v87
v_mfma_f32_16x16x32_bf16 v[76:79], a[136:139], v[8:11], v[76:79]
v_exp_f32 v68, v68
v_mfma_f32_16x16x32_bf16 v[76:79], a[132:135], v[4:7], v[76:79]
v_exp_f32 v69, v69
v_mfma_f32_16x16x32_bf16 v[76:79], a[128:131], v[0:3], v[76:79]
v_exp_f32 v70, v70
v_mfma_f32_16x16x32_bf16 v[192:195], a[208:211], v[36:39], v[192:195]
v_exp_f32 v71, v71
v_mfma_f32_16x16x32_bf16 v[192:195], a[176:179], v[32:35], v[192:195]
v_cvt_pk_bf16_f32 v46, v68, v69
v_cvt_pk_bf16_f32 v47, v70, v71
v_mfma_f32_16x16x32_bf16 v[196:199], a[180:183], v[32:35], v[196:199]
v_exp_f32 v72, v72
v_mfma_f32_16x16x32_bf16 v[196:199], a[212:215], v[36:39], v[196:199]
v_exp_f32 v73, v73
v_mfma_f32_16x16x32_bf16 v[200:203], a[216:219], v[36:39], v[200:203]
s_xor_b32 s21, s23, 395264
v_exp_f32 v74, v74
v_mfma_f32_16x16x32_bf16 v[200:203], a[184:187], v[32:35], v[200:203]
s_add_u32 m0, s22, 84480
v_exp_f32 v75, v75
v_mfma_f32_16x16x32_bf16 v[204:207], a[188:191], v[32:35], v[204:207]
v_exp_f32 v76, v76
v_mfma_f32_16x16x32_bf16 v[204:207], a[220:223], v[36:39], v[204:207]
buffer_load_dwordx4 v97, s[12:15], s21 offen offset:0 nt lds
v_mfma_f32_16x16x32_bf16 v[208:211], a[224:227], v[36:39], v[208:211]
v_exp_f32 v77, v77
v_mfma_f32_16x16x32_bf16 v[208:211], a[192:195], v[32:35], v[208:211]
v_exp_f32 v78, v78
v_mfma_f32_16x16x32_bf16 v[212:215], a[196:199], v[32:35], v[212:215]
v_exp_f32 v79, v79
v_mfma_f32_16x16x32_bf16 v[212:215], a[228:231], v[36:39], v[212:215]
v_cvt_pk_bf16_f32 v40, v72, v73
v_cvt_pk_bf16_f32 v41, v74, v75
v_mfma_f32_16x16x32_bf16 v[216:219], a[232:235], v[36:39], v[216:219]
v_cvt_pk_bf16_f32 v42, v76, v77
v_cvt_pk_bf16_f32 v43, v78, v79
v_mfma_f32_16x16x32_bf16 v[216:219], a[200:203], v[32:35], v[216:219]
v_mfma_f32_16x16x32_bf16 v[220:223], a[204:207], v[32:35], v[220:223]
s_waitcnt vmcnt(6)
s_barrier
v_mfma_f32_16x16x32_bf16 v[220:223], a[236:239], v[36:39], v[220:223]
ds_read_b128 a[144:147], v89 offset:16896
v_smfmac_f32_16x16x64_bf16 a[244:247], a[248:251], v[32:39], v92
ds_read_b128 a[148:151], v89 offset:16960
v_mfma_f32_16x16x32_bf16 v[80:83], a[112:115], v[16:19], v[64:67]
ds_read_b128 a[152:155], v89 offset:17024
v_mfma_f32_16x16x32_bf16 v[80:83], a[116:119], v[20:23], v[80:83]
ds_read_b128 a[156:159], v89 offset:17088
v_mfma_f32_16x16x32_bf16 v[80:83], a[120:123], v[24:27], v[80:83]
ds_read_b128 a[172:175], v89 offset:17600
v_mfma_f32_16x16x32_bf16 v[80:83], a[124:127], v[28:31], v[80:83]
s_xor_b32 s21, s23, 399360
ds_read_b128 a[168:171], v89 offset:17536
v_mfma_f32_16x16x32_bf16 v[84:87], a[140:143], v[28:31], v[64:67]
s_add_u32 m0, s22, 85536
ds_read_b128 a[164:167], v89 offset:17472
v_mfma_f32_16x16x32_bf16 v[84:87], a[136:139], v[24:27], v[84:87]
ds_read_b128 a[160:163], v89 offset:17408
v_mfma_f32_16x16x32_bf16 v[84:87], a[132:135], v[20:23], v[84:87]
buffer_load_dwordx4 v97, s[12:15], s21 offen offset:0 nt lds
v_mfma_f32_16x16x32_bf16 v[84:87], a[128:131], v[16:19], v[84:87]
v_exp_f32 v80, v80
v_mfma_f32_16x16x32_bf16 v[224:227], a[208:211], v[44:47], v[224:227]
ds_read_b128 a[112:115], v88 offset:16896
v_add_f32 v103, v103, v80
v_mfma_f32_16x16x32_bf16 v[224:227], a[176:179], v[40:43], v[224:227]
v_exp_f32 v81, v81
v_mfma_f32_16x16x32_bf16 v[228:231], a[180:183], v[40:43], v[228:231]
ds_read_b128 a[116:119], v88 offset:16960
v_add_f32 v103, v103, v81
v_mfma_f32_16x16x32_bf16 v[228:231], a[212:215], v[44:47], v[228:231]
ds_read_b128 a[120:123], v88 offset:17024
v_cvt_pk_bf16_f32 v32, v80, v81
v_mfma_f32_16x16x32_bf16 v[232:235], a[216:219], v[44:47], v[232:235]
v_exp_f32 v82, v82
v_mfma_f32_16x16x32_bf16 v[232:235], a[184:187], v[40:43], v[232:235]
ds_read_b128 a[124:127], v88 offset:17088
v_add_f32 v103, v103, v82
v_mfma_f32_16x16x32_bf16 v[236:239], a[188:191], v[40:43], v[236:239]
v_exp_f32 v83, v83
v_mfma_f32_16x16x32_bf16 v[236:239], a[220:223], v[44:47], v[236:239]
ds_read_b128 a[140:143], v88 offset:17600
v_add_f32 v103, v103, v83
v_mfma_f32_16x16x32_bf16 v[240:243], a[224:227], v[44:47], v[240:243]
ds_read_b128 a[136:139], v88 offset:17536
v_cvt_pk_bf16_f32 v33, v82, v83
v_mfma_f32_16x16x32_bf16 v[240:243], a[192:195], v[40:43], v[240:243]
v_exp_f32 v84, v84
v_mfma_f32_16x16x32_bf16 v[244:247], a[196:199], v[40:43], v[244:247]
ds_read_b128 a[132:135], v88 offset:17472
v_add_f32 v103, v103, v84
v_mfma_f32_16x16x32_bf16 v[244:247], a[228:231], v[44:47], v[244:247]
v_exp_f32 v85, v85
v_mfma_f32_16x16x32_bf16 v[248:251], a[232:235], v[44:47], v[248:251]
s_xor_b32 s21, s23, 403456
ds_read_b128 a[128:131], v88 offset:17408
v_cvt_pk_bf16_f32 v34, v84, v85
v_mfma_f32_16x16x32_bf16 v[248:251], a[200:203], v[40:43], v[248:251]
s_add_u32 m0, s22, 86592
v_exp_f32 v86, v86
v_mfma_f32_16x16x32_bf16 v[252:255], a[204:207], v[40:43], v[252:255]
v_exp_f32 v87, v87
v_mfma_f32_16x16x32_bf16 v[252:255], a[236:239], v[44:47], v[252:255]
buffer_load_dwordx4 v97, s[12:15], s21 offen offset:0 nt lds
v_smfmac_f32_16x16x64_bf16 a[244:247], a[252:255], v[40:47], v92
s_waitcnt lgkmcnt(2)
v_cvt_pk_bf16_f32 v35, v86, v87
v_mfma_f32_16x16x32_bf16 v[68:71], a[144:147], a[0:3], v[48:51]
v_add_f32 v103, v103, v85
v_add_f32 v103, v103, v86
v_mfma_f32_16x16x32_bf16 v[68:71], a[148:151], a[4:7], v[68:71]
ds_read_b64_tr_b16 a[208:209], v91 offset:16896
v_add_f32 v103, v103, v87
v_mfma_f32_16x16x32_bf16 v[68:71], a[152:155], a[8:11], v[68:71]
ds_read_b64_tr_b16 a[210:211], v91 offset:17408
ds_read_b64_tr_b16 a[212:213], v91 offset:16928
v_mfma_f32_16x16x32_bf16 v[68:71], a[156:159], a[12:15], v[68:71]
ds_read_b64_tr_b16 a[214:215], v91 offset:17440
v_mfma_f32_16x16x32_bf16 v[72:75], a[172:175], a[12:15], v[48:51]
ds_read_b64_tr_b16 a[216:217], v91 offset:16960
ds_read_b64_tr_b16 a[218:219], v91 offset:17472
v_mfma_f32_16x16x32_bf16 v[72:75], a[168:171], a[8:11], v[72:75]
ds_read_b64_tr_b16 a[220:221], v91 offset:16992
v_mfma_f32_16x16x32_bf16 v[72:75], a[164:167], a[4:7], v[72:75]
ds_read_b64_tr_b16 a[222:223], v91 offset:17504
ds_read_b64_tr_b16 a[224:225], v91 offset:17024
v_mfma_f32_16x16x32_bf16 v[72:75], a[160:163], a[0:3], v[72:75]
v_exp_f32 v68, v68
v_mfma_f32_16x16x32_bf16 v[76:79], a[112:115], a[0:3], v[48:51]
v_exp_f32 v69, v69
v_mfma_f32_16x16x32_bf16 v[76:79], a[116:119], a[4:7], v[76:79]
v_exp_f32 v70, v70
v_mfma_f32_16x16x32_bf16 v[76:79], a[120:123], a[8:11], v[76:79]
v_exp_f32 v71, v71
v_mfma_f32_16x16x32_bf16 v[76:79], a[124:127], a[12:15], v[76:79]
s_xor_b32 s21, s23, 407552
v_cvt_pk_bf16_f32 v44, v68, v69
v_cvt_pk_bf16_f32 v45, v70, v71
v_mfma_f32_16x16x32_bf16 v[80:83], a[140:143], a[12:15], v[48:51]
s_add_u32 m0, s22, 87648
v_exp_f32 v72, v72
v_mfma_f32_16x16x32_bf16 v[80:83], a[136:139], a[8:11], v[80:83]
s_waitcnt lgkmcnt(2)
v_exp_f32 v73, v73
v_mfma_f32_16x16x32_bf16 v[80:83], a[132:135], a[4:7], v[80:83]
buffer_load_dwordx4 v97, s[12:15], s21 offen offset:0 nt lds
v_mfma_f32_16x16x32_bf16 v[80:83], a[128:131], a[0:3], v[80:83]
v_exp_f32 v74, v74
v_mfma_f32_16x16x32_bf16 a[48:51], a[176:179], v[32:35], a[48:51]
v_exp_f32 v75, v75
v_mfma_f32_16x16x32_bf16 a[52:55], a[180:183], v[32:35], a[52:55]
ds_read_b128 v[112:115], v95 offset:10880
v_cvt_pk_bf16_f32 v46, v72, v73
v_mfma_f32_16x16x32_bf16 a[56:59], a[184:187], v[32:35], a[56:59]
ds_read_b64_tr_b16 a[176:177], v90 offset:16896
v_cvt_pk_bf16_f32 v47, v74, v75
v_mfma_f32_16x16x32_bf16 a[60:63], a[188:191], v[32:35], a[60:63]
v_exp_f32 v76, v76
v_mfma_f32_16x16x32_bf16 a[64:67], a[192:195], v[32:35], a[64:67]
v_exp_f32 v77, v77
v_mfma_f32_16x16x32_bf16 a[68:71], a[196:199], v[32:35], a[68:71]
v_exp_f32 v78, v78
v_mfma_f32_16x16x32_bf16 a[72:75], a[200:203], v[32:35], a[72:75]
v_exp_f32 v79, v79
v_mfma_f32_16x16x32_bf16 a[76:79], a[204:207], v[32:35], a[76:79]
ds_read_b64_tr_b16 a[178:179], v90 offset:17408
v_cvt_pk_bf16_f32 v40, v76, v77
v_mfma_f32_16x16x32_bf16 v[84:87], a[144:147], a[16:19], v[52:55]
ds_read_b64_tr_b16 a[180:181], v90 offset:16928
v_cvt_pk_bf16_f32 v41, v78, v79
v_mfma_f32_16x16x32_bf16 v[84:87], a[148:151], a[20:23], v[84:87]
ds_read_b64_tr_b16 a[182:183], v90 offset:17440
ds_read_b64_tr_b16 a[184:185], v90 offset:16960
v_mfma_f32_16x16x32_bf16 v[84:87], a[152:155], a[24:27], v[84:87]
v_exp_f32 v80, v80
v_mfma_f32_16x16x32_bf16 v[84:87], a[156:159], a[28:31], v[84:87]
v_exp_f32 v81, v81
v_mfma_f32_16x16x32_bf16 v[68:71], a[172:175], a[28:31], v[52:55]
v_exp_f32 v82, v82
v_mfma_f32_16x16x32_bf16 v[68:71], a[168:171], a[24:27], v[68:71]
v_exp_f32 v83, v83
v_mfma_f32_16x16x32_bf16 v[68:71], a[164:167], a[20:23], v[68:71]
s_waitcnt lgkmcnt(4)
ds_read_b64_tr_b16 a[186:187], v90 offset:17472
v_cvt_pk_bf16_f32 v42, v80, v81
v_mfma_f32_16x16x32_bf16 v[68:71], a[160:163], a[16:19], v[68:71]
buffer_store_dwordx4 v[112:115], v96, s[16:19], s33 offen offset:2048 nt
v_mfma_f32_16x16x32_bf16 v[72:75], a[112:115], a[16:19], v[52:55]
ds_read_b64_tr_b16 a[188:189], v90 offset:16992
v_cvt_pk_bf16_f32 v43, v82, v83
v_mfma_f32_16x16x32_bf16 v[72:75], a[116:119], a[20:23], v[72:75]
ds_read_b64_tr_b16 a[190:191], v90 offset:17504
ds_read_b64_tr_b16 a[226:227], v91 offset:17536
v_mfma_f32_16x16x32_bf16 v[72:75], a[120:123], a[24:27], v[72:75]
v_exp_f32 v84, v84
v_mfma_f32_16x16x32_bf16 v[72:75], a[124:127], a[28:31], v[72:75]
ds_read_b64_tr_b16 a[192:193], v90 offset:17024
ds_read_b64_tr_b16 a[194:195], v90 offset:17536
v_mfma_f32_16x16x32_bf16 v[76:79], a[140:143], a[28:31], v[52:55]
v_exp_f32 v85, v85
v_mfma_f32_16x16x32_bf16 v[76:79], a[136:139], a[24:27], v[76:79]
ds_read_b64_tr_b16 a[196:197], v90 offset:17056
ds_read_b64_tr_b16 a[198:199], v90 offset:17568
v_mfma_f32_16x16x32_bf16 v[76:79], a[132:135], a[20:23], v[76:79]
ds_read_b64_tr_b16 a[228:229], v91 offset:17056
v_cvt_pk_bf16_f32 v36, v84, v85
v_mfma_f32_16x16x32_bf16 v[76:79], a[128:131], a[16:19], v[76:79]
ds_read_b64_tr_b16 a[230:231], v91 offset:17568
ds_read_b64_tr_b16 a[232:233], v91 offset:17088
v_mfma_f32_16x16x32_bf16 v[128:131], a[208:211], v[44:47], v[128:131]
s_waitcnt lgkmcnt(9)
v_exp_f32 v86, v86
v_mfma_f32_16x16x32_bf16 v[128:131], a[176:179], v[40:43], v[128:131]
ds_read_b64_tr_b16 a[234:235], v91 offset:17600
ds_read_b64_tr_b16 a[200:201], v90 offset:17088
v_mfma_f32_16x16x32_bf16 v[132:135], a[180:183], v[40:43], v[132:135]
v_exp_f32 v87, v87
v_mfma_f32_16x16x32_bf16 v[132:135], a[212:215], v[44:47], v[132:135]
ds_read_b64_tr_b16 a[202:203], v90 offset:17600
ds_read_b64_tr_b16 a[204:205], v90 offset:17120
v_mfma_f32_16x16x32_bf16 v[136:139], a[216:219], v[44:47], v[136:139]
s_xor_b32 s21, s23, 396288
ds_read_b64_tr_b16 a[206:207], v90 offset:17632
v_cvt_pk_bf16_f32 v37, v86, v87
v_mfma_f32_16x16x32_bf16 v[136:139], a[184:187], v[40:43], v[136:139]
s_add_u32 m0, s22, 0
ds_read_b64_tr_b16 a[236:237], v91 offset:17120
ds_read_b64_tr_b16 a[238:239], v91 offset:17632
s_waitcnt lgkmcnt(10)
v_mfma_f32_16x16x32_bf16 v[140:143], a[188:191], v[40:43], v[140:143]
v_exp_f32 v68, v68
v_mfma_f32_16x16x32_bf16 v[140:143], a[220:223], v[44:47], v[140:143]
buffer_load_dwordx4 v97, s[8:11], s21 offen offset:0 nt lds
v_mfma_f32_16x16x32_bf16 v[144:147], a[224:227], v[44:47], v[144:147]
v_exp_f32 v69, v69
v_mfma_f32_16x16x32_bf16 v[144:147], a[192:195], v[40:43], v[144:147]
v_exp_f32 v70, v70
v_mfma_f32_16x16x32_bf16 v[148:151], a[196:199], v[40:43], v[148:151]
s_waitcnt lgkmcnt(5)
v_exp_f32 v71, v71
v_mfma_f32_16x16x32_bf16 v[148:151], a[228:231], v[44:47], v[148:151]
v_cvt_pk_bf16_f32 v38, v68, v69
v_cvt_pk_bf16_f32 v39, v70, v71
v_mfma_f32_16x16x32_bf16 v[152:155], a[232:235], v[44:47], v[152:155]
s_waitcnt lgkmcnt(2)
v_exp_f32 v72, v72
v_mfma_f32_16x16x32_bf16 v[152:155], a[200:203], v[40:43], v[152:155]
v_exp_f32 v73, v73
v_mfma_f32_16x16x32_bf16 v[156:159], a[204:207], v[40:43], v[156:159]
s_waitcnt lgkmcnt(0)
v_exp_f32 v74, v74
v_mfma_f32_16x16x32_bf16 v[156:159], a[236:239], v[44:47], v[156:159]
v_exp_f32 v75, v75
v_smfmac_f32_16x16x64_bf16 a[240:243], a[248:251], v[40:47], v92
v_cvt_pk_bf16_f32 v32, v72, v73
v_mfma_f32_16x16x32_bf16 v[80:83], a[144:147], a[32:35], v[56:59]
v_exp_f32 v76, v76
v_mfma_f32_16x16x32_bf16 v[80:83], a[148:151], a[36:39], v[80:83]
v_exp_f32 v77, v77
v_mfma_f32_16x16x32_bf16 v[80:83], a[152:155], a[40:43], v[80:83]
v_cvt_pk_bf16_f32 v33, v74, v75
v_cvt_pk_bf16_f32 v34, v76, v77
v_mfma_f32_16x16x32_bf16 v[80:83], a[156:159], a[44:47], v[80:83]
v_exp_f32 v78, v78
v_mfma_f32_16x16x32_bf16 v[84:87], a[172:175], a[44:47], v[56:59]
s_xor_b32 s21, s23, 400384
v_exp_f32 v79, v79
v_mfma_f32_16x16x32_bf16 v[84:87], a[168:171], a[40:43], v[84:87]
s_add_u32 m0, s22, 1056
v_cvt_pk_bf16_f32 v35, v78, v79
v_mfma_f32_16x16x32_bf16 v[84:87], a[164:167], a[36:39], v[84:87]
v_mfma_f32_16x16x32_bf16 v[84:87], a[160:163], a[32:35], v[84:87]
buffer_load_dwordx4 v97, s[8:11], s21 offen offset:0 nt lds
v_mfma_f32_16x16x32_bf16 v[68:71], a[112:115], a[32:35], v[56:59]
v_exp_f32 v80, v80
v_mfma_f32_16x16x32_bf16 v[68:71], a[116:119], a[36:39], v[68:71]
v_exp_f32 v81, v81
v_mfma_f32_16x16x32_bf16 v[68:71], a[120:123], a[40:43], v[68:71]
v_exp_f32 v82, v82
v_mfma_f32_16x16x32_bf16 v[68:71], a[124:127], a[44:47], v[68:71]
v_exp_f32 v83, v83
v_mfma_f32_16x16x32_bf16 v[72:75], a[140:143], a[44:47], v[56:59]
v_cvt_pk_bf16_f32 v44, v80, v81
v_cvt_pk_bf16_f32 v45, v82, v83
v_mfma_f32_16x16x32_bf16 v[72:75], a[136:139], a[40:43], v[72:75]
v_exp_f32 v84, v84
v_mfma_f32_16x16x32_bf16 v[72:75], a[132:135], a[36:39], v[72:75]
v_exp_f32 v85, v85
v_mfma_f32_16x16x32_bf16 v[72:75], a[128:131], a[32:35], v[72:75]
v_exp_f32 v86, v86
v_mfma_f32_16x16x32_bf16 v[160:163], a[208:211], v[36:39], v[160:163]
v_exp_f32 v87, v87
v_mfma_f32_16x16x32_bf16 v[160:163], a[176:179], v[32:35], v[160:163]
v_cvt_pk_bf16_f32 v46, v84, v85
v_cvt_pk_bf16_f32 v47, v86, v87
v_mfma_f32_16x16x32_bf16 v[164:167], a[180:183], v[32:35], v[164:167]
v_exp_f32 v68, v68
v_mfma_f32_16x16x32_bf16 v[164:167], a[212:215], v[36:39], v[164:167]
v_exp_f32 v69, v69
v_mfma_f32_16x16x32_bf16 v[168:171], a[216:219], v[36:39], v[168:171]
s_xor_b32 s21, s23, 404480
v_exp_f32 v70, v70
v_mfma_f32_16x16x32_bf16 v[168:171], a[184:187], v[32:35], v[168:171]
s_add_u32 m0, s22, 2112
v_exp_f32 v71, v71
v_mfma_f32_16x16x32_bf16 v[172:175], a[188:191], v[32:35], v[172:175]
v_cvt_pk_bf16_f32 v40, v68, v69
v_cvt_pk_bf16_f32 v41, v70, v71
v_mfma_f32_16x16x32_bf16 v[172:175], a[220:223], v[36:39], v[172:175]
buffer_load_dwordx4 v97, s[8:11], s21 offen offset:0 nt lds
v_mfma_f32_16x16x32_bf16 v[176:179], a[224:227], v[36:39], v[176:179]
v_exp_f32 v72, v72
v_mfma_f32_16x16x32_bf16 v[176:179], a[192:195], v[32:35], v[176:179]
v_exp_f32 v73, v73
v_mfma_f32_16x16x32_bf16 v[180:183], a[196:199], v[32:35], v[180:183]
v_exp_f32 v74, v74
v_mfma_f32_16x16x32_bf16 v[180:183], a[228:231], v[36:39], v[180:183]
v_exp_f32 v75, v75
v_mfma_f32_16x16x32_bf16 v[184:187], a[232:235], v[36:39], v[184:187]
v_cvt_pk_bf16_f32 v42, v72, v73
v_cvt_pk_bf16_f32 v43, v74, v75
v_mfma_f32_16x16x32_bf16 v[184:187], a[200:203], v[32:35], v[184:187]
v_mfma_f32_16x16x32_bf16 v[188:191], a[204:207], v[32:35], v[188:191]
v_mfma_f32_16x16x32_bf16 v[188:191], a[236:239], v[36:39], v[188:191]
v_smfmac_f32_16x16x64_bf16 a[240:243], a[252:255], v[32:39], v92
v_mfma_f32_16x16x32_bf16 v[76:79], a[144:147], v[0:3], v[60:63]
v_mfma_f32_16x16x32_bf16 v[76:79], a[148:151], v[4:7], v[76:79]
v_mfma_f32_16x16x32_bf16 v[76:79], a[152:155], v[8:11], v[76:79]
v_mfma_f32_16x16x32_bf16 v[76:79], a[156:159], v[12:15], v[76:79]
v_mfma_f32_16x16x32_bf16 v[80:83], a[172:175], v[12:15], v[60:63]
s_xor_b32 s21, s23, 408576
v_mfma_f32_16x16x32_bf16 v[80:83], a[168:171], v[8:11], v[80:83]
s_add_u32 m0, s22, 3168
v_mfma_f32_16x16x32_bf16 v[80:83], a[164:167], v[4:7], v[80:83]
v_mfma_f32_16x16x32_bf16 v[80:83], a[160:163], v[0:3], v[80:83]
buffer_load_dwordx4 v97, s[8:11], s21 offen offset:0 nt lds
v_mfma_f32_16x16x32_bf16 v[84:87], a[112:115], v[0:3], v[60:63]
v_exp_f32 v76, v76
v_mfma_f32_16x16x32_bf16 v[84:87], a[116:119], v[4:7], v[84:87]
v_exp_f32 v77, v77
v_mfma_f32_16x16x32_bf16 v[84:87], a[120:123], v[8:11], v[84:87]
v_exp_f32 v78, v78
v_mfma_f32_16x16x32_bf16 v[84:87], a[124:127], v[12:15], v[84:87]
v_exp_f32 v79, v79
v_mfma_f32_16x16x32_bf16 v[68:71], a[140:143], v[12:15], v[60:63]
v_cvt_pk_bf16_f32 v36, v76, v77
v_cvt_pk_bf16_f32 v37, v78, v79
v_mfma_f32_16x16x32_bf16 v[68:71], a[136:139], v[8:11], v[68:71]
v_exp_f32 v80, v80
v_mfma_f32_16x16x32_bf16 v[68:71], a[132:135], v[4:7], v[68:71]
v_exp_f32 v81, v81
v_mfma_f32_16x16x32_bf16 v[68:71], a[128:131], v[0:3], v[68:71]
v_exp_f32 v82, v82
v_mfma_f32_16x16x32_bf16 v[192:195], a[208:211], v[44:47], v[192:195]
v_exp_f32 v83, v83
v_mfma_f32_16x16x32_bf16 v[192:195], a[176:179], v[40:43], v[192:195]
v_cvt_pk_bf16_f32 v38, v80, v81
v_cvt_pk_bf16_f32 v39, v82, v83
v_mfma_f32_16x16x32_bf16 v[196:199], a[180:183], v[40:43], v[196:199]
v_exp_f32 v84, v84
v_mfma_f32_16x16x32_bf16 v[196:199], a[212:215], v[44:47], v[196:199]
v_exp_f32 v85, v85
v_mfma_f32_16x16x32_bf16 v[200:203], a[216:219], v[44:47], v[200:203]
s_xor_b32 s21, s23, 396288
v_exp_f32 v86, v86
v_mfma_f32_16x16x32_bf16 v[200:203], a[184:187], v[40:43], v[200:203]
s_add_u32 m0, s22, 50688
v_exp_f32 v87, v87
v_mfma_f32_16x16x32_bf16 v[204:207], a[188:191], v[40:43], v[204:207]
v_exp_f32 v68, v68
v_mfma_f32_16x16x32_bf16 v[204:207], a[220:223], v[44:47], v[204:207]
buffer_load_dwordx4 v97, s[12:15], s21 offen offset:0 nt lds
v_mfma_f32_16x16x32_bf16 v[208:211], a[224:227], v[44:47], v[208:211]
v_exp_f32 v69, v69
v_mfma_f32_16x16x32_bf16 v[208:211], a[192:195], v[40:43], v[208:211]
v_exp_f32 v70, v70
v_mfma_f32_16x16x32_bf16 v[212:215], a[196:199], v[40:43], v[212:215]
v_exp_f32 v71, v71
v_mfma_f32_16x16x32_bf16 v[212:215], a[228:231], v[44:47], v[212:215]
v_cvt_pk_bf16_f32 v32, v84, v85
v_cvt_pk_bf16_f32 v33, v86, v87
v_mfma_f32_16x16x32_bf16 v[216:219], a[232:235], v[44:47], v[216:219]
v_cvt_pk_bf16_f32 v34, v68, v69
v_cvt_pk_bf16_f32 v35, v70, v71
v_mfma_f32_16x16x32_bf16 v[216:219], a[200:203], v[40:43], v[216:219]
v_mfma_f32_16x16x32_bf16 v[220:223], a[204:207], v[40:43], v[220:223]
s_waitcnt vmcnt(6)
s_barrier
v_mfma_f32_16x16x32_bf16 v[220:223], a[236:239], v[44:47], v[220:223]
ds_read_b128 a[144:147], v89 offset:33792
v_smfmac_f32_16x16x64_bf16 a[244:247], a[248:251], v[40:47], v92
ds_read_b128 a[148:151], v89 offset:33856
v_mfma_f32_16x16x32_bf16 v[72:75], a[112:115], v[16:19], v[64:67]
ds_read_b128 a[152:155], v89 offset:33920
v_mfma_f32_16x16x32_bf16 v[72:75], a[116:119], v[20:23], v[72:75]
ds_read_b128 a[156:159], v89 offset:33984
v_mfma_f32_16x16x32_bf16 v[72:75], a[120:123], v[24:27], v[72:75]
ds_read_b128 a[172:175], v89 offset:34496
v_mfma_f32_16x16x32_bf16 v[72:75], a[124:127], v[28:31], v[72:75]
ds_read_b128 a[168:171], v89 offset:34432
v_mfma_f32_16x16x32_bf16 v[76:79], a[140:143], v[28:31], v[64:67]
s_xor_b32 s21, s23, 400384
ds_read_b128 a[164:167], v89 offset:34368
v_mfma_f32_16x16x32_bf16 v[76:79], a[136:139], v[24:27], v[76:79]
s_add_u32 m0, s22, 51744
ds_read_b128 a[160:163], v89 offset:34304
v_mfma_f32_16x16x32_bf16 v[76:79], a[132:135], v[20:23], v[76:79]
ds_read_b128 a[112:115], v88 offset:33792
v_mfma_f32_16x16x32_bf16 v[76:79], a[128:131], v[16:19], v[76:79]
buffer_load_dwordx4 v97, s[12:15], s21 offen offset:0 nt lds
v_mfma_f32_16x16x32_bf16 v[224:227], a[208:211], v[36:39], v[224:227]
v_exp_f32 v72, v72
v_mfma_f32_16x16x32_bf16 v[224:227], a[176:179], v[32:35], v[224:227]
ds_read_b128 a[116:119], v88 offset:33856
v_add_f32 v103, v103, v72
v_mfma_f32_16x16x32_bf16 v[228:231], a[180:183], v[32:35], v[228:231]
v_exp_f32 v73, v73
v_mfma_f32_16x16x32_bf16 v[228:231], a[212:215], v[36:39], v[228:231]
ds_read_b128 a[120:123], v88 offset:33920
v_add_f32 v103, v103, v73
v_mfma_f32_16x16x32_bf16 v[232:235], a[216:219], v[36:39], v[232:235]
ds_read_b128 a[124:127], v88 offset:33984
v_cvt_pk_bf16_f32 v40, v72, v73
v_mfma_f32_16x16x32_bf16 v[232:235], a[184:187], v[32:35], v[232:235]
v_exp_f32 v74, v74
v_mfma_f32_16x16x32_bf16 v[236:239], a[188:191], v[32:35], v[236:239]
ds_read_b128 a[140:143], v88 offset:34496
v_add_f32 v103, v103, v74
v_mfma_f32_16x16x32_bf16 v[236:239], a[220:223], v[36:39], v[236:239]
v_exp_f32 v75, v75
v_mfma_f32_16x16x32_bf16 v[240:243], a[224:227], v[36:39], v[240:243]
ds_read_b128 a[136:139], v88 offset:34432
v_add_f32 v103, v103, v75
v_mfma_f32_16x16x32_bf16 v[240:243], a[192:195], v[32:35], v[240:243]
ds_read_b128 a[132:135], v88 offset:34368
v_cvt_pk_bf16_f32 v41, v74, v75
v_mfma_f32_16x16x32_bf16 v[244:247], a[196:199], v[32:35], v[244:247]
v_exp_f32 v76, v76
v_mfma_f32_16x16x32_bf16 v[244:247], a[228:231], v[36:39], v[244:247]
ds_read_b128 a[128:131], v88 offset:34304
v_add_f32 v103, v103, v76
v_mfma_f32_16x16x32_bf16 v[248:251], a[232:235], v[36:39], v[248:251]
s_xor_b32 s21, s23, 404480
v_exp_f32 v77, v77
v_mfma_f32_16x16x32_bf16 v[248:251], a[200:203], v[32:35], v[248:251]
s_add_u32 m0, s22, 52800
v_exp_f32 v78, v78
v_mfma_f32_16x16x32_bf16 v[252:255], a[204:207], v[32:35], v[252:255]
v_exp_f32 v79, v79
v_mfma_f32_16x16x32_bf16 v[252:255], a[236:239], v[36:39], v[252:255]
buffer_load_dwordx4 v97, s[12:15], s21 offen offset:0 nt lds
v_smfmac_f32_16x16x64_bf16 a[244:247], a[252:255], v[32:39], v92
s_waitcnt lgkmcnt(2)
v_cvt_pk_bf16_f32 v42, v76, v77
v_mfma_f32_16x16x32_bf16 v[80:83], a[144:147], a[0:3], v[48:51]
v_cvt_pk_bf16_f32 v43, v78, v79
v_add_f32 v103, v103, v77
v_mfma_f32_16x16x32_bf16 v[80:83], a[148:151], a[4:7], v[80:83]
v_add_f32 v103, v103, v78
v_add_f32 v103, v103, v79
v_mfma_f32_16x16x32_bf16 v[80:83], a[152:155], a[8:11], v[80:83]
ds_read_b64_tr_b16 a[208:209], v91 offset:33792
ds_read_b64_tr_b16 a[210:211], v91 offset:34304
v_mfma_f32_16x16x32_bf16 v[80:83], a[156:159], a[12:15], v[80:83]
ds_read_b64_tr_b16 a[212:213], v91 offset:33824
v_mfma_f32_16x16x32_bf16 v[84:87], a[172:175], a[12:15], v[48:51]
ds_read_b64_tr_b16 a[214:215], v91 offset:34336
ds_read_b64_tr_b16 a[216:217], v91 offset:33856
v_mfma_f32_16x16x32_bf16 v[84:87], a[168:171], a[8:11], v[84:87]
ds_read_b64_tr_b16 a[218:219], v91 offset:34368
v_mfma_f32_16x16x32_bf16 v[84:87], a[164:167], a[4:7], v[84:87]
ds_read_b64_tr_b16 a[220:221], v91 offset:33888
ds_read_b64_tr_b16 a[222:223], v91 offset:34400
v_mfma_f32_16x16x32_bf16 v[84:87], a[160:163], a[0:3], v[84:87]
v_exp_f32 v80, v80
v_mfma_f32_16x16x32_bf16 v[68:71], a[112:115], a[0:3], v[48:51]
v_exp_f32 v81, v81
v_mfma_f32_16x16x32_bf16 v[68:71], a[116:119], a[4:7], v[68:71]
v_exp_f32 v82, v82
v_mfma_f32_16x16x32_bf16 v[68:71], a[120:123], a[8:11], v[68:71]
v_exp_f32 v83, v83
v_mfma_f32_16x16x32_bf16 v[68:71], a[124:127], a[12:15], v[68:71]
v_cvt_pk_bf16_f32 v36, v80, v81
v_cvt_pk_bf16_f32 v37, v82, v83
v_mfma_f32_16x16x32_bf16 v[72:75], a[140:143], a[12:15], v[48:51]
s_xor_b32 s21, s23, 408576
v_exp_f32 v84, v84
v_mfma_f32_16x16x32_bf16 v[72:75], a[136:139], a[8:11], v[72:75]
s_add_u32 m0, s22, 53856
v_exp_f32 v85, v85
s_waitcnt lgkmcnt(2)
v_mfma_f32_16x16x32_bf16 v[72:75], a[132:135], a[4:7], v[72:75]
v_exp_f32 v86, v86
v_mfma_f32_16x16x32_bf16 v[72:75], a[128:131], a[0:3], v[72:75]
buffer_load_dwordx4 v97, s[12:15], s21 offen offset:0 nt lds
v_mfma_f32_16x16x32_bf16 a[48:51], a[176:179], v[40:43], a[48:51]
v_exp_f32 v87, v87
v_mfma_f32_16x16x32_bf16 a[52:55], a[180:183], v[40:43], a[52:55]
ds_read_b128 v[108:111], v95 offset:11968
v_cvt_pk_bf16_f32 v38, v84, v85
v_mfma_f32_16x16x32_bf16 a[56:59], a[184:187], v[40:43], a[56:59]
ds_read_b64_tr_b16 a[176:177], v90 offset:33792
v_cvt_pk_bf16_f32 v39, v86, v87
v_mfma_f32_16x16x32_bf16 a[60:63], a[188:191], v[40:43], a[60:63]
v_exp_f32 v68, v68
v_mfma_f32_16x16x32_bf16 a[64:67], a[192:195], v[40:43], a[64:67]
v_exp_f32 v69, v69
v_mfma_f32_16x16x32_bf16 a[68:71], a[196:199], v[40:43], a[68:71]
v_exp_f32 v70, v70
v_mfma_f32_16x16x32_bf16 a[72:75], a[200:203], v[40:43], a[72:75]
v_exp_f32 v71, v71
v_mfma_f32_16x16x32_bf16 a[76:79], a[204:207], v[40:43], a[76:79]
ds_read_b64_tr_b16 a[178:179], v90 offset:34304
v_cvt_pk_bf16_f32 v32, v68, v69
v_mfma_f32_16x16x32_bf16 v[76:79], a[144:147], a[16:19], v[52:55]
ds_read_b64_tr_b16 a[180:181], v90 offset:33824
v_cvt_pk_bf16_f32 v33, v70, v71
v_mfma_f32_16x16x32_bf16 v[76:79], a[148:151], a[20:23], v[76:79]
ds_read_b64_tr_b16 a[182:183], v90 offset:34336
ds_read_b64_tr_b16 a[184:185], v90 offset:33856
v_mfma_f32_16x16x32_bf16 v[76:79], a[152:155], a[24:27], v[76:79]
v_exp_f32 v72, v72
v_mfma_f32_16x16x32_bf16 v[76:79], a[156:159], a[28:31], v[76:79]
v_exp_f32 v73, v73
v_mfma_f32_16x16x32_bf16 v[80:83], a[172:175], a[28:31], v[52:55]
v_exp_f32 v74, v74
v_mfma_f32_16x16x32_bf16 v[80:83], a[168:171], a[24:27], v[80:83]
v_exp_f32 v75, v75
v_mfma_f32_16x16x32_bf16 v[80:83], a[164:167], a[20:23], v[80:83]
s_waitcnt lgkmcnt(4)
ds_read_b64_tr_b16 a[186:187], v90 offset:34368
v_cvt_pk_bf16_f32 v34, v72, v73
v_mfma_f32_16x16x32_bf16 v[80:83], a[160:163], a[16:19], v[80:83]
buffer_store_dwordx4 v[108:111], v96, s[16:19], s33 offen offset:3072 nt
v_mfma_f32_16x16x32_bf16 v[84:87], a[112:115], a[16:19], v[52:55]
ds_read_b64_tr_b16 a[188:189], v90 offset:33888
v_cvt_pk_bf16_f32 v35, v74, v75
v_mfma_f32_16x16x32_bf16 v[84:87], a[116:119], a[20:23], v[84:87]
ds_read_b64_tr_b16 a[190:191], v90 offset:34400
ds_read_b64_tr_b16 a[224:225], v91 offset:33920
v_mfma_f32_16x16x32_bf16 v[84:87], a[120:123], a[24:27], v[84:87]
ds_read_b64_tr_b16 a[226:227], v91 offset:34432
v_add_u32 v119, s26, v96
v_mfma_f32_16x16x32_bf16 v[84:87], a[124:127], a[28:31], v[84:87]
ds_read_b64_tr_b16 a[192:193], v90 offset:33920
ds_read_b64_tr_b16 a[194:195], v90 offset:34432
v_mfma_f32_16x16x32_bf16 v[68:71], a[140:143], a[28:31], v[52:55]
ds_read_b64_tr_b16 a[196:197], v90 offset:33952
v_add_u32 v120, s28, v96
v_mfma_f32_16x16x32_bf16 v[68:71], a[136:139], a[24:27], v[68:71]
ds_read_b64_tr_b16 a[198:199], v90 offset:34464
ds_read_b64_tr_b16 a[228:229], v91 offset:33952
v_mfma_f32_16x16x32_bf16 v[68:71], a[132:135], a[20:23], v[68:71]
ds_read_b64_tr_b16 a[230:231], v91 offset:34464
v_lshrrev_b32 v121, 1, v96
v_mfma_f32_16x16x32_bf16 v[68:71], a[128:131], a[16:19], v[68:71]
ds_read_b64_tr_b16 a[232:233], v91 offset:33984
ds_read_b64_tr_b16 a[234:235], v91 offset:34496
v_mfma_f32_16x16x32_bf16 v[128:131], a[208:211], v[36:39], v[128:131]
s_waitcnt lgkmcnt(11)
ds_read_b64_tr_b16 a[200:201], v90 offset:33984
v_add_u32 v118, s25, v121
v_mfma_f32_16x16x32_bf16 v[128:131], a[176:179], v[32:35], v[128:131]
ds_read_b64_tr_b16 a[202:203], v90 offset:34496
ds_read_b64_tr_b16 a[204:205], v90 offset:34016
v_mfma_f32_16x16x32_bf16 v[132:135], a[180:183], v[32:35], v[132:135]
ds_read_b64_tr_b16 a[206:207], v90 offset:34528
v_mov_b32 v117, v101
v_mfma_f32_16x16x32_bf16 v[132:135], a[212:215], v[36:39], v[132:135]
ds_read_b64_tr_b16 a[236:237], v91 offset:34016
ds_read_b64_tr_b16 a[238:239], v91 offset:34528
v_mfma_f32_16x16x32_bf16 v[136:139], a[216:219], v[36:39], v[136:139]
s_waitcnt lgkmcnt(11)
v_exp_f32 v76, v76
v_mfma_f32_16x16x32_bf16 v[136:139], a[184:187], v[32:35], v[136:139]
s_xor_b32 s21, s23, 409600
v_exp_f32 v77, v77
v_mfma_f32_16x16x32_bf16 v[140:143], a[188:191], v[32:35], v[140:143]
s_add_u32 m0, s22, 16896
v_exp_f32 v78, v78
v_mfma_f32_16x16x32_bf16 v[140:143], a[220:223], v[36:39], v[140:143]
v_exp_f32 v79, v79
v_mfma_f32_16x16x32_bf16 v[144:147], a[224:227], v[36:39], v[144:147]
buffer_load_dwordx4 v97, s[8:11], s21 offen offset:0 nt lds
v_mfma_f32_16x16x32_bf16 v[144:147], a[192:195], v[32:35], v[144:147]
s_waitcnt lgkmcnt(3)
v_cvt_pk_bf16_f32 v44, v76, v77
v_cvt_pk_bf16_f32 v45, v78, v79
v_mfma_f32_16x16x32_bf16 v[148:151], a[196:199], v[32:35], v[148:151]
v_exp_f32 v80, v80
v_mfma_f32_16x16x32_bf16 v[148:151], a[228:231], v[36:39], v[148:151]
v_exp_f32 v81, v81
v_mfma_f32_16x16x32_bf16 v[152:155], a[232:235], v[36:39], v[152:155]
v_exp_f32 v82, v82
v_mfma_f32_16x16x32_bf16 v[152:155], a[200:203], v[32:35], v[152:155]
s_waitcnt lgkmcnt(0)
v_exp_f32 v83, v83
v_mfma_f32_16x16x32_bf16 v[156:159], a[204:207], v[32:35], v[156:159]
v_cvt_pk_bf16_f32 v46, v80, v81
v_cvt_pk_bf16_f32 v47, v82, v83
v_mfma_f32_16x16x32_bf16 v[156:159], a[236:239], v[36:39], v[156:159]
v_exp_f32 v84, v84
v_smfmac_f32_16x16x64_bf16 a[240:243], a[248:251], v[32:39], v92
v_mov_b32 v116, v102
v_mfma_f32_16x16x32_bf16 v[72:75], a[144:147], a[32:35], v[56:59]
v_exp_f32 v85, v85
v_mfma_f32_16x16x32_bf16 v[72:75], a[148:151], a[36:39], v[72:75]
v_exp_f32 v86, v86
v_mfma_f32_16x16x32_bf16 v[72:75], a[152:155], a[40:43], v[72:75]
v_exp_f32 v87, v87
v_mfma_f32_16x16x32_bf16 v[72:75], a[156:159], a[44:47], v[72:75]
v_cvt_pk_bf16_f32 v40, v84, v85
v_cvt_pk_bf16_f32 v41, v86, v87
v_mfma_f32_16x16x32_bf16 v[76:79], a[172:175], a[44:47], v[56:59]
s_xor_b32 s21, s23, 413696
v_exp_f32 v68, v68
v_mfma_f32_16x16x32_bf16 v[76:79], a[168:171], a[40:43], v[76:79]
s_add_u32 m0, s22, 17952
v_exp_f32 v69, v69
v_mfma_f32_16x16x32_bf16 v[76:79], a[164:167], a[36:39], v[76:79]
v_exp_f32 v70, v70
v_mfma_f32_16x16x32_bf16 v[76:79], a[160:163], a[32:35], v[76:79]
buffer_load_dwordx4 v97, s[8:11], s21 offen offset:0 nt lds
v_mfma_f32_16x16x32_bf16 v[80:83], a[112:115], a[32:35], v[56:59]
v_exp_f32 v71, v71
v_mfma_f32_16x16x32_bf16 v[80:83], a[116:119], a[36:39], v[80:83]
v_cvt_pk_bf16_f32 v42, v68, v69
v_cvt_pk_bf16_f32 v43, v70, v71
v_mfma_f32_16x16x32_bf16 v[80:83], a[120:123], a[40:43], v[80:83]
v_exp_f32 v72, v72
v_mfma_f32_16x16x32_bf16 v[80:83], a[124:127], a[44:47], v[80:83]
v_exp_f32 v73, v73
v_mfma_f32_16x16x32_bf16 v[84:87], a[140:143], a[44:47], v[56:59]
v_exp_f32 v74, v74
v_mfma_f32_16x16x32_bf16 v[84:87], a[136:139], a[40:43], v[84:87]
v_exp_f32 v75, v75
v_mfma_f32_16x16x32_bf16 v[84:87], a[132:135], a[36:39], v[84:87]
v_cvt_pk_bf16_f32 v36, v72, v73
v_cvt_pk_bf16_f32 v37, v74, v75
v_mfma_f32_16x16x32_bf16 v[84:87], a[128:131], a[32:35], v[84:87]
v_exp_f32 v76, v76
v_mfma_f32_16x16x32_bf16 v[160:163], a[208:211], v[44:47], v[160:163]
v_exp_f32 v77, v77
v_mfma_f32_16x16x32_bf16 v[160:163], a[176:179], v[40:43], v[160:163]
v_exp_f32 v78, v78
v_mfma_f32_16x16x32_bf16 v[164:167], a[180:183], v[40:43], v[164:167]
v_exp_f32 v79, v79
v_mfma_f32_16x16x32_bf16 v[164:167], a[212:215], v[44:47], v[164:167]
v_cvt_pk_bf16_f32 v38, v76, v77
v_cvt_pk_bf16_f32 v39, v78, v79
v_mfma_f32_16x16x32_bf16 v[168:171], a[216:219], v[44:47], v[168:171]
v_exp_f32 v80, v80
v_mfma_f32_16x16x32_bf16 v[168:171], a[184:187], v[40:43], v[168:171]
s_xor_b32 s21, s23, 417792
v_exp_f32 v81, v81
v_mfma_f32_16x16x32_bf16 v[172:175], a[188:191], v[40:43], v[172:175]
s_add_u32 m0, s22, 19008
v_exp_f32 v82, v82
v_mfma_f32_16x16x32_bf16 v[172:175], a[220:223], v[44:47], v[172:175]
v_exp_f32 v83, v83
v_mfma_f32_16x16x32_bf16 v[176:179], a[224:227], v[44:47], v[176:179]
buffer_load_dwordx4 v97, s[8:11], s21 offen offset:0 nt lds
v_mfma_f32_16x16x32_bf16 v[176:179], a[192:195], v[40:43], v[176:179]
v_cvt_pk_bf16_f32 v32, v80, v81
v_cvt_pk_bf16_f32 v33, v82, v83
v_mfma_f32_16x16x32_bf16 v[180:183], a[196:199], v[40:43], v[180:183]
v_exp_f32 v84, v84
v_mfma_f32_16x16x32_bf16 v[180:183], a[228:231], v[44:47], v[180:183]
v_exp_f32 v85, v85
v_mfma_f32_16x16x32_bf16 v[184:187], a[232:235], v[44:47], v[184:187]
v_exp_f32 v86, v86
v_mfma_f32_16x16x32_bf16 v[184:187], a[200:203], v[40:43], v[184:187]
v_exp_f32 v87, v87
v_mfma_f32_16x16x32_bf16 v[188:191], a[204:207], v[40:43], v[188:191]
v_cvt_pk_bf16_f32 v34, v84, v85
v_cvt_pk_bf16_f32 v35, v86, v87
v_mfma_f32_16x16x32_bf16 v[188:191], a[236:239], v[44:47], v[188:191]
v_add_u32 v121, s24, v121
v_add_f32 v100, v100, v116
v_smfmac_f32_16x16x64_bf16 a[240:243], a[252:255], v[40:47], v92
v_mfma_f32_16x16x32_bf16 v[68:71], a[144:147], v[0:3], v[60:63]
v_mfma_f32_16x16x32_bf16 v[68:71], a[148:151], v[4:7], v[68:71]
v_mfma_f32_16x16x32_bf16 v[68:71], a[152:155], v[8:11], v[68:71]
v_mfma_f32_16x16x32_bf16 v[68:71], a[156:159], v[12:15], v[68:71]
v_mfma_f32_16x16x32_bf16 v[72:75], a[172:175], v[12:15], v[60:63]
s_xor_b32 s21, s23, 421888
v_mfma_f32_16x16x32_bf16 v[72:75], a[168:171], v[8:11], v[72:75]
s_add_u32 m0, s22, 20064
v_mfma_f32_16x16x32_bf16 v[72:75], a[164:167], v[4:7], v[72:75]
v_mfma_f32_16x16x32_bf16 v[72:75], a[160:163], v[0:3], v[72:75]
buffer_load_dwordx4 v97, s[8:11], s21 offen offset:0 nt lds
v_mfma_f32_16x16x32_bf16 v[76:79], a[112:115], v[0:3], v[60:63]
v_exp_f32 v68, v68
v_mfma_f32_16x16x32_bf16 v[76:79], a[116:119], v[4:7], v[76:79]
v_exp_f32 v69, v69
v_mfma_f32_16x16x32_bf16 v[76:79], a[120:123], v[8:11], v[76:79]
v_exp_f32 v70, v70
v_mfma_f32_16x16x32_bf16 v[76:79], a[124:127], v[12:15], v[76:79]
v_exp_f32 v71, v71
v_mfma_f32_16x16x32_bf16 v[80:83], a[140:143], v[12:15], v[60:63]
v_cvt_pk_bf16_f32 v44, v68, v69
v_cvt_pk_bf16_f32 v45, v70, v71
v_mfma_f32_16x16x32_bf16 v[80:83], a[136:139], v[8:11], v[80:83]
v_exp_f32 v72, v72
v_mfma_f32_16x16x32_bf16 v[80:83], a[132:135], v[4:7], v[80:83]
v_exp_f32 v73, v73
v_mfma_f32_16x16x32_bf16 v[80:83], a[128:131], v[0:3], v[80:83]
v_exp_f32 v74, v74
v_mfma_f32_16x16x32_bf16 v[192:195], a[208:211], v[36:39], v[192:195]
v_exp_f32 v75, v75
v_mfma_f32_16x16x32_bf16 v[192:195], a[176:179], v[32:35], v[192:195]
v_cvt_pk_bf16_f32 v46, v72, v73
v_cvt_pk_bf16_f32 v47, v74, v75
v_mfma_f32_16x16x32_bf16 v[196:199], a[180:183], v[32:35], v[196:199]
v_exp_f32 v76, v76
v_mfma_f32_16x16x32_bf16 v[196:199], a[212:215], v[36:39], v[196:199]
v_exp_f32 v77, v77
v_mfma_f32_16x16x32_bf16 v[200:203], a[216:219], v[36:39], v[200:203]
v_exp_f32 v78, v78
v_mfma_f32_16x16x32_bf16 v[200:203], a[184:187], v[32:35], v[200:203]
s_xor_b32 s21, s23, 409600
v_exp_f32 v79, v79
v_mfma_f32_16x16x32_bf16 v[204:207], a[188:191], v[32:35], v[204:207]
s_add_u32 m0, s22, 67584
v_exp_f32 v80, v80
v_mfma_f32_16x16x32_bf16 v[204:207], a[220:223], v[36:39], v[204:207]
v_exp_f32 v81, v81
v_mfma_f32_16x16x32_bf16 v[208:211], a[224:227], v[36:39], v[208:211]
buffer_load_dwordx4 v97, s[12:15], s21 offen offset:0 nt lds
v_mfma_f32_16x16x32_bf16 v[208:211], a[192:195], v[32:35], v[208:211]
v_exp_f32 v82, v82
v_mfma_f32_16x16x32_bf16 v[212:215], a[196:199], v[32:35], v[212:215]
v_exp_f32 v83, v83
v_mfma_f32_16x16x32_bf16 v[212:215], a[228:231], v[36:39], v[212:215]
v_cvt_pk_bf16_f32 v40, v76, v77
v_cvt_pk_bf16_f32 v41, v78, v79
v_mfma_f32_16x16x32_bf16 v[216:219], a[232:235], v[36:39], v[216:219]
v_cvt_pk_bf16_f32 v42, v80, v81
v_cvt_pk_bf16_f32 v43, v82, v83
v_mfma_f32_16x16x32_bf16 v[216:219], a[200:203], v[32:35], v[216:219]
v_mfma_f32_16x16x32_bf16 v[220:223], a[204:207], v[32:35], v[220:223]
s_waitcnt vmcnt(6)
s_barrier
v_mfma_f32_16x16x32_bf16 v[220:223], a[236:239], v[36:39], v[220:223]
ds_write_b64 v118, v[116:117] offset:13056
v_smfmac_f32_16x16x64_bf16 a[244:247], a[248:251], v[32:39], v92
ds_read_b128 a[144:147], v89 offset:0
v_mfma_f32_16x16x32_bf16 v[84:87], a[112:115], v[16:19], v[64:67]
ds_read_b128 a[148:151], v89 offset:64
v_mfma_f32_16x16x32_bf16 v[84:87], a[116:119], v[20:23], v[84:87]
ds_read_b128 a[152:155], v89 offset:128
v_and_b32 v93, 0xf0, v96
v_mfma_f32_16x16x32_bf16 v[84:87], a[120:123], v[24:27], v[84:87]
ds_read_b128 a[156:159], v89 offset:192
v_lshrrev_b32 v124, 8, v96
v_mfma_f32_16x16x32_bf16 v[84:87], a[124:127], v[28:31], v[84:87]
ds_read_b128 a[172:175], v89 offset:704
v_lshl_add_u32 v93, v124, 2, v93
v_mfma_f32_16x16x32_bf16 v[68:71], a[140:143], v[28:31], v[64:67]
s_xor_b32 s21, s23, 413696
ds_read_b128 a[168:171], v89 offset:640
v_lshl_add_u32 v93, v93, 1, s24
v_mfma_f32_16x16x32_bf16 v[68:71], a[136:139], v[24:27], v[68:71]
s_add_u32 m0, s22, 68640
ds_read_b128 a[164:167], v89 offset:576
v_lshrrev_b32 v124, 7, v96
v_mfma_f32_16x16x32_bf16 v[68:71], a[132:135], v[20:23], v[68:71]
ds_read_b128 a[160:163], v89 offset:512
v_and_b32 v101, 0x70, v96
v_mfma_f32_16x16x32_bf16 v[68:71], a[128:131], v[16:19], v[68:71]
buffer_load_dwordx4 v97, s[12:15], s21 offen offset:0 nt lds
v_mfma_f32_16x16x32_bf16 v[224:227], a[208:211], v[44:47], v[224:227]
ds_read_b128 a[112:115], v88 offset:0
v_lshl_add_u32 v101, v124, 8, v101
v_mfma_f32_16x16x32_bf16 v[224:227], a[176:179], v[40:43], v[224:227]
ds_read_b128 a[116:119], v88 offset:64
v_bfe_u32 v124, v96, 5, 2
v_mfma_f32_16x16x32_bf16 v[228:231], a[180:183], v[40:43], v[228:231]
ds_read_b128 a[120:123], v88 offset:128
v_and_b32 v102, 0x190, v96
v_mfma_f32_16x16x32_bf16 v[228:231], a[212:215], v[44:47], v[228:231]
ds_read_b128 a[124:127], v88 offset:192
v_lshl_add_u32 v102, v124, 10, v102
v_mfma_f32_16x16x32_bf16 v[232:235], a[216:219], v[44:47], v[232:235]
ds_read_b128 a[140:143], v88 offset:704
v_lshrrev_b32 v124, 9, v96
v_mfma_f32_16x16x32_bf16 v[232:235], a[184:187], v[40:43], v[232:235]
ds_read_b128 a[136:139], v88 offset:640
v_lshl_add_u32 v102, v124, 5, v102
v_mfma_f32_16x16x32_bf16 v[236:239], a[188:191], v[40:43], v[236:239]
ds_read_b128 a[132:135], v88 offset:576
v_add_u32 v102, s24, v102
v_mfma_f32_16x16x32_bf16 v[236:239], a[220:223], v[44:47], v[236:239]
v_exp_f32 v84, v84
v_mfma_f32_16x16x32_bf16 v[240:243], a[224:227], v[44:47], v[240:243]
ds_read_b128 a[128:131], v88 offset:512
v_add_f32 v103, v103, v84
v_mfma_f32_16x16x32_bf16 v[240:243], a[192:195], v[40:43], v[240:243]
v_exp_f32 v85, v85
v_mfma_f32_16x16x32_bf16 v[244:247], a[196:199], v[40:43], v[244:247]
v_exp_f32 v86, v86
v_mfma_f32_16x16x32_bf16 v[244:247], a[228:231], v[44:47], v[244:247]
v_exp_f32 v87, v87
v_mfma_f32_16x16x32_bf16 v[248:251], a[232:235], v[44:47], v[248:251]
v_add_f32 v103, v103, v85
v_cvt_pk_bf16_f32 v32, v84, v85
v_mfma_f32_16x16x32_bf16 v[248:251], a[200:203], v[40:43], v[248:251]
s_xor_b32 s21, s23, 417792
v_add_f32 v103, v103, v86
v_add_f32 v103, v103, v87
v_mfma_f32_16x16x32_bf16 v[252:255], a[204:207], v[40:43], v[252:255]
s_add_u32 m0, s22, 69696
ds_read_b64_tr_b16 a[208:209], v91 offset:0
v_cvt_pk_bf16_f32 v33, v86, v87
v_mfma_f32_16x16x32_bf16 v[252:255], a[236:239], v[44:47], v[252:255]
v_exp_f32 v68, v68
v_smfmac_f32_16x16x64_bf16 a[244:247], a[252:255], v[40:47], v92
s_waitcnt lgkmcnt(1)
v_add_f32 v103, v103, v68
v_mfma_f32_16x16x32_bf16 v[72:75], a[144:147], a[0:3], v[48:51]
buffer_load_dwordx4 v97, s[12:15], s21 offen offset:0 nt lds
v_mfma_f32_16x16x32_bf16 v[72:75], a[148:151], a[4:7], v[72:75]
v_exp_f32 v69, v69
v_mfma_f32_16x16x32_bf16 v[72:75], a[152:155], a[8:11], v[72:75]
ds_write_b128 v119, a[80:83] offset:4352
v_mfma_f32_16x16x32_bf16 v[72:75], a[156:159], a[12:15], v[72:75]
v_exp_f32 v70, v70
v_mfma_f32_16x16x32_bf16 v[76:79], a[172:175], a[12:15], v[48:51]
v_exp_f32 v71, v71
v_mfma_f32_16x16x32_bf16 v[76:79], a[168:171], a[8:11], v[76:79]
v_cvt_pk_bf16_f32 v34, v68, v69
v_cvt_pk_bf16_f32 v35, v70, v71
v_mfma_f32_16x16x32_bf16 v[76:79], a[164:167], a[4:7], v[76:79]
v_add_f32 v103, v103, v69
v_add_f32 v103, v103, v70
v_mfma_f32_16x16x32_bf16 v[76:79], a[160:163], a[0:3], v[76:79]
ds_read_b64_tr_b16 a[210:211], v91 offset:512
v_add_f32 v103, v103, v71
v_mfma_f32_16x16x32_bf16 v[80:83], a[112:115], a[0:3], v[48:51]
v_exp_f32 v72, v72
v_mfma_f32_16x16x32_bf16 v[80:83], a[116:119], a[4:7], v[80:83]
v_exp_f32 v73, v73
v_mfma_f32_16x16x32_bf16 v[80:83], a[120:123], a[8:11], v[80:83]
v_exp_f32 v74, v74
v_mfma_f32_16x16x32_bf16 v[80:83], a[124:127], a[12:15], v[80:83]
v_exp_f32 v75, v75
v_mfma_f32_16x16x32_bf16 v[84:87], a[140:143], a[12:15], v[48:51]
v_cvt_pk_bf16_f32 v44, v72, v73
v_cvt_pk_bf16_f32 v45, v74, v75
v_mfma_f32_16x16x32_bf16 v[84:87], a[136:139], a[8:11], v[84:87]
ds_write_b128 v119, a[84:87] offset:5376
v_mfma_f32_16x16x32_bf16 v[84:87], a[132:135], a[4:7], v[84:87]
s_xor_b32 s21, s23, 421888
v_exp_f32 v76, v76
v_mfma_f32_16x16x32_bf16 v[84:87], a[128:131], a[0:3], v[84:87]
s_add_u32 m0, s22, 70752
v_exp_f32 v77, v77
v_mfma_f32_16x16x32_bf16 a[48:51], a[176:179], v[32:35], a[48:51]
buffer_load_dwordx4 v97, s[12:15], s21 offen offset:0 nt lds
v_mfma_f32_16x16x32_bf16 a[52:55], a[180:183], v[32:35], a[52:55]
v_exp_f32 v78, v78
v_mfma_f32_16x16x32_bf16 a[56:59], a[184:187], v[32:35], a[56:59]
v_exp_f32 v79, v79
v_mfma_f32_16x16x32_bf16 a[60:63], a[188:191], v[32:35], a[60:63]
v_cvt_pk_bf16_f32 v46, v76, v77
v_cvt_pk_bf16_f32 v47, v78, v79
v_mfma_f32_16x16x32_bf16 a[64:67], a[192:195], v[32:35], a[64:67]
v_exp_f32 v80, v80
v_mfma_f32_16x16x32_bf16 a[68:71], a[196:199], v[32:35], a[68:71]
v_exp_f32 v81, v81
v_mfma_f32_16x16x32_bf16 a[72:75], a[200:203], v[32:35], a[72:75]
v_exp_f32 v82, v82
v_mfma_f32_16x16x32_bf16 a[76:79], a[204:207], v[32:35], a[76:79]
v_exp_f32 v83, v83
v_mfma_f32_16x16x32_bf16 v[68:71], a[144:147], a[16:19], v[52:55]
ds_read_b64_tr_b16 a[176:177], v90 offset:0
ds_read_b64_tr_b16 a[178:179], v90 offset:512
v_mfma_f32_16x16x32_bf16 v[68:71], a[148:151], a[20:23], v[68:71]
ds_write_b128 v119, a[88:91] offset:6400
v_mfma_f32_16x16x32_bf16 v[68:71], a[152:155], a[24:27], v[68:71]
v_cvt_pk_bf16_f32 v40, v80, v81
v_cvt_pk_bf16_f32 v41, v82, v83
v_mfma_f32_16x16x32_bf16 v[68:71], a[156:159], a[28:31], v[68:71]
ds_read_b64_tr_b16 a[180:181], v90 offset:32
ds_read_b64_tr_b16 a[182:183], v90 offset:544
v_mfma_f32_16x16x32_bf16 v[72:75], a[172:175], a[28:31], v[52:55]
v_exp_f32 v84, v84
v_mfma_f32_16x16x32_bf16 v[72:75], a[168:171], a[24:27], v[72:75]
s_xor_b32 s21, s23, 410624
ds_read_b64_tr_b16 a[212:213], v91 offset:32
ds_read_b64_tr_b16 a[214:215], v91 offset:544
v_mfma_f32_16x16x32_bf16 v[72:75], a[164:167], a[20:23], v[72:75]
s_add_u32 m0, s22, 33792
v_exp_f32 v85, v85
v_mfma_f32_16x16x32_bf16 v[72:75], a[160:163], a[16:19], v[72:75]
ds_read_b64_tr_b16 a[216:217], v91 offset:64
ds_read_b64_tr_b16 a[218:219], v91 offset:576
v_mfma_f32_16x16x32_bf16 v[76:79], a[112:115], a[16:19], v[52:55]
buffer_load_dwordx4 v97, s[8:11], s21 offen offset:0 nt lds
v_mfma_f32_16x16x32_bf16 v[76:79], a[116:119], a[20:23], v[76:79]
v_exp_f32 v86, v86
v_mfma_f32_16x16x32_bf16 v[76:79], a[120:123], a[24:27], v[76:79]
v_exp_f32 v87, v87
v_mfma_f32_16x16x32_bf16 v[76:79], a[124:127], a[28:31], v[76:79]
ds_read_b64_tr_b16 a[184:185], v90 offset:64
ds_read_b64_tr_b16 a[186:187], v90 offset:576
v_mfma_f32_16x16x32_bf16 v[80:83], a[140:143], a[28:31], v[52:55]
v_cvt_pk_bf16_f32 v42, v84, v85
v_cvt_pk_bf16_f32 v43, v86, v87
v_mfma_f32_16x16x32_bf16 v[80:83], a[136:139], a[24:27], v[80:83]
ds_read_b64_tr_b16 a[188:189], v90 offset:96
ds_read_b64_tr_b16 a[190:191], v90 offset:608
v_mfma_f32_16x16x32_bf16 v[80:83], a[132:135], a[20:23], v[80:83]
ds_write_b128 v119, a[92:95] offset:7424
v_mfma_f32_16x16x32_bf16 v[80:83], a[128:131], a[16:19], v[80:83]
s_waitcnt lgkmcnt(5)
ds_read_b64_tr_b16 a[220:221], v91 offset:96
ds_read_b64_tr_b16 a[222:223], v91 offset:608
v_mfma_f32_16x16x32_bf16 v[128:131], a[208:211], v[44:47], v[128:131]
v_exp_f32 v68, v68
v_mfma_f32_16x16x32_bf16 v[128:131], a[176:179], v[40:43], v[128:131]
ds_read_b64_tr_b16 a[224:225], v91 offset:128
ds_read_b64_tr_b16 a[226:227], v91 offset:640
v_mfma_f32_16x16x32_bf16 v[132:135], a[180:183], v[40:43], v[132:135]
ds_read_b64_tr_b16 a[192:193], v90 offset:128
ds_read_b64_tr_b16 a[194:195], v90 offset:640
v_mfma_f32_16x16x32_bf16 v[132:135], a[212:215], v[44:47], v[132:135]
ds_read_b64_tr_b16 a[196:197], v90 offset:160
ds_read_b64_tr_b16 a[198:199], v90 offset:672
v_mfma_f32_16x16x32_bf16 v[136:139], a[216:219], v[44:47], v[136:139]
s_waitcnt lgkmcnt(11)
ds_read_b64_tr_b16 a[228:229], v91 offset:160
ds_read_b64_tr_b16 a[230:231], v91 offset:672
v_mfma_f32_16x16x32_bf16 v[136:139], a[184:187], v[40:43], v[136:139]
s_waitcnt lgkmcnt(8)
ds_read_b64_tr_b16 a[232:233], v91 offset:192
ds_read_b64_tr_b16 a[234:235], v91 offset:704
v_mfma_f32_16x16x32_bf16 v[140:143], a[188:191], v[40:43], v[140:143]
s_xor_b32 s21, s23, 414720
ds_read_b64_tr_b16 a[200:201], v90 offset:192
ds_read_b64_tr_b16 a[202:203], v90 offset:704
v_mfma_f32_16x16x32_bf16 v[140:143], a[220:223], v[44:47], v[140:143]
s_add_u32 m0, s22, 34848
ds_read_b64_tr_b16 a[204:205], v90 offset:224
ds_read_b64_tr_b16 a[206:207], v90 offset:736
s_waitcnt lgkmcnt(12)
v_mfma_f32_16x16x32_bf16 v[144:147], a[224:227], v[44:47], v[144:147]
s_waitcnt lgkmcnt(8)
ds_read_b64_tr_b16 a[236:237], v91 offset:224
ds_read_b64_tr_b16 a[238:239], v91 offset:736
v_mfma_f32_16x16x32_bf16 v[144:147], a[192:195], v[40:43], v[144:147]
buffer_load_dwordx4 v97, s[8:11], s21 offen offset:0 nt lds
v_mfma_f32_16x16x32_bf16 v[148:151], a[196:199], v[40:43], v[148:151]
ds_write_b128 v120, a[96:99] offset:4352
s_waitcnt lgkmcnt(9)
v_mfma_f32_16x16x32_bf16 v[148:151], a[228:231], v[44:47], v[148:151]
s_waitcnt lgkmcnt(7)
v_exp_f32 v69, v69
v_mfma_f32_16x16x32_bf16 v[152:155], a[232:235], v[44:47], v[152:155]
s_waitcnt lgkmcnt(5)
v_exp_f32 v70, v70
v_mfma_f32_16x16x32_bf16 v[152:155], a[200:203], v[40:43], v[152:155]
s_waitcnt lgkmcnt(3)
v_exp_f32 v71, v71
v_mfma_f32_16x16x32_bf16 v[156:159], a[204:207], v[40:43], v[156:159]
s_waitcnt lgkmcnt(1)
v_cvt_pk_bf16_f32 v36, v68, v69
v_cvt_pk_bf16_f32 v37, v70, v71
v_mfma_f32_16x16x32_bf16 v[156:159], a[236:239], v[44:47], v[156:159]
v_exp_f32 v72, v72
v_smfmac_f32_16x16x64_bf16 a[240:243], a[248:251], v[40:47], v92
v_mfma_f32_16x16x32_bf16 v[84:87], a[144:147], a[32:35], v[56:59]
v_exp_f32 v73, v73
v_mfma_f32_16x16x32_bf16 v[84:87], a[148:151], a[36:39], v[84:87]
v_exp_f32 v74, v74
v_mfma_f32_16x16x32_bf16 v[84:87], a[152:155], a[40:43], v[84:87]
v_exp_f32 v75, v75
v_mfma_f32_16x16x32_bf16 v[84:87], a[156:159], a[44:47], v[84:87]
v_cvt_pk_bf16_f32 v38, v72, v73
v_cvt_pk_bf16_f32 v39, v74, v75
v_mfma_f32_16x16x32_bf16 v[68:71], a[172:175], a[44:47], v[56:59]
ds_write_b128 v120, a[100:103] offset:5376
v_mfma_f32_16x16x32_bf16 v[68:71], a[168:171], a[40:43], v[68:71]
v_exp_f32 v76, v76
v_mfma_f32_16x16x32_bf16 v[68:71], a[164:167], a[36:39], v[68:71]
s_xor_b32 s21, s23, 418816
v_exp_f32 v77, v77
v_mfma_f32_16x16x32_bf16 v[68:71], a[160:163], a[32:35], v[68:71]
s_add_u32 m0, s22, 35904
v_exp_f32 v78, v78
v_mfma_f32_16x16x32_bf16 v[72:75], a[112:115], a[32:35], v[56:59]
v_exp_f32 v79, v79
v_mfma_f32_16x16x32_bf16 v[72:75], a[116:119], a[36:39], v[72:75]
v_cvt_pk_bf16_f32 v32, v76, v77
v_cvt_pk_bf16_f32 v33, v78, v79
v_mfma_f32_16x16x32_bf16 v[72:75], a[120:123], a[40:43], v[72:75]
v_exp_f32 v80, v80
v_mfma_f32_16x16x32_bf16 v[72:75], a[124:127], a[44:47], v[72:75]
v_exp_f32 v81, v81
v_mfma_f32_16x16x32_bf16 v[76:79], a[140:143], a[44:47], v[56:59]
v_exp_f32 v82, v82
v_mfma_f32_16x16x32_bf16 v[76:79], a[136:139], a[40:43], v[76:79]
v_exp_f32 v83, v83
v_mfma_f32_16x16x32_bf16 v[76:79], a[132:135], a[36:39], v[76:79]
buffer_load_dwordx4 v97, s[8:11], s21 offen offset:0 nt lds
v_mfma_f32_16x16x32_bf16 v[76:79], a[128:131], a[32:35], v[76:79]
v_cvt_pk_bf16_f32 v34, v80, v81
v_cvt_pk_bf16_f32 v35, v82, v83
v_mfma_f32_16x16x32_bf16 v[160:163], a[208:211], v[36:39], v[160:163]
ds_write_b128 v120, a[104:107] offset:6400
v_mfma_f32_16x16x32_bf16 v[160:163], a[176:179], v[32:35], v[160:163]
v_exp_f32 v84, v84
v_mfma_f32_16x16x32_bf16 v[164:167], a[180:183], v[32:35], v[164:167]
v_exp_f32 v85, v85
v_mfma_f32_16x16x32_bf16 v[164:167], a[212:215], v[36:39], v[164:167]
v_exp_f32 v86, v86
v_mfma_f32_16x16x32_bf16 v[168:171], a[216:219], v[36:39], v[168:171]
v_exp_f32 v87, v87
v_mfma_f32_16x16x32_bf16 v[168:171], a[184:187], v[32:35], v[168:171]
v_cvt_pk_bf16_f32 v44, v84, v85
v_cvt_pk_bf16_f32 v45, v86, v87
v_mfma_f32_16x16x32_bf16 v[172:175], a[188:191], v[32:35], v[172:175]
v_exp_f32 v68, v68
v_mfma_f32_16x16x32_bf16 v[172:175], a[220:223], v[36:39], v[172:175]
s_xor_b32 s21, s23, 422912
v_exp_f32 v69, v69
v_mfma_f32_16x16x32_bf16 v[176:179], a[224:227], v[36:39], v[176:179]
s_add_u32 m0, s22, 36960
v_exp_f32 v70, v70
v_mfma_f32_16x16x32_bf16 v[176:179], a[192:195], v[32:35], v[176:179]
v_exp_f32 v71, v71
v_mfma_f32_16x16x32_bf16 v[180:183], a[196:199], v[32:35], v[180:183]
buffer_load_dwordx4 v97, s[8:11], s21 offen offset:0 nt lds
v_mfma_f32_16x16x32_bf16 v[180:183], a[228:231], v[36:39], v[180:183]
v_cvt_pk_bf16_f32 v46, v68, v69
v_cvt_pk_bf16_f32 v47, v70, v71
v_mfma_f32_16x16x32_bf16 v[184:187], a[232:235], v[36:39], v[184:187]
ds_write_b128 v120, a[108:111] offset:7424
v_mfma_f32_16x16x32_bf16 v[184:187], a[200:203], v[32:35], v[184:187]
v_exp_f32 v72, v72
v_mfma_f32_16x16x32_bf16 v[188:191], a[204:207], v[32:35], v[188:191]
v_exp_f32 v73, v73
v_mfma_f32_16x16x32_bf16 v[188:191], a[236:239], v[36:39], v[188:191]
v_exp_f32 v74, v74
v_smfmac_f32_16x16x64_bf16 a[240:243], a[252:255], v[32:39], v92
v_cvt_pk_bf16_f32 v40, v72, v73
v_mfma_f32_16x16x32_bf16 v[80:83], a[144:147], v[0:3], v[60:63]
v_exp_f32 v75, v75
v_mfma_f32_16x16x32_bf16 v[80:83], a[148:151], v[4:7], v[80:83]
v_exp_f32 v76, v76
v_mfma_f32_16x16x32_bf16 v[80:83], a[152:155], v[8:11], v[80:83]
v_exp_f32 v77, v77
v_mfma_f32_16x16x32_bf16 v[80:83], a[156:159], v[12:15], v[80:83]
v_cvt_pk_bf16_f32 v41, v74, v75
v_cvt_pk_bf16_f32 v42, v76, v77
v_mfma_f32_16x16x32_bf16 v[84:87], a[172:175], v[12:15], v[60:63]
v_exp_f32 v78, v78
v_mfma_f32_16x16x32_bf16 v[84:87], a[168:171], v[8:11], v[84:87]
v_exp_f32 v79, v79
v_mfma_f32_16x16x32_bf16 v[84:87], a[164:167], v[4:7], v[84:87]
v_cvt_pk_bf16_f32 v43, v78, v79
v_mfma_f32_16x16x32_bf16 v[84:87], a[160:163], v[0:3], v[84:87]
v_exp_f32 v80, v80
v_mfma_f32_16x16x32_bf16 v[68:71], a[112:115], v[0:3], v[60:63]
s_xor_b32 s21, s23, 410624
v_exp_f32 v81, v81
v_mfma_f32_16x16x32_bf16 v[68:71], a[116:119], v[4:7], v[68:71]
s_add_u32 m0, s22, 84480
v_exp_f32 v82, v82
v_mfma_f32_16x16x32_bf16 v[68:71], a[120:123], v[8:11], v[68:71]
v_exp_f32 v83, v83
v_mfma_f32_16x16x32_bf16 v[68:71], a[124:127], v[12:15], v[68:71]
buffer_load_dwordx4 v97, s[12:15], s21 offen offset:0 nt lds
v_mfma_f32_16x16x32_bf16 v[72:75], a[140:143], v[12:15], v[60:63]
v_cmp_ngt_f32 vcc, s35, v100
v_mov_b32 v100, 0
s_cmp_lg_u64 vcc, 0
s_cselect_b32 s40, 1, 0
s_or_b32 s30, s30, s40
v_mfma_f32_16x16x32_bf16 v[72:75], a[136:139], v[8:11], v[72:75]
v_cvt_pk_bf16_f32 v36, v80, v81
v_cvt_pk_bf16_f32 v37, v82, v83
v_mfma_f32_16x16x32_bf16 v[72:75], a[132:135], v[4:7], v[72:75]
v_exp_f32 v84, v84
v_mfma_f32_16x16x32_bf16 v[72:75], a[128:131], v[0:3], v[72:75]
v_exp_f32 v85, v85
v_mfma_f32_16x16x32_bf16 v[192:195], a[208:211], v[44:47], v[192:195]
v_exp_f32 v86, v86
v_mfma_f32_16x16x32_bf16 v[192:195], a[176:179], v[40:43], v[192:195]
v_exp_f32 v87, v87
v_mfma_f32_16x16x32_bf16 v[196:199], a[180:183], v[40:43], v[196:199]
v_cvt_pk_bf16_f32 v38, v84, v85
v_cvt_pk_bf16_f32 v39, v86, v87
v_mfma_f32_16x16x32_bf16 v[196:199], a[212:215], v[44:47], v[196:199]
v_exp_f32 v68, v68
v_mfma_f32_16x16x32_bf16 v[200:203], a[216:219], v[44:47], v[200:203]
v_exp_f32 v69, v69
v_mfma_f32_16x16x32_bf16 v[200:203], a[184:187], v[40:43], v[200:203]
v_exp_f32 v70, v70
v_mfma_f32_16x16x32_bf16 v[204:207], a[188:191], v[40:43], v[204:207]
v_exp_f32 v71, v71
v_mfma_f32_16x16x32_bf16 v[204:207], a[220:223], v[44:47], v[204:207]
v_exp_f32 v72, v72
v_mfma_f32_16x16x32_bf16 v[208:211], a[224:227], v[44:47], v[208:211]
v_exp_f32 v73, v73
v_mfma_f32_16x16x32_bf16 v[208:211], a[192:195], v[40:43], v[208:211]
s_xor_b32 s21, s23, 414720
v_exp_f32 v74, v74
v_mfma_f32_16x16x32_bf16 v[212:215], a[196:199], v[40:43], v[212:215]
s_add_u32 m0, s22, 85536
v_exp_f32 v75, v75
v_mfma_f32_16x16x32_bf16 v[212:215], a[228:231], v[44:47], v[212:215]
v_cvt_pk_bf16_f32 v32, v68, v69
v_cvt_pk_bf16_f32 v33, v70, v71
v_mfma_f32_16x16x32_bf16 v[216:219], a[232:235], v[44:47], v[216:219]
buffer_load_dwordx4 v97, s[12:15], s21 offen offset:0 nt lds
v_mfma_f32_16x16x32_bf16 v[216:219], a[200:203], v[40:43], v[216:219]
v_cvt_pk_bf16_f32 v34, v72, v73
v_cvt_pk_bf16_f32 v35, v74, v75
v_mfma_f32_16x16x32_bf16 v[220:223], a[204:207], v[40:43], v[220:223]
s_waitcnt vmcnt(6) lgkmcnt(0)
s_barrier
v_mfma_f32_16x16x32_bf16 v[220:223], a[236:239], v[44:47], v[220:223]
ds_read_b128 a[144:147], v89 offset:16896
v_smfmac_f32_16x16x64_bf16 a[244:247], a[248:251], v[40:47], v92
ds_read_b128 a[148:151], v89 offset:16960
v_mfma_f32_16x16x32_bf16 v[76:79], a[112:115], v[16:19], v[64:67]
ds_read_b128 a[152:155], v89 offset:17024
v_mfma_f32_16x16x32_bf16 v[76:79], a[116:119], v[20:23], v[76:79]
ds_read_b128 a[156:159], v89 offset:17088
v_mfma_f32_16x16x32_bf16 v[76:79], a[120:123], v[24:27], v[76:79]
ds_read_b128 a[172:175], v89 offset:17600
v_mfma_f32_16x16x32_bf16 v[76:79], a[124:127], v[28:31], v[76:79]
ds_read_b128 a[168:171], v89 offset:17536
v_mfma_f32_16x16x32_bf16 v[80:83], a[140:143], v[28:31], v[64:67]
ds_read_b128 a[164:167], v89 offset:17472
v_mfma_f32_16x16x32_bf16 v[80:83], a[136:139], v[24:27], v[80:83]
ds_read_b128 a[160:163], v89 offset:17408
v_mfma_f32_16x16x32_bf16 v[80:83], a[132:135], v[20:23], v[80:83]
ds_read_b128 a[112:115], v88 offset:16896
v_mfma_f32_16x16x32_bf16 v[80:83], a[128:131], v[16:19], v[80:83]
v_exp_f32 v76, v76
v_mfma_f32_16x16x32_bf16 v[224:227], a[208:211], v[36:39], v[224:227]
ds_read_b128 a[116:119], v88 offset:16960
v_add_f32 v103, v103, v76
v_mfma_f32_16x16x32_bf16 v[224:227], a[176:179], v[32:35], v[224:227]
s_xor_b32 s21, s23, 418816
v_exp_f32 v77, v77
v_mfma_f32_16x16x32_bf16 v[228:231], a[180:183], v[32:35], v[228:231]
s_add_u32 m0, s22, 86592
ds_read_b128 a[120:123], v88 offset:17024
v_add_f32 v103, v103, v77
v_mfma_f32_16x16x32_bf16 v[228:231], a[212:215], v[36:39], v[228:231]
ds_read_b128 a[124:127], v88 offset:17088
v_cvt_pk_bf16_f32 v40, v76, v77
v_mfma_f32_16x16x32_bf16 v[232:235], a[216:219], v[36:39], v[232:235]
buffer_load_dwordx4 v97, s[12:15], s21 offen offset:0 nt lds
v_mfma_f32_16x16x32_bf16 v[232:235], a[184:187], v[32:35], v[232:235]
v_exp_f32 v78, v78
v_mfma_f32_16x16x32_bf16 v[236:239], a[188:191], v[32:35], v[236:239]
ds_read_b128 a[140:143], v88 offset:17600
v_add_f32 v103, v103, v78
v_mfma_f32_16x16x32_bf16 v[236:239], a[220:223], v[36:39], v[236:239]
v_exp_f32 v79, v79
v_mfma_f32_16x16x32_bf16 v[240:243], a[224:227], v[36:39], v[240:243]
ds_read_b128 a[136:139], v88 offset:17536
v_add_f32 v103, v103, v79
v_mfma_f32_16x16x32_bf16 v[240:243], a[192:195], v[32:35], v[240:243]
ds_read_b128 a[132:135], v88 offset:17472
v_cvt_pk_bf16_f32 v41, v78, v79
v_mfma_f32_16x16x32_bf16 v[244:247], a[196:199], v[32:35], v[244:247]
v_exp_f32 v80, v80
v_mfma_f32_16x16x32_bf16 v[244:247], a[228:231], v[36:39], v[244:247]
ds_read_b128 a[128:131], v88 offset:17408
v_add_f32 v103, v103, v80
v_mfma_f32_16x16x32_bf16 v[248:251], a[232:235], v[36:39], v[248:251]
v_exp_f32 v81, v81
v_mfma_f32_16x16x32_bf16 v[248:251], a[200:203], v[32:35], v[248:251]
v_exp_f32 v82, v82
v_mfma_f32_16x16x32_bf16 v[252:255], a[204:207], v[32:35], v[252:255]
v_exp_f32 v83, v83
v_mfma_f32_16x16x32_bf16 v[252:255], a[236:239], v[36:39], v[252:255]
v_cvt_pk_bf16_f32 v42, v80, v81
v_cvt_pk_bf16_f32 v43, v82, v83
v_smfmac_f32_16x16x64_bf16 a[244:247], a[252:255], v[32:39], v92
s_waitcnt lgkmcnt(2)
v_add_f32 v103, v103, v81
v_mfma_f32_16x16x32_bf16 v[84:87], a[144:147], a[0:3], v[48:51]
v_add_f32 v103, v103, v82
v_add_f32 v103, v103, v83
v_mfma_f32_16x16x32_bf16 v[84:87], a[148:151], a[4:7], v[84:87]
ds_read_b64_tr_b16 a[208:209], v91 offset:16896
ds_read_b64_tr_b16 a[210:211], v91 offset:17408
v_mfma_f32_16x16x32_bf16 v[84:87], a[152:155], a[8:11], v[84:87]
s_xor_b32 s21, s23, 422912
ds_read_b64_tr_b16 a[212:213], v91 offset:16928
v_mfma_f32_16x16x32_bf16 v[84:87], a[156:159], a[12:15], v[84:87]
s_add_u32 m0, s22, 87648
ds_read_b64_tr_b16 a[214:215], v91 offset:17440
ds_read_b64_tr_b16 a[216:217], v91 offset:16960
v_mfma_f32_16x16x32_bf16 v[68:71], a[172:175], a[12:15], v[48:51]
ds_read_b64_tr_b16 a[218:219], v91 offset:17472
v_mfma_f32_16x16x32_bf16 v[68:71], a[168:171], a[8:11], v[68:71]
buffer_load_dwordx4 v97, s[12:15], s21 offen offset:0 nt lds
v_mfma_f32_16x16x32_bf16 v[68:71], a[164:167], a[4:7], v[68:71]
ds_read_b64_tr_b16 a[220:221], v91 offset:16992
ds_read_b64_tr_b16 a[222:223], v91 offset:17504
v_mfma_f32_16x16x32_bf16 v[68:71], a[160:163], a[0:3], v[68:71]
v_exp_f32 v84, v84
v_mfma_f32_16x16x32_bf16 v[72:75], a[112:115], a[0:3], v[48:51]
v_exp_f32 v85, v85
v_mfma_f32_16x16x32_bf16 v[72:75], a[116:119], a[4:7], v[72:75]
v_exp_f32 v86, v86
v_mfma_f32_16x16x32_bf16 v[72:75], a[120:123], a[8:11], v[72:75]
v_exp_f32 v87, v87
v_mfma_f32_16x16x32_bf16 v[72:75], a[124:127], a[12:15], v[72:75]
v_cvt_pk_bf16_f32 v36, v84, v85
v_cvt_pk_bf16_f32 v37, v86, v87
v_mfma_f32_16x16x32_bf16 v[76:79], a[140:143], a[12:15], v[48:51]
v_exp_f32 v68, v68
v_mfma_f32_16x16x32_bf16 v[76:79], a[136:139], a[8:11], v[76:79]
s_waitcnt lgkmcnt(2)
v_exp_f32 v69, v69
v_mfma_f32_16x16x32_bf16 v[76:79], a[132:135], a[4:7], v[76:79]
v_exp_f32 v70, v70
v_mfma_f32_16x16x32_bf16 v[76:79], a[128:131], a[0:3], v[76:79]
v_exp_f32 v71, v71
v_mfma_f32_16x16x32_bf16 a[48:51], a[176:179], v[40:43], a[48:51]
v_cvt_pk_bf16_f32 v38, v68, v69
v_cvt_pk_bf16_f32 v39, v70, v71
v_mfma_f32_16x16x32_bf16 a[52:55], a[180:183], v[40:43], a[52:55]
v_exp_f32 v72, v72
v_mfma_f32_16x16x32_bf16 a[56:59], a[184:187], v[40:43], a[56:59]
v_exp_f32 v73, v73
v_mfma_f32_16x16x32_bf16 a[60:63], a[188:191], v[40:43], a[60:63]
s_xor_b32 s21, s23, 411648
v_exp_f32 v74, v74
v_mfma_f32_16x16x32_bf16 a[64:67], a[192:195], v[40:43], a[64:67]
s_add_u32 m0, s22, 0
v_exp_f32 v75, v75
v_mfma_f32_16x16x32_bf16 a[68:71], a[196:199], v[40:43], a[68:71]
ds_read_b64_tr_b16 a[176:177], v90 offset:16896
ds_read_b64_tr_b16 a[178:179], v90 offset:17408
v_mfma_f32_16x16x32_bf16 a[72:75], a[200:203], v[40:43], a[72:75]
buffer_load_dwordx4 v97, s[8:11], s21 offen offset:0 nt lds
v_mfma_f32_16x16x32_bf16 a[76:79], a[204:207], v[40:43], a[76:79]
v_cvt_pk_bf16_f32 v32, v72, v73
v_cvt_pk_bf16_f32 v33, v74, v75
v_mfma_f32_16x16x32_bf16 v[80:83], a[144:147], a[16:19], v[52:55]
ds_read_b64_tr_b16 a[180:181], v90 offset:16928
ds_read_b64_tr_b16 a[182:183], v90 offset:17440
v_mfma_f32_16x16x32_bf16 v[80:83], a[148:151], a[20:23], v[80:83]
v_exp_f32 v76, v76
v_mfma_f32_16x16x32_bf16 v[80:83], a[152:155], a[24:27], v[80:83]
v_exp_f32 v77, v77
v_mfma_f32_16x16x32_bf16 v[80:83], a[156:159], a[28:31], v[80:83]
v_exp_f32 v78, v78
v_mfma_f32_16x16x32_bf16 v[84:87], a[172:175], a[28:31], v[52:55]
v_exp_f32 v79, v79
v_mfma_f32_16x16x32_bf16 v[84:87], a[168:171], a[24:27], v[84:87]
ds_read_b64_tr_b16 a[184:185], v90 offset:16960
ds_read_b64_tr_b16 a[186:187], v90 offset:17472
v_mfma_f32_16x16x32_bf16 v[84:87], a[164:167], a[20:23], v[84:87]
v_cvt_pk_bf16_f32 v34, v76, v77
v_cvt_pk_bf16_f32 v35, v78, v79
v_mfma_f32_16x16x32_bf16 v[84:87], a[160:163], a[16:19], v[84:87]
ds_read_b64_tr_b16 a[188:189], v90 offset:16992
ds_read_b64_tr_b16 a[190:191], v90 offset:17504
v_mfma_f32_16x16x32_bf16 v[68:71], a[112:115], a[16:19], v[52:55]
v_exp_f32 v80, v80
v_mfma_f32_16x16x32_bf16 v[68:71], a[116:119], a[20:23], v[68:71]
ds_read_b64_tr_b16 a[224:225], v91 offset:17024
ds_read_b64_tr_b16 a[226:227], v91 offset:17536
v_mfma_f32_16x16x32_bf16 v[68:71], a[120:123], a[24:27], v[68:71]
v_exp_f32 v81, v81
v_mfma_f32_16x16x32_bf16 v[68:71], a[124:127], a[28:31], v[68:71]
ds_read_b64_tr_b16 a[192:193], v90 offset:17024
ds_read_b64_tr_b16 a[194:195], v90 offset:17536
v_mfma_f32_16x16x32_bf16 v[72:75], a[140:143], a[28:31], v[52:55]
ds_read_b64_tr_b16 a[196:197], v90 offset:17056
v_cvt_pk_bf16_f32 v44, v80, v81
v_mfma_f32_16x16x32_bf16 v[72:75], a[136:139], a[24:27], v[72:75]
s_xor_b32 s21, s23, 415744
ds_read_b64_tr_b16 a[198:199], v90 offset:17568
ds_read_b64_tr_b16 a[228:229], v91 offset:17056
v_mfma_f32_16x16x32_bf16 v[72:75], a[132:135], a[20:23], v[72:75]
s_add_u32 m0, s22, 1056
v_exp_f32 v82, v82
v_mfma_f32_16x16x32_bf16 v[72:75], a[128:131], a[16:19], v[72:75]
s_waitcnt lgkmcnt(7)
ds_read_b64_tr_b16 a[230:231], v91 offset:17568
ds_read_b64_tr_b16 a[232:233], v91 offset:17088
v_mfma_f32_16x16x32_bf16 v[128:131], a[208:211], v[36:39], v[128:131]
buffer_load_dwordx4 v97, s[8:11], s21 offen offset:0 nt lds
v_mfma_f32_16x16x32_bf16 v[128:131], a[176:179], v[32:35], v[128:131]
ds_read_b64_tr_b16 a[234:235], v91 offset:17600
ds_read_b64_tr_b16 a[200:201], v90 offset:17088
v_mfma_f32_16x16x32_bf16 v[132:135], a[180:183], v[32:35], v[132:135]
v_exp_f32 v83, v83
v_mfma_f32_16x16x32_bf16 v[132:135], a[212:215], v[36:39], v[132:135]
ds_read_b64_tr_b16 a[202:203], v90 offset:17600
ds_read_b64_tr_b16 a[204:205], v90 offset:17120
v_mfma_f32_16x16x32_bf16 v[136:139], a[216:219], v[36:39], v[136:139]
ds_read_b64_tr_b16 a[206:207], v90 offset:17632
v_cvt_pk_bf16_f32 v45, v82, v83
v_mfma_f32_16x16x32_bf16 v[136:139], a[184:187], v[32:35], v[136:139]
ds_read_b64_tr_b16 a[236:237], v91 offset:17120
ds_read_b64_tr_b16 a[238:239], v91 offset:17632
v_mfma_f32_16x16x32_bf16 v[140:143], a[188:191], v[32:35], v[140:143]
v_exp_f32 v84, v84
v_mfma_f32_16x16x32_bf16 v[140:143], a[220:223], v[36:39], v[140:143]
s_waitcnt lgkmcnt(7)
v_exp_f32 v85, v85
v_mfma_f32_16x16x32_bf16 v[144:147], a[224:227], v[36:39], v[144:147]
v_exp_f32 v86, v86
v_mfma_f32_16x16x32_bf16 v[144:147], a[192:195], v[32:35], v[144:147]
v_exp_f32 v87, v87
v_mfma_f32_16x16x32_bf16 v[148:151], a[196:199], v[32:35], v[148:151]
v_cvt_pk_bf16_f32 v46, v84, v85
v_cvt_pk_bf16_f32 v47, v86, v87
v_mfma_f32_16x16x32_bf16 v[148:151], a[228:231], v[36:39], v[148:151]
s_waitcnt lgkmcnt(3)
v_exp_f32 v68, v68
v_mfma_f32_16x16x32_bf16 v[152:155], a[232:235], v[36:39], v[152:155]
v_exp_f32 v69, v69
v_mfma_f32_16x16x32_bf16 v[152:155], a[200:203], v[32:35], v[152:155]
s_waitcnt lgkmcnt(0)
v_exp_f32 v70, v70
v_mfma_f32_16x16x32_bf16 v[156:159], a[204:207], v[32:35], v[156:159]
s_xor_b32 s21, s23, 419840
v_exp_f32 v71, v71
v_mfma_f32_16x16x32_bf16 v[156:159], a[236:239], v[36:39], v[156:159]
s_add_u32 m0, s22, 2112
v_cvt_pk_bf16_f32 v40, v68, v69
v_cvt_pk_bf16_f32 v41, v70, v71
v_smfmac_f32_16x16x64_bf16 a[240:243], a[248:251], v[32:39], v92
ds_read_b64 v[118:119], v121 offset:13056
v_mfma_f32_16x16x32_bf16 v[76:79], a[144:147], a[32:35], v[56:59]
buffer_load_dwordx4 v97, s[8:11], s21 offen offset:0 nt lds
v_mfma_f32_16x16x32_bf16 v[76:79], a[148:151], a[36:39], v[76:79]
v_exp_f32 v72, v72
v_mfma_f32_16x16x32_bf16 v[76:79], a[152:155], a[40:43], v[76:79]
v_exp_f32 v73, v73
v_mfma_f32_16x16x32_bf16 v[76:79], a[156:159], a[44:47], v[76:79]
v_exp_f32 v74, v74
v_mfma_f32_16x16x32_bf16 v[80:83], a[172:175], a[44:47], v[56:59]
v_exp_f32 v75, v75
v_mfma_f32_16x16x32_bf16 v[80:83], a[168:171], a[40:43], v[80:83]
v_cvt_pk_bf16_f32 v42, v72, v73
v_cvt_pk_bf16_f32 v43, v74, v75
v_mfma_f32_16x16x32_bf16 v[80:83], a[164:167], a[36:39], v[80:83]
s_waitcnt lgkmcnt(0)
ds_read_b128 v[108:111], v99 offset:4352
v_min_f32 v120, v117, v119
v_mfma_f32_16x16x32_bf16 v[80:83], a[160:163], a[32:35], v[80:83]
v_exp_f32 v76, v76
v_mfma_f32_16x16x32_bf16 v[84:87], a[112:115], a[32:35], v[56:59]
v_exp_f32 v77, v77
v_mfma_f32_16x16x32_bf16 v[84:87], a[116:119], a[36:39], v[84:87]
v_exp_f32 v78, v78
v_mfma_f32_16x16x32_bf16 v[84:87], a[120:123], a[40:43], v[84:87]
v_exp_f32 v79, v79
v_mfma_f32_16x16x32_bf16 v[84:87], a[124:127], a[44:47], v[84:87]
v_cvt_pk_bf16_f32 v36, v76, v77
v_cvt_pk_bf16_f32 v37, v78, v79
v_mfma_f32_16x16x32_bf16 v[68:71], a[140:143], a[44:47], v[56:59]
v_exp_f32 v80, v80
v_mfma_f32_16x16x32_bf16 v[68:71], a[136:139], a[40:43], v[68:71]
v_exp_f32 v81, v81
v_mfma_f32_16x16x32_bf16 v[68:71], a[132:135], a[36:39], v[68:71]
v_exp_f32 v82, v82
v_mfma_f32_16x16x32_bf16 v[68:71], a[128:131], a[32:35], v[68:71]
s_xor_b32 s21, s23, 423936
v_exp_f32 v83, v83
v_mfma_f32_16x16x32_bf16 v[160:163], a[208:211], v[44:47], v[160:163]
s_add_u32 m0, s22, 3168
v_cvt_pk_bf16_f32 v38, v80, v81
v_cvt_pk_bf16_f32 v39, v82, v83
v_mfma_f32_16x16x32_bf16 v[160:163], a[176:179], v[40:43], v[160:163]
v_exp_f32 v84, v84
v_mfma_f32_16x16x32_bf16 v[164:167], a[180:183], v[40:43], v[164:167]
buffer_load_dwordx4 v97, s[8:11], s21 offen offset:0 nt lds
v_mfma_f32_16x16x32_bf16 v[164:167], a[212:215], v[44:47], v[164:167]
v_exp_f32 v85, v85
v_mfma_f32_16x16x32_bf16 v[168:171], a[216:219], v[44:47], v[168:171]
v_exp_f32 v86, v86
v_mfma_f32_16x16x32_bf16 v[168:171], a[184:187], v[40:43], v[168:171]
v_exp_f32 v87, v87
v_mfma_f32_16x16x32_bf16 v[172:175], a[188:191], v[40:43], v[172:175]
v_cvt_pk_bf16_f32 v32, v84, v85
v_cvt_pk_bf16_f32 v33, v86, v87
v_mfma_f32_16x16x32_bf16 v[172:175], a[220:223], v[44:47], v[172:175]
v_exp_f32 v68, v68
v_mfma_f32_16x16x32_bf16 v[176:179], a[224:227], v[44:47], v[176:179]
v_exp_f32 v69, v69
v_mfma_f32_16x16x32_bf16 v[176:179], a[192:195], v[40:43], v[176:179]
v_exp_f32 v70, v70
v_mfma_f32_16x16x32_bf16 v[180:183], a[196:199], v[40:43], v[180:183]
v_exp_f32 v71, v71
v_mfma_f32_16x16x32_bf16 v[180:183], a[228:231], v[44:47], v[180:183]
v_cvt_pk_bf16_f32 v34, v68, v69
v_cvt_pk_bf16_f32 v35, v70, v71
v_mfma_f32_16x16x32_bf16 v[184:187], a[232:235], v[44:47], v[184:187]
ds_read_b128 v[112:115], v99 offset:8704
v_sub_f32 v122, v120, v117
v_mfma_f32_16x16x32_bf16 v[184:187], a[200:203], v[40:43], v[184:187]
v_exp_f32 v122, v122
v_mfma_f32_16x16x32_bf16 v[188:191], a[204:207], v[40:43], v[188:191]
v_sub_f32 v123, v120, v119
v_mul_f32 v120, v116, v122
v_mfma_f32_16x16x32_bf16 v[188:191], a[236:239], v[44:47], v[188:191]
v_exp_f32 v123, v123
v_smfmac_f32_16x16x64_bf16 a[240:243], a[252:255], v[40:47], v92
s_xor_b32 s21, s23, 411648
v_fmac_f32 v120, v118, v123
v_mfma_f32_16x16x32_bf16 v[72:75], a[144:147], v[0:3], v[60:63]
s_add_u32 m0, s22, 50688
v_rcp_f32 v120, v120
v_mfma_f32_16x16x32_bf16 v[72:75], a[148:151], v[4:7], v[72:75]
v_mul_f32 v122, v122, v120
v_mul_f32 v123, v123, v120
v_mfma_f32_16x16x32_bf16 v[72:75], a[152:155], v[8:11], v[72:75]
buffer_load_dwordx4 v97, s[12:15], s21 offen offset:0 nt lds
v_mfma_f32_16x16x32_bf16 v[72:75], a[156:159], v[12:15], v[72:75]
s_waitcnt lgkmcnt(0)
v_mul_f32 v108, v122, v108
v_mul_f32 v109, v122, v109
v_mfma_f32_16x16x32_bf16 v[76:79], a[172:175], v[12:15], v[60:63]
v_mul_f32 v110, v122, v110
v_mul_f32 v111, v122, v111
v_mfma_f32_16x16x32_bf16 v[76:79], a[168:171], v[8:11], v[76:79]
v_fmac_f32 v108, v123, v112
v_fmac_f32 v109, v123, v113
v_mfma_f32_16x16x32_bf16 v[76:79], a[164:167], v[4:7], v[76:79]
v_fmac_f32 v110, v123, v114
v_fmac_f32 v111, v123, v115
v_mfma_f32_16x16x32_bf16 v[76:79], a[160:163], v[0:3], v[76:79]
v_exp_f32 v72, v72
v_mfma_f32_16x16x32_bf16 v[80:83], a[112:115], v[0:3], v[60:63]
v_exp_f32 v73, v73
v_mfma_f32_16x16x32_bf16 v[80:83], a[116:119], v[4:7], v[80:83]
v_exp_f32 v74, v74
v_mfma_f32_16x16x32_bf16 v[80:83], a[120:123], v[8:11], v[80:83]
v_exp_f32 v75, v75
v_mfma_f32_16x16x32_bf16 v[80:83], a[124:127], v[12:15], v[80:83]
v_cvt_pk_bf16_f32 v44, v72, v73
v_cvt_pk_bf16_f32 v45, v74, v75
v_mfma_f32_16x16x32_bf16 v[84:87], a[140:143], v[12:15], v[60:63]
v_exp_f32 v76, v76
v_mfma_f32_16x16x32_bf16 v[84:87], a[136:139], v[8:11], v[84:87]
v_exp_f32 v77, v77
v_mfma_f32_16x16x32_bf16 v[84:87], a[132:135], v[4:7], v[84:87]
v_exp_f32 v78, v78
v_mfma_f32_16x16x32_bf16 v[84:87], a[128:131], v[0:3], v[84:87]
v_exp_f32 v79, v79
v_mfma_f32_16x16x32_bf16 v[192:195], a[208:211], v[36:39], v[192:195]
v_cvt_pk_bf16_f32 v46, v76, v77
v_cvt_pk_bf16_f32 v47, v78, v79
v_mfma_f32_16x16x32_bf16 v[192:195], a[176:179], v[32:35], v[192:195]
s_xor_b32 s21, s23, 415744
v_exp_f32 v80, v80
v_mfma_f32_16x16x32_bf16 v[196:199], a[180:183], v[32:35], v[196:199]
s_add_u32 m0, s22, 51744
v_exp_f32 v81, v81
v_mfma_f32_16x16x32_bf16 v[196:199], a[212:215], v[36:39], v[196:199]
v_exp_f32 v82, v82
v_mfma_f32_16x16x32_bf16 v[200:203], a[216:219], v[36:39], v[200:203]
buffer_load_dwordx4 v97, s[12:15], s21 offen offset:0 nt lds
v_mfma_f32_16x16x32_bf16 v[200:203], a[184:187], v[32:35], v[200:203]
v_exp_f32 v83, v83
v_mfma_f32_16x16x32_bf16 v[204:207], a[188:191], v[32:35], v[204:207]
v_exp_f32 v84, v84
v_mfma_f32_16x16x32_bf16 v[204:207], a[220:223], v[36:39], v[204:207]
v_exp_f32 v85, v85
v_mfma_f32_16x16x32_bf16 v[208:211], a[224:227], v[36:39], v[208:211]
v_exp_f32 v86, v86
v_mfma_f32_16x16x32_bf16 v[208:211], a[192:195], v[32:35], v[208:211]
v_exp_f32 v87, v87
v_mfma_f32_16x16x32_bf16 v[212:215], a[196:199], v[32:35], v[212:215]
v_cvt_pk_bf16_f32 v40, v80, v81
v_cvt_pk_bf16_f32 v41, v82, v83
v_mfma_f32_16x16x32_bf16 v[212:215], a[228:231], v[36:39], v[212:215]
v_cvt_pk_bf16_f32 v42, v84, v85
v_cvt_pk_bf16_f32 v43, v86, v87
v_mfma_f32_16x16x32_bf16 v[216:219], a[232:235], v[36:39], v[216:219]
v_cvt_pk_bf16_f32 v108, v108, v109
v_cvt_pk_bf16_f32 v109, v110, v111
v_mfma_f32_16x16x32_bf16 v[216:219], a[200:203], v[32:35], v[216:219]
ds_write_b64 v93, v[108:109] offset:8704
v_mfma_f32_16x16x32_bf16 v[220:223], a[204:207], v[32:35], v[220:223]
s_waitcnt vmcnt(6)
s_barrier
v_mfma_f32_16x16x32_bf16 v[220:223], a[236:239], v[36:39], v[220:223]
ds_read_b128 a[144:147], v89 offset:33792
v_smfmac_f32_16x16x64_bf16 a[244:247], a[248:251], v[32:39], v92
ds_read_b128 a[148:151], v89 offset:33856
v_mfma_f32_16x16x32_bf16 v[68:71], a[112:115], v[16:19], v[64:67]
ds_read_b128 a[152:155], v89 offset:33920
v_mfma_f32_16x16x32_bf16 v[68:71], a[116:119], v[20:23], v[68:71]
s_xor_b32 s21, s23, 419840
ds_read_b128 a[156:159], v89 offset:33984
v_mfma_f32_16x16x32_bf16 v[68:71], a[120:123], v[24:27], v[68:71]
s_add_u32 m0, s22, 52800
ds_read_b128 a[172:175], v89 offset:34496
v_mfma_f32_16x16x32_bf16 v[68:71], a[124:127], v[28:31], v[68:71]
ds_read_b128 a[168:171], v89 offset:34432
v_mfma_f32_16x16x32_bf16 v[72:75], a[140:143], v[28:31], v[64:67]
buffer_load_dwordx4 v97, s[12:15], s21 offen offset:0 nt lds
v_mfma_f32_16x16x32_bf16 v[72:75], a[136:139], v[24:27], v[72:75]
ds_read_b128 a[164:167], v89 offset:34368
v_mfma_f32_16x16x32_bf16 v[72:75], a[132:135], v[20:23], v[72:75]
ds_read_b128 a[160:163], v89 offset:34304
v_mfma_f32_16x16x32_bf16 v[72:75], a[128:131], v[16:19], v[72:75]
v_exp_f32 v68, v68
v_mfma_f32_16x16x32_bf16 v[224:227], a[208:211], v[44:47], v[224:227]
ds_read_b128 a[112:115], v88 offset:33792
v_add_f32 v103, v103, v68
v_mfma_f32_16x16x32_bf16 v[224:227], a[176:179], v[40:43], v[224:227]
v_exp_f32 v69, v69
v_mfma_f32_16x16x32_bf16 v[228:231], a[180:183], v[40:43], v[228:231]
ds_read_b128 a[116:119], v88 offset:33856
v_add_f32 v103, v103, v69
v_mfma_f32_16x16x32_bf16 v[228:231], a[212:215], v[44:47], v[228:231]
ds_read_b128 a[120:123], v88 offset:33920
v_cvt_pk_bf16_f32 v32, v68, v69
v_mfma_f32_16x16x32_bf16 v[232:235], a[216:219], v[44:47], v[232:235]
v_exp_f32 v70, v70
v_mfma_f32_16x16x32_bf16 v[232:235], a[184:187], v[40:43], v[232:235]
ds_read_b128 a[124:127], v88 offset:33984
v_add_f32 v103, v103, v70
v_mfma_f32_16x16x32_bf16 v[236:239], a[188:191], v[40:43], v[236:239]
v_exp_f32 v71, v71
v_mfma_f32_16x16x32_bf16 v[236:239], a[220:223], v[44:47], v[236:239]
ds_read_b128 a[140:143], v88 offset:34496
v_add_f32 v103, v103, v71
v_mfma_f32_16x16x32_bf16 v[240:243], a[224:227], v[44:47], v[240:243]
ds_read_b128 a[136:139], v88 offset:34432
v_cvt_pk_bf16_f32 v33, v70, v71
v_mfma_f32_16x16x32_bf16 v[240:243], a[192:195], v[40:43], v[240:243]
v_exp_f32 v72, v72
v_mfma_f32_16x16x32_bf16 v[244:247], a[196:199], v[40:43], v[244:247]
ds_read_b128 a[132:135], v88 offset:34368
v_add_f32 v103, v103, v72
v_mfma_f32_16x16x32_bf16 v[244:247], a[228:231], v[44:47], v[244:247]
s_xor_b32 s21, s23, 423936
v_exp_f32 v73, v73
v_mfma_f32_16x16x32_bf16 v[248:251], a[232:235], v[44:47], v[248:251]
s_add_u32 m0, s22, 53856
ds_read_b128 a[128:131], v88 offset:34304
v_cvt_pk_bf16_f32 v34, v72, v73
v_mfma_f32_16x16x32_bf16 v[248:251], a[200:203], v[40:43], v[248:251]
v_exp_f32 v74, v74
v_mfma_f32_16x16x32_bf16 v[252:255], a[204:207], v[40:43], v[252:255]
buffer_load_dwordx4 v97, s[12:15], s21 offen offset:0 nt lds
v_mfma_f32_16x16x32_bf16 v[252:255], a[236:239], v[44:47], v[252:255]
v_exp_f32 v75, v75
v_smfmac_f32_16x16x64_bf16 a[244:247], a[252:255], v[40:47], v92
s_waitcnt lgkmcnt(2)
v_cvt_pk_bf16_f32 v35, v74, v75
v_mfma_f32_16x16x32_bf16 v[76:79], a[144:147], a[0:3], v[48:51]
v_add_f32 v103, v103, v73
v_add_f32 v103, v103, v74
v_mfma_f32_16x16x32_bf16 v[76:79], a[148:151], a[4:7], v[76:79]
ds_read_b64_tr_b16 a[208:209], v91 offset:33792
v_add_f32 v103, v103, v75
v_mfma_f32_16x16x32_bf16 v[76:79], a[152:155], a[8:11], v[76:79]
ds_read_b64_tr_b16 a[210:211], v91 offset:34304
ds_read_b64_tr_b16 a[212:213], v91 offset:33824
v_mfma_f32_16x16x32_bf16 v[76:79], a[156:159], a[12:15], v[76:79]
ds_read_b64_tr_b16 a[214:215], v91 offset:34336
v_mfma_f32_16x16x32_bf16 v[80:83], a[172:175], a[12:15], v[48:51]
ds_read_b64_tr_b16 a[216:217], v91 offset:33856
ds_read_b64_tr_b16 a[218:219], v91 offset:34368
v_mfma_f32_16x16x32_bf16 v[80:83], a[168:171], a[8:11], v[80:83]
ds_read_b64_tr_b16 a[220:221], v91 offset:33888
v_mfma_f32_16x16x32_bf16 v[80:83], a[164:167], a[4:7], v[80:83]
ds_read_b64_tr_b16 a[222:223], v91 offset:34400
ds_read_b64_tr_b16 a[224:225], v91 offset:33920
v_mfma_f32_16x16x32_bf16 v[80:83], a[160:163], a[0:3], v[80:83]
v_exp_f32 v76, v76
v_mfma_f32_16x16x32_bf16 v[84:87], a[112:115], a[0:3], v[48:51]
v_exp_f32 v77, v77
v_mfma_f32_16x16x32_bf16 v[84:87], a[116:119], a[4:7], v[84:87]
v_exp_f32 v78, v78
v_mfma_f32_16x16x32_bf16 v[84:87], a[120:123], a[8:11], v[84:87]
v_exp_f32 v79, v79
v_mfma_f32_16x16x32_bf16 v[84:87], a[124:127], a[12:15], v[84:87]
s_xor_b32 s21, s23, 412672
v_cvt_pk_bf16_f32 v44, v76, v77
v_cvt_pk_bf16_f32 v45, v78, v79
v_mfma_f32_16x16x32_bf16 v[68:71], a[140:143], a[12:15], v[48:51]
s_add_u32 m0, s22, 16896
v_exp_f32 v80, v80
v_mfma_f32_16x16x32_bf16 v[68:71], a[136:139], a[8:11], v[68:71]
s_waitcnt lgkmcnt(2)
v_exp_f32 v81, v81
v_mfma_f32_16x16x32_bf16 v[68:71], a[132:135], a[4:7], v[68:71]
buffer_load_dwordx4 v97, s[8:11], s21 offen offset:0 nt lds
v_mfma_f32_16x16x32_bf16 v[68:71], a[128:131], a[0:3], v[68:71]
v_exp_f32 v82, v82
v_mfma_f32_16x16x32_bf16 a[48:51], a[176:179], v[32:35], a[48:51]
v_exp_f32 v83, v83
v_mfma_f32_16x16x32_bf16 a[52:55], a[180:183], v[32:35], a[52:55]
v_cvt_pk_bf16_f32 v46, v80, v81
v_cvt_pk_bf16_f32 v47, v82, v83
v_mfma_f32_16x16x32_bf16 a[56:59], a[184:187], v[32:35], a[56:59]
v_exp_f32 v84, v84
v_mfma_f32_16x16x32_bf16 a[60:63], a[188:191], v[32:35], a[60:63]
v_exp_f32 v85, v85
v_mfma_f32_16x16x32_bf16 a[64:67], a[192:195], v[32:35], a[64:67]
v_exp_f32 v86, v86
v_mfma_f32_16x16x32_bf16 a[68:71], a[196:199], v[32:35], a[68:71]
v_exp_f32 v87, v87
v_mfma_f32_16x16x32_bf16 a[72:75], a[200:203], v[32:35], a[72:75]
ds_read_b64_tr_b16 a[176:177], v90 offset:33792
ds_read_b64_tr_b16 a[178:179], v90 offset:34304
v_mfma_f32_16x16x32_bf16 a[76:79], a[204:207], v[32:35], a[76:79]
v_cvt_pk_bf16_f32 v40, v84, v85
v_cvt_pk_bf16_f32 v41, v86, v87
v_mfma_f32_16x16x32_bf16 v[72:75], a[144:147], a[16:19], v[52:55]
ds_read_b64_tr_b16 a[180:181], v90 offset:33824
ds_read_b64_tr_b16 a[182:183], v90 offset:34336
v_mfma_f32_16x16x32_bf16 v[72:75], a[148:151], a[20:23], v[72:75]
v_exp_f32 v68, v68
v_mfma_f32_16x16x32_bf16 v[72:75], a[152:155], a[24:27], v[72:75]
v_exp_f32 v69, v69
v_mfma_f32_16x16x32_bf16 v[72:75], a[156:159], a[28:31], v[72:75]
v_exp_f32 v70, v70
v_mfma_f32_16x16x32_bf16 v[76:79], a[172:175], a[28:31], v[52:55]
v_exp_f32 v71, v71
v_mfma_f32_16x16x32_bf16 v[76:79], a[168:171], a[24:27], v[76:79]
s_xor_b32 s21, s23, 416768
ds_read_b64_tr_b16 a[184:185], v90 offset:33856
ds_read_b64_tr_b16 a[186:187], v90 offset:34368
v_mfma_f32_16x16x32_bf16 v[76:79], a[164:167], a[20:23], v[76:79]
s_add_u32 m0, s22, 17952
v_cvt_pk_bf16_f32 v42, v68, v69
v_cvt_pk_bf16_f32 v43, v70, v71
v_mfma_f32_16x16x32_bf16 v[76:79], a[160:163], a[16:19], v[76:79]
ds_read_b64_tr_b16 a[188:189], v90 offset:33888
ds_read_b64_tr_b16 a[190:191], v90 offset:34400
v_mfma_f32_16x16x32_bf16 v[80:83], a[112:115], a[16:19], v[52:55]
buffer_load_dwordx4 v97, s[8:11], s21 offen offset:0 nt lds
v_mfma_f32_16x16x32_bf16 v[80:83], a[116:119], a[20:23], v[80:83]
ds_read_b64_tr_b16 a[226:227], v91 offset:34432
ds_read_b64_tr_b16 a[192:193], v90 offset:33920
v_mfma_f32_16x16x32_bf16 v[80:83], a[120:123], a[24:27], v[80:83]
v_exp_f32 v72, v72
v_mfma_f32_16x16x32_bf16 v[80:83], a[124:127], a[28:31], v[80:83]
ds_read_b64_tr_b16 a[194:195], v90 offset:34432
ds_read_b64_tr_b16 a[196:197], v90 offset:33952
v_mfma_f32_16x16x32_bf16 v[84:87], a[140:143], a[28:31], v[52:55]
v_exp_f32 v73, v73
v_mfma_f32_16x16x32_bf16 v[84:87], a[136:139], a[24:27], v[84:87]
ds_read_b64_tr_b16 a[198:199], v90 offset:34464
ds_read_b64_tr_b16 a[228:229], v91 offset:33952
v_mfma_f32_16x16x32_bf16 v[84:87], a[132:135], a[20:23], v[84:87]
ds_read_b64_tr_b16 a[230:231], v91 offset:34464
v_cvt_pk_bf16_f32 v36, v72, v73
v_mfma_f32_16x16x32_bf16 v[84:87], a[128:131], a[16:19], v[84:87]
ds_read_b64_tr_b16 a[232:233], v91 offset:33984
ds_read_b64_tr_b16 a[234:235], v91 offset:34496
v_mfma_f32_16x16x32_bf16 v[128:131], a[208:211], v[44:47], v[128:131]
s_waitcnt lgkmcnt(9)
v_exp_f32 v74, v74
v_mfma_f32_16x16x32_bf16 v[128:131], a[176:179], v[40:43], v[128:131]
ds_read_b64_tr_b16 a[200:201], v90 offset:33984
ds_read_b64_tr_b16 a[202:203], v90 offset:34496
v_mfma_f32_16x16x32_bf16 v[132:135], a[180:183], v[40:43], v[132:135]
v_exp_f32 v75, v75
v_mfma_f32_16x16x32_bf16 v[132:135], a[212:215], v[44:47], v[132:135]
ds_read_b64_tr_b16 a[204:205], v90 offset:34016
ds_read_b64_tr_b16 a[206:207], v90 offset:34528
v_mfma_f32_16x16x32_bf16 v[136:139], a[216:219], v[44:47], v[136:139]
ds_read_b64_tr_b16 a[236:237], v91 offset:34016
v_cvt_pk_bf16_f32 v37, v74, v75
v_mfma_f32_16x16x32_bf16 v[136:139], a[184:187], v[40:43], v[136:139]
v_exp_f32 v76, v76
v_mfma_f32_16x16x32_bf16 v[140:143], a[188:191], v[40:43], v[140:143]
s_xor_b32 s21, s23, 420864
v_exp_f32 v77, v77
v_mfma_f32_16x16x32_bf16 v[140:143], a[220:223], v[44:47], v[140:143]
s_add_u32 m0, s22, 19008
ds_read_b64_tr_b16 a[238:239], v91 offset:34528
v_cvt_pk_bf16_f32 v38, v76, v77
s_waitcnt lgkmcnt(6)
v_mfma_f32_16x16x32_bf16 v[144:147], a[224:227], v[44:47], v[144:147]
v_exp_f32 v78, v78
v_mfma_f32_16x16x32_bf16 v[144:147], a[192:195], v[40:43], v[144:147]
buffer_load_dwordx4 v97, s[8:11], s21 offen offset:0 nt lds
v_mfma_f32_16x16x32_bf16 v[148:151], a[196:199], v[40:43], v[148:151]
v_exp_f32 v79, v79
v_mfma_f32_16x16x32_bf16 v[148:151], a[228:231], v[44:47], v[148:151]
ds_read_b128 v[108:111], v99 offset:5376
v_cvt_pk_bf16_f32 v39, v78, v79
v_mfma_f32_16x16x32_bf16 v[152:155], a[232:235], v[44:47], v[152:155]
s_waitcnt lgkmcnt(2)
v_exp_f32 v80, v80
v_mfma_f32_16x16x32_bf16 v[152:155], a[200:203], v[40:43], v[152:155]
v_exp_f32 v81, v81
v_mfma_f32_16x16x32_bf16 v[156:159], a[204:207], v[40:43], v[156:159]
s_waitcnt lgkmcnt(1)
v_exp_f32 v82, v82
v_mfma_f32_16x16x32_bf16 v[156:159], a[236:239], v[44:47], v[156:159]
v_exp_f32 v83, v83
v_smfmac_f32_16x16x64_bf16 a[240:243], a[248:251], v[40:47], v92
v_cvt_pk_bf16_f32 v32, v80, v81
v_mfma_f32_16x16x32_bf16 v[68:71], a[144:147], a[32:35], v[56:59]
ds_read_b128 v[112:115], v99 offset:9728
v_cvt_pk_bf16_f32 v33, v82, v83
v_mfma_f32_16x16x32_bf16 v[68:71], a[148:151], a[36:39], v[68:71]
v_exp_f32 v84, v84
v_mfma_f32_16x16x32_bf16 v[68:71], a[152:155], a[40:43], v[68:71]
v_exp_f32 v85, v85
v_mfma_f32_16x16x32_bf16 v[68:71], a[156:159], a[44:47], v[68:71]
v_exp_f32 v86, v86
v_mfma_f32_16x16x32_bf16 v[72:75], a[172:175], a[44:47], v[56:59]
v_exp_f32 v87, v87
v_mfma_f32_16x16x32_bf16 v[72:75], a[168:171], a[40:43], v[72:75]
v_cvt_pk_bf16_f32 v34, v84, v85
v_cvt_pk_bf16_f32 v35, v86, v87
v_mfma_f32_16x16x32_bf16 v[72:75], a[164:167], a[36:39], v[72:75]
s_waitcnt lgkmcnt(1)
v_mul_f32 v108, v122, v108
v_mul_f32 v109, v122, v109
v_mfma_f32_16x16x32_bf16 v[72:75], a[160:163], a[32:35], v[72:75]
s_xor_b32 s21, s23, 424960
v_exp_f32 v68, v68
v_mfma_f32_16x16x32_bf16 v[76:79], a[112:115], a[32:35], v[56:59]
s_add_u32 m0, s22, 20064
v_exp_f32 v69, v69
v_mfma_f32_16x16x32_bf16 v[76:79], a[116:119], a[36:39], v[76:79]
v_exp_f32 v70, v70
v_mfma_f32_16x16x32_bf16 v[76:79], a[120:123], a[40:43], v[76:79]
buffer_load_dwordx4 v97, s[8:11], s21 offen offset:0 nt lds
v_mfma_f32_16x16x32_bf16 v[76:79], a[124:127], a[44:47], v[76:79]
v_exp_f32 v71, v71
v_mfma_f32_16x16x32_bf16 v[80:83], a[140:143], a[44:47], v[56:59]
v_cvt_pk_bf16_f32 v44, v68, v69
v_cvt_pk_bf16_f32 v45, v70, v71
v_mfma_f32_16x16x32_bf16 v[80:83], a[136:139], a[40:43], v[80:83]
v_exp_f32 v72, v72
v_mfma_f32_16x16x32_bf16 v[80:83], a[132:135], a[36:39], v[80:83]
v_exp_f32 v73, v73
v_mfma_f32_16x16x32_bf16 v[80:83], a[128:131], a[32:35], v[80:83]
v_exp_f32 v74, v74
v_mfma_f32_16x16x32_bf16 v[160:163], a[208:211], v[36:39], v[160:163]
v_exp_f32 v75, v75
v_mfma_f32_16x16x32_bf16 v[160:163], a[176:179], v[32:35], v[160:163]
v_cvt_pk_bf16_f32 v46, v72, v73
v_cvt_pk_bf16_f32 v47, v74, v75
v_mfma_f32_16x16x32_bf16 v[164:167], a[180:183], v[32:35], v[164:167]
v_exp_f32 v76, v76
v_mfma_f32_16x16x32_bf16 v[164:167], a[212:215], v[36:39], v[164:167]
v_exp_f32 v77, v77
v_mfma_f32_16x16x32_bf16 v[168:171], a[216:219], v[36:39], v[168:171]
v_exp_f32 v78, v78
v_mfma_f32_16x16x32_bf16 v[168:171], a[184:187], v[32:35], v[168:171]
v_exp_f32 v79, v79
v_mfma_f32_16x16x32_bf16 v[172:175], a[188:191], v[32:35], v[172:175]
v_cvt_pk_bf16_f32 v40, v76, v77
v_cvt_pk_bf16_f32 v41, v78, v79
v_mfma_f32_16x16x32_bf16 v[172:175], a[220:223], v[36:39], v[172:175]
v_exp_f32 v80, v80
v_mfma_f32_16x16x32_bf16 v[176:179], a[224:227], v[36:39], v[176:179]
s_xor_b32 s21, s23, 412672
v_exp_f32 v81, v81
v_mfma_f32_16x16x32_bf16 v[176:179], a[192:195], v[32:35], v[176:179]
s_add_u32 m0, s22, 67584
v_exp_f32 v82, v82
v_mfma_f32_16x16x32_bf16 v[180:183], a[196:199], v[32:35], v[180:183]
v_exp_f32 v83, v83
v_mfma_f32_16x16x32_bf16 v[180:183], a[228:231], v[36:39], v[180:183]
buffer_load_dwordx4 v97, s[12:15], s21 offen offset:0 nt lds
v_mfma_f32_16x16x32_bf16 v[184:187], a[232:235], v[36:39], v[184:187]
v_cvt_pk_bf16_f32 v42, v80, v81
v_cvt_pk_bf16_f32 v43, v82, v83
v_mfma_f32_16x16x32_bf16 v[184:187], a[200:203], v[32:35], v[184:187]
v_mul_f32 v110, v122, v110
v_mul_f32 v111, v122, v111
v_mfma_f32_16x16x32_bf16 v[188:191], a[204:207], v[32:35], v[188:191]
s_waitcnt lgkmcnt(0)
v_fmac_f32 v108, v123, v112
v_fmac_f32 v109, v123, v113
v_mfma_f32_16x16x32_bf16 v[188:191], a[236:239], v[36:39], v[188:191]
v_fmac_f32 v110, v123, v114
v_fmac_f32 v111, v123, v115
v_smfmac_f32_16x16x64_bf16 a[240:243], a[252:255], v[32:39], v92
v_cvt_pk_bf16_f32 v108, v108, v109
v_mfma_f32_16x16x32_bf16 v[84:87], a[144:147], v[0:3], v[60:63]
ds_read_b128 v[112:115], v99 offset:10752
v_cvt_pk_bf16_f32 v109, v110, v111
v_mfma_f32_16x16x32_bf16 v[84:87], a[148:151], v[4:7], v[84:87]
ds_write_b64 v93, v[108:109] offset:9728
v_mfma_f32_16x16x32_bf16 v[84:87], a[152:155], v[8:11], v[84:87]
ds_read_b128 v[108:111], v99 offset:6400
v_mfma_f32_16x16x32_bf16 v[84:87], a[156:159], v[12:15], v[84:87]
v_mfma_f32_16x16x32_bf16 v[68:71], a[172:175], v[12:15], v[60:63]
v_mfma_f32_16x16x32_bf16 v[68:71], a[168:171], v[8:11], v[68:71]
v_mfma_f32_16x16x32_bf16 v[68:71], a[164:167], v[4:7], v[68:71]
v_mfma_f32_16x16x32_bf16 v[68:71], a[160:163], v[0:3], v[68:71]
v_mfma_f32_16x16x32_bf16 v[72:75], a[112:115], v[0:3], v[60:63]
s_waitcnt lgkmcnt(0)
v_mfma_f32_16x16x32_bf16 v[72:75], a[116:119], v[4:7], v[72:75]
s_xor_b32 s21, s23, 416768
v_mul_f32 v108, v122, v108
v_mul_f32 v109, v122, v109
v_mfma_f32_16x16x32_bf16 v[72:75], a[120:123], v[8:11], v[72:75]
s_add_u32 m0, s22, 68640
v_exp_f32 v84, v84
v_mfma_f32_16x16x32_bf16 v[72:75], a[124:127], v[12:15], v[72:75]
v_exp_f32 v85, v85
v_mfma_f32_16x16x32_bf16 v[76:79], a[140:143], v[12:15], v[60:63]
buffer_load_dwordx4 v97, s[12:15], s21 offen offset:0 nt lds
v_mfma_f32_16x16x32_bf16 v[76:79], a[136:139], v[8:11], v[76:79]
v_exp_f32 v86, v86
v_mfma_f32_16x16x32_bf16 v[76:79], a[132:135], v[4:7], v[76:79]
v_exp_f32 v87, v87
v_mfma_f32_16x16x32_bf16 v[76:79], a[128:131], v[0:3], v[76:79]
v_cvt_pk_bf16_f32 v36, v84, v85
v_cvt_pk_bf16_f32 v37, v86, v87
v_mfma_f32_16x16x32_bf16 v[192:195], a[208:211], v[44:47], v[192:195]
v_exp_f32 v68, v68
v_mfma_f32_16x16x32_bf16 v[192:195], a[176:179], v[40:43], v[192:195]
v_exp_f32 v69, v69
v_mfma_f32_16x16x32_bf16 v[196:199], a[180:183], v[40:43], v[196:199]
v_exp_f32 v70, v70
v_mfma_f32_16x16x32_bf16 v[196:199], a[212:215], v[44:47], v[196:199]
v_exp_f32 v71, v71
v_mfma_f32_16x16x32_bf16 v[200:203], a[216:219], v[44:47], v[200:203]
v_cvt_pk_bf16_f32 v38, v68, v69
v_cvt_pk_bf16_f32 v39, v70, v71
v_mfma_f32_16x16x32_bf16 v[200:203], a[184:187], v[40:43], v[200:203]
v_exp_f32 v72, v72
v_mfma_f32_16x16x32_bf16 v[204:207], a[188:191], v[40:43], v[204:207]
v_exp_f32 v73, v73
v_mfma_f32_16x16x32_bf16 v[204:207], a[220:223], v[44:47], v[204:207]
v_exp_f32 v74, v74
v_mfma_f32_16x16x32_bf16 v[208:211], a[224:227], v[44:47], v[208:211]
v_exp_f32 v75, v75
v_mfma_f32_16x16x32_bf16 v[208:211], a[192:195], v[40:43], v[208:211]
v_exp_f32 v76, v76
v_mfma_f32_16x16x32_bf16 v[212:215], a[196:199], v[40:43], v[212:215]
s_xor_b32 s21, s23, 420864
v_exp_f32 v77, v77
v_mfma_f32_16x16x32_bf16 v[212:215], a[228:231], v[44:47], v[212:215]
s_add_u32 m0, s22, 69696
v_exp_f32 v78, v78
v_mfma_f32_16x16x32_bf16 v[216:219], a[232:235], v[44:47], v[216:219]
v_exp_f32 v79, v79
v_mfma_f32_16x16x32_bf16 v[216:219], a[200:203], v[40:43], v[216:219]
buffer_load_dwordx4 v97, s[12:15], s21 offen offset:0 nt lds
v_mfma_f32_16x16x32_bf16 v[220:223], a[204:207], v[40:43], v[220:223]
s_waitcnt vmcnt(7)
s_barrier
v_mfma_f32_16x16x32_bf16 v[220:223], a[236:239], v[44:47], v[220:223]
v_cvt_pk_bf16_f32 v32, v72, v73
v_cvt_pk_bf16_f32 v33, v74, v75
v_smfmac_f32_16x16x64_bf16 a[244:247], a[248:251], v[40:47], v92
v_cvt_pk_bf16_f32 v34, v76, v77
v_mfma_f32_16x16x32_bf16 v[80:83], a[112:115], v[16:19], v[64:67]
ds_read_b128 a[144:147], v89 offset:0
v_cvt_pk_bf16_f32 v35, v78, v79
v_mfma_f32_16x16x32_bf16 v[80:83], a[116:119], v[20:23], v[80:83]
ds_read_b128 a[148:151], v89 offset:64
v_mul_f32 v110, v122, v110
v_mfma_f32_16x16x32_bf16 v[80:83], a[120:123], v[24:27], v[80:83]
ds_read_b128 a[152:155], v89 offset:128
v_mul_f32 v111, v122, v111
v_mfma_f32_16x16x32_bf16 v[80:83], a[124:127], v[28:31], v[80:83]
ds_read_b128 a[156:159], v89 offset:192
v_fmac_f32 v108, v123, v112
v_mfma_f32_16x16x32_bf16 v[84:87], a[140:143], v[28:31], v[64:67]
ds_read_b128 a[172:175], v89 offset:704
v_fmac_f32 v109, v123, v113
v_mfma_f32_16x16x32_bf16 v[84:87], a[136:139], v[24:27], v[84:87]
ds_read_b128 a[168:171], v89 offset:640
v_fmac_f32 v110, v123, v114
v_mfma_f32_16x16x32_bf16 v[84:87], a[132:135], v[20:23], v[84:87]
ds_read_b128 a[164:167], v89 offset:576
v_fmac_f32 v111, v123, v115
v_mfma_f32_16x16x32_bf16 v[84:87], a[128:131], v[16:19], v[84:87]
ds_read_b128 a[160:163], v89 offset:512
v_cvt_pk_bf16_f32 v108, v108, v109
v_mfma_f32_16x16x32_bf16 v[224:227], a[208:211], v[36:39], v[224:227]
ds_read_b128 a[112:115], v88 offset:0
v_cvt_pk_bf16_f32 v109, v110, v111
v_mfma_f32_16x16x32_bf16 v[224:227], a[176:179], v[32:35], v[224:227]
v_exp_f32 v80, v80
v_mfma_f32_16x16x32_bf16 v[228:231], a[180:183], v[32:35], v[228:231]
s_xor_b32 s21, s23, 424960
ds_read_b128 a[116:119], v88 offset:64
v_add_f32 v103, v103, v80
v_mfma_f32_16x16x32_bf16 v[228:231], a[212:215], v[36:39], v[228:231]
s_add_u32 m0, s22, 70752
v_exp_f32 v81, v81
v_mfma_f32_16x16x32_bf16 v[232:235], a[216:219], v[36:39], v[232:235]
ds_read_b128 a[120:123], v88 offset:128
v_add_f32 v103, v103, v81
v_mfma_f32_16x16x32_bf16 v[232:235], a[184:187], v[32:35], v[232:235]
buffer_load_dwordx4 v97, s[12:15], s21 offen offset:0 nt lds
v_mfma_f32_16x16x32_bf16 v[236:239], a[188:191], v[32:35], v[236:239]
ds_read_b128 a[124:127], v88 offset:192
v_cvt_pk_bf16_f32 v40, v80, v81
v_mfma_f32_16x16x32_bf16 v[236:239], a[220:223], v[36:39], v[236:239]
v_exp_f32 v82, v82
v_mfma_f32_16x16x32_bf16 v[240:243], a[224:227], v[36:39], v[240:243]
ds_read_b128 a[140:143], v88 offset:704
v_add_f32 v103, v103, v82
v_mfma_f32_16x16x32_bf16 v[240:243], a[192:195], v[32:35], v[240:243]
v_exp_f32 v83, v83
v_mfma_f32_16x16x32_bf16 v[244:247], a[196:199], v[32:35], v[244:247]
ds_read_b128 v[104:107], v95 offset:0
v_add_f32 v103, v103, v83
v_mfma_f32_16x16x32_bf16 v[244:247], a[228:231], v[36:39], v[244:247]
ds_read_b128 a[136:139], v88 offset:640
v_cvt_pk_bf16_f32 v41, v82, v83
v_mfma_f32_16x16x32_bf16 v[248:251], a[232:235], v[36:39], v[248:251]
v_exp_f32 v84, v84
v_mfma_f32_16x16x32_bf16 v[248:251], a[200:203], v[32:35], v[248:251]
ds_read_b128 a[132:135], v88 offset:576
v_add_f32 v103, v103, v84
v_mfma_f32_16x16x32_bf16 v[252:255], a[204:207], v[32:35], v[252:255]
v_exp_f32 v85, v85
v_mfma_f32_16x16x32_bf16 v[252:255], a[236:239], v[36:39], v[252:255]
ds_read_b128 a[128:131], v88 offset:512
v_cvt_pk_bf16_f32 v42, v84, v85
v_smfmac_f32_16x16x64_bf16 a[244:247], a[252:255], v[32:39], v92
s_waitcnt lgkmcnt(4)
v_add_f32 v103, v103, v85
v_mfma_f32_16x16x32_bf16 v[68:71], a[144:147], a[0:3], v[48:51]
v_exp_f32 v86, v86
v_mfma_f32_16x16x32_bf16 v[68:71], a[148:151], a[4:7], v[68:71]
v_exp_f32 v87, v87
v_mfma_f32_16x16x32_bf16 v[68:71], a[152:155], a[8:11], v[68:71]
s_add_u32 s33, s31, 12288
v_cvt_pk_bf16_f32 v43, v86, v87
v_add_f32 v103, v103, v86
v_mfma_f32_16x16x32_bf16 v[68:71], a[156:159], a[12:15], v[68:71]
ds_read_b64_tr_b16 a[208:209], v91 offset:0
v_add_f32 v103, v103, v87
v_mfma_f32_16x16x32_bf16 v[72:75], a[172:175], a[12:15], v[48:51]
ds_read_b64_tr_b16 a[210:211], v91 offset:512
ds_read_b64_tr_b16 a[212:213], v91 offset:32
v_mfma_f32_16x16x32_bf16 v[72:75], a[168:171], a[8:11], v[72:75]
ds_write_b64 v93, v[108:109] offset:10752
v_mfma_f32_16x16x32_bf16 v[72:75], a[164:167], a[4:7], v[72:75]
s_waitcnt lgkmcnt(4)
buffer_store_dwordx4 v[104:107], v96, s[16:19], s33 offen offset:0 nt
v_mfma_f32_16x16x32_bf16 v[72:75], a[160:163], a[0:3], v[72:75]
v_exp_f32 v68, v68
v_mfma_f32_16x16x32_bf16 v[76:79], a[112:115], a[0:3], v[48:51]
v_exp_f32 v69, v69
v_mfma_f32_16x16x32_bf16 v[76:79], a[116:119], a[4:7], v[76:79]
ds_read_b128 v[104:107], v95 offset:1088
v_cvt_pk_bf16_f32 v36, v68, v69
v_mfma_f32_16x16x32_bf16 v[76:79], a[120:123], a[8:11], v[76:79]
v_exp_f32 v70, v70
v_mfma_f32_16x16x32_bf16 v[76:79], a[124:127], a[12:15], v[76:79]
v_exp_f32 v71, v71
v_mfma_f32_16x16x32_bf16 v[80:83], a[140:143], a[12:15], v[48:51]
ds_read_b64_tr_b16 a[214:215], v91 offset:544
v_cvt_pk_bf16_f32 v37, v70, v71
v_mfma_f32_16x16x32_bf16 v[80:83], a[136:139], a[8:11], v[80:83]
v_exp_f32 v72, v72
v_mfma_f32_16x16x32_bf16 v[80:83], a[132:135], a[4:7], v[80:83]
v_exp_f32 v73, v73
v_mfma_f32_16x16x32_bf16 v[80:83], a[128:131], a[0:3], v[80:83]
v_exp_f32 v74, v74
v_mfma_f32_16x16x32_bf16 a[48:51], a[176:179], v[40:43], a[48:51]
v_exp_f32 v75, v75
v_mfma_f32_16x16x32_bf16 a[52:55], a[180:183], v[40:43], a[52:55]
v_cvt_pk_bf16_f32 v38, v72, v73
v_cvt_pk_bf16_f32 v39, v74, v75
v_mfma_f32_16x16x32_bf16 a[56:59], a[184:187], v[40:43], a[56:59]
v_exp_f32 v76, v76
v_mfma_f32_16x16x32_bf16 a[60:63], a[188:191], v[40:43], a[60:63]
v_exp_f32 v77, v77
v_mfma_f32_16x16x32_bf16 a[64:67], a[192:195], v[40:43], a[64:67]
v_exp_f32 v78, v78
v_mfma_f32_16x16x32_bf16 a[68:71], a[196:199], v[40:43], a[68:71]
v_exp_f32 v79, v79
v_mfma_f32_16x16x32_bf16 a[72:75], a[200:203], v[40:43], a[72:75]
s_waitcnt lgkmcnt(0)
ds_read_b64_tr_b16 a[176:177], v90 offset:0
ds_read_b64_tr_b16 a[178:179], v90 offset:512
v_mfma_f32_16x16x32_bf16 a[76:79], a[204:207], v[40:43], a[76:79]
buffer_store_dwordx4 v[104:107], v96, s[16:19], s33 offen offset:1024 nt
v_mfma_f32_16x16x32_bf16 v[84:87], a[144:147], a[16:19], v[52:55]
v_cvt_pk_bf16_f32 v32, v76, v77
v_cvt_pk_bf16_f32 v33, v78, v79
v_mfma_f32_16x16x32_bf16 v[84:87], a[148:151], a[20:23], v[84:87]
ds_read_b64_tr_b16 a[180:181], v90 offset:32
ds_read_b64_tr_b16 a[182:183], v90 offset:544
v_mfma_f32_16x16x32_bf16 v[84:87], a[152:155], a[24:27], v[84:87]
v_exp_f32 v80, v80
v_mfma_f32_16x16x32_bf16 v[84:87], a[156:159], a[28:31], v[84:87]
ds_read_b64_tr_b16 a[216:217], v91 offset:64
ds_read_b64_tr_b16 a[218:219], v91 offset:576
v_mfma_f32_16x16x32_bf16 v[68:71], a[172:175], a[28:31], v[52:55]
v_exp_f32 v81, v81
v_mfma_f32_16x16x32_bf16 v[68:71], a[168:171], a[24:27], v[68:71]
v_exp_f32 v82, v82
v_mfma_f32_16x16x32_bf16 v[68:71], a[164:167], a[20:23], v[68:71]
v_exp_f32 v83, v83
v_mfma_f32_16x16x32_bf16 v[68:71], a[160:163], a[16:19], v[68:71]
ds_read_b64_tr_b16 a[184:185], v90 offset:64
ds_read_b64_tr_b16 a[186:187], v90 offset:576
v_mfma_f32_16x16x32_bf16 v[72:75], a[112:115], a[16:19], v[52:55]
v_cvt_pk_bf16_f32 v34, v80, v81
v_cvt_pk_bf16_f32 v35, v82, v83
v_mfma_f32_16x16x32_bf16 v[72:75], a[116:119], a[20:23], v[72:75]
ds_read_b64_tr_b16 a[188:189], v90 offset:96
ds_read_b64_tr_b16 a[190:191], v90 offset:608
v_mfma_f32_16x16x32_bf16 v[72:75], a[120:123], a[24:27], v[72:75]
v_exp_f32 v84, v84
v_mfma_f32_16x16x32_bf16 v[72:75], a[124:127], a[28:31], v[72:75]
ds_read_b64_tr_b16 a[220:221], v91 offset:96
ds_read_b64_tr_b16 a[222:223], v91 offset:608
v_mfma_f32_16x16x32_bf16 v[76:79], a[140:143], a[28:31], v[52:55]
v_exp_f32 v85, v85
v_mfma_f32_16x16x32_bf16 v[76:79], a[136:139], a[24:27], v[76:79]
ds_read_b128 v[104:107], v95 offset:2176
v_cvt_pk_bf16_f32 v44, v84, v85
v_mfma_f32_16x16x32_bf16 v[76:79], a[132:135], a[20:23], v[76:79]
ds_read_b64_tr_b16 a[224:225], v91 offset:128
ds_read_b64_tr_b16 a[226:227], v91 offset:640
v_mfma_f32_16x16x32_bf16 v[76:79], a[128:131], a[16:19], v[76:79]
v_exp_f32 v86, v86
v_mfma_f32_16x16x32_bf16 v[128:131], a[208:211], v[36:39], v[128:131]
s_waitcnt lgkmcnt(7)
ds_read_b64_tr_b16 a[192:193], v90 offset:128
ds_read_b64_tr_b16 a[194:195], v90 offset:640
v_mfma_f32_16x16x32_bf16 v[128:131], a[176:179], v[32:35], v[128:131]
v_exp_f32 v87, v87
v_mfma_f32_16x16x32_bf16 v[132:135], a[180:183], v[32:35], v[132:135]
ds_read_b64_tr_b16 a[196:197], v90 offset:160
ds_read_b64_tr_b16 a[198:199], v90 offset:672
v_mfma_f32_16x16x32_bf16 v[132:135], a[212:215], v[36:39], v[132:135]
ds_read_b64_tr_b16 a[228:229], v91 offset:160
v_cvt_pk_bf16_f32 v45, v86, v87
v_mfma_f32_16x16x32_bf16 v[136:139], a[216:219], v[36:39], v[136:139]
ds_read_b64_tr_b16 a[230:231], v91 offset:672
ds_read_b64_tr_b16 a[232:233], v91 offset:192
v_mfma_f32_16x16x32_bf16 v[136:139], a[184:187], v[32:35], v[136:139]
s_waitcnt lgkmcnt(9)
ds_read_b64_tr_b16 a[234:235], v91 offset:704
v_mfma_f32_16x16x32_bf16 v[140:143], a[188:191], v[32:35], v[140:143]
s_waitcnt lgkmcnt(8)
ds_read_b64_tr_b16 a[200:201], v90 offset:192
ds_read_b64_tr_b16 a[202:203], v90 offset:704
v_mfma_f32_16x16x32_bf16 v[140:143], a[220:223], v[36:39], v[140:143]
buffer_store_dwordx4 v[104:107], v96, s[16:19], s33 offen offset:2048 nt
ds_read_b64_tr_b16 a[204:205], v90 offset:224
ds_read_b64_tr_b16 a[206:207], v90 offset:736
v_mfma_f32_16x16x32_bf16 v[144:147], a[224:227], v[36:39], v[144:147]
s_waitcnt lgkmcnt(10)
ds_read_b64_tr_b16 a[236:237], v91 offset:224
ds_read_b64_tr_b16 a[238:239], v91 offset:736
v_mfma_f32_16x16x32_bf16 v[144:147], a[192:195], v[32:35], v[144:147]
s_waitcnt lgkmcnt(10)
v_exp_f32 v68, v68
v_mfma_f32_16x16x32_bf16 v[148:151], a[196:199], v[32:35], v[148:151]
s_waitcnt lgkmcnt(8)
v_exp_f32 v69, v69
v_mfma_f32_16x16x32_bf16 v[148:151], a[228:231], v[36:39], v[148:151]
s_waitcnt lgkmcnt(6)
ds_read_b128 v[108:111], v99 offset:7424
v_cvt_pk_bf16_f32 v46, v68, v69
v_mfma_f32_16x16x32_bf16 v[152:155], a[232:235], v[36:39], v[152:155]
s_waitcnt lgkmcnt(5)
ds_read_b128 v[112:115], v99 offset:11776
v_mfma_f32_16x16x32_bf16 v[152:155], a[200:203], v[32:35], v[152:155]
s_waitcnt lgkmcnt(4)
v_exp_f32 v70, v70
v_mfma_f32_16x16x32_bf16 v[156:159], a[204:207], v[32:35], v[156:159]
s_waitcnt lgkmcnt(2)
v_exp_f32 v71, v71
v_mfma_f32_16x16x32_bf16 v[156:159], a[236:239], v[36:39], v[156:159]
ds_read_b128 v[104:107], v95 offset:3264
v_cvt_pk_bf16_f32 v47, v70, v71
v_smfmac_f32_16x16x64_bf16 a[240:243], a[248:251], v[32:39], v92
v_mfma_f32_16x16x32_bf16 v[80:83], a[144:147], a[32:35], v[56:59]
v_exp_f32 v72, v72
v_mfma_f32_16x16x32_bf16 v[80:83], a[148:151], a[36:39], v[80:83]
s_waitcnt lgkmcnt(1)
v_mul_f32 v108, v122, v108
v_mul_f32 v109, v122, v109
v_mfma_f32_16x16x32_bf16 v[80:83], a[152:155], a[40:43], v[80:83]
v_mul_f32 v110, v122, v110
v_mul_f32 v111, v122, v111
v_fmac_f32 v108, v123, v112
v_fmac_f32 v109, v123, v113
v_fmac_f32 v110, v123, v114
v_fmac_f32 v111, v123, v115
v_cvt_pk_bf16_f32 v108, v108, v109
v_cvt_pk_bf16_f32 v109, v110, v111
v_mfma_f32_16x16x32_bf16 v[80:83], a[156:159], a[44:47], v[80:83]
ds_write_b64 v93, v[108:109] offset:11776
v_mfma_f32_16x16x32_bf16 v[84:87], a[172:175], a[44:47], v[56:59]
s_waitcnt lgkmcnt(1)
v_exp_f32 v73, v73
v_mfma_f32_16x16x32_bf16 v[84:87], a[168:171], a[40:43], v[84:87]
buffer_store_dwordx4 v[104:107], v96, s[16:19], s33 offen offset:3072 nt
v_mfma_f32_16x16x32_bf16 v[84:87], a[164:167], a[36:39], v[84:87]
v_exp_f32 v74, v74
v_mfma_f32_16x16x32_bf16 v[84:87], a[160:163], a[32:35], v[84:87]
v_exp_f32 v75, v75
v_mfma_f32_16x16x32_bf16 v[68:71], a[112:115], a[32:35], v[56:59]
v_cvt_pk_bf16_f32 v40, v72, v73
v_cvt_pk_bf16_f32 v41, v74, v75
v_mfma_f32_16x16x32_bf16 v[68:71], a[116:119], a[36:39], v[68:71]
v_exp_f32 v76, v76
v_mfma_f32_16x16x32_bf16 v[68:71], a[120:123], a[40:43], v[68:71]
v_exp_f32 v77, v77
v_mfma_f32_16x16x32_bf16 v[68:71], a[124:127], a[44:47], v[68:71]
v_exp_f32 v78, v78
v_mfma_f32_16x16x32_bf16 v[72:75], a[140:143], a[44:47], v[56:59]
v_exp_f32 v79, v79
v_mfma_f32_16x16x32_bf16 v[72:75], a[136:139], a[40:43], v[72:75]
s_lshl_b32 s33, s34, 7
v_cvt_pk_bf16_f32 v42, v76, v77
v_cvt_pk_bf16_f32 v43, v78, v79
v_mfma_f32_16x16x32_bf16 v[72:75], a[132:135], a[36:39], v[72:75]
s_add_u32 s33, s33, s32
v_exp_f32 v80, v80
v_mfma_f32_16x16x32_bf16 v[72:75], a[128:131], a[32:35], v[72:75]
v_exp_f32 v81, v81
v_mfma_f32_16x16x32_bf16 v[160:163], a[208:211], v[44:47], v[160:163]
ds_read_b128 a[84:87], v102 offset:8704
v_cvt_pk_bf16_f32 v36, v80, v81
v_mfma_f32_16x16x32_bf16 v[160:163], a[176:179], v[40:43], v[160:163]
v_exp_f32 v82, v82
v_mfma_f32_16x16x32_bf16 v[164:167], a[180:183], v[40:43], v[164:167]
v_exp_f32 v83, v83
v_mfma_f32_16x16x32_bf16 v[164:167], a[212:215], v[44:47], v[164:167]
v_exp_f32 v84, v84
v_mfma_f32_16x16x32_bf16 v[168:171], a[216:219], v[44:47], v[168:171]
v_exp_f32 v85, v85
v_mfma_f32_16x16x32_bf16 v[168:171], a[184:187], v[40:43], v[168:171]
v_cvt_pk_bf16_f32 v37, v82, v83
v_cvt_pk_bf16_f32 v38, v84, v85
v_mfma_f32_16x16x32_bf16 v[172:175], a[188:191], v[40:43], v[172:175]
s_waitcnt lgkmcnt(0)
v_exp_f32 v86, v86
v_mfma_f32_16x16x32_bf16 v[172:175], a[220:223], v[44:47], v[172:175]
buffer_store_dwordx4 a[84:87], v101, s[16:19], s33 offen offset:0 nt
v_mfma_f32_16x16x32_bf16 v[176:179], a[224:227], v[44:47], v[176:179]
v_exp_f32 v87, v87
v_mfma_f32_16x16x32_bf16 v[176:179], a[192:195], v[40:43], v[176:179]
ds_read_b128 a[88:91], v102 offset:8768
v_cvt_pk_bf16_f32 v39, v86, v87
v_mfma_f32_16x16x32_bf16 v[180:183], a[196:199], v[40:43], v[180:183]
v_exp_f32 v68, v68
v_mfma_f32_16x16x32_bf16 v[180:183], a[228:231], v[44:47], v[180:183]
v_exp_f32 v69, v69
v_mfma_f32_16x16x32_bf16 v[184:187], a[232:235], v[44:47], v[184:187]
v_exp_f32 v70, v70
v_mfma_f32_16x16x32_bf16 v[184:187], a[200:203], v[40:43], v[184:187]
v_exp_f32 v71, v71
v_mfma_f32_16x16x32_bf16 v[188:191], a[204:207], v[40:43], v[188:191]
v_cvt_pk_bf16_f32 v32, v68, v69
v_cvt_pk_bf16_f32 v33, v70, v71
v_mfma_f32_16x16x32_bf16 v[188:191], a[236:239], v[44:47], v[188:191]
v_exp_f32 v72, v72
v_smfmac_f32_16x16x64_bf16 a[240:243], a[252:255], v[40:47], v92
v_mfma_f32_16x16x32_bf16 v[76:79], a[144:147], v[0:3], v[60:63]
v_exp_f32 v73, v73
v_mfma_f32_16x16x32_bf16 v[76:79], a[148:151], v[4:7], v[76:79]
v_exp_f32 v74, v74
v_mfma_f32_16x16x32_bf16 v[76:79], a[152:155], v[8:11], v[76:79]
s_waitcnt lgkmcnt(0)
v_exp_f32 v75, v75
v_mfma_f32_16x16x32_bf16 v[76:79], a[156:159], v[12:15], v[76:79]
buffer_store_dwordx4 a[88:91], v101, s[16:19], s33 offen offset:2048 nt
v_mfma_f32_16x16x32_bf16 v[80:83], a[172:175], v[12:15], v[60:63]
v_cvt_pk_bf16_f32 v34, v72, v73
v_cvt_pk_bf16_f32 v35, v74, v75
v_mfma_f32_16x16x32_bf16 v[80:83], a[168:171], v[8:11], v[80:83]
v_mfma_f32_16x16x32_bf16 v[80:83], a[164:167], v[4:7], v[80:83]
v_mfma_f32_16x16x32_bf16 v[80:83], a[160:163], v[0:3], v[80:83]
v_mfma_f32_16x16x32_bf16 v[84:87], a[112:115], v[0:3], v[60:63]
v_exp_f32 v76, v76
v_mfma_f32_16x16x32_bf16 v[84:87], a[116:119], v[4:7], v[84:87]
v_exp_f32 v77, v77
v_mfma_f32_16x16x32_bf16 v[84:87], a[120:123], v[8:11], v[84:87]
v_exp_f32 v78, v78
v_mfma_f32_16x16x32_bf16 v[84:87], a[124:127], v[12:15], v[84:87]
v_exp_f32 v79, v79
v_mfma_f32_16x16x32_bf16 v[68:71], a[140:143], v[12:15], v[60:63]
v_cvt_pk_bf16_f32 v44, v76, v77
v_cvt_pk_bf16_f32 v45, v78, v79
v_mfma_f32_16x16x32_bf16 v[68:71], a[136:139], v[8:11], v[68:71]
v_exp_f32 v80, v80
v_mfma_f32_16x16x32_bf16 v[68:71], a[132:135], v[4:7], v[68:71]
v_exp_f32 v81, v81
v_mfma_f32_16x16x32_bf16 v[68:71], a[128:131], v[0:3], v[68:71]
v_exp_f32 v82, v82
v_mfma_f32_16x16x32_bf16 v[192:195], a[208:211], v[36:39], v[192:195]
v_exp_f32 v83, v83
v_mfma_f32_16x16x32_bf16 v[192:195], a[176:179], v[32:35], v[192:195]
v_cvt_pk_bf16_f32 v46, v80, v81
v_cvt_pk_bf16_f32 v47, v82, v83
v_mfma_f32_16x16x32_bf16 v[196:199], a[180:183], v[32:35], v[196:199]
v_exp_f32 v84, v84
v_mfma_f32_16x16x32_bf16 v[196:199], a[212:215], v[36:39], v[196:199]
v_exp_f32 v85, v85
v_mfma_f32_16x16x32_bf16 v[200:203], a[216:219], v[36:39], v[200:203]
v_exp_f32 v86, v86
v_mfma_f32_16x16x32_bf16 v[200:203], a[184:187], v[32:35], v[200:203]
v_exp_f32 v87, v87
v_mfma_f32_16x16x32_bf16 v[204:207], a[188:191], v[32:35], v[204:207]
v_exp_f32 v68, v68
v_mfma_f32_16x16x32_bf16 v[204:207], a[220:223], v[36:39], v[204:207]
v_exp_f32 v69, v69
v_mfma_f32_16x16x32_bf16 v[208:211], a[224:227], v[36:39], v[208:211]
v_exp_f32 v70, v70
v_mfma_f32_16x16x32_bf16 v[208:211], a[192:195], v[32:35], v[208:211]
v_exp_f32 v71, v71
v_mfma_f32_16x16x32_bf16 v[212:215], a[196:199], v[32:35], v[212:215]
v_cvt_pk_bf16_f32 v40, v84, v85
v_cvt_pk_bf16_f32 v41, v86, v87
v_mfma_f32_16x16x32_bf16 v[212:215], a[228:231], v[36:39], v[212:215]
v_cvt_pk_bf16_f32 v42, v68, v69
v_cvt_pk_bf16_f32 v43, v70, v71
v_mfma_f32_16x16x32_bf16 v[216:219], a[232:235], v[36:39], v[216:219]
v_mfma_f32_16x16x32_bf16 v[216:219], a[200:203], v[32:35], v[216:219]
v_mfma_f32_16x16x32_bf16 v[220:223], a[204:207], v[32:35], v[220:223]
s_waitcnt vmcnt(6)
s_barrier
v_mfma_f32_16x16x32_bf16 v[220:223], a[236:239], v[36:39], v[220:223]
ds_read_b128 a[144:147], v89 offset:16896
v_smfmac_f32_16x16x64_bf16 a[244:247], a[248:251], v[32:39], v92
ds_read_b128 a[148:151], v89 offset:16960
v_mfma_f32_16x16x32_bf16 v[72:75], a[112:115], v[16:19], v[64:67]
ds_read_b128 a[112:115], v88 offset:16896
v_mfma_f32_16x16x32_bf16 v[72:75], a[116:119], v[20:23], v[72:75]
ds_read_b128 a[116:119], v88 offset:16960
v_mfma_f32_16x16x32_bf16 v[72:75], a[120:123], v[24:27], v[72:75]
ds_read_b128 a[120:123], v88 offset:17024
v_mfma_f32_16x16x32_bf16 v[72:75], a[124:127], v[28:31], v[72:75]
ds_read_b128 a[124:127], v88 offset:17088
v_mfma_f32_16x16x32_bf16 v[76:79], a[140:143], v[28:31], v[64:67]
ds_read_b128 a[140:143], v88 offset:17600
v_add_u32 v119, s26, v96
v_mfma_f32_16x16x32_bf16 v[76:79], a[136:139], v[24:27], v[76:79]
ds_read_b128 a[136:139], v88 offset:17536
v_add_u32 v120, s28, v96
v_mfma_f32_16x16x32_bf16 v[76:79], a[132:135], v[20:23], v[76:79]
ds_read_b128 a[132:135], v88 offset:17472
v_lshrrev_b32 v121, 1, v96
v_mfma_f32_16x16x32_bf16 v[76:79], a[128:131], v[16:19], v[76:79]
ds_read_b128 a[128:131], v88 offset:17408
v_add_u32 v118, s25, v121
v_mfma_f32_16x16x32_bf16 v[224:227], a[208:211], v[44:47], v[224:227]
v_exp_f32 v72, v72
v_mfma_f32_16x16x32_bf16 v[224:227], a[176:179], v[40:43], v[224:227]
v_exp_f32 v73, v73
v_mfma_f32_16x16x32_bf16 v[228:231], a[180:183], v[40:43], v[228:231]
v_exp_f32 v74, v74
v_mfma_f32_16x16x32_bf16 v[228:231], a[212:215], v[44:47], v[228:231]
v_exp_f32 v75, v75
v_mfma_f32_16x16x32_bf16 v[232:235], a[216:219], v[44:47], v[232:235]
v_exp_f32 v76, v76
v_mfma_f32_16x16x32_bf16 v[232:235], a[184:187], v[40:43], v[232:235]
v_exp_f32 v77, v77
v_mfma_f32_16x16x32_bf16 v[236:239], a[188:191], v[40:43], v[236:239]
v_exp_f32 v78, v78
v_mfma_f32_16x16x32_bf16 v[236:239], a[220:223], v[44:47], v[236:239]
v_exp_f32 v79, v79
v_mfma_f32_16x16x32_bf16 v[240:243], a[224:227], v[44:47], v[240:243]
v_cvt_pk_bf16_f32 v32, v72, v73
v_cvt_pk_bf16_f32 v33, v74, v75
v_mfma_f32_16x16x32_bf16 v[240:243], a[192:195], v[40:43], v[240:243]
v_cvt_pk_bf16_f32 v34, v76, v77
v_cvt_pk_bf16_f32 v35, v78, v79
v_mfma_f32_16x16x32_bf16 v[244:247], a[196:199], v[40:43], v[244:247]
v_add_f32 v103, v103, v72
v_add_f32 v103, v103, v73
v_mfma_f32_16x16x32_bf16 v[244:247], a[228:231], v[44:47], v[244:247]
v_add_f32 v103, v103, v74
v_add_f32 v103, v103, v75
v_mfma_f32_16x16x32_bf16 v[248:251], a[232:235], v[44:47], v[248:251]
ds_read_b128 a[152:155], v89 offset:17024
v_add_f32 v103, v103, v76
v_mfma_f32_16x16x32_bf16 v[248:251], a[200:203], v[40:43], v[248:251]
ds_read_b128 a[156:159], v89 offset:17088
v_add_f32 v103, v103, v77
v_mfma_f32_16x16x32_bf16 v[252:255], a[204:207], v[40:43], v[252:255]
ds_read_b128 a[172:175], v89 offset:17600
v_add_f32 v103, v103, v78
v_mfma_f32_16x16x32_bf16 v[252:255], a[236:239], v[44:47], v[252:255]
ds_read_b128 a[168:171], v89 offset:17536
v_add_f32 v103, v103, v79
v_smfmac_f32_16x16x64_bf16 a[244:247], a[252:255], v[40:47], v92
s_waitcnt lgkmcnt(4)
ds_read_b128 a[164:167], v89 offset:17472
v_mfma_f32_16x16x32_bf16 v[80:83], a[112:115], v[16:19], v[64:67]
ds_read_b128 a[160:163], v89 offset:17408
v_mov_b32 v117, v64
v_mfma_f32_16x16x32_bf16 v[80:83], a[116:119], v[20:23], v[80:83]
ds_read_b64_tr_b16 a[208:209], v91 offset:16896
ds_read_b64_tr_b16 a[210:211], v91 offset:17408
v_mfma_f32_16x16x32_bf16 v[80:83], a[120:123], v[24:27], v[80:83]
ds_read_b64_tr_b16 a[212:213], v91 offset:16928
v_add_u32 v121, s24, v121
v_mfma_f32_16x16x32_bf16 v[80:83], a[124:127], v[28:31], v[80:83]
ds_read_b64_tr_b16 a[214:215], v91 offset:17440
ds_read_b64_tr_b16 a[216:217], v91 offset:16960
v_mfma_f32_16x16x32_bf16 v[84:87], a[140:143], v[28:31], v[64:67]
ds_read_b64_tr_b16 a[218:219], v91 offset:17472
v_mfma_f32_16x16x32_bf16 v[84:87], a[136:139], v[24:27], v[84:87]
ds_read_b64_tr_b16 a[220:221], v91 offset:16992
ds_read_b64_tr_b16 a[222:223], v91 offset:17504
v_mfma_f32_16x16x32_bf16 v[84:87], a[132:135], v[20:23], v[84:87]
ds_read_b64_tr_b16 a[224:225], v91 offset:17024
v_mfma_f32_16x16x32_bf16 v[84:87], a[128:131], v[16:19], v[84:87]
v_exp_f32 v80, v80
v_mfma_f32_16x16x32_bf16 a[48:51], a[176:179], v[32:35], a[48:51]
ds_read_b64_tr_b16 a[176:177], v90 offset:16896
ds_read_b64_tr_b16 a[178:179], v90 offset:17408
v_mfma_f32_16x16x32_bf16 a[52:55], a[180:183], v[32:35], a[52:55]
v_exp_f32 v81, v81
v_mfma_f32_16x16x32_bf16 a[56:59], a[184:187], v[32:35], a[56:59]
v_exp_f32 v82, v82
v_mfma_f32_16x16x32_bf16 a[60:63], a[188:191], v[32:35], a[60:63]
v_exp_f32 v83, v83
v_mfma_f32_16x16x32_bf16 a[64:67], a[192:195], v[32:35], a[64:67]
ds_read_b64_tr_b16 a[180:181], v90 offset:16928
ds_read_b64_tr_b16 a[182:183], v90 offset:17440
v_mfma_f32_16x16x32_bf16 a[68:71], a[196:199], v[32:35], a[68:71]
v_add_f32 v103, v103, v80
v_add_f32 v103, v103, v81
v_mfma_f32_16x16x32_bf16 a[72:75], a[200:203], v[32:35], a[72:75]
v_cvt_pk_bf16_f32 v40, v80, v81
v_add_f32 v103, v103, v82
v_mfma_f32_16x16x32_bf16 a[76:79], a[204:207], v[32:35], a[76:79]
v_add_f32 v103, v103, v83
v_cvt_pk_bf16_f32 v41, v82, v83
v_mfma_f32_16x16x32_bf16 v[68:71], a[112:115], a[0:3], v[48:51]
ds_read_b64_tr_b16 a[184:185], v90 offset:16960
ds_read_b64_tr_b16 a[186:187], v90 offset:17472
v_mfma_f32_16x16x32_bf16 v[68:71], a[116:119], a[4:7], v[68:71]
v_exp_f32 v84, v84
v_mfma_f32_16x16x32_bf16 v[68:71], a[120:123], a[8:11], v[68:71]
ds_read_b64_tr_b16 a[188:189], v90 offset:16992
ds_read_b64_tr_b16 a[190:191], v90 offset:17504
v_mfma_f32_16x16x32_bf16 v[68:71], a[124:127], a[12:15], v[68:71]
v_exp_f32 v85, v85
v_mfma_f32_16x16x32_bf16 v[72:75], a[140:143], a[12:15], v[48:51]
v_exp_f32 v86, v86
v_mfma_f32_16x16x32_bf16 v[72:75], a[136:139], a[8:11], v[72:75]
v_exp_f32 v87, v87
v_mfma_f32_16x16x32_bf16 v[72:75], a[132:135], a[4:7], v[72:75]
ds_read_b64_tr_b16 a[192:193], v90 offset:17024
ds_read_b64_tr_b16 a[194:195], v90 offset:17536
v_mfma_f32_16x16x32_bf16 v[72:75], a[128:131], a[0:3], v[72:75]
v_cvt_pk_bf16_f32 v42, v84, v85
v_cvt_pk_bf16_f32 v43, v86, v87
v_mfma_f32_16x16x32_bf16 v[76:79], a[144:147], a[0:3], v[48:51]
ds_read_b64_tr_b16 a[196:197], v90 offset:17056
ds_read_b64_tr_b16 a[198:199], v90 offset:17568
v_mfma_f32_16x16x32_bf16 v[76:79], a[148:151], a[4:7], v[76:79]
s_waitcnt lgkmcnt(6)
ds_read_b64_tr_b16 a[200:201], v90 offset:17088
v_add_f32 v103, v103, v84
v_mfma_f32_16x16x32_bf16 v[76:79], a[152:155], a[8:11], v[76:79]
ds_read_b64_tr_b16 a[202:203], v90 offset:17600
ds_read_b64_tr_b16 a[204:205], v90 offset:17120
v_mfma_f32_16x16x32_bf16 v[76:79], a[156:159], a[12:15], v[76:79]
ds_read_b64_tr_b16 a[206:207], v90 offset:17632
v_add_f32 v103, v103, v85
v_mfma_f32_16x16x32_bf16 v[80:83], a[172:175], a[12:15], v[48:51]
v_add_f32 v103, v103, v86
v_add_f32 v103, v103, v87
v_mfma_f32_16x16x32_bf16 v[80:83], a[168:171], a[8:11], v[80:83]
v_exp_f32 v68, v68
v_mfma_f32_16x16x32_bf16 v[80:83], a[164:167], a[4:7], v[80:83]
v_exp_f32 v69, v69
v_mfma_f32_16x16x32_bf16 v[80:83], a[160:163], a[0:3], v[80:83]
v_exp_f32 v70, v70
v_mfma_f32_16x16x32_bf16 a[48:51], a[176:179], v[40:43], a[48:51]
v_exp_f32 v71, v71
v_mfma_f32_16x16x32_bf16 a[52:55], a[180:183], v[40:43], a[52:55]
v_cvt_pk_bf16_f32 v32, v68, v69
v_cvt_pk_bf16_f32 v33, v70, v71
v_mfma_f32_16x16x32_bf16 a[56:59], a[184:187], v[40:43], a[56:59]
s_waitcnt lgkmcnt(1)
v_exp_f32 v72, v72
v_mfma_f32_16x16x32_bf16 a[60:63], a[188:191], v[40:43], a[60:63]
v_exp_f32 v73, v73
v_mfma_f32_16x16x32_bf16 a[64:67], a[192:195], v[40:43], a[64:67]
v_exp_f32 v74, v74
v_mfma_f32_16x16x32_bf16 a[68:71], a[196:199], v[40:43], a[68:71]
ds_write_b128 v119, a[48:51] offset:4352
v_mfma_f32_16x16x32_bf16 a[72:75], a[200:203], v[40:43], a[72:75]
s_waitcnt lgkmcnt(1)
v_exp_f32 v75, v75
v_mfma_f32_16x16x32_bf16 a[76:79], a[204:207], v[40:43], a[76:79]
v_cvt_pk_bf16_f32 v34, v72, v73
v_cvt_pk_bf16_f32 v35, v74, v75
v_mfma_f32_16x16x32_bf16 v[84:87], a[112:115], a[16:19], v[52:55]
ds_write_b128 v119, a[52:55] offset:5376
v_mfma_f32_16x16x32_bf16 v[84:87], a[116:119], a[20:23], v[84:87]
v_exp_f32 v76, v76
v_mfma_f32_16x16x32_bf16 v[84:87], a[120:123], a[24:27], v[84:87]
v_exp_f32 v77, v77
v_mfma_f32_16x16x32_bf16 v[84:87], a[124:127], a[28:31], v[84:87]
ds_write_b128 v119, a[56:59] offset:6400
v_mfma_f32_16x16x32_bf16 v[68:71], a[140:143], a[28:31], v[52:55]
v_exp_f32 v78, v78
v_mfma_f32_16x16x32_bf16 v[68:71], a[136:139], a[24:27], v[68:71]
v_exp_f32 v79, v79
v_mfma_f32_16x16x32_bf16 v[68:71], a[132:135], a[20:23], v[68:71]
v_cvt_pk_bf16_f32 v36, v76, v77
v_cvt_pk_bf16_f32 v37, v78, v79
v_mfma_f32_16x16x32_bf16 v[68:71], a[128:131], a[16:19], v[68:71]
ds_write_b128 v119, a[60:63] offset:7424
v_mfma_f32_16x16x32_bf16 v[72:75], a[144:147], a[16:19], v[52:55]
v_exp_f32 v80, v80
v_mfma_f32_16x16x32_bf16 v[72:75], a[148:151], a[20:23], v[72:75]
v_exp_f32 v81, v81
v_mfma_f32_16x16x32_bf16 v[72:75], a[152:155], a[24:27], v[72:75]
v_exp_f32 v82, v82
v_mfma_f32_16x16x32_bf16 v[72:75], a[156:159], a[28:31], v[72:75]
v_exp_f32 v83, v83
v_mfma_f32_16x16x32_bf16 v[76:79], a[172:175], a[28:31], v[52:55]
v_cvt_pk_bf16_f32 v38, v80, v81
v_cvt_pk_bf16_f32 v39, v82, v83
v_mfma_f32_16x16x32_bf16 v[76:79], a[168:171], a[24:27], v[76:79]
ds_write_b128 v120, a[64:67] offset:4352
v_mfma_f32_16x16x32_bf16 v[76:79], a[164:167], a[20:23], v[76:79]
ds_read_b64_tr_b16 a[226:227], v91 offset:17536
v_mov_b32 v116, v103
v_mfma_f32_16x16x32_bf16 v[76:79], a[160:163], a[16:19], v[76:79]
s_nop 0
v_permlane16_swap_b32 v103, v116
v_smfmac_f32_16x16x64_bf16 a[240:243], a[248:251], v[32:39], v92
v_add_f32 v103, v103, v116
v_mfma_f32_16x16x32_bf16 v[128:131], a[176:179], v[32:35], v[128:131]
ds_read_b64_tr_b16 a[228:229], v91 offset:17056
v_mov_b32 v116, v103
v_mfma_f32_16x16x32_bf16 v[128:131], a[208:211], v[36:39], v[128:131]
ds_write_b128 v120, a[68:71] offset:5376
v_mfma_f32_16x16x32_bf16 v[132:135], a[212:215], v[36:39], v[132:135]
v_permlane32_swap_b32 v103, v116
v_mfma_f32_16x16x32_bf16 v[132:135], a[180:183], v[32:35], v[132:135]
ds_read_b64_tr_b16 a[230:231], v91 offset:17568
v_add_f32 v116, v103, v116
v_mfma_f32_16x16x32_bf16 v[136:139], a[184:187], v[32:35], v[136:139]
ds_write_b64 v118, v[116:117] offset:13056
ds_write_b128 v120, a[72:75] offset:6400
ds_write_b128 v120, a[76:79] offset:7424
v_add_f32 v100, v100, v116
v_mfma_f32_16x16x32_bf16 v[136:139], a[216:219], v[36:39], v[136:139]
ds_read_b64_tr_b16 a[232:233], v91 offset:17088
ds_read_b64_tr_b16 a[234:235], v91 offset:17600
v_mfma_f32_16x16x32_bf16 v[140:143], a[220:223], v[36:39], v[140:143]
ds_read_b64_tr_b16 a[236:237], v91 offset:17120
v_accvgpr_read_b32 v125, a240
v_mfma_f32_16x16x32_bf16 v[140:143], a[188:191], v[32:35], v[140:143]
ds_read_b64_tr_b16 a[238:239], v91 offset:17632
v_accvgpr_read_b32 v124, a241
v_mfma_f32_16x16x32_bf16 v[144:147], a[192:195], v[32:35], v[144:147]
s_waitcnt lgkmcnt(9)
v_exp_f32 v84, v84
v_mfma_f32_16x16x32_bf16 v[144:147], a[224:227], v[36:39], v[144:147]
s_waitcnt lgkmcnt(7)
v_exp_f32 v85, v85
v_mfma_f32_16x16x32_bf16 v[148:151], a[228:231], v[36:39], v[148:151]
v_exp_f32 v86, v86
v_mfma_f32_16x16x32_bf16 v[148:151], a[196:199], v[32:35], v[148:151]
s_waitcnt lgkmcnt(2)
v_exp_f32 v87, v87
v_mfma_f32_16x16x32_bf16 v[152:155], a[200:203], v[32:35], v[152:155]
s_waitcnt lgkmcnt(4)
s_barrier
v_mfma_f32_16x16x32_bf16 v[152:155], a[232:235], v[36:39], v[152:155]
s_waitcnt lgkmcnt(0)
ds_read_b64 v[118:119], v121 offset:13056
v_cvt_pk_bf16_f32 v40, v84, v85
v_mfma_f32_16x16x32_bf16 v[156:159], a[236:239], v[36:39], v[156:159]
v_cvt_pk_bf16_f32 v41, v86, v87
v_add_f32 v125, v125, v124
v_mfma_f32_16x16x32_bf16 v[156:159], a[204:207], v[32:35], v[156:159]
v_rcp_f32 v124, v125
v_mfma_f32_16x16x32_bf16 v[80:83], a[112:115], a[32:35], v[56:59]
v_exp_f32 v68, v68
v_mfma_f32_16x16x32_bf16 v[80:83], a[116:119], a[36:39], v[80:83]
v_exp_f32 v69, v69
v_mfma_f32_16x16x32_bf16 v[80:83], a[120:123], a[40:43], v[80:83]
v_exp_f32 v70, v70
v_mfma_f32_16x16x32_bf16 v[80:83], a[124:127], a[44:47], v[80:83]
v_exp_f32 v71, v71
v_mfma_f32_16x16x32_bf16 v[84:87], a[140:143], a[44:47], v[56:59]
v_pk_mul_f32 v[128:129], v[128:129], v[124:125] op_sel_hi:[1,0]
v_pk_mul_f32 v[130:131], v[130:131], v[124:125] op_sel_hi:[1,0]
v_pk_mul_f32 v[132:133], v[132:133], v[124:125] op_sel_hi:[1,0]
v_pk_mul_f32 v[134:135], v[134:135], v[124:125] op_sel_hi:[1,0]
v_pk_mul_f32 v[136:137], v[136:137], v[124:125] op_sel_hi:[1,0]
v_pk_mul_f32 v[138:139], v[138:139], v[124:125] op_sel_hi:[1,0]
v_pk_mul_f32 v[140:141], v[140:141], v[124:125] op_sel_hi:[1,0]
v_pk_mul_f32 v[142:143], v[142:143], v[124:125] op_sel_hi:[1,0]
v_pk_mul_f32 v[144:145], v[144:145], v[124:125] op_sel_hi:[1,0]
v_pk_mul_f32 v[146:147], v[146:147], v[124:125] op_sel_hi:[1,0]
v_pk_mul_f32 v[148:149], v[148:149], v[124:125] op_sel_hi:[1,0]
v_pk_mul_f32 v[150:151], v[150:151], v[124:125] op_sel_hi:[1,0]
v_pk_mul_f32 v[152:153], v[152:153], v[124:125] op_sel_hi:[1,0]
v_pk_mul_f32 v[154:155], v[154:155], v[124:125] op_sel_hi:[1,0]
v_pk_mul_f32 v[156:157], v[156:157], v[124:125] op_sel_hi:[1,0]
v_pk_mul_f32 v[158:159], v[158:159], v[124:125] op_sel_hi:[1,0]
v_cvt_pk_bf16_f32 v128, v128, v129
v_cvt_pk_bf16_f32 v129, v130, v131
v_cvt_pk_bf16_f32 v132, v132, v133
v_cvt_pk_bf16_f32 v133, v134, v135
v_cvt_pk_bf16_f32 v136, v136, v137
v_cvt_pk_bf16_f32 v137, v138, v139
v_cvt_pk_bf16_f32 v140, v140, v141
v_cvt_pk_bf16_f32 v141, v142, v143
v_cvt_pk_bf16_f32 v144, v144, v145
v_cvt_pk_bf16_f32 v145, v146, v147
v_cvt_pk_bf16_f32 v148, v148, v149
v_cvt_pk_bf16_f32 v149, v150, v151
v_cvt_pk_bf16_f32 v152, v152, v153
v_cvt_pk_bf16_f32 v153, v154, v155
v_cvt_pk_bf16_f32 v156, v156, v157
v_cvt_pk_bf16_f32 v157, v158, v159
v_mfma_f32_16x16x32_bf16 v[84:87], a[136:139], a[40:43], v[84:87]
ds_write_b64 v94, v[128:129] offset:0
v_mfma_f32_16x16x32_bf16 v[84:87], a[132:135], a[36:39], v[84:87]
ds_read_b128 v[16:19], v99 offset:4352
v_cvt_pk_bf16_f32 v42, v68, v69
v_mfma_f32_16x16x32_bf16 v[84:87], a[128:131], a[32:35], v[84:87]
ds_read_b128 v[20:23], v99 offset:8704
v_cvt_pk_bf16_f32 v43, v70, v71
v_mfma_f32_16x16x32_bf16 v[68:71], a[144:147], a[32:35], v[56:59]
ds_write_b64 v94, v[132:133] offset:32
v_mfma_f32_16x16x32_bf16 v[68:71], a[148:151], a[36:39], v[68:71]
s_waitcnt lgkmcnt(4)
v_min_f32 v120, v117, v119
v_sub_f32 v122, v120, v117
v_mfma_f32_16x16x32_bf16 v[68:71], a[152:155], a[40:43], v[68:71]
ds_write_b64 v94, v[136:137] offset:64
v_sub_f32 v123, v120, v119
v_exp_f32 v72, v72
v_exp_f32 v73, v73
v_exp_f32 v74, v74
v_exp_f32 v75, v75
v_mfma_f32_16x16x32_bf16 v[68:71], a[156:159], a[44:47], v[68:71]
v_exp_f32 v122, v122
v_exp_f32 v123, v123
v_cvt_pk_bf16_f32 v44, v72, v73
v_cvt_pk_bf16_f32 v45, v74, v75
v_mfma_f32_16x16x32_bf16 v[72:75], a[172:175], a[44:47], v[56:59]
ds_write_b64 v94, v[140:141] offset:96
v_mul_f32 v120, v116, v122
v_fmac_f32 v120, v118, v123
v_mfma_f32_16x16x32_bf16 v[72:75], a[168:171], a[40:43], v[72:75]
v_rcp_f32 v120, v120
v_exp_f32 v76, v76
v_exp_f32 v77, v77
v_exp_f32 v78, v78
v_exp_f32 v79, v79
v_mfma_f32_16x16x32_bf16 v[72:75], a[164:167], a[36:39], v[72:75]
v_mul_f32 v122, v122, v120
v_mul_f32 v123, v123, v120
s_waitcnt lgkmcnt(4)
v_mul_f32 v16, v122, v16
v_mul_f32 v17, v122, v17
v_mul_f32 v18, v122, v18
v_mul_f32 v19, v122, v19
s_waitcnt lgkmcnt(3)
v_fmac_f32 v16, v123, v20
v_fmac_f32 v17, v123, v21
v_fmac_f32 v18, v123, v22
v_fmac_f32 v19, v123, v23
v_cvt_pk_bf16_f32 v16, v16, v17
v_cvt_pk_bf16_f32 v17, v18, v19
v_cvt_pk_bf16_f32 v46, v76, v77
v_cvt_pk_bf16_f32 v47, v78, v79
ds_write_b64 v94, v[144:145] offset:128
v_mfma_f32_16x16x32_bf16 v[72:75], a[160:163], a[32:35], v[72:75]
ds_write_b64 v93, v[16:17] offset:8704
ds_read_b128 v[24:27], v99 offset:5376
ds_read_b128 v[28:31], v99 offset:9728
ds_read_b128 v[108:111], v99 offset:6400
ds_read_b128 v[112:115], v99 offset:10752
ds_read_b128 v[16:19], v99 offset:7424
ds_read_b128 v[20:23], v99 offset:11776
v_smfmac_f32_16x16x64_bf16 a[240:243], a[252:255], v[40:47], v92
ds_write_b64 v94, v[148:149] offset:160
v_mfma_f32_16x16x32_bf16 v[160:163], a[176:179], v[40:43], v[160:163]
ds_write_b64 v94, v[152:153] offset:192
v_mfma_f32_16x16x32_bf16 v[160:163], a[208:211], v[44:47], v[160:163]
v_exp_f32 v80, v80
v_mfma_f32_16x16x32_bf16 v[164:167], a[212:215], v[44:47], v[164:167]
ds_write_b64 v94, v[156:157] offset:224
v_mfma_f32_16x16x32_bf16 v[164:167], a[180:183], v[40:43], v[164:167]
v_exp_f32 v81, v81
v_mfma_f32_16x16x32_bf16 v[168:171], a[184:187], v[40:43], v[168:171]
s_waitcnt lgkmcnt(3)
v_exp_f32 v82, v82
v_mfma_f32_16x16x32_bf16 v[168:171], a[216:219], v[44:47], v[168:171]
v_mul_f32 v24, v122, v24
v_mul_f32 v25, v122, v25
v_mul_f32 v26, v122, v26
v_mul_f32 v27, v122, v27
v_fmac_f32 v24, v123, v28
v_fmac_f32 v25, v123, v29
v_fmac_f32 v26, v123, v30
v_fmac_f32 v27, v123, v31
v_cvt_pk_bf16_f32 v24, v24, v25
v_cvt_pk_bf16_f32 v25, v26, v27
v_mul_f32 v108, v122, v108
v_mul_f32 v109, v122, v109
v_mul_f32 v110, v122, v110
v_mul_f32 v111, v122, v111
v_fmac_f32 v108, v123, v112
v_fmac_f32 v109, v123, v113
v_fmac_f32 v110, v123, v114
v_fmac_f32 v111, v123, v115
v_cvt_pk_bf16_f32 v108, v108, v109
v_cvt_pk_bf16_f32 v109, v110, v111
v_mul_f32 v16, v122, v16
v_mul_f32 v17, v122, v17
v_mul_f32 v18, v122, v18
v_mul_f32 v19, v122, v19
v_fmac_f32 v16, v123, v20
v_fmac_f32 v17, v123, v21
v_fmac_f32 v18, v123, v22
v_fmac_f32 v19, v123, v23
v_cvt_pk_bf16_f32 v16, v16, v17
v_cvt_pk_bf16_f32 v17, v18, v19
v_mfma_f32_16x16x32_bf16 v[172:175], a[220:223], v[44:47], v[172:175]
ds_write_b64 v93, v[24:25] offset:9728
ds_write_b64 v93, v[108:109] offset:10752
ds_write_b64 v93, v[16:17] offset:11776
v_mfma_f32_16x16x32_bf16 v[172:175], a[188:191], v[40:43], v[172:175]
ds_read_b128 a[92:95], v102 offset:8704
ds_read_b128 a[100:103], v95 offset:0
v_mfma_f32_16x16x32_bf16 v[176:179], a[192:195], v[40:43], v[176:179]
v_exp_f32 v83, v83
v_mfma_f32_16x16x32_bf16 v[176:179], a[224:227], v[44:47], v[176:179]
ds_read_b128 a[104:107], v95 offset:1088
v_cvt_pk_bf16_f32 v32, v80, v81
v_mfma_f32_16x16x32_bf16 v[180:183], a[228:231], v[44:47], v[180:183]
ds_read_b128 a[96:99], v102 offset:8768
v_cvt_pk_bf16_f32 v33, v82, v83
v_mfma_f32_16x16x32_bf16 v[180:183], a[196:199], v[40:43], v[180:183]
ds_read_b128 a[108:111], v95 offset:2176
v_accvgpr_read_b32 v127, a242
v_mfma_f32_16x16x32_bf16 v[184:187], a[200:203], v[40:43], v[184:187]
ds_read_b128 a[80:83], v95 offset:3264
v_accvgpr_read_b32 v126, a243
v_mfma_f32_16x16x32_bf16 v[184:187], a[232:235], v[44:47], v[184:187]
v_add_f32 v127, v127, v126
v_add_f32 v100, v100, v125
v_mfma_f32_16x16x32_bf16 v[188:191], a[236:239], v[44:47], v[188:191]
v_rcp_f32 v126, v127
v_mfma_f32_16x16x32_bf16 v[188:191], a[204:207], v[40:43], v[188:191]
s_lshl_b32 s33, s34, 7
v_exp_f32 v84, v84
v_mfma_f32_16x16x32_bf16 v[76:79], a[112:115], v[0:3], v[60:63]
s_add_u32 s33, s33, s32
v_exp_f32 v85, v85
v_mfma_f32_16x16x32_bf16 v[76:79], a[116:119], v[4:7], v[76:79]
s_add_u32 s33, s33, 73728
v_exp_f32 v86, v86
v_mfma_f32_16x16x32_bf16 v[76:79], a[120:123], v[8:11], v[76:79]
v_exp_f32 v87, v87
v_mfma_f32_16x16x32_bf16 v[76:79], a[124:127], v[12:15], v[76:79]
v_cvt_pk_bf16_f32 v34, v84, v85
v_cvt_pk_bf16_f32 v35, v86, v87
v_mfma_f32_16x16x32_bf16 v[80:83], a[140:143], v[12:15], v[60:63]
v_pk_mul_f32 v[160:161], v[160:161], v[126:127] op_sel_hi:[1,0]
v_pk_mul_f32 v[162:163], v[162:163], v[126:127] op_sel_hi:[1,0]
v_pk_mul_f32 v[164:165], v[164:165], v[126:127] op_sel_hi:[1,0]
v_pk_mul_f32 v[166:167], v[166:167], v[126:127] op_sel_hi:[1,0]
v_pk_mul_f32 v[168:169], v[168:169], v[126:127] op_sel_hi:[1,0]
v_pk_mul_f32 v[170:171], v[170:171], v[126:127] op_sel_hi:[1,0]
v_pk_mul_f32 v[172:173], v[172:173], v[126:127] op_sel_hi:[1,0]
v_pk_mul_f32 v[174:175], v[174:175], v[126:127] op_sel_hi:[1,0]
v_pk_mul_f32 v[176:177], v[176:177], v[126:127] op_sel_hi:[1,0]
v_pk_mul_f32 v[178:179], v[178:179], v[126:127] op_sel_hi:[1,0]
v_pk_mul_f32 v[180:181], v[180:181], v[126:127] op_sel_hi:[1,0]
v_pk_mul_f32 v[182:183], v[182:183], v[126:127] op_sel_hi:[1,0]
v_pk_mul_f32 v[184:185], v[184:185], v[126:127] op_sel_hi:[1,0]
v_pk_mul_f32 v[186:187], v[186:187], v[126:127] op_sel_hi:[1,0]
v_pk_mul_f32 v[188:189], v[188:189], v[126:127] op_sel_hi:[1,0]
v_pk_mul_f32 v[190:191], v[190:191], v[126:127] op_sel_hi:[1,0]
v_cvt_pk_bf16_f32 v160, v160, v161
v_cvt_pk_bf16_f32 v161, v162, v163
v_cvt_pk_bf16_f32 v164, v164, v165
v_cvt_pk_bf16_f32 v165, v166, v167
v_cvt_pk_bf16_f32 v168, v168, v169
v_cvt_pk_bf16_f32 v169, v170, v171
v_cvt_pk_bf16_f32 v172, v172, v173
v_cvt_pk_bf16_f32 v173, v174, v175
v_cvt_pk_bf16_f32 v176, v176, v177
v_cvt_pk_bf16_f32 v177, v178, v179
v_cvt_pk_bf16_f32 v180, v180, v181
v_cvt_pk_bf16_f32 v181, v182, v183
v_cvt_pk_bf16_f32 v184, v184, v185
v_cvt_pk_bf16_f32 v185, v186, v187
v_cvt_pk_bf16_f32 v188, v188, v189
v_cvt_pk_bf16_f32 v189, v190, v191
v_mfma_f32_16x16x32_bf16 v[80:83], a[136:139], v[8:11], v[80:83]
s_waitcnt lgkmcnt(0)
buffer_store_dwordx4 a[92:95], v101, s[16:19], s33 offen offset:0 nt
v_mfma_f32_16x16x32_bf16 v[80:83], a[132:135], v[4:7], v[80:83]
ds_write_b64 v94, v[160:161] offset:4352
v_mfma_f32_16x16x32_bf16 v[80:83], a[128:131], v[0:3], v[80:83]
ds_write_b64 v94, v[164:165] offset:4384
v_mfma_f32_16x16x32_bf16 v[84:87], a[144:147], v[0:3], v[60:63]
buffer_store_dwordx4 a[96:99], v101, s[16:19], s33 offen offset:2048 nt
s_add_u32 s33, s31, 73728
v_mfma_f32_16x16x32_bf16 v[84:87], a[148:151], v[4:7], v[84:87]
buffer_store_dwordx4 a[100:103], v96, s[16:19], s33 offen offset:0 nt
buffer_store_dwordx4 a[104:107], v96, s[16:19], s33 offen offset:1024 nt
buffer_store_dwordx4 a[108:111], v96, s[16:19], s33 offen offset:2048 nt
buffer_store_dwordx4 a[80:83], v96, s[16:19], s33 offen offset:3072 nt
v_mfma_f32_16x16x32_bf16 v[84:87], a[152:155], v[8:11], v[84:87]
ds_write_b64 v94, v[168:169] offset:4416
v_exp_f32 v68, v68
v_exp_f32 v69, v69
v_exp_f32 v70, v70
v_exp_f32 v71, v71
v_mfma_f32_16x16x32_bf16 v[84:87], a[156:159], v[12:15], v[84:87]
v_cvt_pk_bf16_f32 v36, v68, v69
v_cvt_pk_bf16_f32 v37, v70, v71
v_mfma_f32_16x16x32_bf16 v[68:71], a[172:175], v[12:15], v[60:63]
ds_write_b64 v94, v[172:173] offset:4448
v_mfma_f32_16x16x32_bf16 v[68:71], a[168:171], v[8:11], v[68:71]
v_exp_f32 v72, v72
v_exp_f32 v73, v73
v_exp_f32 v74, v74
v_exp_f32 v75, v75
v_mfma_f32_16x16x32_bf16 v[68:71], a[164:167], v[4:7], v[68:71]
ds_write_b64 v94, v[176:177] offset:4480
v_cvt_pk_bf16_f32 v38, v72, v73
v_cvt_pk_bf16_f32 v39, v74, v75
v_mfma_f32_16x16x32_bf16 v[68:71], a[160:163], v[0:3], v[68:71]
ds_write_b64 v94, v[180:181] offset:4512
v_smfmac_f32_16x16x64_bf16 a[244:247], a[248:251], v[32:39], v92
v_add_f32 v100, v100, v127
v_mfma_f32_16x16x32_bf16 v[192:195], a[176:179], v[32:35], v[192:195]
ds_write_b64 v94, v[184:185] offset:4544
v_mfma_f32_16x16x32_bf16 v[192:195], a[208:211], v[36:39], v[192:195]
v_exp_f32 v76, v76
v_mfma_f32_16x16x32_bf16 v[196:199], a[212:215], v[36:39], v[196:199]
ds_write_b64 v94, v[188:189] offset:4576
v_mfma_f32_16x16x32_bf16 v[196:199], a[180:183], v[32:35], v[196:199]
v_exp_f32 v77, v77
v_mfma_f32_16x16x32_bf16 v[200:203], a[184:187], v[32:35], v[200:203]
v_exp_f32 v78, v78
v_mfma_f32_16x16x32_bf16 v[200:203], a[216:219], v[36:39], v[200:203]
ds_read_b128 a[84:87], v95 offset:4352
v_cvt_pk_bf16_f32 v40, v76, v77
v_mfma_f32_16x16x32_bf16 v[204:207], a[220:223], v[36:39], v[204:207]
v_exp_f32 v79, v79
v_mfma_f32_16x16x32_bf16 v[204:207], a[188:191], v[32:35], v[204:207]
ds_read_b128 a[88:91], v95 offset:5440
v_cvt_pk_bf16_f32 v41, v78, v79
v_mfma_f32_16x16x32_bf16 v[208:211], a[192:195], v[32:35], v[208:211]
v_exp_f32 v80, v80
v_mfma_f32_16x16x32_bf16 v[208:211], a[224:227], v[36:39], v[208:211]
s_add_u32 s33, s31, 77824
ds_read_b128 a[92:95], v95 offset:6528
v_accvgpr_read_b32 v125, a244
v_mfma_f32_16x16x32_bf16 v[212:215], a[228:231], v[36:39], v[212:215]
v_exp_f32 v81, v81
v_mfma_f32_16x16x32_bf16 v[212:215], a[196:199], v[32:35], v[212:215]
ds_read_b128 a[96:99], v95 offset:7616
v_cvt_pk_bf16_f32 v42, v80, v81
v_mfma_f32_16x16x32_bf16 v[216:219], a[200:203], v[32:35], v[216:219]
v_exp_f32 v82, v82
v_mfma_f32_16x16x32_bf16 v[216:219], a[232:235], v[36:39], v[216:219]
v_exp_f32 v83, v83
v_exp_f32 v84, v84
v_exp_f32 v85, v85
v_exp_f32 v86, v86
v_exp_f32 v87, v87
v_exp_f32 v68, v68
v_exp_f32 v69, v69
v_exp_f32 v70, v70
v_exp_f32 v71, v71
v_mfma_f32_16x16x32_bf16 v[220:223], a[236:239], v[36:39], v[220:223]
s_waitcnt lgkmcnt(3)
buffer_store_dwordx4 a[84:87], v96, s[16:19], s33 offen offset:0 nt
v_cvt_pk_bf16_f32 v43, v82, v83
v_cvt_pk_bf16_f32 v44, v84, v85
v_cvt_pk_bf16_f32 v45, v86, v87
v_cvt_pk_bf16_f32 v46, v68, v69
v_cvt_pk_bf16_f32 v47, v70, v71
v_mfma_f32_16x16x32_bf16 v[220:223], a[204:207], v[32:35], v[220:223]
s_waitcnt lgkmcnt(2)
v_accvgpr_read_b32 v124, a245
v_add_f32 v125, v125, v124
v_smfmac_f32_16x16x64_bf16 a[244:247], a[252:255], v[40:47], v92
buffer_store_dwordx4 a[88:91], v96, s[16:19], s33 offen offset:1024 nt
v_mfma_f32_16x16x32_bf16 v[224:227], a[176:179], v[40:43], v[224:227]
s_waitcnt lgkmcnt(1)
buffer_store_dwordx4 a[92:95], v96, s[16:19], s33 offen offset:2048 nt
v_mfma_f32_16x16x32_bf16 v[224:227], a[208:211], v[44:47], v[224:227]
s_waitcnt lgkmcnt(0)
v_rcp_f32 v124, v125
v_mfma_f32_16x16x32_bf16 v[228:231], a[212:215], v[44:47], v[228:231]
buffer_store_dwordx4 a[96:99], v96, s[16:19], s33 offen offset:3072 nt
v_mfma_f32_16x16x32_bf16 v[228:231], a[180:183], v[40:43], v[228:231]
v_pk_mul_f32 v[192:193], v[192:193], v[124:125] op_sel_hi:[1,0]
v_pk_mul_f32 v[194:195], v[194:195], v[124:125] op_sel_hi:[1,0]
v_pk_mul_f32 v[196:197], v[196:197], v[124:125] op_sel_hi:[1,0]
v_pk_mul_f32 v[198:199], v[198:199], v[124:125] op_sel_hi:[1,0]
v_pk_mul_f32 v[200:201], v[200:201], v[124:125] op_sel_hi:[1,0]
v_pk_mul_f32 v[202:203], v[202:203], v[124:125] op_sel_hi:[1,0]
v_pk_mul_f32 v[204:205], v[204:205], v[124:125] op_sel_hi:[1,0]
v_pk_mul_f32 v[206:207], v[206:207], v[124:125] op_sel_hi:[1,0]
v_pk_mul_f32 v[208:209], v[208:209], v[124:125] op_sel_hi:[1,0]
v_pk_mul_f32 v[210:211], v[210:211], v[124:125] op_sel_hi:[1,0]
v_pk_mul_f32 v[212:213], v[212:213], v[124:125] op_sel_hi:[1,0]
v_pk_mul_f32 v[214:215], v[214:215], v[124:125] op_sel_hi:[1,0]
v_pk_mul_f32 v[216:217], v[216:217], v[124:125] op_sel_hi:[1,0]
v_pk_mul_f32 v[218:219], v[218:219], v[124:125] op_sel_hi:[1,0]
v_pk_mul_f32 v[220:221], v[220:221], v[124:125] op_sel_hi:[1,0]
v_pk_mul_f32 v[222:223], v[222:223], v[124:125] op_sel_hi:[1,0]
v_cvt_pk_bf16_f32 v192, v192, v193
v_cvt_pk_bf16_f32 v193, v194, v195
v_cvt_pk_bf16_f32 v196, v196, v197
v_cvt_pk_bf16_f32 v197, v198, v199
v_cvt_pk_bf16_f32 v200, v200, v201
v_cvt_pk_bf16_f32 v201, v202, v203
v_cvt_pk_bf16_f32 v204, v204, v205
v_cvt_pk_bf16_f32 v205, v206, v207
v_cvt_pk_bf16_f32 v208, v208, v209
v_cvt_pk_bf16_f32 v209, v210, v211
v_cvt_pk_bf16_f32 v212, v212, v213
v_cvt_pk_bf16_f32 v213, v214, v215
v_cvt_pk_bf16_f32 v216, v216, v217
v_cvt_pk_bf16_f32 v217, v218, v219
v_cvt_pk_bf16_f32 v220, v220, v221
v_cvt_pk_bf16_f32 v221, v222, v223
v_mfma_f32_16x16x32_bf16 v[232:235], a[184:187], v[40:43], v[232:235]
ds_write_b64 v94, v[192:193] offset:0
v_mfma_f32_16x16x32_bf16 v[232:235], a[216:219], v[44:47], v[232:235]
ds_write_b64 v94, v[196:197] offset:32
v_mfma_f32_16x16x32_bf16 v[236:239], a[220:223], v[44:47], v[236:239]
ds_write_b64 v94, v[200:201] offset:64
v_mfma_f32_16x16x32_bf16 v[236:239], a[188:191], v[40:43], v[236:239]
ds_write_b64 v94, v[204:205] offset:96
v_accvgpr_read_b32 v127, a246
v_accvgpr_read_b32 v126, a247
v_add_f32 v127, v127, v126
v_mfma_f32_16x16x32_bf16 v[240:243], a[192:195], v[40:43], v[240:243]
ds_write_b64 v94, v[208:209] offset:128
v_rcp_f32 v126, v127
v_mfma_f32_16x16x32_bf16 v[240:243], a[224:227], v[44:47], v[240:243]
ds_write_b64 v94, v[212:213] offset:160
v_mfma_f32_16x16x32_bf16 v[244:247], a[228:231], v[44:47], v[244:247]
ds_write_b64 v94, v[216:217] offset:192
v_mfma_f32_16x16x32_bf16 v[244:247], a[196:199], v[40:43], v[244:247]
ds_write_b64 v94, v[220:221] offset:224
v_mfma_f32_16x16x32_bf16 v[248:251], a[200:203], v[40:43], v[248:251]
s_add_u32 s33, s31, 81920
ds_read_b128 a[100:103], v95 offset:0
ds_read_b128 a[104:107], v95 offset:1088
ds_read_b128 a[108:111], v95 offset:2176
ds_read_b128 a[80:83], v95 offset:3264
v_mfma_f32_16x16x32_bf16 v[248:251], a[232:235], v[44:47], v[248:251]
v_add_f32 v100, v100, v125
v_add_f32 v100, v100, v127
v_mfma_f32_16x16x32_bf16 v[252:255], a[236:239], v[44:47], v[252:255]
v_mfma_f32_16x16x32_bf16 v[252:255], a[204:207], v[40:43], v[252:255]
v_pk_mul_f32 v[224:225], v[224:225], v[126:127] op_sel_hi:[1,0]
v_pk_mul_f32 v[226:227], v[226:227], v[126:127] op_sel_hi:[1,0]
v_pk_mul_f32 v[228:229], v[228:229], v[126:127] op_sel_hi:[1,0]
v_pk_mul_f32 v[230:231], v[230:231], v[126:127] op_sel_hi:[1,0]
v_pk_mul_f32 v[232:233], v[232:233], v[126:127] op_sel_hi:[1,0]
v_pk_mul_f32 v[234:235], v[234:235], v[126:127] op_sel_hi:[1,0]
v_pk_mul_f32 v[236:237], v[236:237], v[126:127] op_sel_hi:[1,0]
v_pk_mul_f32 v[238:239], v[238:239], v[126:127] op_sel_hi:[1,0]
v_pk_mul_f32 v[240:241], v[240:241], v[126:127] op_sel_hi:[1,0]
v_pk_mul_f32 v[242:243], v[242:243], v[126:127] op_sel_hi:[1,0]
v_pk_mul_f32 v[244:245], v[244:245], v[126:127] op_sel_hi:[1,0]
v_pk_mul_f32 v[246:247], v[246:247], v[126:127] op_sel_hi:[1,0]
v_pk_mul_f32 v[248:249], v[248:249], v[126:127] op_sel_hi:[1,0]
v_pk_mul_f32 v[250:251], v[250:251], v[126:127] op_sel_hi:[1,0]
v_pk_mul_f32 v[252:253], v[252:253], v[126:127] op_sel_hi:[1,0]
v_pk_mul_f32 v[254:255], v[254:255], v[126:127] op_sel_hi:[1,0]
v_cvt_pk_bf16_f32 v224, v224, v225
v_cvt_pk_bf16_f32 v225, v226, v227
v_cvt_pk_bf16_f32 v228, v228, v229
v_cvt_pk_bf16_f32 v229, v230, v231
v_cvt_pk_bf16_f32 v232, v232, v233
v_cvt_pk_bf16_f32 v233, v234, v235
v_cvt_pk_bf16_f32 v236, v236, v237
v_cvt_pk_bf16_f32 v237, v238, v239
v_cvt_pk_bf16_f32 v240, v240, v241
v_cvt_pk_bf16_f32 v241, v242, v243
v_cvt_pk_bf16_f32 v244, v244, v245
v_cvt_pk_bf16_f32 v245, v246, v247
v_cvt_pk_bf16_f32 v248, v248, v249
v_cvt_pk_bf16_f32 v249, v250, v251
v_cvt_pk_bf16_f32 v252, v252, v253
v_cvt_pk_bf16_f32 v253, v254, v255
s_waitcnt lgkmcnt(3)
buffer_store_dwordx4 a[100:103], v96, s[16:19], s33 offen offset:0 nt
s_waitcnt lgkmcnt(2)
buffer_store_dwordx4 a[104:107], v96, s[16:19], s33 offen offset:1024 nt
s_waitcnt lgkmcnt(1)
buffer_store_dwordx4 a[108:111], v96, s[16:19], s33 offen offset:2048 nt
s_waitcnt lgkmcnt(0)
buffer_store_dwordx4 a[80:83], v96, s[16:19], s33 offen offset:3072 nt
ds_write_b64 v94, v[224:225] offset:4352
ds_write_b64 v94, v[228:229] offset:4384
ds_write_b64 v94, v[232:233] offset:4416
ds_write_b64 v94, v[236:237] offset:4448
ds_write_b64 v94, v[240:241] offset:4480
ds_write_b64 v94, v[244:245] offset:4512
ds_write_b64 v94, v[248:249] offset:4544
ds_write_b64 v94, v[252:253] offset:4576
s_add_u32 s33, s31, 86016
ds_read_b128 a[84:87], v95 offset:4352
ds_read_b128 a[88:91], v95 offset:5440
ds_read_b128 a[92:95], v95 offset:6528
ds_read_b128 a[96:99], v95 offset:7616
v_cmp_ngt_f32 vcc, s35, v100
v_mov_b32 v100, 0
s_cmp_lg_u64 vcc, 0
s_cselect_b32 s40, 2, 0
s_or_b32 s30, s30, s40
s_waitcnt lgkmcnt(3)
buffer_store_dwordx4 a[84:87], v96, s[16:19], s33 offen offset:0 nt
s_waitcnt lgkmcnt(2)
buffer_store_dwordx4 a[88:91], v96, s[16:19], s33 offen offset:1024 nt
s_waitcnt lgkmcnt(1)
buffer_store_dwordx4 a[92:95], v96, s[16:19], s33 offen offset:2048 nt
s_waitcnt lgkmcnt(0)
buffer_store_dwordx4 a[96:99], v96, s[16:19], s33 offen offset:3072 nt
s_lshl_b32 s40, s20, 2
s_add_u32 s40, s40, 115456
v_mov_b32 v0, s40
v_mov_b32 v1, s30
v_mov_b32 v2, 115456
ds_write_b32 v0, v1
s_waitcnt lgkmcnt(0)
s_barrier
ds_read_b128 v[4:7], v2
s_waitcnt lgkmcnt(0)
v_or3_b32 v4, v4, v5, v6
v_or_b32 v4, v4, v7
s_nop 0
v_readfirstlane_b32 s29, v4
s_nop 3
s_cmp_eq_u32 s29, 0
s_cbranch_scc0 L_redo0
L_done:
L_end:
s_endpgm
L_hot_end:
L_redo0:
v_mov_b32 v140, v96
L_redo:
s_ff1_i32_b32 s27, s29
s_bitset0_b32 s29, s27
s_waitcnt vmcnt(0) lgkmcnt(0)
s_barrier
v_lshrrev_b32 v0, 4, v140
v_and_b32 v1, 7, v0
v_mul_u32_u24 v1, 1056, v1
v_bfe_u32 v2, v0, 3, 1
v_lshl_add_u32 v1, v2, 8, v1
v_lshrrev_b32 v2, 4, v0
v_lshl_add_u32 v136, v2, 4, v1
v_bfe_u32 v1, v0, 2, 3
v_mul_u32_u24 v1, 1056, v1
v_lshrrev_b32 v2, 5, v0
v_lshl_add_u32 v1, v2, 8, v1
v_and_b32 v2, 3, v0
v_lshl_add_u32 v1, v2, 3, v1
v_add_u32 v138, 16896, v1
v_and_b32 v1, 15, v0
v_lshrrev_b32 v2, 4, v0
v_lshlrev_b32 v3, 8, v1
v_lshl_add_u32 v141, v2, 4, v3
v_lshl_add_u32 v142, v2, 3, v3
v_mov_b32 v144, 0x3f803f80
v_mov_b32 v145, 0x3f803f80
v_mov_b32 v146, 0x3f803f80
v_mov_b32 v147, 0x3f803f80
s_mul_i32 s53, s27, 73728
s_add_u32 s54, s53, s32
s_add_u32 s53, s53, s31
s_mul_i32 s51, s20, 4224
s_add_u32 s55, s53, 0
buffer_load_dwordx4 v[0:3], v141, s[4:7], s55 offen offset:0
buffer_load_dwordx4 v[4:7], v141, s[4:7], s55 offen offset:64
buffer_load_dwordx4 v[8:11], v141, s[4:7], s55 offen offset:128
buffer_load_dwordx4 v[12:15], v141, s[4:7], s55 offen offset:192
s_add_u32 s55, s53, 4096
buffer_load_dwordx4 v[16:19], v141, s[4:7], s55 offen offset:0
buffer_load_dwordx4 v[20:23], v141, s[4:7], s55 offen offset:64
buffer_load_dwordx4 v[24:27], v141, s[4:7], s55 offen offset:128
buffer_load_dwordx4 v[28:31], v141, s[4:7], s55 offen offset:192
s_add_u32 s55, s53, 8192
buffer_load_dwordx4 v[32:35], v141, s[4:7], s55 offen offset:0
buffer_load_dwordx4 v[36:39], v141, s[4:7], s55 offen offset:64
buffer_load_dwordx4 v[40:43], v141, s[4:7], s55 offen offset:128
buffer_load_dwordx4 v[44:47], v141, s[4:7], s55 offen offset:192
s_add_u32 s55, s53, 12288
buffer_load_dwordx4 v[48:51], v141, s[4:7], s55 offen offset:0
buffer_load_dwordx4 v[52:55], v141, s[4:7], s55 offen offset:64
buffer_load_dwordx4 v[56:59], v141, s[4:7], s55 offen offset:128
buffer_load_dwordx4 v[60:63], v141, s[4:7], s55 offen offset:192
s_add_u32 s55, s54, 0
buffer_load_dwordx4 v[64:67], v141, s[4:7], s55 offen offset:0
buffer_load_dwordx4 v[68:71], v141, s[4:7], s55 offen offset:64
buffer_load_dwordx4 v[72:75], v141, s[4:7], s55 offen offset:128
buffer_load_dwordx4 v[76:79], v141, s[4:7], s55 offen offset:192
s_waitcnt vmcnt(0)
v_lshlrev_b32 v80, 16, v0
v_and_b32 v0, s36, v0
v_mul_f32 v80, s38, v80
v_mul_f32 v0, s38, v0
v_cvt_pk_bf16_f32 v0, v80, v0
v_lshlrev_b32 v80, 16, v1
v_and_b32 v1, s36, v1
v_mul_f32 v80, s38, v80
v_mul_f32 v1, s38, v1
v_cvt_pk_bf16_f32 v1, v80, v1
v_lshlrev_b32 v80, 16, v2
v_and_b32 v2, s36, v2
v_mul_f32 v80, s38, v80
v_mul_f32 v2, s38, v2
v_cvt_pk_bf16_f32 v2, v80, v2
v_lshlrev_b32 v80, 16, v3
v_and_b32 v3, s36, v3
v_mul_f32 v80, s38, v80
v_mul_f32 v3, s38, v3
v_cvt_pk_bf16_f32 v3, v80, v3
v_lshlrev_b32 v80, 16, v4
v_and_b32 v4, s36, v4
v_mul_f32 v80, s38, v80
v_mul_f32 v4, s38, v4
v_cvt_pk_bf16_f32 v4, v80, v4
v_lshlrev_b32 v80, 16, v5
v_and_b32 v5, s36, v5
v_mul_f32 v80, s38, v80
v_mul_f32 v5, s38, v5
v_cvt_pk_bf16_f32 v5, v80, v5
v_lshlrev_b32 v80, 16, v6
v_and_b32 v6, s36, v6
v_mul_f32 v80, s38, v80
v_mul_f32 v6, s38, v6
v_cvt_pk_bf16_f32 v6, v80, v6
v_lshlrev_b32 v80, 16, v7
v_and_b32 v7, s36, v7
v_mul_f32 v80, s38, v80
v_mul_f32 v7, s38, v7
v_cvt_pk_bf16_f32 v7, v80, v7
v_lshlrev_b32 v80, 16, v8
v_and_b32 v8, s36, v8
v_mul_f32 v80, s38, v80
v_mul_f32 v8, s38, v8
v_cvt_pk_bf16_f32 v8, v80, v8
v_lshlrev_b32 v80, 16, v9
v_and_b32 v9, s36, v9
v_mul_f32 v80, s38, v80
v_mul_f32 v9, s38, v9
v_cvt_pk_bf16_f32 v9, v80, v9
v_lshlrev_b32 v80, 16, v10
v_and_b32 v10, s36, v10
v_mul_f32 v80, s38, v80
v_mul_f32 v10, s38, v10
v_cvt_pk_bf16_f32 v10, v80, v10
v_lshlrev_b32 v80, 16, v11
v_and_b32 v11, s36, v11
v_mul_f32 v80, s38, v80
v_mul_f32 v11, s38, v11
v_cvt_pk_bf16_f32 v11, v80, v11
v_lshlrev_b32 v80, 16, v12
v_and_b32 v12, s36, v12
v_mul_f32 v80, s38, v80
v_mul_f32 v12, s38, v12
v_cvt_pk_bf16_f32 v12, v80, v12
v_lshlrev_b32 v80, 16, v13
v_and_b32 v13, s36, v13
v_mul_f32 v80, s38, v80
v_mul_f32 v13, s38, v13
v_cvt_pk_bf16_f32 v13, v80, v13
v_lshlrev_b32 v80, 16, v14
v_and_b32 v14, s36, v14
v_mul_f32 v80, s38, v80
v_mul_f32 v14, s38, v14
v_cvt_pk_bf16_f32 v14, v80, v14
v_lshlrev_b32 v80, 16, v15
v_and_b32 v15, s36, v15
v_mul_f32 v80, s38, v80
v_mul_f32 v15, s38, v15
v_cvt_pk_bf16_f32 v15, v80, v15
v_lshlrev_b32 v80, 16, v16
v_and_b32 v16, s36, v16
v_mul_f32 v80, s38, v80
v_mul_f32 v16, s38, v16
v_cvt_pk_bf16_f32 v16, v80, v16
v_lshlrev_b32 v80, 16, v17
v_and_b32 v17, s36, v17
v_mul_f32 v80, s38, v80
v_mul_f32 v17, s38, v17
v_cvt_pk_bf16_f32 v17, v80, v17
v_lshlrev_b32 v80, 16, v18
v_and_b32 v18, s36, v18
v_mul_f32 v80, s38, v80
v_mul_f32 v18, s38, v18
v_cvt_pk_bf16_f32 v18, v80, v18
v_lshlrev_b32 v80, 16, v19
v_and_b32 v19, s36, v19
v_mul_f32 v80, s38, v80
v_mul_f32 v19, s38, v19
v_cvt_pk_bf16_f32 v19, v80, v19
v_lshlrev_b32 v80, 16, v20
v_and_b32 v20, s36, v20
v_mul_f32 v80, s38, v80
v_mul_f32 v20, s38, v20
v_cvt_pk_bf16_f32 v20, v80, v20
v_lshlrev_b32 v80, 16, v21
v_and_b32 v21, s36, v21
v_mul_f32 v80, s38, v80
v_mul_f32 v21, s38, v21
v_cvt_pk_bf16_f32 v21, v80, v21
v_lshlrev_b32 v80, 16, v22
v_and_b32 v22, s36, v22
v_mul_f32 v80, s38, v80
v_mul_f32 v22, s38, v22
v_cvt_pk_bf16_f32 v22, v80, v22
v_lshlrev_b32 v80, 16, v23
v_and_b32 v23, s36, v23
v_mul_f32 v80, s38, v80
v_mul_f32 v23, s38, v23
v_cvt_pk_bf16_f32 v23, v80, v23
v_lshlrev_b32 v80, 16, v24
v_and_b32 v24, s36, v24
v_mul_f32 v80, s38, v80
v_mul_f32 v24, s38, v24
v_cvt_pk_bf16_f32 v24, v80, v24
v_lshlrev_b32 v80, 16, v25
v_and_b32 v25, s36, v25
v_mul_f32 v80, s38, v80
v_mul_f32 v25, s38, v25
v_cvt_pk_bf16_f32 v25, v80, v25
v_lshlrev_b32 v80, 16, v26
v_and_b32 v26, s36, v26
v_mul_f32 v80, s38, v80
v_mul_f32 v26, s38, v26
v_cvt_pk_bf16_f32 v26, v80, v26
v_lshlrev_b32 v80, 16, v27
v_and_b32 v27, s36, v27
v_mul_f32 v80, s38, v80
v_mul_f32 v27, s38, v27
v_cvt_pk_bf16_f32 v27, v80, v27
v_lshlrev_b32 v80, 16, v28
v_and_b32 v28, s36, v28
v_mul_f32 v80, s38, v80
v_mul_f32 v28, s38, v28
v_cvt_pk_bf16_f32 v28, v80, v28
v_lshlrev_b32 v80, 16, v29
v_and_b32 v29, s36, v29
v_mul_f32 v80, s38, v80
v_mul_f32 v29, s38, v29
v_cvt_pk_bf16_f32 v29, v80, v29
v_lshlrev_b32 v80, 16, v30
v_and_b32 v30, s36, v30
v_mul_f32 v80, s38, v80
v_mul_f32 v30, s38, v30
v_cvt_pk_bf16_f32 v30, v80, v30
v_lshlrev_b32 v80, 16, v31
v_and_b32 v31, s36, v31
v_mul_f32 v80, s38, v80
v_mul_f32 v31, s38, v31
v_cvt_pk_bf16_f32 v31, v80, v31
v_lshlrev_b32 v80, 16, v32
v_and_b32 v32, s36, v32
v_mul_f32 v80, s38, v80
v_mul_f32 v32, s38, v32
v_cvt_pk_bf16_f32 v32, v80, v32
v_lshlrev_b32 v80, 16, v33
v_and_b32 v33, s36, v33
v_mul_f32 v80, s38, v80
v_mul_f32 v33, s38, v33
v_cvt_pk_bf16_f32 v33, v80, v33
v_lshlrev_b32 v80, 16, v34
v_and_b32 v34, s36, v34
v_mul_f32 v80, s38, v80
v_mul_f32 v34, s38, v34
v_cvt_pk_bf16_f32 v34, v80, v34
v_lshlrev_b32 v80, 16, v35
v_and_b32 v35, s36, v35
v_mul_f32 v80, s38, v80
v_mul_f32 v35, s38, v35
v_cvt_pk_bf16_f32 v35, v80, v35
v_lshlrev_b32 v80, 16, v36
v_and_b32 v36, s36, v36
v_mul_f32 v80, s38, v80
v_mul_f32 v36, s38, v36
v_cvt_pk_bf16_f32 v36, v80, v36
v_lshlrev_b32 v80, 16, v37
v_and_b32 v37, s36, v37
v_mul_f32 v80, s38, v80
v_mul_f32 v37, s38, v37
v_cvt_pk_bf16_f32 v37, v80, v37
v_lshlrev_b32 v80, 16, v38
v_and_b32 v38, s36, v38
v_mul_f32 v80, s38, v80
v_mul_f32 v38, s38, v38
v_cvt_pk_bf16_f32 v38, v80, v38
v_lshlrev_b32 v80, 16, v39
v_and_b32 v39, s36, v39
v_mul_f32 v80, s38, v80
v_mul_f32 v39, s38, v39
v_cvt_pk_bf16_f32 v39, v80, v39
v_lshlrev_b32 v80, 16, v40
v_and_b32 v40, s36, v40
v_mul_f32 v80, s38, v80
v_mul_f32 v40, s38, v40
v_cvt_pk_bf16_f32 v40, v80, v40
v_lshlrev_b32 v80, 16, v41
v_and_b32 v41, s36, v41
v_mul_f32 v80, s38, v80
v_mul_f32 v41, s38, v41
v_cvt_pk_bf16_f32 v41, v80, v41
v_lshlrev_b32 v80, 16, v42
v_and_b32 v42, s36, v42
v_mul_f32 v80, s38, v80
v_mul_f32 v42, s38, v42
v_cvt_pk_bf16_f32 v42, v80, v42
v_lshlrev_b32 v80, 16, v43
v_and_b32 v43, s36, v43
v_mul_f32 v80, s38, v80
v_mul_f32 v43, s38, v43
v_cvt_pk_bf16_f32 v43, v80, v43
v_lshlrev_b32 v80, 16, v44
v_and_b32 v44, s36, v44
v_mul_f32 v80, s38, v80
v_mul_f32 v44, s38, v44
v_cvt_pk_bf16_f32 v44, v80, v44
v_lshlrev_b32 v80, 16, v45
v_and_b32 v45, s36, v45
v_mul_f32 v80, s38, v80
v_mul_f32 v45, s38, v45
v_cvt_pk_bf16_f32 v45, v80, v45
v_lshlrev_b32 v80, 16, v46
v_and_b32 v46, s36, v46
v_mul_f32 v80, s38, v80
v_mul_f32 v46, s38, v46
v_cvt_pk_bf16_f32 v46, v80, v46
v_lshlrev_b32 v80, 16, v47
v_and_b32 v47, s36, v47
v_mul_f32 v80, s38, v80
v_mul_f32 v47, s38, v47
v_cvt_pk_bf16_f32 v47, v80, v47
v_lshlrev_b32 v80, 16, v48
v_and_b32 v48, s36, v48
v_mul_f32 v80, s38, v80
v_mul_f32 v48, s38, v48
v_cvt_pk_bf16_f32 v48, v80, v48
v_lshlrev_b32 v80, 16, v49
v_and_b32 v49, s36, v49
v_mul_f32 v80, s38, v80
v_mul_f32 v49, s38, v49
v_cvt_pk_bf16_f32 v49, v80, v49
v_lshlrev_b32 v80, 16, v50
v_and_b32 v50, s36, v50
v_mul_f32 v80, s38, v80
v_mul_f32 v50, s38, v50
v_cvt_pk_bf16_f32 v50, v80, v50
v_lshlrev_b32 v80, 16, v51
v_and_b32 v51, s36, v51
v_mul_f32 v80, s38, v80
v_mul_f32 v51, s38, v51
v_cvt_pk_bf16_f32 v51, v80, v51
v_lshlrev_b32 v80, 16, v52
v_and_b32 v52, s36, v52
v_mul_f32 v80, s38, v80
v_mul_f32 v52, s38, v52
v_cvt_pk_bf16_f32 v52, v80, v52
v_lshlrev_b32 v80, 16, v53
v_and_b32 v53, s36, v53
v_mul_f32 v80, s38, v80
v_mul_f32 v53, s38, v53
v_cvt_pk_bf16_f32 v53, v80, v53
v_lshlrev_b32 v80, 16, v54
v_and_b32 v54, s36, v54
v_mul_f32 v80, s38, v80
v_mul_f32 v54, s38, v54
v_cvt_pk_bf16_f32 v54, v80, v54
v_lshlrev_b32 v80, 16, v55
v_and_b32 v55, s36, v55
v_mul_f32 v80, s38, v80
v_mul_f32 v55, s38, v55
v_cvt_pk_bf16_f32 v55, v80, v55
v_lshlrev_b32 v80, 16, v56
v_and_b32 v56, s36, v56
v_mul_f32 v80, s38, v80
v_mul_f32 v56, s38, v56
v_cvt_pk_bf16_f32 v56, v80, v56
v_lshlrev_b32 v80, 16, v57
v_and_b32 v57, s36, v57
v_mul_f32 v80, s38, v80
v_mul_f32 v57, s38, v57
v_cvt_pk_bf16_f32 v57, v80, v57
v_lshlrev_b32 v80, 16, v58
v_and_b32 v58, s36, v58
v_mul_f32 v80, s38, v80
v_mul_f32 v58, s38, v58
v_cvt_pk_bf16_f32 v58, v80, v58
v_lshlrev_b32 v80, 16, v59
v_and_b32 v59, s36, v59
v_mul_f32 v80, s38, v80
v_mul_f32 v59, s38, v59
v_cvt_pk_bf16_f32 v59, v80, v59
v_lshlrev_b32 v80, 16, v60
v_and_b32 v60, s36, v60
v_mul_f32 v80, s38, v80
v_mul_f32 v60, s38, v60
v_cvt_pk_bf16_f32 v60, v80, v60
v_lshlrev_b32 v80, 16, v61
v_and_b32 v61, s36, v61
v_mul_f32 v80, s38, v80
v_mul_f32 v61, s38, v61
v_cvt_pk_bf16_f32 v61, v80, v61
v_lshlrev_b32 v80, 16, v62
v_and_b32 v62, s36, v62
v_mul_f32 v80, s38, v80
v_mul_f32 v62, s38, v62
v_cvt_pk_bf16_f32 v62, v80, v62
v_lshlrev_b32 v80, 16, v63
v_and_b32 v63, s36, v63
v_mul_f32 v80, s38, v80
v_mul_f32 v63, s38, v63
v_cvt_pk_bf16_f32 v63, v80, v63
v_lshlrev_b32 v80, 16, v64
v_and_b32 v64, s36, v64
v_mul_f32 v80, s38, v80
v_mul_f32 v64, s38, v64
v_cvt_pk_bf16_f32 v64, v80, v64
v_lshlrev_b32 v80, 16, v65
v_and_b32 v65, s36, v65
v_mul_f32 v80, s38, v80
v_mul_f32 v65, s38, v65
v_cvt_pk_bf16_f32 v65, v80, v65
v_lshlrev_b32 v80, 16, v66
v_and_b32 v66, s36, v66
v_mul_f32 v80, s38, v80
v_mul_f32 v66, s38, v66
v_cvt_pk_bf16_f32 v66, v80, v66
v_lshlrev_b32 v80, 16, v67
v_and_b32 v67, s36, v67
v_mul_f32 v80, s38, v80
v_mul_f32 v67, s38, v67
v_cvt_pk_bf16_f32 v67, v80, v67
v_lshlrev_b32 v80, 16, v68
v_and_b32 v68, s36, v68
v_mul_f32 v80, s38, v80
v_mul_f32 v68, s38, v68
v_cvt_pk_bf16_f32 v68, v80, v68
v_lshlrev_b32 v80, 16, v69
v_and_b32 v69, s36, v69
v_mul_f32 v80, s38, v80
v_mul_f32 v69, s38, v69
v_cvt_pk_bf16_f32 v69, v80, v69
v_lshlrev_b32 v80, 16, v70
v_and_b32 v70, s36, v70
v_mul_f32 v80, s38, v80
v_mul_f32 v70, s38, v70
v_cvt_pk_bf16_f32 v70, v80, v70
v_lshlrev_b32 v80, 16, v71
v_and_b32 v71, s36, v71
v_mul_f32 v80, s38, v80
v_mul_f32 v71, s38, v71
v_cvt_pk_bf16_f32 v71, v80, v71
v_lshlrev_b32 v80, 16, v72
v_and_b32 v72, s36, v72
v_mul_f32 v80, s38, v80
v_mul_f32 v72, s38, v72
v_cvt_pk_bf16_f32 v72, v80, v72
v_lshlrev_b32 v80, 16, v73
v_and_b32 v73, s36, v73
v_mul_f32 v80, s38, v80
v_mul_f32 v73, s38, v73
v_cvt_pk_bf16_f32 v73, v80, v73
v_lshlrev_b32 v80, 16, v74
v_and_b32 v74, s36, v74
v_mul_f32 v80, s38, v80
v_mul_f32 v74, s38, v74
v_cvt_pk_bf16_f32 v74, v80, v74
v_lshlrev_b32 v80, 16, v75
v_and_b32 v75, s36, v75
v_mul_f32 v80, s38, v80
v_mul_f32 v75, s38, v75
v_cvt_pk_bf16_f32 v75, v80, v75
v_lshlrev_b32 v80, 16, v76
v_and_b32 v76, s36, v76
v_mul_f32 v80, s38, v80
v_mul_f32 v76, s38, v76
v_cvt_pk_bf16_f32 v76, v80, v76
v_lshlrev_b32 v80, 16, v77
v_and_b32 v77, s36, v77
v_mul_f32 v80, s38, v80
v_mul_f32 v77, s38, v77
v_cvt_pk_bf16_f32 v77, v80, v77
v_lshlrev_b32 v80, 16, v78
v_and_b32 v78, s36, v78
v_mul_f32 v80, s38, v80
v_mul_f32 v78, s38, v78
v_cvt_pk_bf16_f32 v78, v80, v78
v_lshlrev_b32 v80, 16, v79
v_and_b32 v79, s36, v79
v_mul_f32 v80, s38, v80
v_mul_f32 v79, s38, v79
v_cvt_pk_bf16_f32 v79, v80, v79
v_mov_b32 v104, 0xff800000
v_mov_b32 v105, 0xff800000
v_mov_b32 v106, 0xff800000
v_mov_b32 v107, 0xff800000
v_mov_b32 v108, 0xff800000
s_lshl_b32 s50, s27, 18
s_lshl_b32 s52, s20, 12
s_add_u32 s50, s50, s52
s_mov_b32 s52, 0
L_fb1:
s_add_u32 m0, s51, 0
s_nop 0
buffer_load_dwordx4 v140, s[8:11], s50 offen offset:0 lds
s_add_u32 m0, s51, 32
s_nop 0
buffer_load_dwordx4 v140, s[8:11], s50 offen offset:1024 lds
s_add_u32 m0, s51, 64
s_nop 0
buffer_load_dwordx4 v140, s[8:11], s50 offen offset:2048 lds
s_add_u32 m0, s51, 96
s_nop 0
buffer_load_dwordx4 v140, s[8:11], s50 offen offset:3072 lds
s_waitcnt vmcnt(0)
s_barrier
ds_read_b128 a[180:183], v136 offset:0
ds_read_b128 a[184:187], v136 offset:64
ds_read_b128 a[188:191], v136 offset:128
ds_read_b128 a[192:195], v136 offset:192
ds_read_b128 a[196:199], v136 offset:512
ds_read_b128 a[200:203], v136 offset:576
ds_read_b128 a[204:207], v136 offset:640
ds_read_b128 a[208:211], v136 offset:704
s_waitcnt lgkmcnt(0)
v_mfma_f32_16x16x32_bf16 v[80:83], a[180:183], v[0:3], 0
v_mfma_f32_16x16x32_bf16 v[80:83], a[184:187], v[4:7], v[80:83]
v_mfma_f32_16x16x32_bf16 v[80:83], a[188:191], v[8:11], v[80:83]
v_mfma_f32_16x16x32_bf16 v[80:83], a[192:195], v[12:15], v[80:83]
v_mfma_f32_16x16x32_bf16 v[84:87], a[180:183], v[16:19], 0
v_mfma_f32_16x16x32_bf16 v[84:87], a[184:187], v[20:23], v[84:87]
v_mfma_f32_16x16x32_bf16 v[84:87], a[188:191], v[24:27], v[84:87]
v_mfma_f32_16x16x32_bf16 v[84:87], a[192:195], v[28:31], v[84:87]
v_mfma_f32_16x16x32_bf16 v[88:91], a[180:183], v[32:35], 0
v_mfma_f32_16x16x32_bf16 v[88:91], a[184:187], v[36:39], v[88:91]
v_mfma_f32_16x16x32_bf16 v[88:91], a[188:191], v[40:43], v[88:91]
v_mfma_f32_16x16x32_bf16 v[88:91], a[192:195], v[44:47], v[88:91]
v_mfma_f32_16x16x32_bf16 v[92:95], a[180:183], v[48:51], 0
v_mfma_f32_16x16x32_bf16 v[92:95], a[184:187], v[52:55], v[92:95]
v_mfma_f32_16x16x32_bf16 v[92:95], a[188:191], v[56:59], v[92:95]
v_mfma_f32_16x16x32_bf16 v[92:95], a[192:195], v[60:63], v[92:95]
v_mfma_f32_16x16x32_bf16 v[96:99], a[180:183], v[64:67], 0
v_mfma_f32_16x16x32_bf16 v[96:99], a[184:187], v[68:71], v[96:99]
v_mfma_f32_16x16x32_bf16 v[96:99], a[188:191], v[72:75], v[96:99]
v_mfma_f32_16x16x32_bf16 v[96:99], a[192:195], v[76:79], v[96:99]
s_nop 7
v_max3_f32 v104, v104, v80, v81
v_max3_f32 v104, v104, v82, v83
v_max3_f32 v105, v105, v84, v85
v_max3_f32 v105, v105, v86, v87
v_max3_f32 v106, v106, v88, v89
v_max3_f32 v106, v106, v90, v91
v_max3_f32 v107, v107, v92, v93
v_max3_f32 v107, v107, v94, v95
v_max3_f32 v108, v108, v96, v97
v_max3_f32 v108, v108, v98, v99
v_mfma_f32_16x16x32_bf16 v[80:83], a[196:199], v[0:3], 0
v_mfma_f32_16x16x32_bf16 v[80:83], a[200:203], v[4:7], v[80:83]
v_mfma_f32_16x16x32_bf16 v[80:83], a[204:207], v[8:11], v[80:83]
v_mfma_f32_16x16x32_bf16 v[80:83], a[208:211], v[12:15], v[80:83]
v_mfma_f32_16x16x32_bf16 v[84:87], a[196:199], v[16:19], 0
v_mfma_f32_16x16x32_bf16 v[84:87], a[200:203], v[20:23], v[84:87]
v_mfma_f32_16x16x32_bf16 v[84:87], a[204:207], v[24:27], v[84:87]
v_mfma_f32_16x16x32_bf16 v[84:87], a[208:211], v[28:31], v[84:87]
v_mfma_f32_16x16x32_bf16 v[88:91], a[196:199], v[32:35], 0
v_mfma_f32_16x16x32_bf16 v[88:91], a[200:203], v[36:39], v[88:91]
v_mfma_f32_16x16x32_bf16 v[88:91], a[204:207], v[40:43], v[88:91]
v_mfma_f32_16x16x32_bf16 v[88:91], a[208:211], v[44:47], v[88:91]
v_mfma_f32_16x16x32_bf16 v[92:95], a[196:199], v[48:51], 0
v_mfma_f32_16x16x32_bf16 v[92:95], a[200:203], v[52:55], v[92:95]
v_mfma_f32_16x16x32_bf16 v[92:95], a[204:207], v[56:59], v[92:95]
v_mfma_f32_16x16x32_bf16 v[92:95], a[208:211], v[60:63], v[92:95]
v_mfma_f32_16x16x32_bf16 v[96:99], a[196:199], v[64:67], 0
v_mfma_f32_16x16x32_bf16 v[96:99], a[200:203], v[68:71], v[96:99]
v_mfma_f32_16x16x32_bf16 v[96:99], a[204:207], v[72:75], v[96:99]
v_mfma_f32_16x16x32_bf16 v[96:99], a[208:211], v[76:79], v[96:99]
s_nop 7
v_max3_f32 v104, v104, v80, v81
v_max3_f32 v104, v104, v82, v83
v_max3_f32 v105, v105, v84, v85
v_max3_f32 v105, v105, v86, v87
v_max3_f32 v106, v106, v88, v89
v_max3_f32 v106, v106, v90, v91
v_max3_f32 v107, v107, v92, v93
v_max3_f32 v107, v107, v94, v95
v_max3_f32 v108, v108, v96, v97
v_max3_f32 v108, v108, v98, v99
ds_read_b128 a[180:183], v136 offset:8448
ds_read_b128 a[184:187], v136 offset:8512
ds_read_b128 a[188:191], v136 offset:8576
ds_read_b128 a[192:195], v136 offset:8640
ds_read_b128 a[196:199], v136 offset:8960
ds_read_b128 a[200:203], v136 offset:9024
ds_read_b128 a[204:207], v136 offset:9088
ds_read_b128 a[208:211], v136 offset:9152
s_waitcnt lgkmcnt(0)
v_mfma_f32_16x16x32_bf16 v[80:83], a[180:183], v[0:3], 0
v_mfma_f32_16x16x32_bf16 v[80:83], a[184:187], v[4:7], v[80:83]
v_mfma_f32_16x16x32_bf16 v[80:83], a[188:191], v[8:11], v[80:83]
v_mfma_f32_16x16x32_bf16 v[80:83], a[192:195], v[12:15], v[80:83]
v_mfma_f32_16x16x32_bf16 v[84:87], a[180:183], v[16:19], 0
v_mfma_f32_16x16x32_bf16 v[84:87], a[184:187], v[20:23], v[84:87]
v_mfma_f32_16x16x32_bf16 v[84:87], a[188:191], v[24:27], v[84:87]
v_mfma_f32_16x16x32_bf16 v[84:87], a[192:195], v[28:31], v[84:87]
v_mfma_f32_16x16x32_bf16 v[88:91], a[180:183], v[32:35], 0
v_mfma_f32_16x16x32_bf16 v[88:91], a[184:187], v[36:39], v[88:91]
v_mfma_f32_16x16x32_bf16 v[88:91], a[188:191], v[40:43], v[88:91]
v_mfma_f32_16x16x32_bf16 v[88:91], a[192:195], v[44:47], v[88:91]
v_mfma_f32_16x16x32_bf16 v[92:95], a[180:183], v[48:51], 0
v_mfma_f32_16x16x32_bf16 v[92:95], a[184:187], v[52:55], v[92:95]
v_mfma_f32_16x16x32_bf16 v[92:95], a[188:191], v[56:59], v[92:95]
v_mfma_f32_16x16x32_bf16 v[92:95], a[192:195], v[60:63], v[92:95]
v_mfma_f32_16x16x32_bf16 v[96:99], a[180:183], v[64:67], 0
v_mfma_f32_16x16x32_bf16 v[96:99], a[184:187], v[68:71], v[96:99]
v_mfma_f32_16x16x32_bf16 v[96:99], a[188:191], v[72:75], v[96:99]
v_mfma_f32_16x16x32_bf16 v[96:99], a[192:195], v[76:79], v[96:99]
s_nop 7
v_max3_f32 v104, v104, v80, v81
v_max3_f32 v104, v104, v82, v83
v_max3_f32 v105, v105, v84, v85
v_max3_f32 v105, v105, v86, v87
v_max3_f32 v106, v106, v88, v89
v_max3_f32 v106, v106, v90, v91
v_max3_f32 v107, v107, v92, v93
v_max3_f32 v107, v107, v94, v95
v_max3_f32 v108, v108, v96, v97
v_max3_f32 v108, v108, v98, v99
v_mfma_f32_16x16x32_bf16 v[80:83], a[196:199], v[0:3], 0
v_mfma_f32_16x16x32_bf16 v[80:83], a[200:203], v[4:7], v[80:83]
v_mfma_f32_16x16x32_bf16 v[80:83], a[204:207], v[8:11], v[80:83]
v_mfma_f32_16x16x32_bf16 v[80:83], a[208:211], v[12:15], v[80:83]
v_mfma_f32_16x16x32_bf16 v[84:87], a[196:199], v[16:19], 0
v_mfma_f32_16x16x32_bf16 v[84:87], a[200:203], v[20:23], v[84:87]
v_mfma_f32_16x16x32_bf16 v[84:87], a[204:207], v[24:27], v[84:87]
v_mfma_f32_16x16x32_bf16 v[84:87], a[208:211], v[28:31], v[84:87]
v_mfma_f32_16x16x32_bf16 v[88:91], a[196:199], v[32:35], 0
v_mfma_f32_16x16x32_bf16 v[88:91], a[200:203], v[36:39], v[88:91]
v_mfma_f32_16x16x32_bf16 v[88:91], a[204:207], v[40:43], v[88:91]
v_mfma_f32_16x16x32_bf16 v[88:91], a[208:211], v[44:47], v[88:91]
v_mfma_f32_16x16x32_bf16 v[92:95], a[196:199], v[48:51], 0
v_mfma_f32_16x16x32_bf16 v[92:95], a[200:203], v[52:55], v[92:95]
v_mfma_f32_16x16x32_bf16 v[92:95], a[204:207], v[56:59], v[92:95]
v_mfma_f32_16x16x32_bf16 v[92:95], a[208:211], v[60:63], v[92:95]
v_mfma_f32_16x16x32_bf16 v[96:99], a[196:199], v[64:67], 0
v_mfma_f32_16x16x32_bf16 v[96:99], a[200:203], v[68:71], v[96:99]
v_mfma_f32_16x16x32_bf16 v[96:99], a[204:207], v[72:75], v[96:99]
v_mfma_f32_16x16x32_bf16 v[96:99], a[208:211], v[76:79], v[96:99]
s_nop 7
v_max3_f32 v104, v104, v80, v81
v_max3_f32 v104, v104, v82, v83
v_max3_f32 v105, v105, v84, v85
v_max3_f32 v105, v105, v86, v87
v_max3_f32 v106, v106, v88, v89
v_max3_f32 v106, v106, v90, v91
v_max3_f32 v107, v107, v92, v93
v_max3_f32 v107, v107, v94, v95
v_max3_f32 v108, v108, v96, v97
v_max3_f32 v108, v108, v98, v99
s_barrier
s_add_u32 s50, s50, 16384
s_add_u32 s52, s52, 1
s_cmp_lt_u32 s52, 16
s_cbranch_scc1 L_fb1
v_mov_b32 v109, v104
s_nop 1
v_permlane16_swap_b32 v104, v109
v_max_f32 v104, v104, v109
v_mov_b32 v109, v104
s_nop 1
v_permlane32_swap_b32 v104, v109
v_min_f32_e64 v116, -v104, -v109
v_min_f32_e64 v117, -v104, -v109
v_min_f32_e64 v118, -v104, -v109
v_min_f32_e64 v119, -v104, -v109
v_mov_b32 v110, v105
s_nop 1
v_permlane16_swap_b32 v105, v110
v_max_f32 v105, v105, v110
v_mov_b32 v110, v105
s_nop 1
v_permlane32_swap_b32 v105, v110
v_min_f32_e64 v120, -v105, -v110
v_min_f32_e64 v121, -v105, -v110
v_min_f32_e64 v122, -v105, -v110
v_min_f32_e64 v123, -v105, -v110
v_mov_b32 v111, v106
s_nop 1
v_permlane16_swap_b32 v106, v111
v_max_f32 v106, v106, v111
v_mov_b32 v111, v106
s_nop 1
v_permlane32_swap_b32 v106, v111
v_min_f32_e64 v124, -v106, -v111
v_min_f32_e64 v125, -v106, -v111
v_min_f32_e64 v126, -v106, -v111
v_min_f32_e64 v127, -v106, -v111
v_mov_b32 v112, v107
s_nop 1
v_permlane16_swap_b32 v107, v112
v_max_f32 v107, v107, v112
v_mov_b32 v112, v107
s_nop 1
v_permlane32_swap_b32 v107, v112
v_min_f32_e64 v128, -v107, -v112
v_min_f32_e64 v129, -v107, -v112
v_min_f32_e64 v130, -v107, -v112
v_min_f32_e64 v131, -v107, -v112
v_mov_b32 v113, v108
s_nop 1
v_permlane16_swap_b32 v108, v113
v_max_f32 v108, v108, v113
v_mov_b32 v113, v108
s_nop 1
v_permlane32_swap_b32 v108, v113
v_min_f32_e64 v132, -v108, -v113
v_min_f32_e64 v133, -v108, -v113
v_min_f32_e64 v134, -v108, -v113
v_min_f32_e64 v135, -v108, -v113
v_accvgpr_write_b32 a0, 0
v_accvgpr_write_b32 a1, 0
v_accvgpr_write_b32 a2, 0
v_accvgpr_write_b32 a3, 0
v_accvgpr_write_b32 a4, 0
v_accvgpr_write_b32 a5, 0
v_accvgpr_write_b32 a6, 0
v_accvgpr_write_b32 a7, 0
v_accvgpr_write_b32 a8, 0
v_accvgpr_write_b32 a9, 0
v_accvgpr_write_b32 a10, 0
v_accvgpr_write_b32 a11, 0
v_accvgpr_write_b32 a12, 0
v_accvgpr_write_b32 a13, 0
v_accvgpr_write_b32 a14, 0
v_accvgpr_write_b32 a15, 0
v_accvgpr_write_b32 a16, 0
v_accvgpr_write_b32 a17, 0
v_accvgpr_write_b32 a18, 0
v_accvgpr_write_b32 a19, 0
v_accvgpr_write_b32 a20, 0
v_accvgpr_write_b32 a21, 0
v_accvgpr_write_b32 a22, 0
v_accvgpr_write_b32 a23, 0
v_accvgpr_write_b32 a24, 0
v_accvgpr_write_b32 a25, 0
v_accvgpr_write_b32 a26, 0
v_accvgpr_write_b32 a27, 0
v_accvgpr_write_b32 a28, 0
v_accvgpr_write_b32 a29, 0
v_accvgpr_write_b32 a30, 0
v_accvgpr_write_b32 a31, 0
v_accvgpr_write_b32 a32, 0
v_accvgpr_write_b32 a33, 0
v_accvgpr_write_b32 a34, 0
v_accvgpr_write_b32 a35, 0
v_accvgpr_write_b32 a36, 0
v_accvgpr_write_b32 a37, 0
v_accvgpr_write_b32 a38, 0
v_accvgpr_write_b32 a39, 0
v_accvgpr_write_b32 a40, 0
v_accvgpr_write_b32 a41, 0
v_accvgpr_write_b32 a42, 0
v_accvgpr_write_b32 a43, 0
v_accvgpr_write_b32 a44, 0
v_accvgpr_write_b32 a45, 0
v_accvgpr_write_b32 a46, 0
v_accvgpr_write_b32 a47, 0
v_accvgpr_write_b32 a48, 0
v_accvgpr_write_b32 a49, 0
v_accvgpr_write_b32 a50, 0
v_accvgpr_write_b32 a51, 0
v_accvgpr_write_b32 a52, 0
v_accvgpr_write_b32 a53, 0
v_accvgpr_write_b32 a54, 0
v_accvgpr_write_b32 a55, 0
v_accvgpr_write_b32 a56, 0
v_accvgpr_write_b32 a57, 0
v_accvgpr_write_b32 a58, 0
v_accvgpr_write_b32 a59, 0
v_accvgpr_write_b32 a60, 0
v_accvgpr_write_b32 a61, 0
v_accvgpr_write_b32 a62, 0
v_accvgpr_write_b32 a63, 0
v_accvgpr_write_b32 a64, 0
v_accvgpr_write_b32 a65, 0
v_accvgpr_write_b32 a66, 0
v_accvgpr_write_b32 a67, 0
v_accvgpr_write_b32 a68, 0
v_accvgpr_write_b32 a69, 0
v_accvgpr_write_b32 a70, 0
v_accvgpr_write_b32 a71, 0
v_accvgpr_write_b32 a72, 0
v_accvgpr_write_b32 a73, 0
v_accvgpr_write_b32 a74, 0
v_accvgpr_write_b32 a75, 0
v_accvgpr_write_b32 a76, 0
v_accvgpr_write_b32 a77, 0
v_accvgpr_write_b32 a78, 0
v_accvgpr_write_b32 a79, 0
v_accvgpr_write_b32 a80, 0
v_accvgpr_write_b32 a81, 0
v_accvgpr_write_b32 a82, 0
v_accvgpr_write_b32 a83, 0
v_accvgpr_write_b32 a84, 0
v_accvgpr_write_b32 a85, 0
v_accvgpr_write_b32 a86, 0
v_accvgpr_write_b32 a87, 0
v_accvgpr_write_b32 a88, 0
v_accvgpr_write_b32 a89, 0
v_accvgpr_write_b32 a90, 0
v_accvgpr_write_b32 a91, 0
v_accvgpr_write_b32 a92, 0
v_accvgpr_write_b32 a93, 0
v_accvgpr_write_b32 a94, 0
v_accvgpr_write_b32 a95, 0
v_accvgpr_write_b32 a96, 0
v_accvgpr_write_b32 a97, 0
v_accvgpr_write_b32 a98, 0
v_accvgpr_write_b32 a99, 0
v_accvgpr_write_b32 a100, 0
v_accvgpr_write_b32 a101, 0
v_accvgpr_write_b32 a102, 0
v_accvgpr_write_b32 a103, 0
v_accvgpr_write_b32 a104, 0
v_accvgpr_write_b32 a105, 0
v_accvgpr_write_b32 a106, 0
v_accvgpr_write_b32 a107, 0
v_accvgpr_write_b32 a108, 0
v_accvgpr_write_b32 a109, 0
v_accvgpr_write_b32 a110, 0
v_accvgpr_write_b32 a111, 0
v_accvgpr_write_b32 a112, 0
v_accvgpr_write_b32 a113, 0
v_accvgpr_write_b32 a114, 0
v_accvgpr_write_b32 a115, 0
v_accvgpr_write_b32 a116, 0
v_accvgpr_write_b32 a117, 0
v_accvgpr_write_b32 a118, 0
v_accvgpr_write_b32 a119, 0
v_accvgpr_write_b32 a120, 0
v_accvgpr_write_b32 a121, 0
v_accvgpr_write_b32 a122, 0
v_accvgpr_write_b32 a123, 0
v_accvgpr_write_b32 a124, 0
v_accvgpr_write_b32 a125, 0
v_accvgpr_write_b32 a126, 0
v_accvgpr_write_b32 a127, 0
v_accvgpr_write_b32 a128, 0
v_accvgpr_write_b32 a129, 0
v_accvgpr_write_b32 a130, 0
v_accvgpr_write_b32 a131, 0
v_accvgpr_write_b32 a132, 0
v_accvgpr_write_b32 a133, 0
v_accvgpr_write_b32 a134, 0
v_accvgpr_write_b32 a135, 0
v_accvgpr_write_b32 a136, 0
v_accvgpr_write_b32 a137, 0
v_accvgpr_write_b32 a138, 0
v_accvgpr_write_b32 a139, 0
v_accvgpr_write_b32 a140, 0
v_accvgpr_write_b32 a141, 0
v_accvgpr_write_b32 a142, 0
v_accvgpr_write_b32 a143, 0
v_accvgpr_write_b32 a144, 0
v_accvgpr_write_b32 a145, 0
v_accvgpr_write_b32 a146, 0
v_accvgpr_write_b32 a147, 0
v_accvgpr_write_b32 a148, 0
v_accvgpr_write_b32 a149, 0
v_accvgpr_write_b32 a150, 0
v_accvgpr_write_b32 a151, 0
v_accvgpr_write_b32 a152, 0
v_accvgpr_write_b32 a153, 0
v_accvgpr_write_b32 a154, 0
v_accvgpr_write_b32 a155, 0
v_accvgpr_write_b32 a156, 0
v_accvgpr_write_b32 a157, 0
v_accvgpr_write_b32 a158, 0
v_accvgpr_write_b32 a159, 0
v_accvgpr_write_b32 a160, 0
v_accvgpr_write_b32 a161, 0
v_accvgpr_write_b32 a162, 0
v_accvgpr_write_b32 a163, 0
v_accvgpr_write_b32 a164, 0
v_accvgpr_write_b32 a165, 0
v_accvgpr_write_b32 a166, 0
v_accvgpr_write_b32 a167, 0
v_accvgpr_write_b32 a168, 0
v_accvgpr_write_b32 a169, 0
v_accvgpr_write_b32 a170, 0
v_accvgpr_write_b32 a171, 0
v_accvgpr_write_b32 a172, 0
v_accvgpr_write_b32 a173, 0
v_accvgpr_write_b32 a174, 0
v_accvgpr_write_b32 a175, 0
v_accvgpr_write_b32 a176, 0
v_accvgpr_write_b32 a177, 0
v_accvgpr_write_b32 a178, 0
v_accvgpr_write_b32 a179, 0
s_lshl_b32 s50, s27, 18
s_lshl_b32 s52, s20, 12
s_add_u32 s50, s50, s52
s_mov_b32 s52, 0
L_fb2:
s_add_u32 m0, s51, 0
s_nop 0
buffer_load_dwordx4 v140, s[8:11], s50 offen offset:0 lds
s_add_u32 m0, s51, 32
s_nop 0
buffer_load_dwordx4 v140, s[8:11], s50 offen offset:1024 lds
s_add_u32 m0, s51, 64
s_nop 0
buffer_load_dwordx4 v140, s[8:11], s50 offen offset:2048 lds
s_add_u32 m0, s51, 96
s_nop 0
buffer_load_dwordx4 v140, s[8:11], s50 offen offset:3072 lds
s_add_u32 m0, s51, 16896
s_nop 0
buffer_load_dwordx4 v140, s[12:15], s50 offen offset:0 lds
s_add_u32 m0, s51, 16928
s_nop 0
buffer_load_dwordx4 v140, s[12:15], s50 offen offset:1024 lds
s_add_u32 m0, s51, 16960
s_nop 0
buffer_load_dwordx4 v140, s[12:15], s50 offen offset:2048 lds
s_add_u32 m0, s51, 16992
s_nop 0
buffer_load_dwordx4 v140, s[12:15], s50 offen offset:3072 lds
s_waitcnt vmcnt(0)
s_barrier
ds_read_b128 a[180:183], v136 offset:0
ds_read_b128 a[184:187], v136 offset:64
ds_read_b128 a[188:191], v136 offset:128
ds_read_b128 a[192:195], v136 offset:192
ds_read_b128 a[196:199], v136 offset:512
ds_read_b128 a[200:203], v136 offset:576
ds_read_b128 a[204:207], v136 offset:640
ds_read_b128 a[208:211], v136 offset:704
s_waitcnt lgkmcnt(0)
ds_read_b64_tr_b16 a[212:213], v138 offset:0
ds_read_b64_tr_b16 a[214:215], v138 offset:512
ds_read_b64_tr_b16 a[216:217], v138 offset:32
ds_read_b64_tr_b16 a[218:219], v138 offset:544
ds_read_b64_tr_b16 a[220:221], v138 offset:64
ds_read_b64_tr_b16 a[222:223], v138 offset:576
ds_read_b64_tr_b16 a[224:225], v138 offset:96
ds_read_b64_tr_b16 a[226:227], v138 offset:608
ds_read_b64_tr_b16 a[228:229], v138 offset:128
ds_read_b64_tr_b16 a[230:231], v138 offset:640
ds_read_b64_tr_b16 a[232:233], v138 offset:160
ds_read_b64_tr_b16 a[234:235], v138 offset:672
ds_read_b64_tr_b16 a[236:237], v138 offset:192
ds_read_b64_tr_b16 a[238:239], v138 offset:704
ds_read_b64_tr_b16 a[240:241], v138 offset:224
ds_read_b64_tr_b16 a[242:243], v138 offset:736
v_mfma_f32_16x16x32_bf16 v[80:83], a[180:183], v[0:3], v[116:119]
v_mfma_f32_16x16x32_bf16 v[80:83], a[184:187], v[4:7], v[80:83]
v_mfma_f32_16x16x32_bf16 v[80:83], a[188:191], v[8:11], v[80:83]
v_mfma_f32_16x16x32_bf16 v[80:83], a[192:195], v[12:15], v[80:83]
v_mfma_f32_16x16x32_bf16 v[84:87], a[196:199], v[0:3], v[116:119]
v_mfma_f32_16x16x32_bf16 v[84:87], a[200:203], v[4:7], v[84:87]
v_mfma_f32_16x16x32_bf16 v[84:87], a[204:207], v[8:11], v[84:87]
v_mfma_f32_16x16x32_bf16 v[84:87], a[208:211], v[12:15], v[84:87]
s_nop 7
v_exp_f32 v80, v80
v_exp_f32 v81, v81
v_exp_f32 v82, v82
v_exp_f32 v83, v83
v_exp_f32 v84, v84
v_exp_f32 v85, v85
v_exp_f32 v86, v86
v_exp_f32 v87, v87
s_nop 0
v_cvt_pk_bf16_f32 v104, v80, v81
v_cvt_pk_bf16_f32 v105, v82, v83
v_cvt_pk_bf16_f32 v106, v84, v85
v_cvt_pk_bf16_f32 v107, v86, v87
s_waitcnt lgkmcnt(0)
s_nop 0
v_mfma_f32_16x16x32_bf16 a[0:3], a[212:215], v[104:107], a[0:3]
v_mfma_f32_16x16x32_bf16 a[4:7], a[216:219], v[104:107], a[4:7]
v_mfma_f32_16x16x32_bf16 a[8:11], a[220:223], v[104:107], a[8:11]
v_mfma_f32_16x16x32_bf16 a[12:15], a[224:227], v[104:107], a[12:15]
v_mfma_f32_16x16x32_bf16 a[16:19], a[228:231], v[104:107], a[16:19]
v_mfma_f32_16x16x32_bf16 a[20:23], a[232:235], v[104:107], a[20:23]
v_mfma_f32_16x16x32_bf16 a[24:27], a[236:239], v[104:107], a[24:27]
v_mfma_f32_16x16x32_bf16 a[28:31], a[240:243], v[104:107], a[28:31]
v_mfma_f32_16x16x32_bf16 a[160:163], v[144:147], v[104:107], a[160:163]
v_mfma_f32_16x16x32_bf16 v[80:83], a[180:183], v[16:19], v[120:123]
v_mfma_f32_16x16x32_bf16 v[80:83], a[184:187], v[20:23], v[80:83]
v_mfma_f32_16x16x32_bf16 v[80:83], a[188:191], v[24:27], v[80:83]
v_mfma_f32_16x16x32_bf16 v[80:83], a[192:195], v[28:31], v[80:83]
v_mfma_f32_16x16x32_bf16 v[84:87], a[196:199], v[16:19], v[120:123]
v_mfma_f32_16x16x32_bf16 v[84:87], a[200:203], v[20:23], v[84:87]
v_mfma_f32_16x16x32_bf16 v[84:87], a[204:207], v[24:27], v[84:87]
v_mfma_f32_16x16x32_bf16 v[84:87], a[208:211], v[28:31], v[84:87]
s_nop 7
v_exp_f32 v80, v80
v_exp_f32 v81, v81
v_exp_f32 v82, v82
v_exp_f32 v83, v83
v_exp_f32 v84, v84
v_exp_f32 v85, v85
v_exp_f32 v86, v86
v_exp_f32 v87, v87
s_nop 0
v_cvt_pk_bf16_f32 v104, v80, v81
v_cvt_pk_bf16_f32 v105, v82, v83
v_cvt_pk_bf16_f32 v106, v84, v85
v_cvt_pk_bf16_f32 v107, v86, v87
s_waitcnt lgkmcnt(0)
s_nop 0
v_mfma_f32_16x16x32_bf16 a[32:35], a[212:215], v[104:107], a[32:35]
v_mfma_f32_16x16x32_bf16 a[36:39], a[216:219], v[104:107], a[36:39]
v_mfma_f32_16x16x32_bf16 a[40:43], a[220:223], v[104:107], a[40:43]
v_mfma_f32_16x16x32_bf16 a[44:47], a[224:227], v[104:107], a[44:47]
v_mfma_f32_16x16x32_bf16 a[48:51], a[228:231], v[104:107], a[48:51]
v_mfma_f32_16x16x32_bf16 a[52:55], a[232:235], v[104:107], a[52:55]
v_mfma_f32_16x16x32_bf16 a[56:59], a[236:239], v[104:107], a[56:59]
v_mfma_f32_16x16x32_bf16 a[60:63], a[240:243], v[104:107], a[60:63]
v_mfma_f32_16x16x32_bf16 a[164:167], v[144:147], v[104:107], a[164:167]
v_mfma_f32_16x16x32_bf16 v[80:83], a[180:183], v[32:35], v[124:127]
v_mfma_f32_16x16x32_bf16 v[80:83], a[184:187], v[36:39], v[80:83]
v_mfma_f32_16x16x32_bf16 v[80:83], a[188:191], v[40:43], v[80:83]
v_mfma_f32_16x16x32_bf16 v[80:83], a[192:195], v[44:47], v[80:83]
v_mfma_f32_16x16x32_bf16 v[84:87], a[196:199], v[32:35], v[124:127]
v_mfma_f32_16x16x32_bf16 v[84:87], a[200:203], v[36:39], v[84:87]
v_mfma_f32_16x16x32_bf16 v[84:87], a[204:207], v[40:43], v[84:87]
v_mfma_f32_16x16x32_bf16 v[84:87], a[208:211], v[44:47], v[84:87]
s_nop 7
v_exp_f32 v80, v80
v_exp_f32 v81, v81
v_exp_f32 v82, v82
v_exp_f32 v83, v83
v_exp_f32 v84, v84
v_exp_f32 v85, v85
v_exp_f32 v86, v86
v_exp_f32 v87, v87
s_nop 0
v_cvt_pk_bf16_f32 v104, v80, v81
v_cvt_pk_bf16_f32 v105, v82, v83
v_cvt_pk_bf16_f32 v106, v84, v85
v_cvt_pk_bf16_f32 v107, v86, v87
s_waitcnt lgkmcnt(0)
s_nop 0
v_mfma_f32_16x16x32_bf16 a[64:67], a[212:215], v[104:107], a[64:67]
v_mfma_f32_16x16x32_bf16 a[68:71], a[216:219], v[104:107], a[68:71]
v_mfma_f32_16x16x32_bf16 a[72:75], a[220:223], v[104:107], a[72:75]
v_mfma_f32_16x16x32_bf16 a[76:79], a[224:227], v[104:107], a[76:79]
v_mfma_f32_16x16x32_bf16 a[80:83], a[228:231], v[104:107], a[80:83]
v_mfma_f32_16x16x32_bf16 a[84:87], a[232:235], v[104:107], a[84:87]
v_mfma_f32_16x16x32_bf16 a[88:91], a[236:239], v[104:107], a[88:91]
v_mfma_f32_16x16x32_bf16 a[92:95], a[240:243], v[104:107], a[92:95]
v_mfma_f32_16x16x32_bf16 a[168:171], v[144:147], v[104:107], a[168:171]
v_mfma_f32_16x16x32_bf16 v[80:83], a[180:183], v[48:51], v[128:131]
v_mfma_f32_16x16x32_bf16 v[80:83], a[184:187], v[52:55], v[80:83]
v_mfma_f32_16x16x32_bf16 v[80:83], a[188:191], v[56:59], v[80:83]
v_mfma_f32_16x16x32_bf16 v[80:83], a[192:195], v[60:63], v[80:83]
v_mfma_f32_16x16x32_bf16 v[84:87], a[196:199], v[48:51], v[128:131]
v_mfma_f32_16x16x32_bf16 v[84:87], a[200:203], v[52:55], v[84:87]
v_mfma_f32_16x16x32_bf16 v[84:87], a[204:207], v[56:59], v[84:87]
v_mfma_f32_16x16x32_bf16 v[84:87], a[208:211], v[60:63], v[84:87]
s_nop 7
v_exp_f32 v80, v80
v_exp_f32 v81, v81
v_exp_f32 v82, v82
v_exp_f32 v83, v83
v_exp_f32 v84, v84
v_exp_f32 v85, v85
v_exp_f32 v86, v86
v_exp_f32 v87, v87
s_nop 0
v_cvt_pk_bf16_f32 v104, v80, v81
v_cvt_pk_bf16_f32 v105, v82, v83
v_cvt_pk_bf16_f32 v106, v84, v85
v_cvt_pk_bf16_f32 v107, v86, v87
s_waitcnt lgkmcnt(0)
s_nop 0
v_mfma_f32_16x16x32_bf16 a[96:99], a[212:215], v[104:107], a[96:99]
v_mfma_f32_16x16x32_bf16 a[100:103], a[216:219], v[104:107], a[100:103]
v_mfma_f32_16x16x32_bf16 a[104:107], a[220:223], v[104:107], a[104:107]
v_mfma_f32_16x16x32_bf16 a[108:111], a[224:227], v[104:107], a[108:111]
v_mfma_f32_16x16x32_bf16 a[112:115], a[228:231], v[104:107], a[112:115]
v_mfma_f32_16x16x32_bf16 a[116:119], a[232:235], v[104:107], a[116:119]
v_mfma_f32_16x16x32_bf16 a[120:123], a[236:239], v[104:107], a[120:123]
v_mfma_f32_16x16x32_bf16 a[124:127], a[240:243], v[104:107], a[124:127]
v_mfma_f32_16x16x32_bf16 a[172:175], v[144:147], v[104:107], a[172:175]
v_mfma_f32_16x16x32_bf16 v[80:83], a[180:183], v[64:67], v[132:135]
v_mfma_f32_16x16x32_bf16 v[80:83], a[184:187], v[68:71], v[80:83]
v_mfma_f32_16x16x32_bf16 v[80:83], a[188:191], v[72:75], v[80:83]
v_mfma_f32_16x16x32_bf16 v[80:83], a[192:195], v[76:79], v[80:83]
v_mfma_f32_16x16x32_bf16 v[84:87], a[196:199], v[64:67], v[132:135]
v_mfma_f32_16x16x32_bf16 v[84:87], a[200:203], v[68:71], v[84:87]
v_mfma_f32_16x16x32_bf16 v[84:87], a[204:207], v[72:75], v[84:87]
v_mfma_f32_16x16x32_bf16 v[84:87], a[208:211], v[76:79], v[84:87]
s_nop 7
v_exp_f32 v80, v80
v_exp_f32 v81, v81
v_exp_f32 v82, v82
v_exp_f32 v83, v83
v_exp_f32 v84, v84
v_exp_f32 v85, v85
v_exp_f32 v86, v86
v_exp_f32 v87, v87
s_nop 0
v_cvt_pk_bf16_f32 v104, v80, v81
v_cvt_pk_bf16_f32 v105, v82, v83
v_cvt_pk_bf16_f32 v106, v84, v85
v_cvt_pk_bf16_f32 v107, v86, v87
s_waitcnt lgkmcnt(0)
s_nop 0
v_mfma_f32_16x16x32_bf16 a[128:131], a[212:215], v[104:107], a[128:131]
v_mfma_f32_16x16x32_bf16 a[132:135], a[216:219], v[104:107], a[132:135]
v_mfma_f32_16x16x32_bf16 a[136:139], a[220:223], v[104:107], a[136:139]
v_mfma_f32_16x16x32_bf16 a[140:143], a[224:227], v[104:107], a[140:143]
v_mfma_f32_16x16x32_bf16 a[144:147], a[228:231], v[104:107], a[144:147]
v_mfma_f32_16x16x32_bf16 a[148:151], a[232:235], v[104:107], a[148:151]
v_mfma_f32_16x16x32_bf16 a[152:155], a[236:239], v[104:107], a[152:155]
v_mfma_f32_16x16x32_bf16 a[156:159], a[240:243], v[104:107], a[156:159]
v_mfma_f32_16x16x32_bf16 a[176:179], v[144:147], v[104:107], a[176:179]
ds_read_b128 a[180:183], v136 offset:8448
ds_read_b128 a[184:187], v136 offset:8512
ds_read_b128 a[188:191], v136 offset:8576
ds_read_b128 a[192:195], v136 offset:8640
ds_read_b128 a[196:199], v136 offset:8960
ds_read_b128 a[200:203], v136 offset:9024
ds_read_b128 a[204:207], v136 offset:9088
ds_read_b128 a[208:211], v136 offset:9152
s_waitcnt lgkmcnt(0)
ds_read_b64_tr_b16 a[212:213], v138 offset:8448
ds_read_b64_tr_b16 a[214:215], v138 offset:8960
ds_read_b64_tr_b16 a[216:217], v138 offset:8480
ds_read_b64_tr_b16 a[218:219], v138 offset:8992
ds_read_b64_tr_b16 a[220:221], v138 offset:8512
ds_read_b64_tr_b16 a[222:223], v138 offset:9024
ds_read_b64_tr_b16 a[224:225], v138 offset:8544
ds_read_b64_tr_b16 a[226:227], v138 offset:9056
ds_read_b64_tr_b16 a[228:229], v138 offset:8576
ds_read_b64_tr_b16 a[230:231], v138 offset:9088
ds_read_b64_tr_b16 a[232:233], v138 offset:8608
ds_read_b64_tr_b16 a[234:235], v138 offset:9120
ds_read_b64_tr_b16 a[236:237], v138 offset:8640
ds_read_b64_tr_b16 a[238:239], v138 offset:9152
ds_read_b64_tr_b16 a[240:241], v138 offset:8672
ds_read_b64_tr_b16 a[242:243], v138 offset:9184
v_mfma_f32_16x16x32_bf16 v[80:83], a[180:183], v[0:3], v[116:119]
v_mfma_f32_16x16x32_bf16 v[80:83], a[184:187], v[4:7], v[80:83]
v_mfma_f32_16x16x32_bf16 v[80:83], a[188:191], v[8:11], v[80:83]
v_mfma_f32_16x16x32_bf16 v[80:83], a[192:195], v[12:15], v[80:83]
v_mfma_f32_16x16x32_bf16 v[84:87], a[196:199], v[0:3], v[116:119]
v_mfma_f32_16x16x32_bf16 v[84:87], a[200:203], v[4:7], v[84:87]
v_mfma_f32_16x16x32_bf16 v[84:87], a[204:207], v[8:11], v[84:87]
v_mfma_f32_16x16x32_bf16 v[84:87], a[208:211], v[12:15], v[84:87]
s_nop 7
v_exp_f32 v80, v80
v_exp_f32 v81, v81
v_exp_f32 v82, v82
v_exp_f32 v83, v83
v_exp_f32 v84, v84
v_exp_f32 v85, v85
v_exp_f32 v86, v86
v_exp_f32 v87, v87
s_nop 0
v_cvt_pk_bf16_f32 v104, v80, v81
v_cvt_pk_bf16_f32 v105, v82, v83
v_cvt_pk_bf16_f32 v106, v84, v85
v_cvt_pk_bf16_f32 v107, v86, v87
s_waitcnt lgkmcnt(0)
s_nop 0
v_mfma_f32_16x16x32_bf16 a[0:3], a[212:215], v[104:107], a[0:3]
v_mfma_f32_16x16x32_bf16 a[4:7], a[216:219], v[104:107], a[4:7]
v_mfma_f32_16x16x32_bf16 a[8:11], a[220:223], v[104:107], a[8:11]
v_mfma_f32_16x16x32_bf16 a[12:15], a[224:227], v[104:107], a[12:15]
v_mfma_f32_16x16x32_bf16 a[16:19], a[228:231], v[104:107], a[16:19]
v_mfma_f32_16x16x32_bf16 a[20:23], a[232:235], v[104:107], a[20:23]
v_mfma_f32_16x16x32_bf16 a[24:27], a[236:239], v[104:107], a[24:27]
v_mfma_f32_16x16x32_bf16 a[28:31], a[240:243], v[104:107], a[28:31]
v_mfma_f32_16x16x32_bf16 a[160:163], v[144:147], v[104:107], a[160:163]
v_mfma_f32_16x16x32_bf16 v[80:83], a[180:183], v[16:19], v[120:123]
v_mfma_f32_16x16x32_bf16 v[80:83], a[184:187], v[20:23], v[80:83]
v_mfma_f32_16x16x32_bf16 v[80:83], a[188:191], v[24:27], v[80:83]
v_mfma_f32_16x16x32_bf16 v[80:83], a[192:195], v[28:31], v[80:83]
v_mfma_f32_16x16x32_bf16 v[84:87], a[196:199], v[16:19], v[120:123]
v_mfma_f32_16x16x32_bf16 v[84:87], a[200:203], v[20:23], v[84:87]
v_mfma_f32_16x16x32_bf16 v[84:87], a[204:207], v[24:27], v[84:87]
v_mfma_f32_16x16x32_bf16 v[84:87], a[208:211], v[28:31], v[84:87]
s_nop 7
v_exp_f32 v80, v80
v_exp_f32 v81, v81
v_exp_f32 v82, v82
v_exp_f32 v83, v83
v_exp_f32 v84, v84
v_exp_f32 v85, v85
v_exp_f32 v86, v86
v_exp_f32 v87, v87
s_nop 0
v_cvt_pk_bf16_f32 v104, v80, v81
v_cvt_pk_bf16_f32 v105, v82, v83
v_cvt_pk_bf16_f32 v106, v84, v85
v_cvt_pk_bf16_f32 v107, v86, v87
s_waitcnt lgkmcnt(0)
s_nop 0
v_mfma_f32_16x16x32_bf16 a[32:35], a[212:215], v[104:107], a[32:35]
v_mfma_f32_16x16x32_bf16 a[36:39], a[216:219], v[104:107], a[36:39]
v_mfma_f32_16x16x32_bf16 a[40:43], a[220:223], v[104:107], a[40:43]
v_mfma_f32_16x16x32_bf16 a[44:47], a[224:227], v[104:107], a[44:47]
v_mfma_f32_16x16x32_bf16 a[48:51], a[228:231], v[104:107], a[48:51]
v_mfma_f32_16x16x32_bf16 a[52:55], a[232:235], v[104:107], a[52:55]
v_mfma_f32_16x16x32_bf16 a[56:59], a[236:239], v[104:107], a[56:59]
v_mfma_f32_16x16x32_bf16 a[60:63], a[240:243], v[104:107], a[60:63]
v_mfma_f32_16x16x32_bf16 a[164:167], v[144:147], v[104:107], a[164:167]
v_mfma_f32_16x16x32_bf16 v[80:83], a[180:183], v[32:35], v[124:127]
v_mfma_f32_16x16x32_bf16 v[80:83], a[184:187], v[36:39], v[80:83]
v_mfma_f32_16x16x32_bf16 v[80:83], a[188:191], v[40:43], v[80:83]
v_mfma_f32_16x16x32_bf16 v[80:83], a[192:195], v[44:47], v[80:83]
v_mfma_f32_16x16x32_bf16 v[84:87], a[196:199], v[32:35], v[124:127]
v_mfma_f32_16x16x32_bf16 v[84:87], a[200:203], v[36:39], v[84:87]
v_mfma_f32_16x16x32_bf16 v[84:87], a[204:207], v[40:43], v[84:87]
v_mfma_f32_16x16x32_bf16 v[84:87], a[208:211], v[44:47], v[84:87]
s_nop 7
v_exp_f32 v80, v80
v_exp_f32 v81, v81
v_exp_f32 v82, v82
v_exp_f32 v83, v83
v_exp_f32 v84, v84
v_exp_f32 v85, v85
v_exp_f32 v86, v86
v_exp_f32 v87, v87
s_nop 0
v_cvt_pk_bf16_f32 v104, v80, v81
v_cvt_pk_bf16_f32 v105, v82, v83
v_cvt_pk_bf16_f32 v106, v84, v85
v_cvt_pk_bf16_f32 v107, v86, v87
s_waitcnt lgkmcnt(0)
s_nop 0
v_mfma_f32_16x16x32_bf16 a[64:67], a[212:215], v[104:107], a[64:67]
v_mfma_f32_16x16x32_bf16 a[68:71], a[216:219], v[104:107], a[68:71]
v_mfma_f32_16x16x32_bf16 a[72:75], a[220:223], v[104:107], a[72:75]
v_mfma_f32_16x16x32_bf16 a[76:79], a[224:227], v[104:107], a[76:79]
v_mfma_f32_16x16x32_bf16 a[80:83], a[228:231], v[104:107], a[80:83]
v_mfma_f32_16x16x32_bf16 a[84:87], a[232:235], v[104:107], a[84:87]
v_mfma_f32_16x16x32_bf16 a[88:91], a[236:239], v[104:107], a[88:91]
v_mfma_f32_16x16x32_bf16 a[92:95], a[240:243], v[104:107], a[92:95]
v_mfma_f32_16x16x32_bf16 a[168:171], v[144:147], v[104:107], a[168:171]
v_mfma_f32_16x16x32_bf16 v[80:83], a[180:183], v[48:51], v[128:131]
v_mfma_f32_16x16x32_bf16 v[80:83], a[184:187], v[52:55], v[80:83]
v_mfma_f32_16x16x32_bf16 v[80:83], a[188:191], v[56:59], v[80:83]
v_mfma_f32_16x16x32_bf16 v[80:83], a[192:195], v[60:63], v[80:83]
v_mfma_f32_16x16x32_bf16 v[84:87], a[196:199], v[48:51], v[128:131]
v_mfma_f32_16x16x32_bf16 v[84:87], a[200:203], v[52:55], v[84:87]
v_mfma_f32_16x16x32_bf16 v[84:87], a[204:207], v[56:59], v[84:87]
v_mfma_f32_16x16x32_bf16 v[84:87], a[208:211], v[60:63], v[84:87]
s_nop 7
v_exp_f32 v80, v80
v_exp_f32 v81, v81
v_exp_f32 v82, v82
v_exp_f32 v83, v83
v_exp_f32 v84, v84
v_exp_f32 v85, v85
v_exp_f32 v86, v86
v_exp_f32 v87, v87
s_nop 0
v_cvt_pk_bf16_f32 v104, v80, v81
v_cvt_pk_bf16_f32 v105, v82, v83
v_cvt_pk_bf16_f32 v106, v84, v85
v_cvt_pk_bf16_f32 v107, v86, v87
s_waitcnt lgkmcnt(0)
s_nop 0
v_mfma_f32_16x16x32_bf16 a[96:99], a[212:215], v[104:107], a[96:99]
v_mfma_f32_16x16x32_bf16 a[100:103], a[216:219], v[104:107], a[100:103]
v_mfma_f32_16x16x32_bf16 a[104:107], a[220:223], v[104:107], a[104:107]
v_mfma_f32_16x16x32_bf16 a[108:111], a[224:227], v[104:107], a[108:111]
v_mfma_f32_16x16x32_bf16 a[112:115], a[228:231], v[104:107], a[112:115]
v_mfma_f32_16x16x32_bf16 a[116:119], a[232:235], v[104:107], a[116:119]
v_mfma_f32_16x16x32_bf16 a[120:123], a[236:239], v[104:107], a[120:123]
v_mfma_f32_16x16x32_bf16 a[124:127], a[240:243], v[104:107], a[124:127]
v_mfma_f32_16x16x32_bf16 a[172:175], v[144:147], v[104:107], a[172:175]
v_mfma_f32_16x16x32_bf16 v[80:83], a[180:183], v[64:67], v[132:135]
v_mfma_f32_16x16x32_bf16 v[80:83], a[184:187], v[68:71], v[80:83]
v_mfma_f32_16x16x32_bf16 v[80:83], a[188:191], v[72:75], v[80:83]
v_mfma_f32_16x16x32_bf16 v[80:83], a[192:195], v[76:79], v[80:83]
v_mfma_f32_16x16x32_bf16 v[84:87], a[196:199], v[64:67], v[132:135]
v_mfma_f32_16x16x32_bf16 v[84:87], a[200:203], v[68:71], v[84:87]
v_mfma_f32_16x16x32_bf16 v[84:87], a[204:207], v[72:75], v[84:87]
v_mfma_f32_16x16x32_bf16 v[84:87], a[208:211], v[76:79], v[84:87]
s_nop 7
v_exp_f32 v80, v80
v_exp_f32 v81, v81
v_exp_f32 v82, v82
v_exp_f32 v83, v83
v_exp_f32 v84, v84
v_exp_f32 v85, v85
v_exp_f32 v86, v86
v_exp_f32 v87, v87
s_nop 0
v_cvt_pk_bf16_f32 v104, v80, v81
v_cvt_pk_bf16_f32 v105, v82, v83
v_cvt_pk_bf16_f32 v106, v84, v85
v_cvt_pk_bf16_f32 v107, v86, v87
s_waitcnt lgkmcnt(0)
s_nop 0
v_mfma_f32_16x16x32_bf16 a[128:131], a[212:215], v[104:107], a[128:131]
v_mfma_f32_16x16x32_bf16 a[132:135], a[216:219], v[104:107], a[132:135]
v_mfma_f32_16x16x32_bf16 a[136:139], a[220:223], v[104:107], a[136:139]
v_mfma_f32_16x16x32_bf16 a[140:143], a[224:227], v[104:107], a[140:143]
v_mfma_f32_16x16x32_bf16 a[144:147], a[228:231], v[104:107], a[144:147]
v_mfma_f32_16x16x32_bf16 a[148:151], a[232:235], v[104:107], a[148:151]
v_mfma_f32_16x16x32_bf16 a[152:155], a[236:239], v[104:107], a[152:155]
v_mfma_f32_16x16x32_bf16 a[156:159], a[240:243], v[104:107], a[156:159]
v_mfma_f32_16x16x32_bf16 a[176:179], v[144:147], v[104:107], a[176:179]
s_barrier
s_add_u32 s50, s50, 16384
s_add_u32 s52, s52, 1
s_cmp_lt_u32 s52, 16
s_cbranch_scc1 L_fb2
s_nop 7
v_accvgpr_read_b32 v80, a160
s_add_u32 s55, s53, 0
v_rcp_f32 v80, v80
v_accvgpr_read_b32 v0, a0
v_accvgpr_read_b32 v1, a1
v_accvgpr_read_b32 v2, a2
v_accvgpr_read_b32 v3, a3
v_mul_f32 v0, v80, v0
v_mul_f32 v1, v80, v1
v_mul_f32 v2, v80, v2
v_mul_f32 v3, v80, v3
v_cvt_pk_bf16_f32 v0, v0, v1
v_cvt_pk_bf16_f32 v1, v2, v3
buffer_store_dwordx2 v[0:1], v142, s[16:19], s55 offen offset:0
v_accvgpr_read_b32 v4, a4
v_accvgpr_read_b32 v5, a5
v_accvgpr_read_b32 v6, a6
v_accvgpr_read_b32 v7, a7
v_mul_f32 v4, v80, v4
v_mul_f32 v5, v80, v5
v_mul_f32 v6, v80, v6
v_mul_f32 v7, v80, v7
v_cvt_pk_bf16_f32 v4, v4, v5
v_cvt_pk_bf16_f32 v5, v6, v7
buffer_store_dwordx2 v[4:5], v142, s[16:19], s55 offen offset:32
v_accvgpr_read_b32 v8, a8
v_accvgpr_read_b32 v9, a9
v_accvgpr_read_b32 v10, a10
v_accvgpr_read_b32 v11, a11
v_mul_f32 v8, v80, v8
v_mul_f32 v9, v80, v9
v_mul_f32 v10, v80, v10
v_mul_f32 v11, v80, v11
v_cvt_pk_bf16_f32 v8, v8, v9
v_cvt_pk_bf16_f32 v9, v10, v11
buffer_store_dwordx2 v[8:9], v142, s[16:19], s55 offen offset:64
v_accvgpr_read_b32 v12, a12
v_accvgpr_read_b32 v13, a13
v_accvgpr_read_b32 v14, a14
v_accvgpr_read_b32 v15, a15
v_mul_f32 v12, v80, v12
v_mul_f32 v13, v80, v13
v_mul_f32 v14, v80, v14
v_mul_f32 v15, v80, v15
v_cvt_pk_bf16_f32 v12, v12, v13
v_cvt_pk_bf16_f32 v13, v14, v15
buffer_store_dwordx2 v[12:13], v142, s[16:19], s55 offen offset:96
v_accvgpr_read_b32 v16, a16
v_accvgpr_read_b32 v17, a17
v_accvgpr_read_b32 v18, a18
v_accvgpr_read_b32 v19, a19
v_mul_f32 v16, v80, v16
v_mul_f32 v17, v80, v17
v_mul_f32 v18, v80, v18
v_mul_f32 v19, v80, v19
v_cvt_pk_bf16_f32 v16, v16, v17
v_cvt_pk_bf16_f32 v17, v18, v19
buffer_store_dwordx2 v[16:17], v142, s[16:19], s55 offen offset:128
v_accvgpr_read_b32 v20, a20
v_accvgpr_read_b32 v21, a21
v_accvgpr_read_b32 v22, a22
v_accvgpr_read_b32 v23, a23
v_mul_f32 v20, v80, v20
v_mul_f32 v21, v80, v21
v_mul_f32 v22, v80, v22
v_mul_f32 v23, v80, v23
v_cvt_pk_bf16_f32 v20, v20, v21
v_cvt_pk_bf16_f32 v21, v22, v23
buffer_store_dwordx2 v[20:21], v142, s[16:19], s55 offen offset:160
v_accvgpr_read_b32 v24, a24
v_accvgpr_read_b32 v25, a25
v_accvgpr_read_b32 v26, a26
v_accvgpr_read_b32 v27, a27
v_mul_f32 v24, v80, v24
v_mul_f32 v25, v80, v25
v_mul_f32 v26, v80, v26
v_mul_f32 v27, v80, v27
v_cvt_pk_bf16_f32 v24, v24, v25
v_cvt_pk_bf16_f32 v25, v26, v27
buffer_store_dwordx2 v[24:25], v142, s[16:19], s55 offen offset:192
v_accvgpr_read_b32 v28, a28
v_accvgpr_read_b32 v29, a29
v_accvgpr_read_b32 v30, a30
v_accvgpr_read_b32 v31, a31
v_mul_f32 v28, v80, v28
v_mul_f32 v29, v80, v29
v_mul_f32 v30, v80, v30
v_mul_f32 v31, v80, v31
v_cvt_pk_bf16_f32 v28, v28, v29
v_cvt_pk_bf16_f32 v29, v30, v31
buffer_store_dwordx2 v[28:29], v142, s[16:19], s55 offen offset:224
s_waitcnt vmcnt(0)
v_accvgpr_read_b32 v80, a164
s_add_u32 s55, s53, 4096
v_rcp_f32 v80, v80
v_accvgpr_read_b32 v0, a32
v_accvgpr_read_b32 v1, a33
v_accvgpr_read_b32 v2, a34
v_accvgpr_read_b32 v3, a35
v_mul_f32 v0, v80, v0
v_mul_f32 v1, v80, v1
v_mul_f32 v2, v80, v2
v_mul_f32 v3, v80, v3
v_cvt_pk_bf16_f32 v0, v0, v1
v_cvt_pk_bf16_f32 v1, v2, v3
buffer_store_dwordx2 v[0:1], v142, s[16:19], s55 offen offset:0
v_accvgpr_read_b32 v4, a36
v_accvgpr_read_b32 v5, a37
v_accvgpr_read_b32 v6, a38
v_accvgpr_read_b32 v7, a39
v_mul_f32 v4, v80, v4
v_mul_f32 v5, v80, v5
v_mul_f32 v6, v80, v6
v_mul_f32 v7, v80, v7
v_cvt_pk_bf16_f32 v4, v4, v5
v_cvt_pk_bf16_f32 v5, v6, v7
buffer_store_dwordx2 v[4:5], v142, s[16:19], s55 offen offset:32
v_accvgpr_read_b32 v8, a40
v_accvgpr_read_b32 v9, a41
v_accvgpr_read_b32 v10, a42
v_accvgpr_read_b32 v11, a43
v_mul_f32 v8, v80, v8
v_mul_f32 v9, v80, v9
v_mul_f32 v10, v80, v10
v_mul_f32 v11, v80, v11
v_cvt_pk_bf16_f32 v8, v8, v9
v_cvt_pk_bf16_f32 v9, v10, v11
buffer_store_dwordx2 v[8:9], v142, s[16:19], s55 offen offset:64
v_accvgpr_read_b32 v12, a44
v_accvgpr_read_b32 v13, a45
v_accvgpr_read_b32 v14, a46
v_accvgpr_read_b32 v15, a47
v_mul_f32 v12, v80, v12
v_mul_f32 v13, v80, v13
v_mul_f32 v14, v80, v14
v_mul_f32 v15, v80, v15
v_cvt_pk_bf16_f32 v12, v12, v13
v_cvt_pk_bf16_f32 v13, v14, v15
buffer_store_dwordx2 v[12:13], v142, s[16:19], s55 offen offset:96
v_accvgpr_read_b32 v16, a48
v_accvgpr_read_b32 v17, a49
v_accvgpr_read_b32 v18, a50
v_accvgpr_read_b32 v19, a51
v_mul_f32 v16, v80, v16
v_mul_f32 v17, v80, v17
v_mul_f32 v18, v80, v18
v_mul_f32 v19, v80, v19
v_cvt_pk_bf16_f32 v16, v16, v17
v_cvt_pk_bf16_f32 v17, v18, v19
buffer_store_dwordx2 v[16:17], v142, s[16:19], s55 offen offset:128
v_accvgpr_read_b32 v20, a52
v_accvgpr_read_b32 v21, a53
v_accvgpr_read_b32 v22, a54
v_accvgpr_read_b32 v23, a55
v_mul_f32 v20, v80, v20
v_mul_f32 v21, v80, v21
v_mul_f32 v22, v80, v22
v_mul_f32 v23, v80, v23
v_cvt_pk_bf16_f32 v20, v20, v21
v_cvt_pk_bf16_f32 v21, v22, v23
buffer_store_dwordx2 v[20:21], v142, s[16:19], s55 offen offset:160
v_accvgpr_read_b32 v24, a56
v_accvgpr_read_b32 v25, a57
v_accvgpr_read_b32 v26, a58
v_accvgpr_read_b32 v27, a59
v_mul_f32 v24, v80, v24
v_mul_f32 v25, v80, v25
v_mul_f32 v26, v80, v26
v_mul_f32 v27, v80, v27
v_cvt_pk_bf16_f32 v24, v24, v25
v_cvt_pk_bf16_f32 v25, v26, v27
buffer_store_dwordx2 v[24:25], v142, s[16:19], s55 offen offset:192
v_accvgpr_read_b32 v28, a60
v_accvgpr_read_b32 v29, a61
v_accvgpr_read_b32 v30, a62
v_accvgpr_read_b32 v31, a63
v_mul_f32 v28, v80, v28
v_mul_f32 v29, v80, v29
v_mul_f32 v30, v80, v30
v_mul_f32 v31, v80, v31
v_cvt_pk_bf16_f32 v28, v28, v29
v_cvt_pk_bf16_f32 v29, v30, v31
buffer_store_dwordx2 v[28:29], v142, s[16:19], s55 offen offset:224
s_waitcnt vmcnt(0)
v_accvgpr_read_b32 v80, a168
s_add_u32 s55, s53, 8192
v_rcp_f32 v80, v80
v_accvgpr_read_b32 v0, a64
v_accvgpr_read_b32 v1, a65
v_accvgpr_read_b32 v2, a66
v_accvgpr_read_b32 v3, a67
v_mul_f32 v0, v80, v0
v_mul_f32 v1, v80, v1
v_mul_f32 v2, v80, v2
v_mul_f32 v3, v80, v3
v_cvt_pk_bf16_f32 v0, v0, v1
v_cvt_pk_bf16_f32 v1, v2, v3
buffer_store_dwordx2 v[0:1], v142, s[16:19], s55 offen offset:0
v_accvgpr_read_b32 v4, a68
v_accvgpr_read_b32 v5, a69
v_accvgpr_read_b32 v6, a70
v_accvgpr_read_b32 v7, a71
v_mul_f32 v4, v80, v4
v_mul_f32 v5, v80, v5
v_mul_f32 v6, v80, v6
v_mul_f32 v7, v80, v7
v_cvt_pk_bf16_f32 v4, v4, v5
v_cvt_pk_bf16_f32 v5, v6, v7
buffer_store_dwordx2 v[4:5], v142, s[16:19], s55 offen offset:32
v_accvgpr_read_b32 v8, a72
v_accvgpr_read_b32 v9, a73
v_accvgpr_read_b32 v10, a74
v_accvgpr_read_b32 v11, a75
v_mul_f32 v8, v80, v8
v_mul_f32 v9, v80, v9
v_mul_f32 v10, v80, v10
v_mul_f32 v11, v80, v11
v_cvt_pk_bf16_f32 v8, v8, v9
v_cvt_pk_bf16_f32 v9, v10, v11
buffer_store_dwordx2 v[8:9], v142, s[16:19], s55 offen offset:64
v_accvgpr_read_b32 v12, a76
v_accvgpr_read_b32 v13, a77
v_accvgpr_read_b32 v14, a78
v_accvgpr_read_b32 v15, a79
v_mul_f32 v12, v80, v12
v_mul_f32 v13, v80, v13
v_mul_f32 v14, v80, v14
v_mul_f32 v15, v80, v15
v_cvt_pk_bf16_f32 v12, v12, v13
v_cvt_pk_bf16_f32 v13, v14, v15
buffer_store_dwordx2 v[12:13], v142, s[16:19], s55 offen offset:96
v_accvgpr_read_b32 v16, a80
v_accvgpr_read_b32 v17, a81
v_accvgpr_read_b32 v18, a82
v_accvgpr_read_b32 v19, a83
v_mul_f32 v16, v80, v16
v_mul_f32 v17, v80, v17
v_mul_f32 v18, v80, v18
v_mul_f32 v19, v80, v19
v_cvt_pk_bf16_f32 v16, v16, v17
v_cvt_pk_bf16_f32 v17, v18, v19
buffer_store_dwordx2 v[16:17], v142, s[16:19], s55 offen offset:128
v_accvgpr_read_b32 v20, a84
v_accvgpr_read_b32 v21, a85
v_accvgpr_read_b32 v22, a86
v_accvgpr_read_b32 v23, a87
v_mul_f32 v20, v80, v20
v_mul_f32 v21, v80, v21
v_mul_f32 v22, v80, v22
v_mul_f32 v23, v80, v23
v_cvt_pk_bf16_f32 v20, v20, v21
v_cvt_pk_bf16_f32 v21, v22, v23
buffer_store_dwordx2 v[20:21], v142, s[16:19], s55 offen offset:160
v_accvgpr_read_b32 v24, a88
v_accvgpr_read_b32 v25, a89
v_accvgpr_read_b32 v26, a90
v_accvgpr_read_b32 v27, a91
v_mul_f32 v24, v80, v24
v_mul_f32 v25, v80, v25
v_mul_f32 v26, v80, v26
v_mul_f32 v27, v80, v27
v_cvt_pk_bf16_f32 v24, v24, v25
v_cvt_pk_bf16_f32 v25, v26, v27
buffer_store_dwordx2 v[24:25], v142, s[16:19], s55 offen offset:192
v_accvgpr_read_b32 v28, a92
v_accvgpr_read_b32 v29, a93
v_accvgpr_read_b32 v30, a94
v_accvgpr_read_b32 v31, a95
v_mul_f32 v28, v80, v28
v_mul_f32 v29, v80, v29
v_mul_f32 v30, v80, v30
v_mul_f32 v31, v80, v31
v_cvt_pk_bf16_f32 v28, v28, v29
v_cvt_pk_bf16_f32 v29, v30, v31
buffer_store_dwordx2 v[28:29], v142, s[16:19], s55 offen offset:224
s_waitcnt vmcnt(0)
v_accvgpr_read_b32 v80, a172
s_add_u32 s55, s53, 12288
v_rcp_f32 v80, v80
v_accvgpr_read_b32 v0, a96
v_accvgpr_read_b32 v1, a97
v_accvgpr_read_b32 v2, a98
v_accvgpr_read_b32 v3, a99
v_mul_f32 v0, v80, v0
v_mul_f32 v1, v80, v1
v_mul_f32 v2, v80, v2
v_mul_f32 v3, v80, v3
v_cvt_pk_bf16_f32 v0, v0, v1
v_cvt_pk_bf16_f32 v1, v2, v3
buffer_store_dwordx2 v[0:1], v142, s[16:19], s55 offen offset:0
v_accvgpr_read_b32 v4, a100
v_accvgpr_read_b32 v5, a101
v_accvgpr_read_b32 v6, a102
v_accvgpr_read_b32 v7, a103
v_mul_f32 v4, v80, v4
v_mul_f32 v5, v80, v5
v_mul_f32 v6, v80, v6
v_mul_f32 v7, v80, v7
v_cvt_pk_bf16_f32 v4, v4, v5
v_cvt_pk_bf16_f32 v5, v6, v7
buffer_store_dwordx2 v[4:5], v142, s[16:19], s55 offen offset:32
v_accvgpr_read_b32 v8, a104
v_accvgpr_read_b32 v9, a105
v_accvgpr_read_b32 v10, a106
v_accvgpr_read_b32 v11, a107
v_mul_f32 v8, v80, v8
v_mul_f32 v9, v80, v9
v_mul_f32 v10, v80, v10
v_mul_f32 v11, v80, v11
v_cvt_pk_bf16_f32 v8, v8, v9
v_cvt_pk_bf16_f32 v9, v10, v11
buffer_store_dwordx2 v[8:9], v142, s[16:19], s55 offen offset:64
v_accvgpr_read_b32 v12, a108
v_accvgpr_read_b32 v13, a109
v_accvgpr_read_b32 v14, a110
v_accvgpr_read_b32 v15, a111
v_mul_f32 v12, v80, v12
v_mul_f32 v13, v80, v13
v_mul_f32 v14, v80, v14
v_mul_f32 v15, v80, v15
v_cvt_pk_bf16_f32 v12, v12, v13
v_cvt_pk_bf16_f32 v13, v14, v15
buffer_store_dwordx2 v[12:13], v142, s[16:19], s55 offen offset:96
v_accvgpr_read_b32 v16, a112
v_accvgpr_read_b32 v17, a113
v_accvgpr_read_b32 v18, a114
v_accvgpr_read_b32 v19, a115
v_mul_f32 v16, v80, v16
v_mul_f32 v17, v80, v17
v_mul_f32 v18, v80, v18
v_mul_f32 v19, v80, v19
v_cvt_pk_bf16_f32 v16, v16, v17
v_cvt_pk_bf16_f32 v17, v18, v19
buffer_store_dwordx2 v[16:17], v142, s[16:19], s55 offen offset:128
v_accvgpr_read_b32 v20, a116
v_accvgpr_read_b32 v21, a117
v_accvgpr_read_b32 v22, a118
v_accvgpr_read_b32 v23, a119
v_mul_f32 v20, v80, v20
v_mul_f32 v21, v80, v21
v_mul_f32 v22, v80, v22
v_mul_f32 v23, v80, v23
v_cvt_pk_bf16_f32 v20, v20, v21
v_cvt_pk_bf16_f32 v21, v22, v23
buffer_store_dwordx2 v[20:21], v142, s[16:19], s55 offen offset:160
v_accvgpr_read_b32 v24, a120
v_accvgpr_read_b32 v25, a121
v_accvgpr_read_b32 v26, a122
v_accvgpr_read_b32 v27, a123
v_mul_f32 v24, v80, v24
v_mul_f32 v25, v80, v25
v_mul_f32 v26, v80, v26
v_mul_f32 v27, v80, v27
v_cvt_pk_bf16_f32 v24, v24, v25
v_cvt_pk_bf16_f32 v25, v26, v27
buffer_store_dwordx2 v[24:25], v142, s[16:19], s55 offen offset:192
v_accvgpr_read_b32 v28, a124
v_accvgpr_read_b32 v29, a125
v_accvgpr_read_b32 v30, a126
v_accvgpr_read_b32 v31, a127
v_mul_f32 v28, v80, v28
v_mul_f32 v29, v80, v29
v_mul_f32 v30, v80, v30
v_mul_f32 v31, v80, v31
v_cvt_pk_bf16_f32 v28, v28, v29
v_cvt_pk_bf16_f32 v29, v30, v31
buffer_store_dwordx2 v[28:29], v142, s[16:19], s55 offen offset:224
s_waitcnt vmcnt(0)
v_accvgpr_read_b32 v80, a176
s_add_u32 s55, s54, 0
v_rcp_f32 v80, v80
v_accvgpr_read_b32 v0, a128
v_accvgpr_read_b32 v1, a129
v_accvgpr_read_b32 v2, a130
v_accvgpr_read_b32 v3, a131
v_mul_f32 v0, v80, v0
v_mul_f32 v1, v80, v1
v_mul_f32 v2, v80, v2
v_mul_f32 v3, v80, v3
v_cvt_pk_bf16_f32 v0, v0, v1
v_cvt_pk_bf16_f32 v1, v2, v3
buffer_store_dwordx2 v[0:1], v142, s[16:19], s55 offen offset:0
v_accvgpr_read_b32 v4, a132
v_accvgpr_read_b32 v5, a133
v_accvgpr_read_b32 v6, a134
v_accvgpr_read_b32 v7, a135
v_mul_f32 v4, v80, v4
v_mul_f32 v5, v80, v5
v_mul_f32 v6, v80, v6
v_mul_f32 v7, v80, v7
v_cvt_pk_bf16_f32 v4, v4, v5
v_cvt_pk_bf16_f32 v5, v6, v7
buffer_store_dwordx2 v[4:5], v142, s[16:19], s55 offen offset:32
v_accvgpr_read_b32 v8, a136
v_accvgpr_read_b32 v9, a137
v_accvgpr_read_b32 v10, a138
v_accvgpr_read_b32 v11, a139
v_mul_f32 v8, v80, v8
v_mul_f32 v9, v80, v9
v_mul_f32 v10, v80, v10
v_mul_f32 v11, v80, v11
v_cvt_pk_bf16_f32 v8, v8, v9
v_cvt_pk_bf16_f32 v9, v10, v11
buffer_store_dwordx2 v[8:9], v142, s[16:19], s55 offen offset:64
v_accvgpr_read_b32 v12, a140
v_accvgpr_read_b32 v13, a141
v_accvgpr_read_b32 v14, a142
v_accvgpr_read_b32 v15, a143
v_mul_f32 v12, v80, v12
v_mul_f32 v13, v80, v13
v_mul_f32 v14, v80, v14
v_mul_f32 v15, v80, v15
v_cvt_pk_bf16_f32 v12, v12, v13
v_cvt_pk_bf16_f32 v13, v14, v15
buffer_store_dwordx2 v[12:13], v142, s[16:19], s55 offen offset:96
v_accvgpr_read_b32 v16, a144
v_accvgpr_read_b32 v17, a145
v_accvgpr_read_b32 v18, a146
v_accvgpr_read_b32 v19, a147
v_mul_f32 v16, v80, v16
v_mul_f32 v17, v80, v17
v_mul_f32 v18, v80, v18
v_mul_f32 v19, v80, v19
v_cvt_pk_bf16_f32 v16, v16, v17
v_cvt_pk_bf16_f32 v17, v18, v19
buffer_store_dwordx2 v[16:17], v142, s[16:19], s55 offen offset:128
v_accvgpr_read_b32 v20, a148
v_accvgpr_read_b32 v21, a149
v_accvgpr_read_b32 v22, a150
v_accvgpr_read_b32 v23, a151
v_mul_f32 v20, v80, v20
v_mul_f32 v21, v80, v21
v_mul_f32 v22, v80, v22
v_mul_f32 v23, v80, v23
v_cvt_pk_bf16_f32 v20, v20, v21
v_cvt_pk_bf16_f32 v21, v22, v23
buffer_store_dwordx2 v[20:21], v142, s[16:19], s55 offen offset:160
v_accvgpr_read_b32 v24, a152
v_accvgpr_read_b32 v25, a153
v_accvgpr_read_b32 v26, a154
v_accvgpr_read_b32 v27, a155
v_mul_f32 v24, v80, v24
v_mul_f32 v25, v80, v25
v_mul_f32 v26, v80, v26
v_mul_f32 v27, v80, v27
v_cvt_pk_bf16_f32 v24, v24, v25
v_cvt_pk_bf16_f32 v25, v26, v27
buffer_store_dwordx2 v[24:25], v142, s[16:19], s55 offen offset:192
v_accvgpr_read_b32 v28, a156
v_accvgpr_read_b32 v29, a157
v_accvgpr_read_b32 v30, a158
v_accvgpr_read_b32 v31, a159
v_mul_f32 v28, v80, v28
v_mul_f32 v29, v80, v29
v_mul_f32 v30, v80, v30
v_mul_f32 v31, v80, v31
v_cvt_pk_bf16_f32 v28, v28, v29
v_cvt_pk_bf16_f32 v29, v30, v31
buffer_store_dwordx2 v[28:29], v142, s[16:19], s55 offen offset:224
s_waitcnt vmcnt(0)
s_cmp_eq_u32 s29, 0
s_cbranch_scc0 L_redo
s_endpgm
.section .rodata,"a"
.p2align 6
.amdhsa_kernel standalone__gqa_softmax__near_ridge_kernel
  .amdhsa_next_free_vgpr 512
  .amdhsa_next_free_sgpr 102
  .amdhsa_accum_offset 256
  .amdhsa_group_segment_fixed_size 0
  .amdhsa_kernarg_size 48
  .amdhsa_user_sgpr_count 2
  .amdhsa_user_sgpr_kernarg_segment_ptr 1
  .amdhsa_system_sgpr_workgroup_id_x 1
.end_amdhsa_kernel
```
